```python
import torch

def _softmax(x, axis=-1):
    return torch.softmax(x, dim=axis)

def _gelu(x):
    return torch.nn.functional.gelu(x, approximate='tanh')

def _silu(x):
    return torch.nn.functional.silu(x)

def _sigmoid(x):
    return torch.sigmoid(x)

def _layernorm(x, axis=-1, eps=1e-05):
    m = x.mean(dim=axis, keepdim=True)
    v = x.var(dim=axis, keepdim=True, unbiased=False)
    return (x - m) / torch.sqrt(v + eps)

def _scatter_add(tgt, idx, src, axis=0):
    return tgt.clone().index_add_(axis, idx, src)

def _segment_sum(src, seg, n):
    out = torch.zeros((n,) + src.shape[1:], dtype=src.dtype)
    return out.index_add_(0, seg, src)

def _pad(x, pw):
    flat = tuple((v for pair in reversed(pw) for v in pair))
    return torch.nn.functional.pad(x, flat)
kernel_name = 'adaLN_cond__gqa_block_cached__glu_gated_reglu__prompt'

def setup_inputs():

    _w = lambda a: (lambda t: t.to(torch.bfloat16) if t.is_floating_point() else t)(torch.as_tensor(a))

    def _A_setup():
        B, Sq, D = (1, 2048, 640)
        Hq, Hkv, Sk, Dh = (32, 32, 2048, 128)
        assert Hq % Hkv == 0, (Hq, Hkv)
        return {'x': _w((lambda *s: torch.randn(*s, dtype=torch.bfloat16) * 0.05)(B, Sq, D)), 'k_cache': _w((lambda *s: torch.randn(*s, dtype=torch.bfloat16) * 1.6)(B, Hkv, Sk, Dh)), 'v_cache': _w((lambda *s: torch.randn(*s, dtype=torch.bfloat16) * 0.8)(B, Hkv, Sk, Dh)), 'wq': _w((lambda *s: torch.randn(*s, dtype=torch.bfloat16) * 1.6)(D, Hq * Dh) * D ** (-0.5)), 'wo': _w((lambda *s: torch.randn(*s, dtype=torch.bfloat16) * 0.8)(Hq * Dh, D) * (Hq * Dh) ** (-0.5))}
    _A_in = _A_setup()

    def _B_setup():
        B, S, D, F = (1, 2048, 640, 1728)
        return {'x': _w((lambda *s: torch.randn(*s, dtype=torch.bfloat16) * 0.05)(B, S, D)), 'W_gate': _w((lambda *s: torch.randn(*s, dtype=torch.bfloat16) * 0.4)(D, F) * (2.0 / D) ** 0.5), 'W_up': _w((lambda *s: torch.randn(*s, dtype=torch.bfloat16) * 0.4)(D, F) * (2.0 / D) ** 0.5), 'W_down': _w((lambda *s: torch.randn(*s, dtype=torch.bfloat16) * 0.4)(F, D) * (1.0 / F) ** 0.5)}
    _B_in = _B_setup()
    return {'A_x': _A_in['x'], 'A_k_cache': _A_in['k_cache'], 'A_v_cache': _A_in['v_cache'], 'A_wq': _A_in['wq'], 'A_wo': _A_in['wo'], 'B_x': _B_in['x'], 'B_W_gate': _B_in['W_gate'], 'B_W_up': _B_in['W_up'], 'B_W_down': _B_in['W_down'], 'c': _w((lambda *s: torch.randn(*s, dtype=torch.bfloat16) * 0.2)(1, 640) * 8.0), 'w_mod': _w((lambda *s: torch.randn(*s, dtype=torch.bfloat16) * 0.2)(640, 6 * 640) * 640 ** (-0.5) * 8.0)}

def reference(A_x, A_k_cache, A_v_cache, A_wq, A_wo, B_x, B_W_gate, B_W_up, B_W_down, c, w_mod):

    def _A_ref(x, k_cache, v_cache, wq, wo):
        B, Sq, D = x.shape
        Hq, Dh = (32, 128)
        Hkv = k_cache.shape[1]
        rep = Hq // Hkv
        q = (lambda x, *d: x.permute(*d))((x @ wq).reshape(B, Sq, Hq, Dh), 0, 2, 1, 3)
        k = (lambda x, n, axis: torch.repeat_interleave(x, n, dim=axis))(k_cache, rep, axis=1)
        v = (lambda x, n, axis: torch.repeat_interleave(x, n, dim=axis))(v_cache, rep, axis=1)
        scores = torch.einsum('bhqd,bhkd->bhqk', q, k) * Dh ** (-0.5)
        p = _softmax(scores, axis=-1)
        o = torch.einsum('bhqk,bhkd->bhqd', p, v)
        return (lambda x, *d: x.permute(*d))(o, 0, 2, 1, 3).reshape(B, Sq, Hq * Dh) @ wo

    def _B_ref(x, W_gate, W_up, W_down):
        gate = torch.einsum('bsd,df->bsf', x, W_gate)
        up = torch.einsum('bsd,df->bsf', x, W_up)
        gate = gate * (lambda x, dt: x.to(dt))(gate > 0, gate.dtype)
        h = gate * up
        return torch.einsum('bsf,fd->bsd', h, W_down)
    x = A_x
    mod = (_silu(c) @ w_mod).reshape(c.shape[0], 6, 1, -1)
    sa, ca, ga, sb, cb, gb = (mod[:, 0].clone(), mod[:, 1].clone(), mod[:, 2].clone(), mod[:, 3].clone(), mod[:, 4].clone(), mod[:, 5].clone())
    h = _layernorm(x, axis=-1) * (1 + ca) + sa
    x = x + ga * _A_ref(h, A_k_cache, A_v_cache, A_wq, A_wo)
    h = _layernorm(x, axis=-1) * (1 + cb) + sb
    x = x + gb * _B_ref(h, B_W_gate, B_W_up, B_W_down)
    return x
```

```asm
; @launch grid=(256,1,1) block=(256,1,1) lds=163840
.amdgcn_target "amdgcn-amd-amdhsa--gfx950"
.text
.globl adaLN_cond__gqa_block_cached__glu_gated_reglu__prompt_kernel
.p2align 8
.type adaLN_cond__gqa_block_cached__glu_gated_reglu__prompt_kernel,@function
adaLN_cond__gqa_block_cached__glu_gated_reglu__prompt_kernel:
  s_cmp_ge_u32 s2, 256
  s_cbranch_scc1 L_end
  s_load_dwordx4 s[4:7], s[0:1], 8
  s_load_dwordx2 s[16:17], s[0:1], 24
  s_load_dwordx2 s[20:21], s[0:1], 104
  s_load_dwordx2 s[56:57], s[0:1], 32
  s_load_dwordx4 s[60:63], s[0:1], 48
  s_load_dwordx2 s[64:65], s[0:1], 64
  s_load_dwordx4 s[44:47], s[0:1], 72
  s_load_dwordx2 s[48:49], s[0:1], 0
  s_load_dwordx2 s[52:53], s[0:1], 96
  s_cmp_ge_u32 s2, 248
  s_cbranch_scc1 L_f3
  s_cmp_ge_u32 s2, 120
  s_cbranch_scc1 L_f1
  v_and_b32 v52, 3, v0
  v_lshrrev_b32 v53, 2, v0
  v_lshlrev_b32 v54, 1, v53
  v_mul_u32_u24 v55, 7680, v53
  v_lshl_add_u32 v55, v52, 4, v55
  s_and_b32 s3, s2, 7
  s_lshl_b32 s3, s3, 1
  s_bfe_u32 s8, s2, 0x10003
  s_or_b32 s3, s3, s8
  s_and_b32 s8, s2, 0x70
  s_or_b32 s3, s3, s8
  s_cmp_lt_u32 s2, 112
  s_cselect_b32 s3, s3, s2
  s_lshl_b32 s12, s3, 6
  s_mov_b32 s70, 4915200
  s_mov_b32 s71, 0x20000
  s_mov_b32 s74, 1280
  s_mov_b32 s75, 0x20000
  s_waitcnt lgkmcnt(0)
  s_mov_b32 s68, s46
  s_mov_b32 s69, s47
  s_mov_b32 s72, s44
  s_mov_b32 s73, s45
  buffer_load_ushort v104, v54, s[72:75], 0 offen offset:0
  buffer_load_ushort v105, v54, s[72:75], 0 offen offset:128
  buffer_load_ushort v106, v54, s[72:75], 0 offen offset:256
  buffer_load_ushort v107, v54, s[72:75], 0 offen offset:384
  buffer_load_ushort v108, v54, s[72:75], 0 offen offset:512
  buffer_load_ushort v109, v54, s[72:75], 0 offen offset:640
  buffer_load_ushort v110, v54, s[72:75], 0 offen offset:768
  buffer_load_ushort v111, v54, s[72:75], 0 offen offset:896
  buffer_load_ushort v112, v54, s[72:75], 0 offen offset:1024
  buffer_load_ushort v113, v54, s[72:75], 0 offen offset:1152
  buffer_load_dwordx4 v[64:67], v55, s[68:71], s12 offen
  s_add_u32 s12, s12, 491520
  buffer_load_dwordx4 v[68:71], v55, s[68:71], s12 offen
  s_add_u32 s12, s12, 491520
  buffer_load_dwordx4 v[72:75], v55, s[68:71], s12 offen
  s_add_u32 s12, s12, 491520
  buffer_load_dwordx4 v[76:79], v55, s[68:71], s12 offen
  s_add_u32 s12, s12, 491520
  buffer_load_dwordx4 v[80:83], v55, s[68:71], s12 offen
  s_add_u32 s12, s12, 491520
  buffer_load_dwordx4 v[84:87], v55, s[68:71], s12 offen
  s_add_u32 s12, s12, 491520
  buffer_load_dwordx4 v[88:91], v55, s[68:71], s12 offen
  s_add_u32 s12, s12, 491520
  buffer_load_dwordx4 v[92:95], v55, s[68:71], s12 offen
  s_add_u32 s12, s12, 491520
  buffer_load_dwordx4 v[96:99], v55, s[68:71], s12 offen
  s_add_u32 s12, s12, 491520
  buffer_load_dwordx4 v[100:103], v55, s[68:71], s12 offen
  s_branch L_f2
L_f3:
  v_readfirstlane_b32 s8, v0
  s_sub_u32 s12, s2, 248
  s_lshl_b32 s13, s12, 13
  s_add_u32 s13, s13, 52477952
  s_mul_i32 s12, s12, 16384
  s_add_u32 s12, s12, 52346880
  v_lshlrev_b32 v62, 8, v0
  v_lshlrev_b32 v55, 4, v0
  v_mov_b32 v56, 0
  v_mov_b32 v57, 0
  v_mov_b32 v58, 0
  v_mov_b32 v59, 0
  s_mov_b32 s14, 4096
  s_mov_b32 s70, 5120
  s_mov_b32 s71, 0x20000
  v_lshlrev_b32 v60, 7, v0
  v_mov_b32 v61, 1
  s_mov_b32 s50, 16384
  s_mov_b32 s51, 0x20000
  s_mov_b32 s54, 256
  s_mov_b32 s55, 0x20000
  s_waitcnt lgkmcnt(0)
  s_add_u32 s48, s20, s12
  s_addc_u32 s49, s21, 0
  s_add_u32 s68, s20, s13
  s_addc_u32 s69, s21, 0
  buffer_store_dwordx4 v[56:59], v62, s[48:51], 0 offen sc1
  buffer_store_dwordx4 v[56:59], v55, s[68:71], 0 offen sc1
  buffer_store_dwordx4 v[56:59], v55, s[68:71], s14 offen sc1
  s_waitcnt vmcnt(0)
  s_barrier
  s_cmp_lg_u32 s8, 0
  s_cbranch_scc1 L_f2
  s_mov_b64 exec, 3
  buffer_atomic_add v61, v60, s[52:55], 0 offen sc1
  s_mov_b64 exec, -1
  s_branch L_f2
L_f1:
  s_sub_u32 s3, s2, 120
  v_and_b32 v52, 15, v0
  v_mul_u32_u24 v55, 1280, v52
  v_bfe_u32 v53, v0, 4, 2
  v_lshl_add_u32 v55, v53, 3, v55
  v_lshrrev_b32 v54, 6, v0
  v_lshl_add_u32 v55, v54, 6, v55
  s_mul_i32 s12, s3, 20480
  s_mov_b32 s50, 2621440
  s_mov_b32 s51, 0x20000
  s_waitcnt lgkmcnt(0)
  buffer_load_dwordx2 v[64:65], v55, s[48:51], s12 offen offset:0
  buffer_load_dwordx2 v[66:67], v55, s[48:51], s12 offen offset:32
  buffer_load_dwordx2 v[68:69], v55, s[48:51], s12 offen offset:256
  buffer_load_dwordx2 v[70:71], v55, s[48:51], s12 offen offset:288
  buffer_load_dwordx2 v[72:73], v55, s[48:51], s12 offen offset:512
  buffer_load_dwordx2 v[74:75], v55, s[48:51], s12 offen offset:544
  buffer_load_dwordx2 v[76:77], v55, s[48:51], s12 offen offset:768
  buffer_load_dwordx2 v[78:79], v55, s[48:51], s12 offen offset:800
  buffer_load_dwordx2 v[80:81], v55, s[48:51], s12 offen offset:1024
  buffer_load_dwordx2 v[82:83], v55, s[48:51], s12 offen offset:1056
L_f2:
  s_lshr_b32 s8, s2, 3
  s_mul_i32 s8, s8, 2048
  v_lshlrev_b32 v58, 3, v0
  v_add_u32 v58, s8, v58
  v_min_u32 v58, L_t0-L_f2-64, v58
  s_getpc_b64 s[8:9]
cpf_here1:
  v_mov_b32 v57, s9
  v_add_co_u32 v56, vcc, s8, v58
  s_nop 1
  v_addc_co_u32 v57, vcc, 0, v57, vcc
  global_load_dword v63, v[56:57], off
  s_mov_b32 s54, 256
  s_mov_b32 s55, 0x20000
  s_add_u32 s32, s20, 52477952
  s_addc_u32 s33, s21, 0
  s_mov_b32 s34, 65536
  s_mov_b32 s35, 0x20000
  s_cmp_ge_u32 s2, 120
  s_cbranch_scc1 L_mdone
  v_lshrrev_b32 v60, 6, v0
  s_and_b32 s66, s2, 1
  s_lshl_b32 s66, s66, 7
  v_readfirstlane_b32 s28, v60
  v_mov_b32 v60, s66
  s_lshl_b32 s36, s28, 7
  s_add_u32 s36, s36, 159744
  v_lshl_add_u32 v56, v52, 5, s36
  v_bfe_u32 v57, v0, 4, 2
  v_lshl_add_u32 v56, v57, 2, v56
  v_and_b32 v57, 31, v0
  v_lshlrev_b32 v57, 2, v57
  s_sub_u32 s36, s3, 20
  s_cmp_lt_u32 s36, 20
  s_cselect_b32 s44, 1.0, 0
  s_sub_u32 s36, s3, 80
  s_cmp_lt_u32 s36, 20
  s_cselect_b32 s44, 1.0, s44
  s_cmp_lt_u32 s3, 40
  s_cselect_b32 s45, 0x3e0293ee, 1.0
  s_lshl_b32 s46, s3, 7
  s_cmp_ge_u32 s3, 20
  s_cselect_b32 s36, 1, 0
  s_mul_i32 s37, s36, 20
  s_sub_u32 s37, s3, s37
  s_lshl_b32 s37, s37, 8
  s_lshl_b32 s47, s36, 5
  s_add_u32 s37, s37, s47
  v_bfe_u32 v58, v0, 2, 2
  v_lshlrev_b32 v58, 6, v58
  v_bfe_u32 v59, v0, 1, 1
  v_lshl_add_u32 v58, v59, 4, v58
  v_bfe_u32 v59, v0, 4, 1
  v_xor_b32 v59, 1, v59
  v_lshl_add_u32 v58, v59, 3, v58
  v_and_b32 v59, 1, v0
  v_xor_b32 v59, s36, v59
  v_lshl_add_u32 v59, v59, 2, v58
  s_cmp_lt_u32 s3, 40
  s_cselect_b32 s46, s37, s46
  s_cselect_b64 vcc, -1, 0
  v_cndmask_b32 v59, v57, v59, vcc
  v_add_u32 v57, 159744, v57
  v_lshrrev_b32 v58, 5, v0
  v_lshl_add_u32 v58, v58, 13, v59
  s_add_u32 s48, s20, 0
  s_addc_u32 s49, s21, 0
  s_mov_b32 s50, 15360
  s_mov_b32 s51, 0x20000
  s_waitcnt vmcnt(11)
  v_lshlrev_b32 v104, 16, v104
  v_lshlrev_b32 v105, 16, v105
  v_lshlrev_b32 v106, 16, v106
  v_lshlrev_b32 v107, 16, v107
  v_lshlrev_b32 v108, 16, v108
  v_lshlrev_b32 v109, 16, v109
  v_lshlrev_b32 v110, 16, v110
  v_lshlrev_b32 v111, 16, v111
  v_lshlrev_b32 v112, 16, v112
  v_lshlrev_b32 v113, 16, v113
  v_mul_f32 v124, 0xbfb8aa3b, v104
  v_mul_f32 v125, 0xbfb8aa3b, v105
  v_mul_f32 v126, 0xbfb8aa3b, v106
  v_mul_f32 v127, 0xbfb8aa3b, v107
  v_mul_f32 v128, 0xbfb8aa3b, v108
  v_mul_f32 v129, 0xbfb8aa3b, v109
  v_mul_f32 v130, 0xbfb8aa3b, v110
  v_mul_f32 v131, 0xbfb8aa3b, v111
  v_mul_f32 v132, 0xbfb8aa3b, v112
  v_mul_f32 v133, 0xbfb8aa3b, v113
  v_exp_f32 v124, v124
  v_exp_f32 v125, v125
  v_exp_f32 v126, v126
  v_exp_f32 v127, v127
  v_exp_f32 v128, v128
  v_exp_f32 v129, v129
  v_exp_f32 v130, v130
  v_exp_f32 v131, v131
  v_exp_f32 v132, v132
  v_exp_f32 v133, v133
  v_add_f32 v124, 1.0, v124
  v_add_f32 v125, 1.0, v125
  v_add_f32 v126, 1.0, v126
  v_add_f32 v127, 1.0, v127
  v_add_f32 v128, 1.0, v128
  v_add_f32 v129, 1.0, v129
  v_add_f32 v130, 1.0, v130
  v_add_f32 v131, 1.0, v131
  v_add_f32 v132, 1.0, v132
  v_add_f32 v133, 1.0, v133
  v_rcp_f32 v124, v124
  v_rcp_f32 v125, v125
  v_rcp_f32 v126, v126
  v_rcp_f32 v127, v127
  v_rcp_f32 v128, v128
  v_rcp_f32 v129, v129
  v_rcp_f32 v130, v130
  v_rcp_f32 v131, v131
  v_rcp_f32 v132, v132
  v_rcp_f32 v133, v133
  v_mul_f32 v104, v104, v124
  v_mul_f32 v105, v105, v125
  v_mul_f32 v106, v106, v126
  v_mul_f32 v107, v107, v127
  v_mul_f32 v108, v108, v128
  v_mul_f32 v109, v109, v129
  v_mul_f32 v110, v110, v130
  v_mul_f32 v111, v111, v131
  v_mul_f32 v112, v112, v132
  v_mul_f32 v113, v113, v133
  v_cvt_pk_bf16_f32 v104, v104, v104
  v_cvt_pk_bf16_f32 v105, v105, v105
  v_cvt_pk_bf16_f32 v106, v106, v106
  v_cvt_pk_bf16_f32 v107, v107, v107
  v_cvt_pk_bf16_f32 v108, v108, v108
  v_cvt_pk_bf16_f32 v109, v109, v109
  v_cvt_pk_bf16_f32 v110, v110, v110
  v_cvt_pk_bf16_f32 v111, v111, v111
  v_cvt_pk_bf16_f32 v112, v112, v112
  v_cvt_pk_bf16_f32 v113, v113, v113
  v_and_b32 v104, 0xffff0000, v104
  v_and_b32 v105, 0xffff0000, v105
  v_and_b32 v106, 0xffff0000, v106
  v_and_b32 v107, 0xffff0000, v107
  v_and_b32 v108, 0xffff0000, v108
  v_and_b32 v109, 0xffff0000, v109
  v_and_b32 v110, 0xffff0000, v110
  v_and_b32 v111, 0xffff0000, v111
  v_and_b32 v112, 0xffff0000, v112
  v_and_b32 v113, 0xffff0000, v113
  buffer_load_dword v212, v60, s[52:55], 0 offen sc1
  s_waitcnt vmcnt(11)
  v_lshlrev_b32 v124, 16, v64
  v_and_b32 v125, 0xffff0000, v64
  v_pk_mul_f32 v[116:117], v[124:125], v[104:105] op_sel_hi:[1,0]
  v_lshlrev_b32 v126, 16, v65
  v_and_b32 v127, 0xffff0000, v65
  v_pk_mul_f32 v[118:119], v[126:127], v[104:105] op_sel_hi:[1,0]
  v_lshlrev_b32 v124, 16, v66
  v_and_b32 v125, 0xffff0000, v66
  v_pk_mul_f32 v[120:121], v[124:125], v[104:105] op_sel_hi:[1,0]
  v_lshlrev_b32 v126, 16, v67
  v_and_b32 v127, 0xffff0000, v67
  v_pk_mul_f32 v[122:123], v[126:127], v[104:105] op_sel_hi:[1,0]
  s_waitcnt vmcnt(10)
  v_lshlrev_b32 v124, 16, v68
  v_and_b32 v125, 0xffff0000, v68
  v_pk_fma_f32 v[116:117], v[124:125], v[104:105], v[116:117] op_sel:[0,1,0] op_sel_hi:[1,1,1]
  v_lshlrev_b32 v126, 16, v69
  v_and_b32 v127, 0xffff0000, v69
  v_pk_fma_f32 v[118:119], v[126:127], v[104:105], v[118:119] op_sel:[0,1,0] op_sel_hi:[1,1,1]
  v_lshlrev_b32 v124, 16, v70
  v_and_b32 v125, 0xffff0000, v70
  v_pk_fma_f32 v[120:121], v[124:125], v[104:105], v[120:121] op_sel:[0,1,0] op_sel_hi:[1,1,1]
  v_lshlrev_b32 v126, 16, v71
  v_and_b32 v127, 0xffff0000, v71
  v_pk_fma_f32 v[122:123], v[126:127], v[104:105], v[122:123] op_sel:[0,1,0] op_sel_hi:[1,1,1]
  s_waitcnt vmcnt(9)
  v_lshlrev_b32 v124, 16, v72
  v_and_b32 v125, 0xffff0000, v72
  v_pk_fma_f32 v[116:117], v[124:125], v[106:107], v[116:117] op_sel_hi:[1,0,1]
  v_lshlrev_b32 v126, 16, v73
  v_and_b32 v127, 0xffff0000, v73
  v_pk_fma_f32 v[118:119], v[126:127], v[106:107], v[118:119] op_sel_hi:[1,0,1]
  v_lshlrev_b32 v124, 16, v74
  v_and_b32 v125, 0xffff0000, v74
  v_pk_fma_f32 v[120:121], v[124:125], v[106:107], v[120:121] op_sel_hi:[1,0,1]
  v_lshlrev_b32 v126, 16, v75
  v_and_b32 v127, 0xffff0000, v75
  v_pk_fma_f32 v[122:123], v[126:127], v[106:107], v[122:123] op_sel_hi:[1,0,1]
  s_waitcnt vmcnt(8)
  v_lshlrev_b32 v124, 16, v76
  v_and_b32 v125, 0xffff0000, v76
  v_pk_fma_f32 v[116:117], v[124:125], v[106:107], v[116:117] op_sel:[0,1,0] op_sel_hi:[1,1,1]
  v_lshlrev_b32 v126, 16, v77
  v_and_b32 v127, 0xffff0000, v77
  v_pk_fma_f32 v[118:119], v[126:127], v[106:107], v[118:119] op_sel:[0,1,0] op_sel_hi:[1,1,1]
  v_lshlrev_b32 v124, 16, v78
  v_and_b32 v125, 0xffff0000, v78
  v_pk_fma_f32 v[120:121], v[124:125], v[106:107], v[120:121] op_sel:[0,1,0] op_sel_hi:[1,1,1]
  v_lshlrev_b32 v126, 16, v79
  v_and_b32 v127, 0xffff0000, v79
  v_pk_fma_f32 v[122:123], v[126:127], v[106:107], v[122:123] op_sel:[0,1,0] op_sel_hi:[1,1,1]
  s_waitcnt vmcnt(7)
  v_lshlrev_b32 v124, 16, v80
  v_and_b32 v125, 0xffff0000, v80
  v_pk_fma_f32 v[116:117], v[124:125], v[108:109], v[116:117] op_sel_hi:[1,0,1]
  v_lshlrev_b32 v126, 16, v81
  v_and_b32 v127, 0xffff0000, v81
  v_pk_fma_f32 v[118:119], v[126:127], v[108:109], v[118:119] op_sel_hi:[1,0,1]
  v_lshlrev_b32 v124, 16, v82
  v_and_b32 v125, 0xffff0000, v82
  v_pk_fma_f32 v[120:121], v[124:125], v[108:109], v[120:121] op_sel_hi:[1,0,1]
  v_lshlrev_b32 v126, 16, v83
  v_and_b32 v127, 0xffff0000, v83
  v_pk_fma_f32 v[122:123], v[126:127], v[108:109], v[122:123] op_sel_hi:[1,0,1]
  s_waitcnt vmcnt(6)
  v_lshlrev_b32 v124, 16, v84
  v_and_b32 v125, 0xffff0000, v84
  v_pk_fma_f32 v[116:117], v[124:125], v[108:109], v[116:117] op_sel:[0,1,0] op_sel_hi:[1,1,1]
  v_lshlrev_b32 v126, 16, v85
  v_and_b32 v127, 0xffff0000, v85
  v_pk_fma_f32 v[118:119], v[126:127], v[108:109], v[118:119] op_sel:[0,1,0] op_sel_hi:[1,1,1]
  v_lshlrev_b32 v124, 16, v86
  v_and_b32 v125, 0xffff0000, v86
  v_pk_fma_f32 v[120:121], v[124:125], v[108:109], v[120:121] op_sel:[0,1,0] op_sel_hi:[1,1,1]
  v_lshlrev_b32 v126, 16, v87
  v_and_b32 v127, 0xffff0000, v87
  v_pk_fma_f32 v[122:123], v[126:127], v[108:109], v[122:123] op_sel:[0,1,0] op_sel_hi:[1,1,1]
  s_waitcnt vmcnt(5)
  v_lshlrev_b32 v124, 16, v88
  v_and_b32 v125, 0xffff0000, v88
  v_pk_fma_f32 v[116:117], v[124:125], v[110:111], v[116:117] op_sel_hi:[1,0,1]
  v_lshlrev_b32 v126, 16, v89
  v_and_b32 v127, 0xffff0000, v89
  v_pk_fma_f32 v[118:119], v[126:127], v[110:111], v[118:119] op_sel_hi:[1,0,1]
  v_lshlrev_b32 v124, 16, v90
  v_and_b32 v125, 0xffff0000, v90
  v_pk_fma_f32 v[120:121], v[124:125], v[110:111], v[120:121] op_sel_hi:[1,0,1]
  v_lshlrev_b32 v126, 16, v91
  v_and_b32 v127, 0xffff0000, v91
  v_pk_fma_f32 v[122:123], v[126:127], v[110:111], v[122:123] op_sel_hi:[1,0,1]
  s_waitcnt vmcnt(4)
  v_lshlrev_b32 v124, 16, v92
  v_and_b32 v125, 0xffff0000, v92
  v_pk_fma_f32 v[116:117], v[124:125], v[110:111], v[116:117] op_sel:[0,1,0] op_sel_hi:[1,1,1]
  v_lshlrev_b32 v126, 16, v93
  v_and_b32 v127, 0xffff0000, v93
  v_pk_fma_f32 v[118:119], v[126:127], v[110:111], v[118:119] op_sel:[0,1,0] op_sel_hi:[1,1,1]
  v_lshlrev_b32 v124, 16, v94
  v_and_b32 v125, 0xffff0000, v94
  v_pk_fma_f32 v[120:121], v[124:125], v[110:111], v[120:121] op_sel:[0,1,0] op_sel_hi:[1,1,1]
  v_lshlrev_b32 v126, 16, v95
  v_and_b32 v127, 0xffff0000, v95
  v_pk_fma_f32 v[122:123], v[126:127], v[110:111], v[122:123] op_sel:[0,1,0] op_sel_hi:[1,1,1]
  s_waitcnt vmcnt(3)
  v_lshlrev_b32 v124, 16, v96
  v_and_b32 v125, 0xffff0000, v96
  v_pk_fma_f32 v[116:117], v[124:125], v[112:113], v[116:117] op_sel_hi:[1,0,1]
  v_lshlrev_b32 v126, 16, v97
  v_and_b32 v127, 0xffff0000, v97
  v_pk_fma_f32 v[118:119], v[126:127], v[112:113], v[118:119] op_sel_hi:[1,0,1]
  v_lshlrev_b32 v124, 16, v98
  v_and_b32 v125, 0xffff0000, v98
  v_pk_fma_f32 v[120:121], v[124:125], v[112:113], v[120:121] op_sel_hi:[1,0,1]
  v_lshlrev_b32 v126, 16, v99
  v_and_b32 v127, 0xffff0000, v99
  v_pk_fma_f32 v[122:123], v[126:127], v[112:113], v[122:123] op_sel_hi:[1,0,1]
  s_waitcnt vmcnt(2)
  v_lshlrev_b32 v124, 16, v100
  v_and_b32 v125, 0xffff0000, v100
  v_pk_fma_f32 v[116:117], v[124:125], v[112:113], v[116:117] op_sel:[0,1,0] op_sel_hi:[1,1,1]
  v_lshlrev_b32 v126, 16, v101
  v_and_b32 v127, 0xffff0000, v101
  v_pk_fma_f32 v[118:119], v[126:127], v[112:113], v[118:119] op_sel:[0,1,0] op_sel_hi:[1,1,1]
  v_lshlrev_b32 v124, 16, v102
  v_and_b32 v125, 0xffff0000, v102
  v_pk_fma_f32 v[120:121], v[124:125], v[112:113], v[120:121] op_sel:[0,1,0] op_sel_hi:[1,1,1]
  v_lshlrev_b32 v126, 16, v103
  v_and_b32 v127, 0xffff0000, v103
  v_pk_fma_f32 v[122:123], v[126:127], v[112:113], v[122:123] op_sel:[0,1,0] op_sel_hi:[1,1,1]
  v_permlane16_swap_b32 v116, v117
  v_permlane16_swap_b32 v118, v119
  v_permlane16_swap_b32 v120, v121
  v_permlane16_swap_b32 v122, v123
  v_add_f32 v116, v116, v117
  v_add_f32 v118, v118, v119
  v_add_f32 v120, v120, v121
  v_add_f32 v122, v122, v123
  v_permlane32_swap_b32 v116, v118
  s_nop 0
  v_permlane32_swap_b32 v120, v122
  v_add_f32 v116, v116, v118
  v_add_f32 v120, v120, v122
  s_nop 0
  v_add_f32_dpp v116, v116, v116 row_ror:4 row_mask:0xf bank_mask:0xf
  v_add_f32_dpp v120, v120, v120 row_ror:4 row_mask:0xf bank_mask:0xf
  s_nop 0
  v_add_f32_dpp v116, v116, v116 row_ror:8 row_mask:0xf bank_mask:0xf
  v_add_f32_dpp v120, v120, v120 row_ror:8 row_mask:0xf bank_mask:0xf
  s_cmp_lg_u32 s28, 0
  s_cbranch_scc1 L_mgot
  s_waitcnt vmcnt(0)
  v_readfirstlane_b32 s36, v212
  s_cmp_ge_u32 s36, 8
  s_cbranch_scc1 L_mgot
  v_mov_b32 v60, s66
  s_mov_b32 s37, 131072
L_mpoll:
  buffer_load_dword v61, v60, s[52:55], 0 offen sc1
  s_sub_u32 s37, s37, 1
  s_cmp_eq_u32 s37, 0
  s_cbranch_scc1 L_mgot
  s_waitcnt vmcnt(0)
  v_readfirstlane_b32 s36, v61
  s_cmp_ge_u32 s36, 8
  s_cbranch_scc1 L_mgot
  s_branch L_mpoll
L_mgot:
  ds_write_b32 v56, v116
  ds_write_b32 v56, v120 offset:16
  s_waitcnt lgkmcnt(0)
  s_barrier
  s_cmp_lg_u32 s28, 0
  s_cbranch_scc1 L_mdone
  ds_read_b32 v64, v57 offset:0
  ds_read_b32 v65, v57 offset:128
  ds_read_b32 v66, v57 offset:256
  ds_read_b32 v67, v57 offset:384
  s_waitcnt lgkmcnt(0)
  v_add_f32 v64, v64, v65
  v_add_f32 v66, v66, v67
  v_add_f32 v64, v64, v66
  v_cvt_pk_bf16_f32 v64, v64, v64
  v_and_b32 v64, 0xffff0000, v64
  v_add_f32 v64, s44, v64
  v_cvt_pk_bf16_f32 v64, v64, v64
  v_and_b32 v64, 0xffff0000, v64
  v_mul_f32 v64, s45, v64
  s_cmp_lt_u32 s3, 40
  s_cbranch_scc1 L_mtab
  buffer_store_dword v64, v59, s[48:51], s46 offen sc1
  s_branch L_mdone
L_mtab:
  v_or_b32 v64, 1, v64
  buffer_store_dword v64, v58, s[32:35], s46 offen sc1
  s_add_u32 s46, s46, 16384
  buffer_store_dword v64, v58, s[32:35], s46 offen sc1
  s_add_u32 s46, s46, 16384
  buffer_store_dword v64, v58, s[32:35], s46 offen sc1
  s_add_u32 s46, s46, 16384
  buffer_store_dword v64, v58, s[32:35], s46 offen sc1
  s_add_u32 s46, s46, 16384
L_mdone:
  v_lshrrev_b32 v1, 6, v0
  v_and_b32 v0, 63, v0
  v_readfirstlane_b32 s28, v1
  s_bfe_u32 s30, s2, 0x20001
  s_lshl_b32 s30, s30, 3
  s_bfe_u32 s38, s2, 0x30003
  s_add_u32 s30, s30, s38
  s_and_b32 s31, s2, 1
  s_lshl_b32 s31, s31, 2
  s_lshr_b32 s38, s2, 6
  s_add_u32 s31, s31, s38
  s_lshl_b32 s29, s28, 10
  v_bfe_u32 v2, v0, 1, 2
  v_lshrrev_b32 v3, 4, v0
  v_xor_b32 v2, v2, v3
  v_lshlrev_b32 v2, 5, v2
  v_and_b32 v3, 1, v0
  v_lshl_add_u32 v4, v3, 4, v2
  v_lshrrev_b32 v1, 3, v0
  s_lshl_b32 s38, s28, 3
  v_add_u32 v1, s38, v1
  v_lshl_add_u32 v23, v1, 8, v4
  v_lshl_add_u32 v24, v1, 13, v4
  v_lshlrev_b32 v25, 4, v0
  s_lshl_b32 s40, s31, 4
  s_mul_i32 s39, s28, 4
  s_add_u32 s40, s40, s39
  s_waitcnt lgkmcnt(0)
  s_lshl_b32 s38, s30, 8
  s_add_u32 s16, s16, s38
  s_addc_u32 s17, s17, 0
  s_sub_u32 s18, 5242880, s38
  s_mov_b32 s19, 0x20000
  s_add_u32 s24, s20, 2686976
  s_addc_u32 s25, s21, 0
  s_add_u32 s80, s20, 0
  s_addc_u32 s81, s21, 0
  s_mov_b32 s82, 5120
  s_mov_b32 s83, 0x20000
  s_lshr_b32 s38, s40, 2
  s_mul_i32 s38, s38, 81920
  s_and_b32 s39, s40, 3
  s_lshl_b32 s39, s39, 10
  s_add_u32 s38, s38, s39
  s_add_u32 s38, s38, 49725440
  s_add_u32 s20, s20, s38
  s_addc_u32 s21, s21, 0
  s_sub_u32 s22, 81920, s39
  s_mov_b32 s23, 0x20000
  v_lshrrev_b32 v245, 4, v0
  v_lshlrev_b32 v245, 6, v245
  s_lshl_b32 s38, s30, 19
  s_add_u32 s8, s4, s38
  s_addc_u32 s9, s5, 0
  s_mov_b32 s10, 0x80000
  s_mov_b32 s11, 0x20000
  s_add_u32 s12, s6, s38
  s_addc_u32 s13, s7, 0
  s_mov_b32 s14, 0x80000
  s_mov_b32 s15, 0x20000
  s_mov_b32 s26, 16777216
  s_mov_b32 s27, 0x20000
  v_lshrrev_b32 v2, 3, v0
  v_mul_u32_u24 v2, 1280, v2
  v_add_u32 v244, v2, v4
  s_lshl_b32 s41, s28, 13
  s_and_b32 s90, s2, 63
  s_lshl_b32 s90, s90, 2
  s_add_u32 s90, s90, s28
  s_lshr_b32 s38, s2, 6
  s_and_b32 s39, s38, 1
  s_lshl_b32 s39, s39, 10
  s_cmp_lt_u32 s38, 2
  s_cselect_b32 s39, 2048, s39
  s_cselect_b32 s91, 0x20, 0xe0
  s_add_u32 s90, s90, s39
  s_add_u32 s38, s90, 0
  s_lshl_b32 s42, s38, 12
  s_mul_i32 s39, s38, 6554
  s_lshr_b32 s39, s39, 16
  s_mul_i32 s66, s39, 10
  s_sub_u32 s66, s38, s66
  s_lshl_b32 s66, s66, 7
  s_cmp_lt_u32 s38, 1820
  s_cselect_b32 s70, 39808, 0
  s_cmp_lt_u32 s39, 128
  s_cselect_b32 s68, s56, s64
  s_cselect_b32 s69, s57, s65
  s_cselect_b32 s67, 0, 128
  s_sub_u32 s39, s39, s67
  s_min_u32 s39, s39, 127
  s_mul_i32 s39, s39, 40960
  s_add_u32 s39, s39, s66
  s_add_u32 s68, s68, s39
  s_addc_u32 s69, s69, 0
  s_mov_b32 s71, 0x20000
  s_add_u32 s38, s90, 256
  s_lshl_b32 s43, s38, 12
  s_mul_i32 s39, s38, 6554
  s_lshr_b32 s39, s39, 16
  s_mul_i32 s66, s39, 10
  s_sub_u32 s66, s38, s66
  s_lshl_b32 s66, s66, 7
  s_cmp_lt_u32 s38, 1820
  s_cselect_b32 s74, 39808, 0
  s_cmp_lt_u32 s39, 128
  s_cselect_b32 s72, s56, s64
  s_cselect_b32 s73, s57, s65
  s_cselect_b32 s67, 0, 128
  s_sub_u32 s39, s39, s67
  s_min_u32 s39, s39, 127
  s_mul_i32 s39, s39, 40960
  s_add_u32 s39, s39, s66
  s_add_u32 s72, s72, s39
  s_addc_u32 s73, s73, 0
  s_mov_b32 s75, 0x20000
  s_add_u32 s76, s24, 16777216
  s_addc_u32 s77, s25, 0
  s_mov_b32 s78, 7454720
  s_mov_b32 s79, 0x20000
  s_add_u32 s84, s80, 52346880
  s_addc_u32 s85, s81, 0
  s_mov_b32 s86, 131072
  s_mov_b32 s87, 0x20000
  s_mul_i32 s88, s31, 16384
  s_lshr_b32 s89, s30, 3
  s_lshl_b32 s89, s89, 8
  s_add_u32 s88, s88, s89
  s_add_u32 s88, s88, 1024
  s_and_b32 s89, s2, 7
  s_mul_i32 s89, s89, 16384
  s_add_u32 s89, s89, 2048
  v_lshrrev_b32 v2, 4, v0
  s_and_b32 s38, s28, 1
  s_mul_i32 s38, s38, 6
  v_and_b32 v3, 1, v2
  v_lshrrev_b32 v2, 1, v2
  v_lshl_add_u32 v3, v2, 2, v3
  v_xor_b32 v3, s38, v3
  v_and_b32 v2, 7, v0
  v_xor_b32 v3, v3, v2
  v_lshlrev_b32 v3, 4, v3
  v_lshl_add_u32 v22, v1, 8, v3
  v_bfe_u32 v1, v0, 1, 1
  v_bfe_u32 v2, v0, 2, 1
  v_bfe_u32 v3, v0, 3, 1
  v_xor_b32 v2, v2, v3
  v_lshl_add_u32 v1, v3, 1, v1
  v_lshl_add_u32 v1, v2, 2, v1
  v_bfe_u32 v2, v0, 4, 1
  v_bfe_u32 v3, v0, 5, 1
  v_lshl_add_u32 v2, v2, 1, v3
  v_xor_b32 v1, v1, v2
  v_and_b32 v2, 15, v0
  v_lshlrev_b32 v2, 7, v2
  v_lshl_add_u32 v8, v1, 4, v2
  v_xor_b32 v9, 64, v8
  v_lshrrev_b32 v1, 2, v0
  v_lshlrev_b32 v2, 7, v1
  v_and_b32 v3, 3, v0
  v_lshl_add_u32 v2, v3, 3, v2
  v_bfe_u32 v1, v0, 3, 2
  v_lshl_add_u32 v14, v1, 5, v2
  v_xor_b32 v15, 32, v14
  v_xor_b32 v16, 64, v14
  v_xor_b32 v17, 0x60, v14
  v_add_u32 v10, 0x10000, v14
  v_add_u32 v18, 0x20000, v14
  v_add_u32 v11, 0x10000, v15
  v_add_u32 v19, 0x20000, v15
  v_add_u32 v12, 0x10000, v16
  v_add_u32 v20, 0x20000, v16
  v_add_u32 v13, 0x10000, v17
  v_add_u32 v21, 0x20000, v17
  v_mov_b32 v7, 0x42700000
  v_mov_b32 v6, 0x3f803f80
  v_accvgpr_write_b32 a240, v6
  v_accvgpr_write_b32 a241, v6
  v_accvgpr_write_b32 a242, v6
  v_accvgpr_write_b32 a243, v6
  v_mov_b32 v6, 0x40004000
  v_and_b32 v251, 7, v0
  v_mul_u32_u24 v251, 16384, v251
  v_add_u32 v251, 2048, v251
  s_lshr_b32 s38, s2, 3
  s_lshl_b32 s38, s38, 12
  s_add_u32 s38, s38, s29
  v_add_u32 v4, s38, v25
  v_min_u32 v4, L_end-L_t0-16, v4
  s_getpc_b64 s[58:59]
cpf_here2:
  s_add_u32 s58, s58, L_t0-cpf_here2
  s_addc_u32 s59, s59, 0
  v_mov_b32 v253, s59
  v_add_co_u32 v252, vcc, s58, v4
  s_nop 1
  v_addc_co_u32 v253, vcc, 0, v253, vcc
  s_cmp_lt_u32 s2, 120
  s_cbranch_scc1 L_gw
  s_and_b32 s66, s2, 1
  s_lshl_b32 s66, s66, 7
  v_mov_b32 v60, s66
  buffer_load_dword v212, v60, s[52:55], 0 offen sc1
  s_cmp_lt_u32 s2, 248
  s_cbranch_scc1 L_g2
  s_cmp_lg_u32 s28, 0
  s_cbranch_scc1 L_agot
  v_mov_b32 v60, s66
  s_mov_b32 s37, 131072
L_apoll:
  buffer_load_dword v61, v60, s[52:55], 0 offen sc1
  s_sub_u32 s37, s37, 1
  s_cmp_eq_u32 s37, 0
  s_cbranch_scc1 L_agot
  s_waitcnt vmcnt(0)
  v_readfirstlane_b32 s36, v61
  s_cmp_ge_u32 s36, 8
  s_cbranch_scc1 L_agot
  s_branch L_apoll
L_agot:
L_gw:
  s_add_u32 m0, s29, 0
  s_mov_b32 s38, 0
  buffer_load_dwordx4 v24, s[16:19], s38 offen lds
  s_add_u32 m0, s29, 8064
  s_mov_b32 s38, 0
  buffer_load_dwordx4 v24, s[16:19], s38 offen offset:128 lds
  s_add_u32 m0, s29, 4096
  s_mov_b32 s38, 262144
  buffer_load_dwordx4 v24, s[16:19], s38 offen lds
  s_add_u32 m0, s29, 12160
  s_mov_b32 s38, 262144
  buffer_load_dwordx4 v24, s[16:19], s38 offen offset:128 lds
  s_add_u32 m0, s29, 16384
  s_mov_b32 s38, 524288
  buffer_load_dwordx4 v24, s[16:19], s38 offen lds
  s_add_u32 m0, s29, 24448
  s_mov_b32 s38, 524288
  buffer_load_dwordx4 v24, s[16:19], s38 offen offset:128 lds
  s_add_u32 m0, s29, 20480
  s_mov_b32 s38, 786432
  buffer_load_dwordx4 v24, s[16:19], s38 offen lds
  s_add_u32 m0, s29, 28544
  s_mov_b32 s38, 786432
  buffer_load_dwordx4 v24, s[16:19], s38 offen offset:128 lds
  s_add_u32 m0, s29, 65536
  s_mov_b32 s38, 1048576
  buffer_load_dwordx4 v24, s[16:19], s38 offen lds
  s_add_u32 m0, s29, 73600
  s_mov_b32 s38, 1048576
  buffer_load_dwordx4 v24, s[16:19], s38 offen offset:128 lds
  s_add_u32 m0, s29, 69632
  s_mov_b32 s38, 1310720
  buffer_load_dwordx4 v24, s[16:19], s38 offen lds
  s_add_u32 m0, s29, 77696
  s_mov_b32 s38, 1310720
  buffer_load_dwordx4 v24, s[16:19], s38 offen offset:128 lds
  s_add_u32 m0, s29, 32768
  s_mov_b32 s38, 1572864
  buffer_load_dwordx4 v24, s[16:19], s38 offen lds
  s_add_u32 m0, s29, 40832
  s_mov_b32 s38, 1572864
  buffer_load_dwordx4 v24, s[16:19], s38 offen offset:128 lds
  s_add_u32 m0, s29, 36864
  s_mov_b32 s38, 1835008
  buffer_load_dwordx4 v24, s[16:19], s38 offen lds
  s_add_u32 m0, s29, 44928
  s_mov_b32 s38, 1835008
  buffer_load_dwordx4 v24, s[16:19], s38 offen offset:128 lds
  v_lshrrev_b32 v56, 1, v0
  v_lshlrev_b32 v56, 13, v56
  v_and_b32 v57, 1, v0
  v_lshl_add_u32 v56, v57, 7, v56
  s_bfe_u32 s36, s2, 0x10006
  s_lshl_b32 s36, s36, 2
  s_add_u32 s36, s36, s28
  s_mul_i32 s36, s36, 458752
  s_add_u32 s36, s36, 2097152
  buffer_load_dword v62, v56, s[16:19], s36 offen
  s_add_u32 s36, s36, 196608
  buffer_load_dword v62, v56, s[16:19], s36 offen
  s_branch L_g3
L_g2:
  s_add_u32 m0, s29, 0
  s_mov_b32 s38, 0
  buffer_load_dwordx4 v24, s[16:19], s38 offen lds
  s_add_u32 m0, s29, 8064
  s_mov_b32 s38, 0
  buffer_load_dwordx4 v24, s[16:19], s38 offen offset:128 lds
  s_add_u32 m0, s29, 4096
  s_mov_b32 s38, 262144
  buffer_load_dwordx4 v24, s[16:19], s38 offen lds
  s_add_u32 m0, s29, 12160
  s_mov_b32 s38, 262144
  buffer_load_dwordx4 v24, s[16:19], s38 offen offset:128 lds
  s_add_u32 m0, s29, 16384
  s_mov_b32 s38, 524288
  buffer_load_dwordx4 v24, s[16:19], s38 offen lds
  s_add_u32 m0, s29, 24448
  s_mov_b32 s38, 524288
  buffer_load_dwordx4 v24, s[16:19], s38 offen offset:128 lds
  s_add_u32 m0, s29, 20480
  s_mov_b32 s38, 786432
  buffer_load_dwordx4 v24, s[16:19], s38 offen lds
  s_add_u32 m0, s29, 28544
  s_mov_b32 s38, 786432
  buffer_load_dwordx4 v24, s[16:19], s38 offen offset:128 lds
  s_add_u32 m0, s29, 65536
  s_mov_b32 s38, 1048576
  buffer_load_dwordx4 v24, s[16:19], s38 offen lds
  s_add_u32 m0, s29, 73600
  s_mov_b32 s38, 1048576
  buffer_load_dwordx4 v24, s[16:19], s38 offen offset:128 lds
  s_add_u32 m0, s29, 69632
  s_mov_b32 s38, 1310720
  buffer_load_dwordx4 v24, s[16:19], s38 offen lds
  s_add_u32 m0, s29, 77696
  s_mov_b32 s38, 1310720
  buffer_load_dwordx4 v24, s[16:19], s38 offen offset:128 lds
  s_add_u32 m0, s29, 32768
  s_mov_b32 s38, 1572864
  buffer_load_dwordx4 v24, s[16:19], s38 offen lds
  s_add_u32 m0, s29, 40832
  s_mov_b32 s38, 1572864
  buffer_load_dwordx4 v24, s[16:19], s38 offen offset:128 lds
  s_add_u32 m0, s29, 36864
  s_mov_b32 s38, 1835008
  buffer_load_dwordx4 v24, s[16:19], s38 offen lds
  s_add_u32 m0, s29, 44928
  s_mov_b32 s38, 1835008
  buffer_load_dwordx4 v24, s[16:19], s38 offen offset:128 lds
  v_lshlrev_b32 v52, 3, v52
  v_add_u32 v52, 159744, v52
  v_lshl_add_u32 v55, v54, 7, v52
  v_lshlrev_b32 v53, 6, v53
  v_lshl_add_u32 v53, v54, 8, v53
  s_lshr_b32 s36, s3, 2
  s_mul_i32 s36, s36, 81920
  s_and_b32 s37, s3, 3
  s_lshl_b32 s37, s37, 10
  s_add_u32 s36, s36, s37
  s_add_u32 s36, s36, 49725440
  s_add_u32 s48, s80, s36
  s_addc_u32 s49, s81, 0
  s_sub_u32 s50, 81920, s37
  s_mov_b32 s51, 0x20000
  s_lshr_b32 s47, s3, 4
  s_mul_i32 s47, s47, 16384
  s_add_u32 s47, s47, 12288
  s_waitcnt vmcnt(18)
  v_lshlrev_b32 v84, 16, v64
  v_and_b32 v85, 0xffff0000, v64
  v_lshlrev_b32 v86, 16, v65
  v_and_b32 v87, 0xffff0000, v65
  v_lshlrev_b32 v88, 16, v66
  v_and_b32 v89, 0xffff0000, v66
  v_lshlrev_b32 v90, 16, v67
  v_and_b32 v91, 0xffff0000, v67
  v_lshlrev_b32 v92, 16, v68
  v_and_b32 v93, 0xffff0000, v68
  v_lshlrev_b32 v94, 16, v69
  v_and_b32 v95, 0xffff0000, v69
  v_lshlrev_b32 v96, 16, v70
  v_and_b32 v97, 0xffff0000, v70
  v_lshlrev_b32 v98, 16, v71
  v_and_b32 v99, 0xffff0000, v71
  v_lshlrev_b32 v100, 16, v72
  v_and_b32 v101, 0xffff0000, v72
  v_lshlrev_b32 v102, 16, v73
  v_and_b32 v103, 0xffff0000, v73
  v_lshlrev_b32 v104, 16, v74
  v_and_b32 v105, 0xffff0000, v74
  v_lshlrev_b32 v106, 16, v75
  v_and_b32 v107, 0xffff0000, v75
  v_lshlrev_b32 v108, 16, v76
  v_and_b32 v109, 0xffff0000, v76
  v_lshlrev_b32 v110, 16, v77
  v_and_b32 v111, 0xffff0000, v77
  v_lshlrev_b32 v112, 16, v78
  v_and_b32 v113, 0xffff0000, v78
  v_lshlrev_b32 v114, 16, v79
  v_and_b32 v115, 0xffff0000, v79
  v_lshlrev_b32 v116, 16, v80
  v_and_b32 v117, 0xffff0000, v80
  v_lshlrev_b32 v118, 16, v81
  v_and_b32 v119, 0xffff0000, v81
  v_lshlrev_b32 v120, 16, v82
  v_and_b32 v121, 0xffff0000, v82
  v_lshlrev_b32 v122, 16, v83
  v_and_b32 v123, 0xffff0000, v83
  v_pk_add_f32 v[56:57], v[84:85], v[86:87]
  v_pk_add_f32 v[58:59], v[88:89], v[90:91]
  v_pk_add_f32 v[56:57], v[56:57], v[92:93]
  v_pk_add_f32 v[58:59], v[58:59], v[94:95]
  v_pk_add_f32 v[56:57], v[56:57], v[96:97]
  v_pk_add_f32 v[58:59], v[58:59], v[98:99]
  v_pk_add_f32 v[56:57], v[56:57], v[100:101]
  v_pk_add_f32 v[58:59], v[58:59], v[102:103]
  v_pk_add_f32 v[56:57], v[56:57], v[104:105]
  v_pk_add_f32 v[58:59], v[58:59], v[106:107]
  v_pk_add_f32 v[56:57], v[56:57], v[108:109]
  v_pk_add_f32 v[58:59], v[58:59], v[110:111]
  v_pk_add_f32 v[56:57], v[56:57], v[112:113]
  v_pk_add_f32 v[58:59], v[58:59], v[114:115]
  v_pk_add_f32 v[56:57], v[56:57], v[116:117]
  v_pk_add_f32 v[58:59], v[58:59], v[118:119]
  v_pk_add_f32 v[56:57], v[56:57], v[120:121]
  v_pk_add_f32 v[58:59], v[58:59], v[122:123]
  v_pk_add_f32 v[56:57], v[56:57], v[58:59]
  v_add_f32 v56, v56, v57
  v_mov_b32 v57, v56
  s_nop 1
  v_permlane16_swap_b32 v56, v57
  v_add_f32 v56, v56, v57
  v_mov_b32 v57, v56
  s_nop 1
  v_permlane32_swap_b32 v56, v57
  v_add_f32 v56, v56, v57
  v_mul_f32 v56, 0x3bcccccd, v56
  v_pk_add_f32 v[58:59], v[84:85], v[56:57] op_sel_hi:[1,0] neg_lo:[0,1] neg_hi:[0,1]
  v_pk_mul_f32 v[204:205], v[58:59], v[58:59]
  v_pk_add_f32 v[60:61], v[86:87], v[56:57] op_sel_hi:[1,0] neg_lo:[0,1] neg_hi:[0,1]
  v_pk_mul_f32 v[206:207], v[60:61], v[60:61]
  v_pk_add_f32 v[58:59], v[88:89], v[56:57] op_sel_hi:[1,0] neg_lo:[0,1] neg_hi:[0,1]
  v_pk_fma_f32 v[204:205], v[58:59], v[58:59], v[204:205]
  v_pk_add_f32 v[60:61], v[90:91], v[56:57] op_sel_hi:[1,0] neg_lo:[0,1] neg_hi:[0,1]
  v_pk_fma_f32 v[206:207], v[60:61], v[60:61], v[206:207]
  v_pk_add_f32 v[58:59], v[92:93], v[56:57] op_sel_hi:[1,0] neg_lo:[0,1] neg_hi:[0,1]
  v_pk_fma_f32 v[204:205], v[58:59], v[58:59], v[204:205]
  v_pk_add_f32 v[60:61], v[94:95], v[56:57] op_sel_hi:[1,0] neg_lo:[0,1] neg_hi:[0,1]
  v_pk_fma_f32 v[206:207], v[60:61], v[60:61], v[206:207]
  v_pk_add_f32 v[58:59], v[96:97], v[56:57] op_sel_hi:[1,0] neg_lo:[0,1] neg_hi:[0,1]
  v_pk_fma_f32 v[204:205], v[58:59], v[58:59], v[204:205]
  v_pk_add_f32 v[60:61], v[98:99], v[56:57] op_sel_hi:[1,0] neg_lo:[0,1] neg_hi:[0,1]
  v_pk_fma_f32 v[206:207], v[60:61], v[60:61], v[206:207]
  v_pk_add_f32 v[58:59], v[100:101], v[56:57] op_sel_hi:[1,0] neg_lo:[0,1] neg_hi:[0,1]
  v_pk_fma_f32 v[204:205], v[58:59], v[58:59], v[204:205]
  v_pk_add_f32 v[60:61], v[102:103], v[56:57] op_sel_hi:[1,0] neg_lo:[0,1] neg_hi:[0,1]
  v_pk_fma_f32 v[206:207], v[60:61], v[60:61], v[206:207]
  v_pk_add_f32 v[58:59], v[104:105], v[56:57] op_sel_hi:[1,0] neg_lo:[0,1] neg_hi:[0,1]
  v_pk_fma_f32 v[204:205], v[58:59], v[58:59], v[204:205]
  v_pk_add_f32 v[60:61], v[106:107], v[56:57] op_sel_hi:[1,0] neg_lo:[0,1] neg_hi:[0,1]
  v_pk_fma_f32 v[206:207], v[60:61], v[60:61], v[206:207]
  v_pk_add_f32 v[58:59], v[108:109], v[56:57] op_sel_hi:[1,0] neg_lo:[0,1] neg_hi:[0,1]
  v_pk_fma_f32 v[204:205], v[58:59], v[58:59], v[204:205]
  v_pk_add_f32 v[60:61], v[110:111], v[56:57] op_sel_hi:[1,0] neg_lo:[0,1] neg_hi:[0,1]
  v_pk_fma_f32 v[206:207], v[60:61], v[60:61], v[206:207]
  v_pk_add_f32 v[58:59], v[112:113], v[56:57] op_sel_hi:[1,0] neg_lo:[0,1] neg_hi:[0,1]
  v_pk_fma_f32 v[204:205], v[58:59], v[58:59], v[204:205]
  v_pk_add_f32 v[60:61], v[114:115], v[56:57] op_sel_hi:[1,0] neg_lo:[0,1] neg_hi:[0,1]
  v_pk_fma_f32 v[206:207], v[60:61], v[60:61], v[206:207]
  v_pk_add_f32 v[58:59], v[116:117], v[56:57] op_sel_hi:[1,0] neg_lo:[0,1] neg_hi:[0,1]
  v_pk_fma_f32 v[204:205], v[58:59], v[58:59], v[204:205]
  v_pk_add_f32 v[60:61], v[118:119], v[56:57] op_sel_hi:[1,0] neg_lo:[0,1] neg_hi:[0,1]
  v_pk_fma_f32 v[206:207], v[60:61], v[60:61], v[206:207]
  v_pk_add_f32 v[58:59], v[120:121], v[56:57] op_sel_hi:[1,0] neg_lo:[0,1] neg_hi:[0,1]
  v_pk_fma_f32 v[204:205], v[58:59], v[58:59], v[204:205]
  v_pk_add_f32 v[60:61], v[122:123], v[56:57] op_sel_hi:[1,0] neg_lo:[0,1] neg_hi:[0,1]
  v_pk_fma_f32 v[206:207], v[60:61], v[60:61], v[206:207]
  v_pk_add_f32 v[204:205], v[204:205], v[206:207]
  v_add_f32 v57, v204, v205
  v_mov_b32 v58, v57
  s_nop 1
  v_permlane16_swap_b32 v57, v58
  v_add_f32 v57, v57, v58
  v_mov_b32 v58, v57
  s_nop 1
  v_permlane32_swap_b32 v57, v58
  v_add_f32 v57, v57, v58
  ds_write_b64 v55, v[56:57]
  s_cmp_lg_u32 s28, 0
  s_cbranch_scc1 L_bgot
  s_waitcnt vmcnt(16)
  v_readfirstlane_b32 s36, v212
  s_cmp_ge_u32 s36, 8
  s_cbranch_scc1 L_bgot
  v_mov_b32 v60, s66
  s_mov_b32 s37, 131072
L_bpoll:
  buffer_load_dword v61, v60, s[52:55], 0 offen sc1
  s_sub_u32 s37, s37, 1
  s_cmp_eq_u32 s37, 0
  s_cbranch_scc1 L_bgot
  s_waitcnt vmcnt(0)
  v_readfirstlane_b32 s36, v61
  s_cmp_ge_u32 s36, 8
  s_cbranch_scc1 L_bgot
  s_branch L_bpoll
L_bgot:
  s_waitcnt lgkmcnt(0)
  s_barrier
  ds_read_b64 v[204:205], v52 offset:0
  ds_read_b64 v[206:207], v52 offset:128
  ds_read_b64 v[208:209], v52 offset:256
  ds_read_b64 v[210:211], v52 offset:384
  s_waitcnt lgkmcnt(0)
  v_pk_add_f32 v[56:57], v[204:205], v[206:207]
  v_pk_add_f32 v[58:59], v[208:209], v[210:211]
  v_pk_add_f32 v[56:57], v[56:57], v[58:59]
  v_mul_f32 v56, 0x3e800000, v56
  v_sub_f32 v58, v204, v56
  v_mul_f32 v61, v58, v58
  v_sub_f32 v59, v206, v56
  v_fmac_f32 v61, v59, v59
  v_sub_f32 v58, v208, v56
  v_fmac_f32 v61, v58, v58
  v_sub_f32 v59, v210, v56
  v_fmac_f32 v61, v59, v59
  v_fmac_f32 v57, 0x43200000, v61
  v_mov_b32 v58, 0x3727c5ac
  v_fmac_f32 v58, 0x3acccccd, v57
  v_rsq_f32 v58, v58
  v_pk_add_f32 v[84:85], v[84:85], v[56:57] op_sel_hi:[1,0] neg_lo:[0,1] neg_hi:[0,1]
  v_pk_add_f32 v[86:87], v[86:87], v[56:57] op_sel_hi:[1,0] neg_lo:[0,1] neg_hi:[0,1]
  v_pk_add_f32 v[88:89], v[88:89], v[56:57] op_sel_hi:[1,0] neg_lo:[0,1] neg_hi:[0,1]
  v_pk_add_f32 v[90:91], v[90:91], v[56:57] op_sel_hi:[1,0] neg_lo:[0,1] neg_hi:[0,1]
  v_pk_add_f32 v[92:93], v[92:93], v[56:57] op_sel_hi:[1,0] neg_lo:[0,1] neg_hi:[0,1]
  v_pk_add_f32 v[94:95], v[94:95], v[56:57] op_sel_hi:[1,0] neg_lo:[0,1] neg_hi:[0,1]
  v_pk_add_f32 v[96:97], v[96:97], v[56:57] op_sel_hi:[1,0] neg_lo:[0,1] neg_hi:[0,1]
  v_pk_add_f32 v[98:99], v[98:99], v[56:57] op_sel_hi:[1,0] neg_lo:[0,1] neg_hi:[0,1]
  v_pk_add_f32 v[100:101], v[100:101], v[56:57] op_sel_hi:[1,0] neg_lo:[0,1] neg_hi:[0,1]
  v_pk_add_f32 v[102:103], v[102:103], v[56:57] op_sel_hi:[1,0] neg_lo:[0,1] neg_hi:[0,1]
  v_pk_add_f32 v[104:105], v[104:105], v[56:57] op_sel_hi:[1,0] neg_lo:[0,1] neg_hi:[0,1]
  v_pk_add_f32 v[106:107], v[106:107], v[56:57] op_sel_hi:[1,0] neg_lo:[0,1] neg_hi:[0,1]
  v_pk_add_f32 v[108:109], v[108:109], v[56:57] op_sel_hi:[1,0] neg_lo:[0,1] neg_hi:[0,1]
  v_pk_add_f32 v[110:111], v[110:111], v[56:57] op_sel_hi:[1,0] neg_lo:[0,1] neg_hi:[0,1]
  v_pk_add_f32 v[112:113], v[112:113], v[56:57] op_sel_hi:[1,0] neg_lo:[0,1] neg_hi:[0,1]
  v_pk_add_f32 v[114:115], v[114:115], v[56:57] op_sel_hi:[1,0] neg_lo:[0,1] neg_hi:[0,1]
  v_pk_add_f32 v[116:117], v[116:117], v[56:57] op_sel_hi:[1,0] neg_lo:[0,1] neg_hi:[0,1]
  v_pk_add_f32 v[118:119], v[118:119], v[56:57] op_sel_hi:[1,0] neg_lo:[0,1] neg_hi:[0,1]
  v_pk_add_f32 v[120:121], v[120:121], v[56:57] op_sel_hi:[1,0] neg_lo:[0,1] neg_hi:[0,1]
  v_pk_add_f32 v[122:123], v[122:123], v[56:57] op_sel_hi:[1,0] neg_lo:[0,1] neg_hi:[0,1]
  v_pk_mul_f32 v[84:85], v[84:85], v[58:59] op_sel_hi:[1,0]
  v_pk_mul_f32 v[86:87], v[86:87], v[58:59] op_sel_hi:[1,0]
  v_pk_mul_f32 v[88:89], v[88:89], v[58:59] op_sel_hi:[1,0]
  v_pk_mul_f32 v[90:91], v[90:91], v[58:59] op_sel_hi:[1,0]
  v_pk_mul_f32 v[92:93], v[92:93], v[58:59] op_sel_hi:[1,0]
  v_pk_mul_f32 v[94:95], v[94:95], v[58:59] op_sel_hi:[1,0]
  v_pk_mul_f32 v[96:97], v[96:97], v[58:59] op_sel_hi:[1,0]
  v_pk_mul_f32 v[98:99], v[98:99], v[58:59] op_sel_hi:[1,0]
  v_pk_mul_f32 v[100:101], v[100:101], v[58:59] op_sel_hi:[1,0]
  v_pk_mul_f32 v[102:103], v[102:103], v[58:59] op_sel_hi:[1,0]
  v_pk_mul_f32 v[104:105], v[104:105], v[58:59] op_sel_hi:[1,0]
  v_pk_mul_f32 v[106:107], v[106:107], v[58:59] op_sel_hi:[1,0]
  v_pk_mul_f32 v[108:109], v[108:109], v[58:59] op_sel_hi:[1,0]
  v_pk_mul_f32 v[110:111], v[110:111], v[58:59] op_sel_hi:[1,0]
  v_pk_mul_f32 v[112:113], v[112:113], v[58:59] op_sel_hi:[1,0]
  v_pk_mul_f32 v[114:115], v[114:115], v[58:59] op_sel_hi:[1,0]
  v_pk_mul_f32 v[116:117], v[116:117], v[58:59] op_sel_hi:[1,0]
  v_pk_mul_f32 v[118:119], v[118:119], v[58:59] op_sel_hi:[1,0]
  v_pk_mul_f32 v[120:121], v[120:121], v[58:59] op_sel_hi:[1,0]
  v_pk_mul_f32 v[122:123], v[122:123], v[58:59] op_sel_hi:[1,0]
  s_and_b32 s45, s2, 7
  s_lshl_b32 s45, s45, 13
  s_add_u32 s46, s45, 4096
  s_mov_b32 s37, 131072
L_tpoll:
  buffer_load_dwordx4 v[124:127], v53, s[32:35], s45 offen offset:0 sc1
  buffer_load_dwordx4 v[128:131], v53, s[32:35], s45 offen offset:16 sc1
  buffer_load_dwordx4 v[132:135], v53, s[32:35], s45 offen offset:32 sc1
  buffer_load_dwordx4 v[136:139], v53, s[32:35], s45 offen offset:48 sc1
  buffer_load_dwordx4 v[140:143], v53, s[32:35], s45 offen offset:1024 sc1
  buffer_load_dwordx4 v[144:147], v53, s[32:35], s45 offen offset:1040 sc1
  buffer_load_dwordx4 v[148:151], v53, s[32:35], s45 offen offset:1056 sc1
  buffer_load_dwordx4 v[152:155], v53, s[32:35], s45 offen offset:1072 sc1
  buffer_load_dwordx4 v[156:159], v53, s[32:35], s45 offen offset:2048 sc1
  buffer_load_dwordx4 v[160:163], v53, s[32:35], s45 offen offset:2064 sc1
  buffer_load_dwordx4 v[164:167], v53, s[32:35], s45 offen offset:2080 sc1
  buffer_load_dwordx4 v[168:171], v53, s[32:35], s45 offen offset:2096 sc1
  buffer_load_dwordx4 v[172:175], v53, s[32:35], s45 offen offset:3072 sc1
  buffer_load_dwordx4 v[176:179], v53, s[32:35], s45 offen offset:3088 sc1
  buffer_load_dwordx4 v[180:183], v53, s[32:35], s45 offen offset:3104 sc1
  buffer_load_dwordx4 v[184:187], v53, s[32:35], s45 offen offset:3120 sc1
  buffer_load_dwordx4 v[188:191], v53, s[32:35], s46 offen offset:0 sc1
  buffer_load_dwordx4 v[192:195], v53, s[32:35], s46 offen offset:16 sc1
  buffer_load_dwordx4 v[196:199], v53, s[32:35], s46 offen offset:32 sc1
  buffer_load_dwordx4 v[200:203], v53, s[32:35], s46 offen offset:48 sc1
  s_waitcnt vmcnt(16)
  v_and_b32 v60, v124, v125
  v_and_b32 v61, v126, v127
  v_bitop3_b32 v60, v60, v128, v129 bitop3:0x80
  v_bitop3_b32 v61, v61, v130, v131 bitop3:0x80
  v_bitop3_b32 v60, v60, v132, v133 bitop3:0x80
  v_bitop3_b32 v61, v61, v134, v135 bitop3:0x80
  v_bitop3_b32 v60, v60, v136, v137 bitop3:0x80
  v_bitop3_b32 v61, v61, v138, v139 bitop3:0x80
  s_waitcnt vmcnt(12)
  v_bitop3_b32 v60, v60, v140, v141 bitop3:0x80
  v_bitop3_b32 v61, v61, v142, v143 bitop3:0x80
  v_bitop3_b32 v60, v60, v144, v145 bitop3:0x80
  v_bitop3_b32 v61, v61, v146, v147 bitop3:0x80
  v_bitop3_b32 v60, v60, v148, v149 bitop3:0x80
  v_bitop3_b32 v61, v61, v150, v151 bitop3:0x80
  v_bitop3_b32 v60, v60, v152, v153 bitop3:0x80
  v_bitop3_b32 v61, v61, v154, v155 bitop3:0x80
  s_waitcnt vmcnt(8)
  v_bitop3_b32 v60, v60, v156, v157 bitop3:0x80
  v_bitop3_b32 v61, v61, v158, v159 bitop3:0x80
  v_bitop3_b32 v60, v60, v160, v161 bitop3:0x80
  v_bitop3_b32 v61, v61, v162, v163 bitop3:0x80
  v_bitop3_b32 v60, v60, v164, v165 bitop3:0x80
  v_bitop3_b32 v61, v61, v166, v167 bitop3:0x80
  v_bitop3_b32 v60, v60, v168, v169 bitop3:0x80
  v_bitop3_b32 v61, v61, v170, v171 bitop3:0x80
  s_waitcnt vmcnt(4)
  v_bitop3_b32 v60, v60, v172, v173 bitop3:0x80
  v_bitop3_b32 v61, v61, v174, v175 bitop3:0x80
  v_bitop3_b32 v60, v60, v176, v177 bitop3:0x80
  v_bitop3_b32 v61, v61, v178, v179 bitop3:0x80
  v_bitop3_b32 v60, v60, v180, v181 bitop3:0x80
  v_bitop3_b32 v61, v61, v182, v183 bitop3:0x80
  v_bitop3_b32 v60, v60, v184, v185 bitop3:0x80
  v_bitop3_b32 v61, v61, v186, v187 bitop3:0x80
  s_waitcnt vmcnt(0)
  v_bitop3_b32 v60, v60, v188, v189 bitop3:0x80
  v_bitop3_b32 v61, v61, v190, v191 bitop3:0x80
  v_bitop3_b32 v60, v60, v192, v193 bitop3:0x80
  v_bitop3_b32 v61, v61, v194, v195 bitop3:0x80
  v_bitop3_b32 v60, v60, v196, v197 bitop3:0x80
  v_bitop3_b32 v61, v61, v198, v199 bitop3:0x80
  v_bitop3_b32 v60, v60, v200, v201 bitop3:0x80
  v_bitop3_b32 v61, v61, v202, v203 bitop3:0x80
  v_and_b32 v60, v60, v61
  v_and_b32 v60, 1, v60
  v_cmp_eq_u32 vcc, 0, v60
  s_cbranch_vccz L_tgot
  s_sub_u32 s37, s37, 1
  s_cmp_lg_u32 s37, 0
  s_cbranch_scc1 L_tpoll
L_tgot:
  s_lshl_b32 s37, s28, 12
  v_pk_fma_f32 v[84:85], v[84:85], v[134:135], v[126:127] op_sel:[0,1,0] op_sel_hi:[1,0,1]
  v_pk_fma_f32 v[86:87], v[86:87], v[138:139], v[130:131] op_sel:[0,1,0] op_sel_hi:[1,0,1]
  v_pk_fma_f32 v[88:89], v[88:89], v[132:133], v[124:125] op_sel:[0,1,0] op_sel_hi:[1,0,1]
  v_pk_fma_f32 v[90:91], v[90:91], v[136:137], v[128:129] op_sel:[0,1,0] op_sel_hi:[1,0,1]
  v_cvt_pk_bf16_f32 v64, v84, v85
  v_cvt_pk_bf16_f32 v65, v86, v87
  v_cvt_pk_bf16_f32 v66, v88, v89
  v_cvt_pk_bf16_f32 v67, v90, v91
  buffer_store_dwordx4 v[64:67], v25, s[48:51], s37 offen sc1
  s_add_u32 s37, s37, 16384
  v_pk_fma_f32 v[92:93], v[92:93], v[150:151], v[142:143] op_sel:[0,1,0] op_sel_hi:[1,0,1]
  v_pk_fma_f32 v[94:95], v[94:95], v[154:155], v[146:147] op_sel:[0,1,0] op_sel_hi:[1,0,1]
  v_pk_fma_f32 v[96:97], v[96:97], v[148:149], v[140:141] op_sel:[0,1,0] op_sel_hi:[1,0,1]
  v_pk_fma_f32 v[98:99], v[98:99], v[152:153], v[144:145] op_sel:[0,1,0] op_sel_hi:[1,0,1]
  v_cvt_pk_bf16_f32 v68, v92, v93
  v_cvt_pk_bf16_f32 v69, v94, v95
  v_cvt_pk_bf16_f32 v70, v96, v97
  v_cvt_pk_bf16_f32 v71, v98, v99
  buffer_store_dwordx4 v[68:71], v25, s[48:51], s37 offen sc1
  s_add_u32 s37, s37, 16384
  v_pk_fma_f32 v[100:101], v[100:101], v[166:167], v[158:159] op_sel:[0,1,0] op_sel_hi:[1,0,1]
  v_pk_fma_f32 v[102:103], v[102:103], v[170:171], v[162:163] op_sel:[0,1,0] op_sel_hi:[1,0,1]
  v_pk_fma_f32 v[104:105], v[104:105], v[164:165], v[156:157] op_sel:[0,1,0] op_sel_hi:[1,0,1]
  v_pk_fma_f32 v[106:107], v[106:107], v[168:169], v[160:161] op_sel:[0,1,0] op_sel_hi:[1,0,1]
  v_cvt_pk_bf16_f32 v72, v100, v101
  v_cvt_pk_bf16_f32 v73, v102, v103
  v_cvt_pk_bf16_f32 v74, v104, v105
  v_cvt_pk_bf16_f32 v75, v106, v107
  buffer_store_dwordx4 v[72:75], v25, s[48:51], s37 offen sc1
  s_add_u32 s37, s37, 16384
  v_pk_fma_f32 v[108:109], v[108:109], v[182:183], v[174:175] op_sel:[0,1,0] op_sel_hi:[1,0,1]
  v_pk_fma_f32 v[110:111], v[110:111], v[186:187], v[178:179] op_sel:[0,1,0] op_sel_hi:[1,0,1]
  v_pk_fma_f32 v[112:113], v[112:113], v[180:181], v[172:173] op_sel:[0,1,0] op_sel_hi:[1,0,1]
  v_pk_fma_f32 v[114:115], v[114:115], v[184:185], v[176:177] op_sel:[0,1,0] op_sel_hi:[1,0,1]
  v_cvt_pk_bf16_f32 v76, v108, v109
  v_cvt_pk_bf16_f32 v77, v110, v111
  v_cvt_pk_bf16_f32 v78, v112, v113
  v_cvt_pk_bf16_f32 v79, v114, v115
  buffer_store_dwordx4 v[76:79], v25, s[48:51], s37 offen sc1
  s_add_u32 s37, s37, 16384
  v_pk_fma_f32 v[116:117], v[116:117], v[198:199], v[190:191] op_sel:[0,1,0] op_sel_hi:[1,0,1]
  v_pk_fma_f32 v[118:119], v[118:119], v[202:203], v[194:195] op_sel:[0,1,0] op_sel_hi:[1,0,1]
  v_pk_fma_f32 v[120:121], v[120:121], v[196:197], v[188:189] op_sel:[0,1,0] op_sel_hi:[1,0,1]
  v_pk_fma_f32 v[122:123], v[122:123], v[200:201], v[192:193] op_sel:[0,1,0] op_sel_hi:[1,0,1]
  v_cvt_pk_bf16_f32 v80, v116, v117
  v_cvt_pk_bf16_f32 v81, v118, v119
  v_cvt_pk_bf16_f32 v82, v120, v121
  v_cvt_pk_bf16_f32 v83, v122, v123
  buffer_store_dwordx4 v[80:83], v25, s[48:51], s37 offen sc1
  s_add_u32 s37, s37, 16384
  v_lshlrev_b32 v60, 8, v0
  v_add_u32 v60, s47, v60
  v_mov_b32 v61, 1
  s_waitcnt vmcnt(0)
  s_barrier
  s_cmp_lg_u32 s28, 0
  s_cbranch_scc1 L_g4
  s_mov_b64 exec, 0xff
  buffer_atomic_add v61, v60, s[84:87], 0 offen sc1
  s_mov_b64 exec, -1
L_g4:
L_g3:
  s_mul_i32 s38, s31, 16384
  s_add_u32 s38, s38, 12288
  s_bfe_u32 s39, s2, 0x30001
  s_lshl_b32 s39, s39, 8
  s_add_u32 s38, s38, s39
  s_cmp_lg_u32 s28, 0
  s_cbranch_scc1 L_cgot
  v_mov_b32 v60, s38
  s_mov_b32 s37, 131072
L_cpoll:
  buffer_load_dword v61, v60, s[84:87], 0 offen sc1
  s_sub_u32 s37, s37, 1
  s_cmp_eq_u32 s37, 0
  s_cbranch_scc1 L_cgot
  s_waitcnt vmcnt(0)
  v_readfirstlane_b32 s36, v61
  s_cmp_ge_u32 s36, 16
  s_cbranch_scc1 L_cgot
  s_branch L_cpoll
L_cgot:
  s_barrier
  s_mov_b32 s39, 0
  buffer_load_dwordx4 a[0:3], v25, s[20:23], s39 offen offset:0 sc1
  buffer_load_dwordx4 a[4:7], v25, s[20:23], s39 offen offset:1024 sc1
  buffer_load_dwordx4 a[8:11], v25, s[20:23], s39 offen offset:2048 sc1
  buffer_load_dwordx4 a[12:15], v25, s[20:23], s39 offen offset:3072 sc1
  s_mov_b32 s39, 4096
  buffer_load_dwordx4 a[16:19], v25, s[20:23], s39 offen offset:0 sc1
  buffer_load_dwordx4 a[20:23], v25, s[20:23], s39 offen offset:1024 sc1
  buffer_load_dwordx4 a[24:27], v25, s[20:23], s39 offen offset:2048 sc1
  buffer_load_dwordx4 a[28:31], v25, s[20:23], s39 offen offset:3072 sc1
  s_mov_b32 s39, 8192
  buffer_load_dwordx4 a[32:35], v25, s[20:23], s39 offen offset:0 sc1
  buffer_load_dwordx4 a[36:39], v25, s[20:23], s39 offen offset:1024 sc1
  buffer_load_dwordx4 a[40:43], v25, s[20:23], s39 offen offset:2048 sc1
  buffer_load_dwordx4 a[44:47], v25, s[20:23], s39 offen offset:3072 sc1
  s_mov_b32 s39, 12288
  buffer_load_dwordx4 a[48:51], v25, s[20:23], s39 offen offset:0 sc1
  buffer_load_dwordx4 a[52:55], v25, s[20:23], s39 offen offset:1024 sc1
  buffer_load_dwordx4 a[56:59], v25, s[20:23], s39 offen offset:2048 sc1
  buffer_load_dwordx4 a[60:63], v25, s[20:23], s39 offen offset:3072 sc1
  s_lshr_b32 s48, s30, 3
  s_mul_i32 s48, s48, 1310720
  s_bfe_u32 s49, s30, 0x20001
  s_mul_i32 s49, s49, 10240
  s_add_u32 s48, s48, s49
  s_add_u32 s44, s76, s48
  s_addc_u32 s45, s77, 0
  s_sub_u32 s46, 1310720, s49
  s_or_b32 s91, s91, 2
  s_add_u32 s48, s28, 0
  s_cmp_ge_u32 s48, 10
  s_cselect_b32 s49, 30, 0
  s_add_u32 s48, s48, s49
  s_lshl_b32 s48, s48, 10
  v_add_u32 v245, s48, v25
  s_add_u32 s48, s28, 4
  s_cmp_ge_u32 s48, 10
  s_cselect_b32 s49, 30, 0
  s_add_u32 s48, s48, s49
  s_lshl_b32 s48, s48, 10
  v_add_u32 v246, s48, v25
  s_add_u32 s48, s28, 8
  s_cmp_ge_u32 s48, 10
  s_cselect_b32 s49, 30, 0
  s_add_u32 s48, s48, s49
  s_lshl_b32 s48, s48, 10
  v_add_u32 v247, s48, v25
  s_add_u32 s48, s28, 12
  s_cmp_ge_u32 s48, 10
  s_cselect_b32 s49, 30, 0
  s_add_u32 s48, s48, s49
  s_lshl_b32 s48, s48, 10
  v_add_u32 v248, s48, v25
  s_add_u32 s48, s28, 16
  s_cmp_ge_u32 s48, 10
  s_cselect_b32 s49, 30, 0
  s_add_u32 s48, s48, s49
  s_lshl_b32 s48, s48, 10
  v_add_u32 v249, s48, v25
  s_waitcnt vmcnt(8)
  s_barrier
  ds_read_b64_tr_b16 a[128:129], v14 offset:0
  ds_read_b64_tr_b16 a[130:131], v14 offset:2048
  ds_read_b64_tr_b16 a[132:133], v14 offset:4096
  ds_read_b64_tr_b16 a[134:135], v14 offset:6144
  ds_read_b64_tr_b16 a[136:137], v15 offset:0
  ds_read_b64_tr_b16 a[138:139], v15 offset:2048
  ds_read_b64_tr_b16 a[140:141], v15 offset:4096
  ds_read_b64_tr_b16 a[142:143], v15 offset:6144
  ds_read_b64_tr_b16 a[144:145], v16 offset:0
  ds_read_b64_tr_b16 a[146:147], v16 offset:2048
  ds_read_b64_tr_b16 a[148:149], v16 offset:4096
  ds_read_b64_tr_b16 a[150:151], v16 offset:6144
  s_waitcnt lgkmcnt(4)
  v_mfma_f32_16x16x32_bf16 v[52:55], a[128:131], a[0:3], 0
  ds_read_b64_tr_b16 a[152:153], v17 offset:0
  v_mfma_f32_16x16x32_bf16 v[52:55], a[132:135], a[16:19], v[52:55]
  s_mov_b32 s39, 16384
  ds_read_b64_tr_b16 a[154:155], v17 offset:2048
  v_mfma_f32_16x16x32_bf16 v[84:87], a[132:135], a[20:23], 0
  buffer_load_dwordx4 a[64:67], v25, s[20:23], s39 offen offset:0 sc1
  v_mfma_f32_16x16x32_bf16 v[84:87], a[128:131], a[4:7], v[84:87]
  v_mfma_f32_16x16x32_bf16 v[116:119], a[128:131], a[8:11], 0
  ds_read_b64_tr_b16 a[156:157], v17 offset:4096
  v_mfma_f32_16x16x32_bf16 v[116:119], a[132:135], a[24:27], v[116:119]
  ds_read_b64_tr_b16 a[158:159], v17 offset:6144
  v_mfma_f32_16x16x32_bf16 v[148:151], a[132:135], a[28:31], 0
  buffer_load_dwordx4 a[68:71], v25, s[20:23], s39 offen offset:1024 sc1
  v_mfma_f32_16x16x32_bf16 v[148:151], a[128:131], a[12:15], v[148:151]
  buffer_load_dwordx4 a[72:75], v25, s[20:23], s39 offen offset:2048 sc1
  v_mfma_f32_16x16x32_bf16 v[56:59], a[136:139], a[0:3], 0
  ds_read_b64_tr_b16 a[160:161], v14 offset:8192
  v_mfma_f32_16x16x32_bf16 v[56:59], a[140:143], a[16:19], v[56:59]
  ds_read_b64_tr_b16 a[162:163], v14 offset:10240
  v_mfma_f32_16x16x32_bf16 v[88:91], a[140:143], a[20:23], 0
  buffer_load_dwordx4 a[76:79], v25, s[20:23], s39 offen offset:3072 sc1
  v_mfma_f32_16x16x32_bf16 v[88:91], a[136:139], a[4:7], v[88:91]
  v_mfma_f32_16x16x32_bf16 v[120:123], a[136:139], a[8:11], 0
  ds_read_b64_tr_b16 a[164:165], v14 offset:12288
  v_mfma_f32_16x16x32_bf16 v[120:123], a[140:143], a[24:27], v[120:123]
  s_mov_b32 s39, 20480
  ds_read_b64_tr_b16 a[166:167], v14 offset:14336
  v_mfma_f32_16x16x32_bf16 v[152:155], a[140:143], a[28:31], 0
  buffer_load_dwordx4 a[80:83], v25, s[20:23], s39 offen offset:0 sc1
  v_mfma_f32_16x16x32_bf16 v[152:155], a[136:139], a[12:15], v[152:155]
  s_waitcnt lgkmcnt(4)
  v_mfma_f32_16x16x32_bf16 v[60:63], a[144:147], a[0:3], 0
  ds_read_b64_tr_b16 a[168:169], v15 offset:8192
  v_mfma_f32_16x16x32_bf16 v[60:63], a[148:151], a[16:19], v[60:63]
  ds_read_b64_tr_b16 a[170:171], v15 offset:10240
  v_mfma_f32_16x16x32_bf16 v[92:95], a[148:151], a[20:23], 0
  buffer_load_dwordx4 a[84:87], v25, s[20:23], s39 offen offset:1024 sc1
  v_mfma_f32_16x16x32_bf16 v[92:95], a[144:147], a[4:7], v[92:95]
  buffer_load_dwordx4 a[88:91], v25, s[20:23], s39 offen offset:2048 sc1
  v_mfma_f32_16x16x32_bf16 v[124:127], a[144:147], a[8:11], 0
  ds_read_b64_tr_b16 a[172:173], v15 offset:12288
  v_mfma_f32_16x16x32_bf16 v[124:127], a[148:151], a[24:27], v[124:127]
  ds_read_b64_tr_b16 a[174:175], v15 offset:14336
  v_mfma_f32_16x16x32_bf16 v[156:159], a[148:151], a[28:31], 0
  v_mfma_f32_16x16x32_bf16 v[156:159], a[144:147], a[12:15], v[156:159]
  buffer_load_dwordx4 a[92:95], v25, s[20:23], s39 offen offset:3072 sc1
  v_mfma_f32_16x16x32_bf16 v[64:67], a[152:155], a[0:3], 0
  ds_read_b64_tr_b16 a[176:177], v16 offset:8192
  v_mfma_f32_16x16x32_bf16 v[64:67], a[156:159], a[16:19], v[64:67]
  s_mov_b32 s39, 24576
  ds_read_b64_tr_b16 a[178:179], v16 offset:10240
  v_mfma_f32_16x16x32_bf16 v[96:99], a[156:159], a[20:23], 0
  buffer_load_dwordx4 a[96:99], v25, s[20:23], s39 offen offset:0 sc1
  v_mfma_f32_16x16x32_bf16 v[96:99], a[152:155], a[4:7], v[96:99]
  v_mfma_f32_16x16x32_bf16 v[128:131], a[152:155], a[8:11], 0
  ds_read_b64_tr_b16 a[180:181], v16 offset:12288
  v_mfma_f32_16x16x32_bf16 v[128:131], a[156:159], a[24:27], v[128:131]
  ds_read_b64_tr_b16 a[182:183], v16 offset:14336
  v_mfma_f32_16x16x32_bf16 v[160:163], a[156:159], a[28:31], 0
  buffer_load_dwordx4 a[100:103], v25, s[20:23], s39 offen offset:1024 sc1
  v_mfma_f32_16x16x32_bf16 v[160:163], a[152:155], a[12:15], v[160:163]
  s_waitcnt lgkmcnt(4)
  v_mfma_f32_16x16x32_bf16 v[68:71], a[160:163], a[0:3], 0
  ds_read_b64_tr_b16 a[184:185], v17 offset:8192
  v_mfma_f32_16x16x32_bf16 v[68:71], a[164:167], a[16:19], v[68:71]
  ds_read_b64_tr_b16 a[186:187], v17 offset:10240
  v_mfma_f32_16x16x32_bf16 v[100:103], a[164:167], a[20:23], 0
  buffer_load_dwordx4 a[104:107], v25, s[20:23], s39 offen offset:2048 sc1
  v_mfma_f32_16x16x32_bf16 v[100:103], a[160:163], a[4:7], v[100:103]
  buffer_load_dwordx4 a[108:111], v25, s[20:23], s39 offen offset:3072 sc1
  v_mfma_f32_16x16x32_bf16 v[132:135], a[160:163], a[8:11], 0
  ds_read_b64_tr_b16 a[188:189], v17 offset:12288
  v_mfma_f32_16x16x32_bf16 v[132:135], a[164:167], a[24:27], v[132:135]
  s_mov_b32 s39, 28672
  ds_read_b64_tr_b16 a[190:191], v17 offset:14336
  v_mfma_f32_16x16x32_bf16 v[164:167], a[164:167], a[28:31], 0
  buffer_load_dwordx4 a[112:115], v25, s[20:23], s39 offen offset:0 sc1
  v_mfma_f32_16x16x32_bf16 v[164:167], a[160:163], a[12:15], v[164:167]
  s_waitcnt vmcnt(13)
  v_mfma_f32_16x16x32_bf16 v[72:75], a[168:171], a[0:3], 0
  s_barrier
  ds_read_b64_tr_b16 a[128:129], v14 offset:16384
  v_mfma_f32_16x16x32_bf16 v[72:75], a[172:175], a[16:19], v[72:75]
  ds_read_b64_tr_b16 a[130:131], v14 offset:18432
  v_mfma_f32_16x16x32_bf16 v[104:107], a[172:175], a[20:23], 0
  buffer_load_dwordx4 a[116:119], v25, s[20:23], s39 offen offset:1024 sc1
  v_mfma_f32_16x16x32_bf16 v[104:107], a[168:171], a[4:7], v[104:107]
  v_mfma_f32_16x16x32_bf16 v[136:139], a[168:171], a[8:11], 0
  ds_read_b64_tr_b16 a[132:133], v14 offset:20480
  v_mfma_f32_16x16x32_bf16 v[136:139], a[172:175], a[24:27], v[136:139]
  ds_read_b64_tr_b16 a[134:135], v14 offset:22528
  v_mfma_f32_16x16x32_bf16 v[168:171], a[172:175], a[28:31], 0
  buffer_load_dwordx4 a[120:123], v25, s[20:23], s39 offen offset:2048 sc1
  v_mfma_f32_16x16x32_bf16 v[168:171], a[168:171], a[12:15], v[168:171]
  s_waitcnt lgkmcnt(4)
  v_mfma_f32_16x16x32_bf16 v[76:79], a[176:179], a[0:3], 0
  ds_read_b64_tr_b16 a[136:137], v15 offset:16384
  v_mfma_f32_16x16x32_bf16 v[76:79], a[180:183], a[16:19], v[76:79]
  ds_read_b64_tr_b16 a[138:139], v15 offset:18432
  v_mfma_f32_16x16x32_bf16 v[108:111], a[180:183], a[20:23], 0
  buffer_load_dwordx4 a[124:127], v25, s[20:23], s39 offen offset:3072 sc1
  v_mfma_f32_16x16x32_bf16 v[108:111], a[176:179], a[4:7], v[108:111]
  v_mfma_f32_16x16x32_bf16 v[140:143], a[176:179], a[8:11], 0
  s_mov_b32 s38, 2097152
  ds_read_b64_tr_b16 a[140:141], v15 offset:20480
  v_mfma_f32_16x16x32_bf16 v[140:143], a[180:183], a[24:27], v[140:143]
  s_add_u32 m0, s29, 81920
  ds_read_b64_tr_b16 a[142:143], v15 offset:22528
  v_mfma_f32_16x16x32_bf16 v[172:175], a[180:183], a[28:31], 0
  buffer_load_dwordx4 v24, s[16:19], s38 offen lds
  v_mfma_f32_16x16x32_bf16 v[172:175], a[176:179], a[12:15], v[172:175]
  v_mfma_f32_16x16x32_bf16 v[80:83], a[184:187], a[0:3], 0
  s_mov_b32 s38, 2097152
  ds_read_b64_tr_b16 a[144:145], v16 offset:16384
  v_mfma_f32_16x16x32_bf16 v[80:83], a[188:191], a[16:19], v[80:83]
  s_add_u32 m0, s29, 89984
  ds_read_b64_tr_b16 a[146:147], v16 offset:18432
  v_mfma_f32_16x16x32_bf16 v[112:115], a[188:191], a[20:23], 0
  buffer_load_dwordx4 v24, s[16:19], s38 offen offset:128 lds
  v_mfma_f32_16x16x32_bf16 v[112:115], a[184:187], a[4:7], v[112:115]
  v_mfma_f32_16x16x32_bf16 v[144:147], a[184:187], a[8:11], 0
  s_mov_b32 s38, 2359296
  ds_read_b64_tr_b16 a[148:149], v16 offset:20480
  v_mfma_f32_16x16x32_bf16 v[144:147], a[188:191], a[24:27], v[144:147]
  s_add_u32 m0, s29, 86016
  ds_read_b64_tr_b16 a[150:151], v16 offset:22528
  v_mfma_f32_16x16x32_bf16 v[176:179], a[188:191], a[28:31], 0
  buffer_load_dwordx4 v24, s[16:19], s38 offen lds
  v_mfma_f32_16x16x32_bf16 v[176:179], a[184:187], a[12:15], v[176:179]
  s_waitcnt lgkmcnt(4)
  s_add_u32 m0, s29, 94080
  s_mov_b32 s38, 2359296
  buffer_load_dwordx4 v24, s[16:19], s38 offen offset:128 lds
  v_mfma_f32_16x16x32_bf16 v[52:55], a[128:131], a[32:35], v[52:55]
  ds_read_b64_tr_b16 a[152:153], v17 offset:16384
  v_mfma_f32_16x16x32_bf16 v[52:55], a[132:135], a[48:51], v[52:55]
  s_mov_b32 s39, 32768
  ds_read_b64_tr_b16 a[154:155], v17 offset:18432
  v_mfma_f32_16x16x32_bf16 v[84:87], a[132:135], a[52:55], v[84:87]
  buffer_load_dwordx4 a[0:3], v25, s[20:23], s39 offen offset:0 sc1
  v_mfma_f32_16x16x32_bf16 v[84:87], a[128:131], a[36:39], v[84:87]
  v_mfma_f32_16x16x32_bf16 v[116:119], a[128:131], a[40:43], v[116:119]
  ds_read_b64_tr_b16 a[156:157], v17 offset:20480
  v_mfma_f32_16x16x32_bf16 v[116:119], a[132:135], a[56:59], v[116:119]
  ds_read_b64_tr_b16 a[158:159], v17 offset:22528
  v_mfma_f32_16x16x32_bf16 v[148:151], a[132:135], a[60:63], v[148:151]
  buffer_load_dwordx4 a[4:7], v25, s[20:23], s39 offen offset:1024 sc1
  v_mfma_f32_16x16x32_bf16 v[148:151], a[128:131], a[44:47], v[148:151]
  v_mfma_f32_16x16x32_bf16 v[56:59], a[136:139], a[32:35], v[56:59]
  ds_read_b64_tr_b16 a[160:161], v14 offset:24576
  v_mfma_f32_16x16x32_bf16 v[56:59], a[140:143], a[48:51], v[56:59]
  ds_read_b64_tr_b16 a[162:163], v14 offset:26624
  v_mfma_f32_16x16x32_bf16 v[88:91], a[140:143], a[52:55], v[88:91]
  v_mfma_f32_16x16x32_bf16 v[88:91], a[136:139], a[36:39], v[88:91]
  buffer_load_dwordx4 a[8:11], v25, s[20:23], s39 offen offset:2048 sc1
  v_mfma_f32_16x16x32_bf16 v[120:123], a[136:139], a[40:43], v[120:123]
  ds_read_b64_tr_b16 a[164:165], v14 offset:28672
  v_mfma_f32_16x16x32_bf16 v[120:123], a[140:143], a[56:59], v[120:123]
  ds_read_b64_tr_b16 a[166:167], v14 offset:30720
  v_mfma_f32_16x16x32_bf16 v[152:155], a[140:143], a[60:63], v[152:155]
  v_mfma_f32_16x16x32_bf16 v[152:155], a[136:139], a[44:47], v[152:155]
  s_waitcnt lgkmcnt(4)
  v_mfma_f32_16x16x32_bf16 v[60:63], a[144:147], a[32:35], v[60:63]
  ds_read_b64_tr_b16 a[168:169], v15 offset:24576
  v_mfma_f32_16x16x32_bf16 v[60:63], a[148:151], a[48:51], v[60:63]
  ds_read_b64_tr_b16 a[170:171], v15 offset:26624
  v_mfma_f32_16x16x32_bf16 v[92:95], a[148:151], a[52:55], v[92:95]
  buffer_load_dwordx4 a[12:15], v25, s[20:23], s39 offen offset:3072 sc1
  v_mfma_f32_16x16x32_bf16 v[92:95], a[144:147], a[36:39], v[92:95]
  v_mfma_f32_16x16x32_bf16 v[124:127], a[144:147], a[40:43], v[124:127]
  ds_read_b64_tr_b16 a[172:173], v15 offset:28672
  v_mfma_f32_16x16x32_bf16 v[124:127], a[148:151], a[56:59], v[124:127]
  s_mov_b32 s39, 36864
  ds_read_b64_tr_b16 a[174:175], v15 offset:30720
  v_mfma_f32_16x16x32_bf16 v[156:159], a[148:151], a[60:63], v[156:159]
  buffer_load_dwordx4 a[16:19], v25, s[20:23], s39 offen offset:0 sc1
  v_mfma_f32_16x16x32_bf16 v[156:159], a[144:147], a[44:47], v[156:159]
  v_mfma_f32_16x16x32_bf16 v[64:67], a[152:155], a[32:35], v[64:67]
  ds_read_b64_tr_b16 a[176:177], v16 offset:24576
  v_mfma_f32_16x16x32_bf16 v[64:67], a[156:159], a[48:51], v[64:67]
  ds_read_b64_tr_b16 a[178:179], v16 offset:26624
  v_mfma_f32_16x16x32_bf16 v[96:99], a[156:159], a[52:55], v[96:99]
  v_mfma_f32_16x16x32_bf16 v[96:99], a[152:155], a[36:39], v[96:99]
  buffer_load_dwordx4 a[20:23], v25, s[20:23], s39 offen offset:1024 sc1
  v_mfma_f32_16x16x32_bf16 v[128:131], a[152:155], a[40:43], v[128:131]
  ds_read_b64_tr_b16 a[180:181], v16 offset:28672
  v_mfma_f32_16x16x32_bf16 v[128:131], a[156:159], a[56:59], v[128:131]
  ds_read_b64_tr_b16 a[182:183], v16 offset:30720
  v_mfma_f32_16x16x32_bf16 v[160:163], a[156:159], a[60:63], v[160:163]
  v_mfma_f32_16x16x32_bf16 v[160:163], a[152:155], a[44:47], v[160:163]
  s_waitcnt lgkmcnt(4)
  v_mfma_f32_16x16x32_bf16 v[68:71], a[160:163], a[32:35], v[68:71]
  ds_read_b64_tr_b16 a[184:185], v17 offset:24576
  v_mfma_f32_16x16x32_bf16 v[68:71], a[164:167], a[48:51], v[68:71]
  ds_read_b64_tr_b16 a[186:187], v17 offset:26624
  v_mfma_f32_16x16x32_bf16 v[100:103], a[164:167], a[52:55], v[100:103]
  buffer_load_dwordx4 a[24:27], v25, s[20:23], s39 offen offset:2048 sc1
  v_mfma_f32_16x16x32_bf16 v[100:103], a[160:163], a[36:39], v[100:103]
  v_mfma_f32_16x16x32_bf16 v[132:135], a[160:163], a[40:43], v[132:135]
  ds_read_b64_tr_b16 a[188:189], v17 offset:28672
  v_mfma_f32_16x16x32_bf16 v[132:135], a[164:167], a[56:59], v[132:135]
  ds_read_b64_tr_b16 a[190:191], v17 offset:30720
  v_mfma_f32_16x16x32_bf16 v[164:167], a[164:167], a[60:63], v[164:167]
  buffer_load_dwordx4 a[28:31], v25, s[20:23], s39 offen offset:3072 sc1
  v_mfma_f32_16x16x32_bf16 v[164:167], a[160:163], a[44:47], v[164:167]
  s_waitcnt vmcnt(20)
  v_mfma_f32_16x16x32_bf16 v[72:75], a[168:171], a[32:35], v[72:75]
  s_barrier
  ds_read_b64_tr_b16 a[128:129], v10 offset:0
  v_mfma_f32_16x16x32_bf16 v[72:75], a[172:175], a[48:51], v[72:75]
  s_mov_b32 s38, 2621440
  ds_read_b64_tr_b16 a[130:131], v10 offset:2048
  v_mfma_f32_16x16x32_bf16 v[104:107], a[172:175], a[52:55], v[104:107]
  s_add_u32 m0, s29, 49152
  v_mfma_f32_16x16x32_bf16 v[104:107], a[168:171], a[36:39], v[104:107]
  buffer_load_dwordx4 v24, s[16:19], s38 offen lds
  v_mfma_f32_16x16x32_bf16 v[136:139], a[168:171], a[40:43], v[136:139]
  ds_read_b64_tr_b16 a[132:133], v10 offset:4096
  v_mfma_f32_16x16x32_bf16 v[136:139], a[172:175], a[56:59], v[136:139]
  ds_read_b64_tr_b16 a[134:135], v10 offset:6144
  v_mfma_f32_16x16x32_bf16 v[168:171], a[172:175], a[60:63], v[168:171]
  v_mfma_f32_16x16x32_bf16 v[168:171], a[168:171], a[44:47], v[168:171]
  s_waitcnt lgkmcnt(4)
  v_mfma_f32_16x16x32_bf16 v[76:79], a[176:179], a[32:35], v[76:79]
  s_mov_b32 s38, 2621440
  ds_read_b64_tr_b16 a[136:137], v11 offset:0
  v_mfma_f32_16x16x32_bf16 v[76:79], a[180:183], a[48:51], v[76:79]
  s_add_u32 m0, s29, 57216
  ds_read_b64_tr_b16 a[138:139], v11 offset:2048
  v_mfma_f32_16x16x32_bf16 v[108:111], a[180:183], a[52:55], v[108:111]
  buffer_load_dwordx4 v24, s[16:19], s38 offen offset:128 lds
  v_mfma_f32_16x16x32_bf16 v[108:111], a[176:179], a[36:39], v[108:111]
  v_mfma_f32_16x16x32_bf16 v[140:143], a[176:179], a[40:43], v[140:143]
  s_mov_b32 s38, 2883584
  ds_read_b64_tr_b16 a[140:141], v11 offset:4096
  v_mfma_f32_16x16x32_bf16 v[140:143], a[180:183], a[56:59], v[140:143]
  s_add_u32 m0, s29, 53248
  ds_read_b64_tr_b16 a[142:143], v11 offset:6144
  v_mfma_f32_16x16x32_bf16 v[172:175], a[180:183], a[60:63], v[172:175]
  buffer_load_dwordx4 v24, s[16:19], s38 offen lds
  v_mfma_f32_16x16x32_bf16 v[172:175], a[176:179], a[44:47], v[172:175]
  v_mfma_f32_16x16x32_bf16 v[80:83], a[184:187], a[32:35], v[80:83]
  s_mov_b32 s38, 2883584
  ds_read_b64_tr_b16 a[144:145], v12 offset:0
  v_mfma_f32_16x16x32_bf16 v[80:83], a[188:191], a[48:51], v[80:83]
  s_add_u32 m0, s29, 61312
  ds_read_b64_tr_b16 a[146:147], v12 offset:2048
  v_mfma_f32_16x16x32_bf16 v[112:115], a[188:191], a[52:55], v[112:115]
  buffer_load_dwordx4 v24, s[16:19], s38 offen offset:128 lds
  v_mfma_f32_16x16x32_bf16 v[112:115], a[184:187], a[36:39], v[112:115]
  v_mfma_f32_16x16x32_bf16 v[144:147], a[184:187], a[40:43], v[144:147]
  ds_read_b64_tr_b16 a[148:149], v12 offset:4096
  v_mfma_f32_16x16x32_bf16 v[144:147], a[188:191], a[56:59], v[144:147]
  ds_read_b64_tr_b16 a[150:151], v12 offset:6144
  v_mfma_f32_16x16x32_bf16 v[176:179], a[188:191], a[60:63], v[176:179]
  v_mfma_f32_16x16x32_bf16 v[176:179], a[184:187], a[44:47], v[176:179]
  s_waitcnt lgkmcnt(4)
  v_mfma_f32_16x16x32_bf16 v[52:55], a[128:131], a[64:67], v[52:55]
  ds_read_b64_tr_b16 a[152:153], v13 offset:0
  v_mfma_f32_16x16x32_bf16 v[52:55], a[132:135], a[80:83], v[52:55]
  s_mov_b32 s39, 40960
  ds_read_b64_tr_b16 a[154:155], v13 offset:2048
  v_mfma_f32_16x16x32_bf16 v[84:87], a[132:135], a[84:87], v[84:87]
  buffer_load_dwordx4 a[32:35], v25, s[20:23], s39 offen offset:0 sc1
  v_mfma_f32_16x16x32_bf16 v[84:87], a[128:131], a[68:71], v[84:87]
  v_mfma_f32_16x16x32_bf16 v[116:119], a[128:131], a[72:75], v[116:119]
  ds_read_b64_tr_b16 a[156:157], v13 offset:4096
  v_mfma_f32_16x16x32_bf16 v[116:119], a[132:135], a[88:91], v[116:119]
  ds_read_b64_tr_b16 a[158:159], v13 offset:6144
  v_mfma_f32_16x16x32_bf16 v[148:151], a[132:135], a[92:95], v[148:151]
  buffer_load_dwordx4 a[36:39], v25, s[20:23], s39 offen offset:1024 sc1
  v_mfma_f32_16x16x32_bf16 v[148:151], a[128:131], a[76:79], v[148:151]
  v_mfma_f32_16x16x32_bf16 v[56:59], a[136:139], a[64:67], v[56:59]
  ds_read_b64_tr_b16 a[160:161], v10 offset:8192
  v_mfma_f32_16x16x32_bf16 v[56:59], a[140:143], a[80:83], v[56:59]
  ds_read_b64_tr_b16 a[162:163], v10 offset:10240
  v_mfma_f32_16x16x32_bf16 v[88:91], a[140:143], a[84:87], v[88:91]
  v_mfma_f32_16x16x32_bf16 v[88:91], a[136:139], a[68:71], v[88:91]
  buffer_load_dwordx4 a[40:43], v25, s[20:23], s39 offen offset:2048 sc1
  v_mfma_f32_16x16x32_bf16 v[120:123], a[136:139], a[72:75], v[120:123]
  ds_read_b64_tr_b16 a[164:165], v10 offset:12288
  v_mfma_f32_16x16x32_bf16 v[120:123], a[140:143], a[88:91], v[120:123]
  ds_read_b64_tr_b16 a[166:167], v10 offset:14336
  v_mfma_f32_16x16x32_bf16 v[152:155], a[140:143], a[92:95], v[152:155]
  v_mfma_f32_16x16x32_bf16 v[152:155], a[136:139], a[76:79], v[152:155]
  s_waitcnt lgkmcnt(4)
  v_mfma_f32_16x16x32_bf16 v[60:63], a[144:147], a[64:67], v[60:63]
  ds_read_b64_tr_b16 a[168:169], v11 offset:8192
  v_mfma_f32_16x16x32_bf16 v[60:63], a[148:151], a[80:83], v[60:63]
  ds_read_b64_tr_b16 a[170:171], v11 offset:10240
  v_mfma_f32_16x16x32_bf16 v[92:95], a[148:151], a[84:87], v[92:95]
  buffer_load_dwordx4 a[44:47], v25, s[20:23], s39 offen offset:3072 sc1
  v_mfma_f32_16x16x32_bf16 v[92:95], a[144:147], a[68:71], v[92:95]
  v_mfma_f32_16x16x32_bf16 v[124:127], a[144:147], a[72:75], v[124:127]
  ds_read_b64_tr_b16 a[172:173], v11 offset:12288
  v_mfma_f32_16x16x32_bf16 v[124:127], a[148:151], a[88:91], v[124:127]
  s_mov_b32 s39, 45056
  ds_read_b64_tr_b16 a[174:175], v11 offset:14336
  v_mfma_f32_16x16x32_bf16 v[156:159], a[148:151], a[92:95], v[156:159]
  buffer_load_dwordx4 a[48:51], v25, s[20:23], s39 offen offset:0 sc1
  v_mfma_f32_16x16x32_bf16 v[156:159], a[144:147], a[76:79], v[156:159]
  v_mfma_f32_16x16x32_bf16 v[64:67], a[152:155], a[64:67], v[64:67]
  ds_read_b64_tr_b16 a[176:177], v12 offset:8192
  v_mfma_f32_16x16x32_bf16 v[64:67], a[156:159], a[80:83], v[64:67]
  ds_read_b64_tr_b16 a[178:179], v12 offset:10240
  v_mfma_f32_16x16x32_bf16 v[96:99], a[156:159], a[84:87], v[96:99]
  v_mfma_f32_16x16x32_bf16 v[96:99], a[152:155], a[68:71], v[96:99]
  buffer_load_dwordx4 a[52:55], v25, s[20:23], s39 offen offset:1024 sc1
  v_mfma_f32_16x16x32_bf16 v[128:131], a[152:155], a[72:75], v[128:131]
  ds_read_b64_tr_b16 a[180:181], v12 offset:12288
  v_mfma_f32_16x16x32_bf16 v[128:131], a[156:159], a[88:91], v[128:131]
  ds_read_b64_tr_b16 a[182:183], v12 offset:14336
  v_mfma_f32_16x16x32_bf16 v[160:163], a[156:159], a[92:95], v[160:163]
  v_mfma_f32_16x16x32_bf16 v[160:163], a[152:155], a[76:79], v[160:163]
  s_waitcnt lgkmcnt(4)
  v_mfma_f32_16x16x32_bf16 v[68:71], a[160:163], a[64:67], v[68:71]
  ds_read_b64_tr_b16 a[184:185], v13 offset:8192
  v_mfma_f32_16x16x32_bf16 v[68:71], a[164:167], a[80:83], v[68:71]
  ds_read_b64_tr_b16 a[186:187], v13 offset:10240
  v_mfma_f32_16x16x32_bf16 v[100:103], a[164:167], a[84:87], v[100:103]
  buffer_load_dwordx4 a[56:59], v25, s[20:23], s39 offen offset:2048 sc1
  v_mfma_f32_16x16x32_bf16 v[100:103], a[160:163], a[68:71], v[100:103]
  v_mfma_f32_16x16x32_bf16 v[132:135], a[160:163], a[72:75], v[132:135]
  ds_read_b64_tr_b16 a[188:189], v13 offset:12288
  v_mfma_f32_16x16x32_bf16 v[132:135], a[164:167], a[88:91], v[132:135]
  ds_read_b64_tr_b16 a[190:191], v13 offset:14336
  v_mfma_f32_16x16x32_bf16 v[164:167], a[164:167], a[92:95], v[164:167]
  buffer_load_dwordx4 a[60:63], v25, s[20:23], s39 offen offset:3072 sc1
  v_mfma_f32_16x16x32_bf16 v[164:167], a[160:163], a[76:79], v[164:167]
  s_waitcnt vmcnt(24)
  v_mfma_f32_16x16x32_bf16 v[72:75], a[168:171], a[64:67], v[72:75]
  s_barrier
  ds_read_b64_tr_b16 a[128:129], v14 offset:32768
  v_mfma_f32_16x16x32_bf16 v[72:75], a[172:175], a[80:83], v[72:75]
  s_mov_b32 s38, 3145728
  ds_read_b64_tr_b16 a[130:131], v14 offset:34816
  v_mfma_f32_16x16x32_bf16 v[104:107], a[172:175], a[84:87], v[104:107]
  s_add_u32 m0, s29, 98304
  v_mfma_f32_16x16x32_bf16 v[104:107], a[168:171], a[68:71], v[104:107]
  buffer_load_dwordx4 v24, s[16:19], s38 offen lds
  v_mfma_f32_16x16x32_bf16 v[136:139], a[168:171], a[72:75], v[136:139]
  ds_read_b64_tr_b16 a[132:133], v14 offset:36864
  v_mfma_f32_16x16x32_bf16 v[136:139], a[172:175], a[88:91], v[136:139]
  ds_read_b64_tr_b16 a[134:135], v14 offset:38912
  v_mfma_f32_16x16x32_bf16 v[168:171], a[172:175], a[92:95], v[168:171]
  v_mfma_f32_16x16x32_bf16 v[168:171], a[168:171], a[76:79], v[168:171]
  s_waitcnt lgkmcnt(4)
  v_mfma_f32_16x16x32_bf16 v[76:79], a[176:179], a[64:67], v[76:79]
  s_mov_b32 s38, 3145728
  ds_read_b64_tr_b16 a[136:137], v15 offset:32768
  v_mfma_f32_16x16x32_bf16 v[76:79], a[180:183], a[80:83], v[76:79]
  s_add_u32 m0, s29, 106368
  ds_read_b64_tr_b16 a[138:139], v15 offset:34816
  v_mfma_f32_16x16x32_bf16 v[108:111], a[180:183], a[84:87], v[108:111]
  buffer_load_dwordx4 v24, s[16:19], s38 offen offset:128 lds
  v_mfma_f32_16x16x32_bf16 v[108:111], a[176:179], a[68:71], v[108:111]
  v_mfma_f32_16x16x32_bf16 v[140:143], a[176:179], a[72:75], v[140:143]
  s_mov_b32 s38, 3407872
  ds_read_b64_tr_b16 a[140:141], v15 offset:36864
  v_mfma_f32_16x16x32_bf16 v[140:143], a[180:183], a[88:91], v[140:143]
  s_add_u32 m0, s29, 102400
  ds_read_b64_tr_b16 a[142:143], v15 offset:38912
  v_mfma_f32_16x16x32_bf16 v[172:175], a[180:183], a[92:95], v[172:175]
  buffer_load_dwordx4 v24, s[16:19], s38 offen lds
  v_mfma_f32_16x16x32_bf16 v[172:175], a[176:179], a[76:79], v[172:175]
  v_mfma_f32_16x16x32_bf16 v[80:83], a[184:187], a[64:67], v[80:83]
  s_mov_b32 s38, 3407872
  ds_read_b64_tr_b16 a[144:145], v16 offset:32768
  v_mfma_f32_16x16x32_bf16 v[80:83], a[188:191], a[80:83], v[80:83]
  s_add_u32 m0, s29, 110464
  ds_read_b64_tr_b16 a[146:147], v16 offset:34816
  v_mfma_f32_16x16x32_bf16 v[112:115], a[188:191], a[84:87], v[112:115]
  buffer_load_dwordx4 v24, s[16:19], s38 offen offset:128 lds
  v_mfma_f32_16x16x32_bf16 v[112:115], a[184:187], a[68:71], v[112:115]
  v_mfma_f32_16x16x32_bf16 v[144:147], a[184:187], a[72:75], v[144:147]
  ds_read_b64_tr_b16 a[148:149], v16 offset:36864
  v_mfma_f32_16x16x32_bf16 v[144:147], a[188:191], a[88:91], v[144:147]
  ds_read_b64_tr_b16 a[150:151], v16 offset:38912
  v_mfma_f32_16x16x32_bf16 v[176:179], a[188:191], a[92:95], v[176:179]
  v_mfma_f32_16x16x32_bf16 v[176:179], a[184:187], a[76:79], v[176:179]
  s_waitcnt lgkmcnt(4)
  v_mfma_f32_16x16x32_bf16 v[52:55], a[128:131], a[96:99], v[52:55]
  ds_read_b64_tr_b16 a[152:153], v17 offset:32768
  v_mfma_f32_16x16x32_bf16 v[52:55], a[132:135], a[112:115], v[52:55]
  s_mov_b32 s39, 49152
  ds_read_b64_tr_b16 a[154:155], v17 offset:34816
  v_mfma_f32_16x16x32_bf16 v[84:87], a[132:135], a[116:119], v[84:87]
  buffer_load_dwordx4 a[64:67], v25, s[20:23], s39 offen offset:0 sc1
  v_mfma_f32_16x16x32_bf16 v[84:87], a[128:131], a[100:103], v[84:87]
  v_mfma_f32_16x16x32_bf16 v[116:119], a[128:131], a[104:107], v[116:119]
  ds_read_b64_tr_b16 a[156:157], v17 offset:36864
  v_mfma_f32_16x16x32_bf16 v[116:119], a[132:135], a[120:123], v[116:119]
  ds_read_b64_tr_b16 a[158:159], v17 offset:38912
  v_mfma_f32_16x16x32_bf16 v[148:151], a[132:135], a[124:127], v[148:151]
  buffer_load_dwordx4 a[68:71], v25, s[20:23], s39 offen offset:1024 sc1
  v_mfma_f32_16x16x32_bf16 v[148:151], a[128:131], a[108:111], v[148:151]
  v_mfma_f32_16x16x32_bf16 v[56:59], a[136:139], a[96:99], v[56:59]
  ds_read_b64_tr_b16 a[160:161], v14 offset:40960
  v_mfma_f32_16x16x32_bf16 v[56:59], a[140:143], a[112:115], v[56:59]
  ds_read_b64_tr_b16 a[162:163], v14 offset:43008
  v_mfma_f32_16x16x32_bf16 v[88:91], a[140:143], a[116:119], v[88:91]
  v_mfma_f32_16x16x32_bf16 v[88:91], a[136:139], a[100:103], v[88:91]
  buffer_load_dwordx4 a[72:75], v25, s[20:23], s39 offen offset:2048 sc1
  v_mfma_f32_16x16x32_bf16 v[120:123], a[136:139], a[104:107], v[120:123]
  ds_read_b64_tr_b16 a[164:165], v14 offset:45056
  v_mfma_f32_16x16x32_bf16 v[120:123], a[140:143], a[120:123], v[120:123]
  ds_read_b64_tr_b16 a[166:167], v14 offset:47104
  v_mfma_f32_16x16x32_bf16 v[152:155], a[140:143], a[124:127], v[152:155]
  v_mfma_f32_16x16x32_bf16 v[152:155], a[136:139], a[108:111], v[152:155]
  s_waitcnt lgkmcnt(4)
  v_mfma_f32_16x16x32_bf16 v[60:63], a[144:147], a[96:99], v[60:63]
  ds_read_b64_tr_b16 a[168:169], v15 offset:40960
  v_mfma_f32_16x16x32_bf16 v[60:63], a[148:151], a[112:115], v[60:63]
  ds_read_b64_tr_b16 a[170:171], v15 offset:43008
  v_mfma_f32_16x16x32_bf16 v[92:95], a[148:151], a[116:119], v[92:95]
  buffer_load_dwordx4 a[76:79], v25, s[20:23], s39 offen offset:3072 sc1
  v_mfma_f32_16x16x32_bf16 v[92:95], a[144:147], a[100:103], v[92:95]
  v_mfma_f32_16x16x32_bf16 v[124:127], a[144:147], a[104:107], v[124:127]
  ds_read_b64_tr_b16 a[172:173], v15 offset:45056
  v_mfma_f32_16x16x32_bf16 v[124:127], a[148:151], a[120:123], v[124:127]
  s_mov_b32 s39, 53248
  ds_read_b64_tr_b16 a[174:175], v15 offset:47104
  v_mfma_f32_16x16x32_bf16 v[156:159], a[148:151], a[124:127], v[156:159]
  buffer_load_dwordx4 a[80:83], v25, s[20:23], s39 offen offset:0 sc1
  v_mfma_f32_16x16x32_bf16 v[156:159], a[144:147], a[108:111], v[156:159]
  v_mfma_f32_16x16x32_bf16 v[64:67], a[152:155], a[96:99], v[64:67]
  ds_read_b64_tr_b16 a[176:177], v16 offset:40960
  v_mfma_f32_16x16x32_bf16 v[64:67], a[156:159], a[112:115], v[64:67]
  ds_read_b64_tr_b16 a[178:179], v16 offset:43008
  v_mfma_f32_16x16x32_bf16 v[96:99], a[156:159], a[116:119], v[96:99]
  v_mfma_f32_16x16x32_bf16 v[96:99], a[152:155], a[100:103], v[96:99]
  buffer_load_dwordx4 a[84:87], v25, s[20:23], s39 offen offset:1024 sc1
  v_mfma_f32_16x16x32_bf16 v[128:131], a[152:155], a[104:107], v[128:131]
  ds_read_b64_tr_b16 a[180:181], v16 offset:45056
  v_mfma_f32_16x16x32_bf16 v[128:131], a[156:159], a[120:123], v[128:131]
  ds_read_b64_tr_b16 a[182:183], v16 offset:47104
  v_mfma_f32_16x16x32_bf16 v[160:163], a[156:159], a[124:127], v[160:163]
  v_mfma_f32_16x16x32_bf16 v[160:163], a[152:155], a[108:111], v[160:163]
  s_waitcnt lgkmcnt(4)
  v_mfma_f32_16x16x32_bf16 v[68:71], a[160:163], a[96:99], v[68:71]
  ds_read_b64_tr_b16 a[184:185], v17 offset:40960
  v_mfma_f32_16x16x32_bf16 v[68:71], a[164:167], a[112:115], v[68:71]
  ds_read_b64_tr_b16 a[186:187], v17 offset:43008
  v_mfma_f32_16x16x32_bf16 v[100:103], a[164:167], a[116:119], v[100:103]
  buffer_load_dwordx4 a[88:91], v25, s[20:23], s39 offen offset:2048 sc1
  v_mfma_f32_16x16x32_bf16 v[100:103], a[160:163], a[100:103], v[100:103]
  v_mfma_f32_16x16x32_bf16 v[132:135], a[160:163], a[104:107], v[132:135]
  ds_read_b64_tr_b16 a[188:189], v17 offset:45056
  v_mfma_f32_16x16x32_bf16 v[132:135], a[164:167], a[120:123], v[132:135]
  ds_read_b64_tr_b16 a[190:191], v17 offset:47104
  v_mfma_f32_16x16x32_bf16 v[164:167], a[164:167], a[124:127], v[164:167]
  buffer_load_dwordx4 a[92:95], v25, s[20:23], s39 offen offset:3072 sc1
  v_mfma_f32_16x16x32_bf16 v[164:167], a[160:163], a[108:111], v[164:167]
  s_waitcnt vmcnt(24)
  v_mfma_f32_16x16x32_bf16 v[72:75], a[168:171], a[96:99], v[72:75]
  s_barrier
  ds_read_b64_tr_b16 a[128:129], v10 offset:16384
  v_mfma_f32_16x16x32_bf16 v[72:75], a[172:175], a[112:115], v[72:75]
  s_mov_b32 s38, 3670016
  ds_read_b64_tr_b16 a[130:131], v10 offset:18432
  v_mfma_f32_16x16x32_bf16 v[104:107], a[172:175], a[116:119], v[104:107]
  s_add_u32 m0, s29, 114688
  v_mfma_f32_16x16x32_bf16 v[104:107], a[168:171], a[100:103], v[104:107]
  buffer_load_dwordx4 v24, s[16:19], s38 offen lds
  v_mfma_f32_16x16x32_bf16 v[136:139], a[168:171], a[104:107], v[136:139]
  ds_read_b64_tr_b16 a[132:133], v10 offset:20480
  v_mfma_f32_16x16x32_bf16 v[136:139], a[172:175], a[120:123], v[136:139]
  ds_read_b64_tr_b16 a[134:135], v10 offset:22528
  v_mfma_f32_16x16x32_bf16 v[168:171], a[172:175], a[124:127], v[168:171]
  v_mfma_f32_16x16x32_bf16 v[168:171], a[168:171], a[108:111], v[168:171]
  s_waitcnt lgkmcnt(4)
  v_mfma_f32_16x16x32_bf16 v[76:79], a[176:179], a[96:99], v[76:79]
  s_mov_b32 s38, 3670016
  ds_read_b64_tr_b16 a[136:137], v11 offset:16384
  v_mfma_f32_16x16x32_bf16 v[76:79], a[180:183], a[112:115], v[76:79]
  s_add_u32 m0, s29, 122752
  ds_read_b64_tr_b16 a[138:139], v11 offset:18432
  v_mfma_f32_16x16x32_bf16 v[108:111], a[180:183], a[116:119], v[108:111]
  buffer_load_dwordx4 v24, s[16:19], s38 offen offset:128 lds
  v_mfma_f32_16x16x32_bf16 v[108:111], a[176:179], a[100:103], v[108:111]
  v_mfma_f32_16x16x32_bf16 v[140:143], a[176:179], a[104:107], v[140:143]
  s_mov_b32 s38, 3932160
  ds_read_b64_tr_b16 a[140:141], v11 offset:20480
  v_mfma_f32_16x16x32_bf16 v[140:143], a[180:183], a[120:123], v[140:143]
  s_add_u32 m0, s29, 118784
  ds_read_b64_tr_b16 a[142:143], v11 offset:22528
  v_mfma_f32_16x16x32_bf16 v[172:175], a[180:183], a[124:127], v[172:175]
  buffer_load_dwordx4 v24, s[16:19], s38 offen lds
  v_mfma_f32_16x16x32_bf16 v[172:175], a[176:179], a[108:111], v[172:175]
  v_mfma_f32_16x16x32_bf16 v[80:83], a[184:187], a[96:99], v[80:83]
  s_mov_b32 s38, 3932160
  ds_read_b64_tr_b16 a[144:145], v12 offset:16384
  v_mfma_f32_16x16x32_bf16 v[80:83], a[188:191], a[112:115], v[80:83]
  s_add_u32 m0, s29, 126848
  ds_read_b64_tr_b16 a[146:147], v12 offset:18432
  v_mfma_f32_16x16x32_bf16 v[112:115], a[188:191], a[116:119], v[112:115]
  buffer_load_dwordx4 v24, s[16:19], s38 offen offset:128 lds
  v_mfma_f32_16x16x32_bf16 v[112:115], a[184:187], a[100:103], v[112:115]
  v_mfma_f32_16x16x32_bf16 v[144:147], a[184:187], a[104:107], v[144:147]
  ds_read_b64_tr_b16 a[148:149], v12 offset:20480
  v_mfma_f32_16x16x32_bf16 v[144:147], a[188:191], a[120:123], v[144:147]
  ds_read_b64_tr_b16 a[150:151], v12 offset:22528
  v_mfma_f32_16x16x32_bf16 v[176:179], a[188:191], a[124:127], v[176:179]
  v_mfma_f32_16x16x32_bf16 v[176:179], a[184:187], a[108:111], v[176:179]
  s_waitcnt lgkmcnt(4)
  v_mfma_f32_16x16x32_bf16 v[52:55], a[128:131], a[0:3], v[52:55]
  ds_read_b64_tr_b16 a[152:153], v13 offset:16384
  v_mfma_f32_16x16x32_bf16 v[52:55], a[132:135], a[16:19], v[52:55]
  s_mov_b32 s39, 57344
  ds_read_b64_tr_b16 a[154:155], v13 offset:18432
  v_mfma_f32_16x16x32_bf16 v[84:87], a[132:135], a[20:23], v[84:87]
  buffer_load_dwordx4 a[96:99], v25, s[20:23], s39 offen offset:0 sc1
  v_mfma_f32_16x16x32_bf16 v[84:87], a[128:131], a[4:7], v[84:87]
  v_mfma_f32_16x16x32_bf16 v[116:119], a[128:131], a[8:11], v[116:119]
  ds_read_b64_tr_b16 a[156:157], v13 offset:20480
  v_mfma_f32_16x16x32_bf16 v[116:119], a[132:135], a[24:27], v[116:119]
  ds_read_b64_tr_b16 a[158:159], v13 offset:22528
  v_mfma_f32_16x16x32_bf16 v[148:151], a[132:135], a[28:31], v[148:151]
  buffer_load_dwordx4 a[100:103], v25, s[20:23], s39 offen offset:1024 sc1
  v_mfma_f32_16x16x32_bf16 v[148:151], a[128:131], a[12:15], v[148:151]
  v_mfma_f32_16x16x32_bf16 v[56:59], a[136:139], a[0:3], v[56:59]
  ds_read_b64_tr_b16 a[160:161], v10 offset:24576
  v_mfma_f32_16x16x32_bf16 v[56:59], a[140:143], a[16:19], v[56:59]
  ds_read_b64_tr_b16 a[162:163], v10 offset:26624
  v_mfma_f32_16x16x32_bf16 v[88:91], a[140:143], a[20:23], v[88:91]
  v_mfma_f32_16x16x32_bf16 v[88:91], a[136:139], a[4:7], v[88:91]
  buffer_load_dwordx4 a[104:107], v25, s[20:23], s39 offen offset:2048 sc1
  v_mfma_f32_16x16x32_bf16 v[120:123], a[136:139], a[8:11], v[120:123]
  ds_read_b64_tr_b16 a[164:165], v10 offset:28672
  v_mfma_f32_16x16x32_bf16 v[120:123], a[140:143], a[24:27], v[120:123]
  ds_read_b64_tr_b16 a[166:167], v10 offset:30720
  v_mfma_f32_16x16x32_bf16 v[152:155], a[140:143], a[28:31], v[152:155]
  v_mfma_f32_16x16x32_bf16 v[152:155], a[136:139], a[12:15], v[152:155]
  s_waitcnt lgkmcnt(4)
  v_mfma_f32_16x16x32_bf16 v[60:63], a[144:147], a[0:3], v[60:63]
  ds_read_b64_tr_b16 a[168:169], v11 offset:24576
  v_mfma_f32_16x16x32_bf16 v[60:63], a[148:151], a[16:19], v[60:63]
  ds_read_b64_tr_b16 a[170:171], v11 offset:26624
  v_mfma_f32_16x16x32_bf16 v[92:95], a[148:151], a[20:23], v[92:95]
  buffer_load_dwordx4 a[108:111], v25, s[20:23], s39 offen offset:3072 sc1
  v_mfma_f32_16x16x32_bf16 v[92:95], a[144:147], a[4:7], v[92:95]
  v_mfma_f32_16x16x32_bf16 v[124:127], a[144:147], a[8:11], v[124:127]
  ds_read_b64_tr_b16 a[172:173], v11 offset:28672
  v_mfma_f32_16x16x32_bf16 v[124:127], a[148:151], a[24:27], v[124:127]
  s_mov_b32 s39, 61440
  ds_read_b64_tr_b16 a[174:175], v11 offset:30720
  v_mfma_f32_16x16x32_bf16 v[156:159], a[148:151], a[28:31], v[156:159]
  buffer_load_dwordx4 a[112:115], v25, s[20:23], s39 offen offset:0 sc1
  v_mfma_f32_16x16x32_bf16 v[156:159], a[144:147], a[12:15], v[156:159]
  v_mfma_f32_16x16x32_bf16 v[64:67], a[152:155], a[0:3], v[64:67]
  ds_read_b64_tr_b16 a[176:177], v12 offset:24576
  v_mfma_f32_16x16x32_bf16 v[64:67], a[156:159], a[16:19], v[64:67]
  ds_read_b64_tr_b16 a[178:179], v12 offset:26624
  v_mfma_f32_16x16x32_bf16 v[96:99], a[156:159], a[20:23], v[96:99]
  v_mfma_f32_16x16x32_bf16 v[96:99], a[152:155], a[4:7], v[96:99]
  buffer_load_dwordx4 a[116:119], v25, s[20:23], s39 offen offset:1024 sc1
  v_mfma_f32_16x16x32_bf16 v[128:131], a[152:155], a[8:11], v[128:131]
  ds_read_b64_tr_b16 a[180:181], v12 offset:28672
  v_mfma_f32_16x16x32_bf16 v[128:131], a[156:159], a[24:27], v[128:131]
  ds_read_b64_tr_b16 a[182:183], v12 offset:30720
  v_mfma_f32_16x16x32_bf16 v[160:163], a[156:159], a[28:31], v[160:163]
  v_mfma_f32_16x16x32_bf16 v[160:163], a[152:155], a[12:15], v[160:163]
  s_waitcnt lgkmcnt(4)
  v_mfma_f32_16x16x32_bf16 v[68:71], a[160:163], a[0:3], v[68:71]
  ds_read_b64_tr_b16 a[184:185], v13 offset:24576
  v_mfma_f32_16x16x32_bf16 v[68:71], a[164:167], a[16:19], v[68:71]
  ds_read_b64_tr_b16 a[186:187], v13 offset:26624
  v_mfma_f32_16x16x32_bf16 v[100:103], a[164:167], a[20:23], v[100:103]
  buffer_load_dwordx4 a[120:123], v25, s[20:23], s39 offen offset:2048 sc1
  v_mfma_f32_16x16x32_bf16 v[100:103], a[160:163], a[4:7], v[100:103]
  v_mfma_f32_16x16x32_bf16 v[132:135], a[160:163], a[8:11], v[132:135]
  ds_read_b64_tr_b16 a[188:189], v13 offset:28672
  v_mfma_f32_16x16x32_bf16 v[132:135], a[164:167], a[24:27], v[132:135]
  ds_read_b64_tr_b16 a[190:191], v13 offset:30720
  v_mfma_f32_16x16x32_bf16 v[164:167], a[164:167], a[28:31], v[164:167]
  buffer_load_dwordx4 a[124:127], v25, s[20:23], s39 offen offset:3072 sc1
  v_mfma_f32_16x16x32_bf16 v[164:167], a[160:163], a[12:15], v[164:167]
  s_waitcnt vmcnt(24)
  v_mfma_f32_16x16x32_bf16 v[72:75], a[168:171], a[0:3], v[72:75]
  s_barrier
  ds_read_b64_tr_b16 a[128:129], v14 offset:49152
  v_mfma_f32_16x16x32_bf16 v[72:75], a[172:175], a[16:19], v[72:75]
  s_mov_b32 s38, 4194304
  ds_read_b64_tr_b16 a[130:131], v14 offset:51200
  v_mfma_f32_16x16x32_bf16 v[104:107], a[172:175], a[20:23], v[104:107]
  s_add_u32 m0, s29, 131072
  v_mfma_f32_16x16x32_bf16 v[104:107], a[168:171], a[4:7], v[104:107]
  buffer_load_dwordx4 v24, s[16:19], s38 offen lds
  v_mfma_f32_16x16x32_bf16 v[136:139], a[168:171], a[8:11], v[136:139]
  ds_read_b64_tr_b16 a[132:133], v14 offset:53248
  v_mfma_f32_16x16x32_bf16 v[136:139], a[172:175], a[24:27], v[136:139]
  ds_read_b64_tr_b16 a[134:135], v14 offset:55296
  v_mfma_f32_16x16x32_bf16 v[168:171], a[172:175], a[28:31], v[168:171]
  v_mfma_f32_16x16x32_bf16 v[168:171], a[168:171], a[12:15], v[168:171]
  s_waitcnt lgkmcnt(4)
  v_mfma_f32_16x16x32_bf16 v[76:79], a[176:179], a[0:3], v[76:79]
  s_mov_b32 s38, 4194304
  ds_read_b64_tr_b16 a[136:137], v15 offset:49152
  v_mfma_f32_16x16x32_bf16 v[76:79], a[180:183], a[16:19], v[76:79]
  s_add_u32 m0, s29, 139136
  ds_read_b64_tr_b16 a[138:139], v15 offset:51200
  v_mfma_f32_16x16x32_bf16 v[108:111], a[180:183], a[20:23], v[108:111]
  buffer_load_dwordx4 v24, s[16:19], s38 offen offset:128 lds
  v_mfma_f32_16x16x32_bf16 v[108:111], a[176:179], a[4:7], v[108:111]
  v_mfma_f32_16x16x32_bf16 v[140:143], a[176:179], a[8:11], v[140:143]
  s_mov_b32 s38, 4456448
  ds_read_b64_tr_b16 a[140:141], v15 offset:53248
  v_mfma_f32_16x16x32_bf16 v[140:143], a[180:183], a[24:27], v[140:143]
  s_add_u32 m0, s29, 135168
  ds_read_b64_tr_b16 a[142:143], v15 offset:55296
  v_mfma_f32_16x16x32_bf16 v[172:175], a[180:183], a[28:31], v[172:175]
  buffer_load_dwordx4 v24, s[16:19], s38 offen lds
  v_mfma_f32_16x16x32_bf16 v[172:175], a[176:179], a[12:15], v[172:175]
  v_mfma_f32_16x16x32_bf16 v[80:83], a[184:187], a[0:3], v[80:83]
  s_mov_b32 s38, 4456448
  ds_read_b64_tr_b16 a[144:145], v16 offset:49152
  v_mfma_f32_16x16x32_bf16 v[80:83], a[188:191], a[16:19], v[80:83]
  s_add_u32 m0, s29, 143232
  ds_read_b64_tr_b16 a[146:147], v16 offset:51200
  v_mfma_f32_16x16x32_bf16 v[112:115], a[188:191], a[20:23], v[112:115]
  buffer_load_dwordx4 v24, s[16:19], s38 offen offset:128 lds
  v_mfma_f32_16x16x32_bf16 v[112:115], a[184:187], a[4:7], v[112:115]
  v_mfma_f32_16x16x32_bf16 v[144:147], a[184:187], a[8:11], v[144:147]
  ds_read_b64_tr_b16 a[148:149], v16 offset:53248
  v_mfma_f32_16x16x32_bf16 v[144:147], a[188:191], a[24:27], v[144:147]
  ds_read_b64_tr_b16 a[150:151], v16 offset:55296
  v_mfma_f32_16x16x32_bf16 v[176:179], a[188:191], a[28:31], v[176:179]
  v_mfma_f32_16x16x32_bf16 v[176:179], a[184:187], a[12:15], v[176:179]
  s_waitcnt lgkmcnt(4)
  v_mfma_f32_16x16x32_bf16 v[52:55], a[128:131], a[32:35], v[52:55]
  ds_read_b64_tr_b16 a[152:153], v17 offset:49152
  v_mfma_f32_16x16x32_bf16 v[52:55], a[132:135], a[48:51], v[52:55]
  s_mov_b32 s39, 65536
  ds_read_b64_tr_b16 a[154:155], v17 offset:51200
  v_mfma_f32_16x16x32_bf16 v[84:87], a[132:135], a[52:55], v[84:87]
  buffer_load_dwordx4 a[0:3], v25, s[20:23], s39 offen offset:0 sc1
  v_mfma_f32_16x16x32_bf16 v[84:87], a[128:131], a[36:39], v[84:87]
  v_mfma_f32_16x16x32_bf16 v[116:119], a[128:131], a[40:43], v[116:119]
  ds_read_b64_tr_b16 a[156:157], v17 offset:53248
  v_mfma_f32_16x16x32_bf16 v[116:119], a[132:135], a[56:59], v[116:119]
  ds_read_b64_tr_b16 a[158:159], v17 offset:55296
  v_mfma_f32_16x16x32_bf16 v[148:151], a[132:135], a[60:63], v[148:151]
  buffer_load_dwordx4 a[4:7], v25, s[20:23], s39 offen offset:1024 sc1
  v_mfma_f32_16x16x32_bf16 v[148:151], a[128:131], a[44:47], v[148:151]
  v_mfma_f32_16x16x32_bf16 v[56:59], a[136:139], a[32:35], v[56:59]
  ds_read_b64_tr_b16 a[160:161], v14 offset:57344
  v_mfma_f32_16x16x32_bf16 v[56:59], a[140:143], a[48:51], v[56:59]
  ds_read_b64_tr_b16 a[162:163], v14 offset:59392
  v_mfma_f32_16x16x32_bf16 v[88:91], a[140:143], a[52:55], v[88:91]
  buffer_load_dwordx4 a[8:11], v25, s[20:23], s39 offen offset:2048 sc1
  v_mfma_f32_16x16x32_bf16 v[88:91], a[136:139], a[36:39], v[88:91]
  v_mfma_f32_16x16x32_bf16 v[120:123], a[136:139], a[40:43], v[120:123]
  ds_read_b64_tr_b16 a[164:165], v14 offset:61440
  v_mfma_f32_16x16x32_bf16 v[120:123], a[140:143], a[56:59], v[120:123]
  ds_read_b64_tr_b16 a[166:167], v14 offset:63488
  v_mfma_f32_16x16x32_bf16 v[152:155], a[140:143], a[60:63], v[152:155]
  buffer_load_dwordx4 a[12:15], v25, s[20:23], s39 offen offset:3072 sc1
  v_mfma_f32_16x16x32_bf16 v[152:155], a[136:139], a[44:47], v[152:155]
  s_waitcnt lgkmcnt(4)
  v_mfma_f32_16x16x32_bf16 v[60:63], a[144:147], a[32:35], v[60:63]
  ds_read_b64_tr_b16 a[168:169], v15 offset:57344
  v_mfma_f32_16x16x32_bf16 v[60:63], a[148:151], a[48:51], v[60:63]
  s_mov_b32 s39, 69632
  ds_read_b64_tr_b16 a[170:171], v15 offset:59392
  v_mfma_f32_16x16x32_bf16 v[92:95], a[148:151], a[52:55], v[92:95]
  buffer_load_dwordx4 a[16:19], v25, s[20:23], s39 offen offset:0 sc1
  v_mfma_f32_16x16x32_bf16 v[92:95], a[144:147], a[36:39], v[92:95]
  v_mfma_f32_16x16x32_bf16 v[124:127], a[144:147], a[40:43], v[124:127]
  ds_read_b64_tr_b16 a[172:173], v15 offset:61440
  v_mfma_f32_16x16x32_bf16 v[124:127], a[148:151], a[56:59], v[124:127]
  ds_read_b64_tr_b16 a[174:175], v15 offset:63488
  v_mfma_f32_16x16x32_bf16 v[156:159], a[148:151], a[60:63], v[156:159]
  buffer_load_dwordx4 a[20:23], v25, s[20:23], s39 offen offset:1024 sc1
  v_mfma_f32_16x16x32_bf16 v[156:159], a[144:147], a[44:47], v[156:159]
  v_mfma_f32_16x16x32_bf16 v[64:67], a[152:155], a[32:35], v[64:67]
  ds_read_b64_tr_b16 a[176:177], v16 offset:57344
  v_mfma_f32_16x16x32_bf16 v[64:67], a[156:159], a[48:51], v[64:67]
  ds_read_b64_tr_b16 a[178:179], v16 offset:59392
  v_mfma_f32_16x16x32_bf16 v[96:99], a[156:159], a[52:55], v[96:99]
  buffer_load_dwordx4 a[24:27], v25, s[20:23], s39 offen offset:2048 sc1
  v_mfma_f32_16x16x32_bf16 v[96:99], a[152:155], a[36:39], v[96:99]
  v_mfma_f32_16x16x32_bf16 v[128:131], a[152:155], a[40:43], v[128:131]
  ds_read_b64_tr_b16 a[180:181], v16 offset:61440
  v_mfma_f32_16x16x32_bf16 v[128:131], a[156:159], a[56:59], v[128:131]
  ds_read_b64_tr_b16 a[182:183], v16 offset:63488
  v_mfma_f32_16x16x32_bf16 v[160:163], a[156:159], a[60:63], v[160:163]
  buffer_load_dwordx4 a[28:31], v25, s[20:23], s39 offen offset:3072 sc1
  v_mfma_f32_16x16x32_bf16 v[160:163], a[152:155], a[44:47], v[160:163]
  s_waitcnt lgkmcnt(4)
  v_mfma_f32_16x16x32_bf16 v[68:71], a[160:163], a[32:35], v[68:71]
  s_mov_b32 s38, 4718592
  ds_read_b64_tr_b16 a[184:185], v17 offset:57344
  v_mfma_f32_16x16x32_bf16 v[68:71], a[164:167], a[48:51], v[68:71]
  s_add_u32 m0, s29, 147456
  ds_read_b64_tr_b16 a[186:187], v17 offset:59392
  v_mfma_f32_16x16x32_bf16 v[100:103], a[164:167], a[52:55], v[100:103]
  buffer_load_dwordx4 v24, s[16:19], s38 offen lds
  v_mfma_f32_16x16x32_bf16 v[100:103], a[160:163], a[36:39], v[100:103]
  v_mfma_f32_16x16x32_bf16 v[132:135], a[160:163], a[40:43], v[132:135]
  s_mov_b32 s38, 4718592
  ds_read_b64_tr_b16 a[188:189], v17 offset:61440
  v_mfma_f32_16x16x32_bf16 v[132:135], a[164:167], a[56:59], v[132:135]
  s_add_u32 m0, s29, 155520
  ds_read_b64_tr_b16 a[190:191], v17 offset:63488
  v_mfma_f32_16x16x32_bf16 v[164:167], a[164:167], a[60:63], v[164:167]
  buffer_load_dwordx4 v24, s[16:19], s38 offen offset:128 lds
  v_mfma_f32_16x16x32_bf16 v[164:167], a[160:163], a[44:47], v[164:167]
  s_waitcnt vmcnt(26)
  v_mfma_f32_16x16x32_bf16 v[72:75], a[168:171], a[32:35], v[72:75]
  s_barrier
  ds_read_b64_tr_b16 a[128:129], v10 offset:32768
  v_mfma_f32_16x16x32_bf16 v[72:75], a[172:175], a[48:51], v[72:75]
  s_add_u32 m0, s29, 151552
  s_mov_b32 s38, 4980736
  ds_read_b64_tr_b16 a[130:131], v10 offset:34816
  v_mfma_f32_16x16x32_bf16 v[104:107], a[172:175], a[52:55], v[104:107]
  buffer_load_dwordx4 v24, s[16:19], s38 offen lds
  v_mfma_f32_16x16x32_bf16 v[104:107], a[168:171], a[36:39], v[104:107]
  v_mfma_f32_16x16x32_bf16 v[136:139], a[168:171], a[40:43], v[136:139]
  s_mov_b32 s38, 4980736
  ds_read_b64_tr_b16 a[132:133], v10 offset:36864
  v_mfma_f32_16x16x32_bf16 v[136:139], a[172:175], a[56:59], v[136:139]
  s_add_u32 m0, s29, 159616
  ds_read_b64_tr_b16 a[134:135], v10 offset:38912
  v_mfma_f32_16x16x32_bf16 v[168:171], a[172:175], a[60:63], v[168:171]
  buffer_load_dwordx4 v24, s[16:19], s38 offen offset:128 lds
  v_mfma_f32_16x16x32_bf16 v[168:171], a[168:171], a[44:47], v[168:171]
  s_waitcnt lgkmcnt(4)
  v_mfma_f32_16x16x32_bf16 v[76:79], a[176:179], a[32:35], v[76:79]
  s_mov_b32 s38, 0
  ds_read_b64_tr_b16 a[136:137], v11 offset:32768
  v_mfma_f32_16x16x32_bf16 v[76:79], a[180:183], a[48:51], v[76:79]
  s_add_u32 m0, s29, 0
  ds_read_b64_tr_b16 a[138:139], v11 offset:34816
  v_mfma_f32_16x16x32_bf16 v[108:111], a[180:183], a[52:55], v[108:111]
  buffer_load_dwordx4 v22, s[8:11], s38 offen lds
  v_mfma_f32_16x16x32_bf16 v[108:111], a[176:179], a[36:39], v[108:111]
  v_mfma_f32_16x16x32_bf16 v[140:143], a[176:179], a[40:43], v[140:143]
  s_mov_b32 s38, 0
  ds_read_b64_tr_b16 a[140:141], v11 offset:36864
  v_mfma_f32_16x16x32_bf16 v[140:143], a[180:183], a[56:59], v[140:143]
  s_add_u32 m0, s29, 8064
  ds_read_b64_tr_b16 a[142:143], v11 offset:38912
  v_mfma_f32_16x16x32_bf16 v[172:175], a[180:183], a[60:63], v[172:175]
  buffer_load_dwordx4 v22, s[8:11], s38 offen offset:128 lds
  v_mfma_f32_16x16x32_bf16 v[172:175], a[176:179], a[44:47], v[172:175]
  v_mfma_f32_16x16x32_bf16 v[80:83], a[184:187], a[32:35], v[80:83]
  s_mov_b32 s38, 8192
  ds_read_b64_tr_b16 a[144:145], v12 offset:32768
  v_mfma_f32_16x16x32_bf16 v[80:83], a[188:191], a[48:51], v[80:83]
  s_add_u32 m0, s29, 4096
  ds_read_b64_tr_b16 a[146:147], v12 offset:34816
  v_mfma_f32_16x16x32_bf16 v[112:115], a[188:191], a[52:55], v[112:115]
  buffer_load_dwordx4 v22, s[8:11], s38 offen lds
  v_mfma_f32_16x16x32_bf16 v[112:115], a[184:187], a[36:39], v[112:115]
  v_mfma_f32_16x16x32_bf16 v[144:147], a[184:187], a[40:43], v[144:147]
  s_mov_b32 s38, 8192
  ds_read_b64_tr_b16 a[148:149], v12 offset:36864
  v_mfma_f32_16x16x32_bf16 v[144:147], a[188:191], a[56:59], v[144:147]
  s_add_u32 m0, s29, 12160
  ds_read_b64_tr_b16 a[150:151], v12 offset:38912
  v_mfma_f32_16x16x32_bf16 v[176:179], a[188:191], a[60:63], v[176:179]
  buffer_load_dwordx4 v22, s[8:11], s38 offen offset:128 lds
  v_mfma_f32_16x16x32_bf16 v[176:179], a[184:187], a[44:47], v[176:179]
  s_waitcnt lgkmcnt(4)
  v_mfma_f32_16x16x32_bf16 v[52:55], a[128:131], a[64:67], v[52:55]
  ds_read_b64_tr_b16 a[152:153], v13 offset:32768
  v_mfma_f32_16x16x32_bf16 v[52:55], a[132:135], a[80:83], v[52:55]
  s_mov_b32 s39, 73728
  ds_read_b64_tr_b16 a[154:155], v13 offset:34816
  v_mfma_f32_16x16x32_bf16 v[84:87], a[132:135], a[84:87], v[84:87]
  buffer_load_dwordx4 a[32:35], v25, s[20:23], s39 offen offset:0 sc1
  v_mfma_f32_16x16x32_bf16 v[84:87], a[128:131], a[68:71], v[84:87]
  v_mfma_f32_16x16x32_bf16 v[116:119], a[128:131], a[72:75], v[116:119]
  ds_read_b64_tr_b16 a[156:157], v13 offset:36864
  v_mfma_f32_16x16x32_bf16 v[116:119], a[132:135], a[88:91], v[116:119]
  ds_read_b64_tr_b16 a[158:159], v13 offset:38912
  v_mfma_f32_16x16x32_bf16 v[148:151], a[132:135], a[92:95], v[148:151]
  buffer_load_dwordx4 a[36:39], v25, s[20:23], s39 offen offset:1024 sc1
  v_mfma_f32_16x16x32_bf16 v[148:151], a[128:131], a[76:79], v[148:151]
  v_mfma_f32_16x16x32_bf16 v[56:59], a[136:139], a[64:67], v[56:59]
  ds_read_b64_tr_b16 a[160:161], v10 offset:40960
  v_mfma_f32_16x16x32_bf16 v[56:59], a[140:143], a[80:83], v[56:59]
  ds_read_b64_tr_b16 a[162:163], v10 offset:43008
  v_mfma_f32_16x16x32_bf16 v[88:91], a[140:143], a[84:87], v[88:91]
  v_mfma_f32_16x16x32_bf16 v[88:91], a[136:139], a[68:71], v[88:91]
  buffer_load_dwordx4 a[40:43], v25, s[20:23], s39 offen offset:2048 sc1
  v_mfma_f32_16x16x32_bf16 v[120:123], a[136:139], a[72:75], v[120:123]
  ds_read_b64_tr_b16 a[164:165], v10 offset:45056
  v_mfma_f32_16x16x32_bf16 v[120:123], a[140:143], a[88:91], v[120:123]
  ds_read_b64_tr_b16 a[166:167], v10 offset:47104
  v_mfma_f32_16x16x32_bf16 v[152:155], a[140:143], a[92:95], v[152:155]
  v_mfma_f32_16x16x32_bf16 v[152:155], a[136:139], a[76:79], v[152:155]
  s_waitcnt lgkmcnt(4)
  v_mfma_f32_16x16x32_bf16 v[60:63], a[144:147], a[64:67], v[60:63]
  ds_read_b64_tr_b16 a[168:169], v11 offset:40960
  v_mfma_f32_16x16x32_bf16 v[60:63], a[148:151], a[80:83], v[60:63]
  ds_read_b64_tr_b16 a[170:171], v11 offset:43008
  v_mfma_f32_16x16x32_bf16 v[92:95], a[148:151], a[84:87], v[92:95]
  buffer_load_dwordx4 a[44:47], v25, s[20:23], s39 offen offset:3072 sc1
  v_mfma_f32_16x16x32_bf16 v[92:95], a[144:147], a[68:71], v[92:95]
  v_mfma_f32_16x16x32_bf16 v[124:127], a[144:147], a[72:75], v[124:127]
  ds_read_b64_tr_b16 a[172:173], v11 offset:45056
  v_mfma_f32_16x16x32_bf16 v[124:127], a[148:151], a[88:91], v[124:127]
  s_mov_b32 s39, 77824
  ds_read_b64_tr_b16 a[174:175], v11 offset:47104
  v_mfma_f32_16x16x32_bf16 v[156:159], a[148:151], a[92:95], v[156:159]
  buffer_load_dwordx4 a[48:51], v25, s[20:23], s39 offen offset:0 sc1
  v_mfma_f32_16x16x32_bf16 v[156:159], a[144:147], a[76:79], v[156:159]
  v_mfma_f32_16x16x32_bf16 v[64:67], a[152:155], a[64:67], v[64:67]
  ds_read_b64_tr_b16 a[176:177], v12 offset:40960
  v_mfma_f32_16x16x32_bf16 v[64:67], a[156:159], a[80:83], v[64:67]
  ds_read_b64_tr_b16 a[178:179], v12 offset:43008
  v_mfma_f32_16x16x32_bf16 v[96:99], a[156:159], a[84:87], v[96:99]
  v_mfma_f32_16x16x32_bf16 v[96:99], a[152:155], a[68:71], v[96:99]
  buffer_load_dwordx4 a[52:55], v25, s[20:23], s39 offen offset:1024 sc1
  v_mfma_f32_16x16x32_bf16 v[128:131], a[152:155], a[72:75], v[128:131]
  ds_read_b64_tr_b16 a[180:181], v12 offset:45056
  v_mfma_f32_16x16x32_bf16 v[128:131], a[156:159], a[88:91], v[128:131]
  ds_read_b64_tr_b16 a[182:183], v12 offset:47104
  v_mfma_f32_16x16x32_bf16 v[160:163], a[156:159], a[92:95], v[160:163]
  v_mfma_f32_16x16x32_bf16 v[160:163], a[152:155], a[76:79], v[160:163]
  s_waitcnt lgkmcnt(4)
  v_mfma_f32_16x16x32_bf16 v[68:71], a[160:163], a[64:67], v[68:71]
  ds_read_b64_tr_b16 a[184:185], v13 offset:40960
  v_mfma_f32_16x16x32_bf16 v[68:71], a[164:167], a[80:83], v[68:71]
  ds_read_b64_tr_b16 a[186:187], v13 offset:43008
  v_mfma_f32_16x16x32_bf16 v[100:103], a[164:167], a[84:87], v[100:103]
  buffer_load_dwordx4 a[56:59], v25, s[20:23], s39 offen offset:2048 sc1
  v_mfma_f32_16x16x32_bf16 v[100:103], a[160:163], a[68:71], v[100:103]
  v_mfma_f32_16x16x32_bf16 v[132:135], a[160:163], a[72:75], v[132:135]
  ds_read_b64_tr_b16 a[188:189], v13 offset:45056
  v_mfma_f32_16x16x32_bf16 v[132:135], a[164:167], a[88:91], v[132:135]
  ds_read_b64_tr_b16 a[190:191], v13 offset:47104
  v_mfma_f32_16x16x32_bf16 v[164:167], a[164:167], a[92:95], v[164:167]
  buffer_load_dwordx4 a[60:63], v25, s[20:23], s39 offen offset:3072 sc1
  v_mfma_f32_16x16x32_bf16 v[164:167], a[160:163], a[76:79], v[164:167]
  s_waitcnt vmcnt(28)
  v_mfma_f32_16x16x32_bf16 v[72:75], a[168:171], a[64:67], v[72:75]
  s_barrier
  ds_read_b64_tr_b16 a[128:129], v10 offset:49152
  v_mfma_f32_16x16x32_bf16 v[72:75], a[172:175], a[80:83], v[72:75]
  s_mov_b32 s38, 16384
  ds_read_b64_tr_b16 a[130:131], v10 offset:51200
  v_mfma_f32_16x16x32_bf16 v[104:107], a[172:175], a[84:87], v[104:107]
  s_add_u32 m0, s29, 16384
  v_mfma_f32_16x16x32_bf16 v[104:107], a[168:171], a[68:71], v[104:107]
  buffer_load_dwordx4 v22, s[8:11], s38 offen lds
  v_mfma_f32_16x16x32_bf16 v[136:139], a[168:171], a[72:75], v[136:139]
  ds_read_b64_tr_b16 a[132:133], v10 offset:53248
  v_mfma_f32_16x16x32_bf16 v[136:139], a[172:175], a[88:91], v[136:139]
  ds_read_b64_tr_b16 a[134:135], v10 offset:55296
  v_mfma_f32_16x16x32_bf16 v[168:171], a[172:175], a[92:95], v[168:171]
  v_mfma_f32_16x16x32_bf16 v[168:171], a[168:171], a[76:79], v[168:171]
  s_waitcnt lgkmcnt(4)
  v_mfma_f32_16x16x32_bf16 v[76:79], a[176:179], a[64:67], v[76:79]
  s_mov_b32 s38, 16384
  ds_read_b64_tr_b16 a[136:137], v11 offset:49152
  v_mfma_f32_16x16x32_bf16 v[76:79], a[180:183], a[80:83], v[76:79]
  s_add_u32 m0, s29, 24448
  ds_read_b64_tr_b16 a[138:139], v11 offset:51200
  v_mfma_f32_16x16x32_bf16 v[108:111], a[180:183], a[84:87], v[108:111]
  buffer_load_dwordx4 v22, s[8:11], s38 offen offset:128 lds
  v_mfma_f32_16x16x32_bf16 v[108:111], a[176:179], a[68:71], v[108:111]
  v_mfma_f32_16x16x32_bf16 v[140:143], a[176:179], a[72:75], v[140:143]
  s_mov_b32 s38, 24576
  ds_read_b64_tr_b16 a[140:141], v11 offset:53248
  v_mfma_f32_16x16x32_bf16 v[140:143], a[180:183], a[88:91], v[140:143]
  s_add_u32 m0, s29, 20480
  ds_read_b64_tr_b16 a[142:143], v11 offset:55296
  v_mfma_f32_16x16x32_bf16 v[172:175], a[180:183], a[92:95], v[172:175]
  buffer_load_dwordx4 v22, s[8:11], s38 offen lds
  v_mfma_f32_16x16x32_bf16 v[172:175], a[176:179], a[76:79], v[172:175]
  v_mfma_f32_16x16x32_bf16 v[80:83], a[184:187], a[64:67], v[80:83]
  s_mov_b32 s38, 24576
  ds_read_b64_tr_b16 a[144:145], v12 offset:49152
  v_mfma_f32_16x16x32_bf16 v[80:83], a[188:191], a[80:83], v[80:83]
  s_add_u32 m0, s29, 28544
  ds_read_b64_tr_b16 a[146:147], v12 offset:51200
  v_mfma_f32_16x16x32_bf16 v[112:115], a[188:191], a[84:87], v[112:115]
  buffer_load_dwordx4 v22, s[8:11], s38 offen offset:128 lds
  v_mfma_f32_16x16x32_bf16 v[112:115], a[184:187], a[68:71], v[112:115]
  v_mfma_f32_16x16x32_bf16 v[144:147], a[184:187], a[72:75], v[144:147]
  ds_read_b64_tr_b16 a[148:149], v12 offset:53248
  v_mfma_f32_16x16x32_bf16 v[144:147], a[188:191], a[88:91], v[144:147]
  ds_read_b64_tr_b16 a[150:151], v12 offset:55296
  v_mfma_f32_16x16x32_bf16 v[176:179], a[188:191], a[92:95], v[176:179]
  v_mfma_f32_16x16x32_bf16 v[176:179], a[184:187], a[76:79], v[176:179]
  s_waitcnt lgkmcnt(4)
  v_mfma_f32_16x16x32_bf16 v[52:55], a[128:131], a[96:99], v[52:55]
  ds_read_b64_tr_b16 a[152:153], v13 offset:49152
  v_mfma_f32_16x16x32_bf16 v[52:55], a[132:135], a[112:115], v[52:55]
  s_mov_b32 s38, 0
  ds_read_b64_tr_b16 a[154:155], v13 offset:51200
  v_mfma_f32_16x16x32_bf16 v[84:87], a[132:135], a[116:119], v[84:87]
  s_add_u32 m0, s29, 65536
  v_mfma_f32_16x16x32_bf16 v[84:87], a[128:131], a[100:103], v[84:87]
  buffer_load_dwordx4 v23, s[12:15], s38 offen lds
  v_mfma_f32_16x16x32_bf16 v[116:119], a[128:131], a[104:107], v[116:119]
  ds_read_b64_tr_b16 a[156:157], v13 offset:53248
  v_mfma_f32_16x16x32_bf16 v[116:119], a[132:135], a[120:123], v[116:119]
  ds_read_b64_tr_b16 a[158:159], v13 offset:55296
  v_mfma_f32_16x16x32_bf16 v[148:151], a[132:135], a[124:127], v[148:151]
  v_mfma_f32_16x16x32_bf16 v[148:151], a[128:131], a[108:111], v[148:151]
  v_mfma_f32_16x16x32_bf16 v[56:59], a[136:139], a[96:99], v[56:59]
  ds_read_b64_tr_b16 a[160:161], v10 offset:57344
  v_mfma_f32_16x16x32_bf16 v[56:59], a[140:143], a[112:115], v[56:59]
  ds_read_b64_tr_b16 a[162:163], v10 offset:59392
  v_mfma_f32_16x16x32_bf16 v[88:91], a[140:143], a[116:119], v[88:91]
  v_mfma_f32_16x16x32_bf16 v[88:91], a[136:139], a[100:103], v[88:91]
  v_mfma_f32_16x16x32_bf16 v[120:123], a[136:139], a[104:107], v[120:123]
  ds_read_b64_tr_b16 a[164:165], v10 offset:61440
  v_mfma_f32_16x16x32_bf16 v[120:123], a[140:143], a[120:123], v[120:123]
  ds_read_b64_tr_b16 a[166:167], v10 offset:63488
  v_mfma_f32_16x16x32_bf16 v[152:155], a[140:143], a[124:127], v[152:155]
  v_mfma_f32_16x16x32_bf16 v[152:155], a[136:139], a[108:111], v[152:155]
  s_waitcnt lgkmcnt(4)
  v_mfma_f32_16x16x32_bf16 v[60:63], a[144:147], a[96:99], v[60:63]
  s_mov_b32 s38, 0
  ds_read_b64_tr_b16 a[168:169], v11 offset:57344
  v_mfma_f32_16x16x32_bf16 v[60:63], a[148:151], a[112:115], v[60:63]
  s_add_u32 m0, s29, 73600
  ds_read_b64_tr_b16 a[170:171], v11 offset:59392
  v_mfma_f32_16x16x32_bf16 v[92:95], a[148:151], a[116:119], v[92:95]
  buffer_load_dwordx4 v23, s[12:15], s38 offen offset:128 lds
  v_mfma_f32_16x16x32_bf16 v[92:95], a[144:147], a[100:103], v[92:95]
  v_mfma_f32_16x16x32_bf16 v[124:127], a[144:147], a[104:107], v[124:127]
  ds_read_b64_tr_b16 a[172:173], v11 offset:61440
  v_mfma_f32_16x16x32_bf16 v[124:127], a[148:151], a[120:123], v[124:127]
  ds_read_b64_tr_b16 a[174:175], v11 offset:63488
  v_mfma_f32_16x16x32_bf16 v[156:159], a[148:151], a[124:127], v[156:159]
  v_mfma_f32_16x16x32_bf16 v[156:159], a[144:147], a[108:111], v[156:159]
  v_mfma_f32_16x16x32_bf16 v[64:67], a[152:155], a[96:99], v[64:67]
  ds_read_b64_tr_b16 a[176:177], v12 offset:57344
  v_mfma_f32_16x16x32_bf16 v[64:67], a[156:159], a[112:115], v[64:67]
  ds_read_b64_tr_b16 a[178:179], v12 offset:59392
  v_mfma_f32_16x16x32_bf16 v[96:99], a[156:159], a[116:119], v[96:99]
  v_mfma_f32_16x16x32_bf16 v[96:99], a[152:155], a[100:103], v[96:99]
  v_mfma_f32_16x16x32_bf16 v[128:131], a[152:155], a[104:107], v[128:131]
  ds_read_b64_tr_b16 a[180:181], v12 offset:61440
  v_mfma_f32_16x16x32_bf16 v[128:131], a[156:159], a[120:123], v[128:131]
  ds_read_b64_tr_b16 a[182:183], v12 offset:63488
  v_mfma_f32_16x16x32_bf16 v[160:163], a[156:159], a[124:127], v[160:163]
  v_mfma_f32_16x16x32_bf16 v[160:163], a[152:155], a[108:111], v[160:163]
  s_waitcnt lgkmcnt(4)
  v_mfma_f32_16x16x32_bf16 v[68:71], a[160:163], a[96:99], v[68:71]
  s_mov_b32 s38, 8192
  ds_read_b64_tr_b16 a[184:185], v13 offset:57344
  v_mfma_f32_16x16x32_bf16 v[68:71], a[164:167], a[112:115], v[68:71]
  s_add_u32 m0, s29, 69632
  ds_read_b64_tr_b16 a[186:187], v13 offset:59392
  v_mfma_f32_16x16x32_bf16 v[100:103], a[164:167], a[116:119], v[100:103]
  buffer_load_dwordx4 v23, s[12:15], s38 offen lds
  v_mfma_f32_16x16x32_bf16 v[100:103], a[160:163], a[100:103], v[100:103]
  v_mfma_f32_16x16x32_bf16 v[132:135], a[160:163], a[104:107], v[132:135]
  ds_read_b64_tr_b16 a[188:189], v13 offset:61440
  v_mfma_f32_16x16x32_bf16 v[132:135], a[164:167], a[120:123], v[132:135]
  ds_read_b64_tr_b16 a[190:191], v13 offset:63488
  v_mfma_f32_16x16x32_bf16 v[164:167], a[164:167], a[124:127], v[164:167]
  v_mfma_f32_16x16x32_bf16 v[164:167], a[160:163], a[108:111], v[164:167]
  s_waitcnt vmcnt(23)
  v_mfma_f32_16x16x32_bf16 v[72:75], a[168:171], a[96:99], v[72:75]
  s_barrier
  ds_read_b64_tr_b16 a[128:129], v18 offset:0
  v_mfma_f32_16x16x32_bf16 v[72:75], a[172:175], a[112:115], v[72:75]
  ds_read_b64_tr_b16 a[130:131], v18 offset:2048
  v_mfma_f32_16x16x32_bf16 v[104:107], a[172:175], a[116:119], v[104:107]
  v_mfma_f32_16x16x32_bf16 v[104:107], a[168:171], a[100:103], v[104:107]
  v_mfma_f32_16x16x32_bf16 v[136:139], a[168:171], a[104:107], v[136:139]
  ds_read_b64_tr_b16 a[132:133], v18 offset:4096
  v_mfma_f32_16x16x32_bf16 v[136:139], a[172:175], a[120:123], v[136:139]
  ds_read_b64_tr_b16 a[134:135], v18 offset:6144
  v_mfma_f32_16x16x32_bf16 v[168:171], a[172:175], a[124:127], v[168:171]
  v_mfma_f32_16x16x32_bf16 v[168:171], a[168:171], a[108:111], v[168:171]
  s_waitcnt lgkmcnt(4)
  v_mfma_f32_16x16x32_bf16 v[76:79], a[176:179], a[96:99], v[76:79]
  s_mov_b32 s38, 8192
  ds_read_b64_tr_b16 a[136:137], v19 offset:0
  v_mfma_f32_16x16x32_bf16 v[76:79], a[180:183], a[112:115], v[76:79]
  s_add_u32 m0, s29, 77696
  ds_read_b64_tr_b16 a[138:139], v19 offset:2048
  v_mfma_f32_16x16x32_bf16 v[108:111], a[180:183], a[116:119], v[108:111]
  buffer_load_dwordx4 v23, s[12:15], s38 offen offset:128 lds
  v_mfma_f32_16x16x32_bf16 v[108:111], a[176:179], a[100:103], v[108:111]
  v_mfma_f32_16x16x32_bf16 v[140:143], a[176:179], a[104:107], v[140:143]
  ds_read_b64_tr_b16 a[140:141], v19 offset:4096
  v_mfma_f32_16x16x32_bf16 v[140:143], a[180:183], a[120:123], v[140:143]
  ds_read_b64_tr_b16 a[142:143], v19 offset:6144
  v_mfma_f32_16x16x32_bf16 v[172:175], a[180:183], a[124:127], v[172:175]
  v_mfma_f32_16x16x32_bf16 v[172:175], a[176:179], a[108:111], v[172:175]
  v_mfma_f32_16x16x32_bf16 v[80:83], a[184:187], a[96:99], v[80:83]
  ds_read_b64_tr_b16 a[144:145], v20 offset:0
  v_mfma_f32_16x16x32_bf16 v[80:83], a[188:191], a[112:115], v[80:83]
  ds_read_b64_tr_b16 a[146:147], v20 offset:2048
  v_mfma_f32_16x16x32_bf16 v[112:115], a[188:191], a[116:119], v[112:115]
  v_mfma_f32_16x16x32_bf16 v[112:115], a[184:187], a[100:103], v[112:115]
  v_mfma_f32_16x16x32_bf16 v[144:147], a[184:187], a[104:107], v[144:147]
  ds_read_b64_tr_b16 a[148:149], v20 offset:4096
  v_mfma_f32_16x16x32_bf16 v[144:147], a[188:191], a[120:123], v[144:147]
  ds_read_b64_tr_b16 a[150:151], v20 offset:6144
  v_mfma_f32_16x16x32_bf16 v[176:179], a[188:191], a[124:127], v[176:179]
  v_mfma_f32_16x16x32_bf16 v[176:179], a[184:187], a[108:111], v[176:179]
  s_waitcnt lgkmcnt(4)
  v_mfma_f32_16x16x32_bf16 v[52:55], a[128:131], a[0:3], v[52:55]
  ds_read_b64_tr_b16 a[152:153], v21 offset:0
  v_mfma_f32_16x16x32_bf16 v[52:55], a[132:135], a[16:19], v[52:55]
  ds_read_b64_tr_b16 a[154:155], v21 offset:2048
  v_mfma_f32_16x16x32_bf16 v[84:87], a[132:135], a[20:23], v[84:87]
  v_mfma_f32_16x16x32_bf16 v[84:87], a[128:131], a[4:7], v[84:87]
  v_mfma_f32_16x16x32_bf16 v[116:119], a[128:131], a[8:11], v[116:119]
  ds_read_b64_tr_b16 a[156:157], v21 offset:4096
  v_mfma_f32_16x16x32_bf16 v[116:119], a[132:135], a[24:27], v[116:119]
  ds_read_b64_tr_b16 a[158:159], v21 offset:6144
  v_mfma_f32_16x16x32_bf16 v[148:151], a[132:135], a[28:31], v[148:151]
  v_mfma_f32_16x16x32_bf16 v[148:151], a[128:131], a[12:15], v[148:151]
  v_mfma_f32_16x16x32_bf16 v[56:59], a[136:139], a[0:3], v[56:59]
  ds_read_b64_tr_b16 a[160:161], v18 offset:8192
  v_mfma_f32_16x16x32_bf16 v[56:59], a[140:143], a[16:19], v[56:59]
  ds_read_b64_tr_b16 a[162:163], v18 offset:10240
  v_mfma_f32_16x16x32_bf16 v[88:91], a[140:143], a[20:23], v[88:91]
  v_mfma_f32_16x16x32_bf16 v[88:91], a[136:139], a[4:7], v[88:91]
  v_mfma_f32_16x16x32_bf16 v[120:123], a[136:139], a[8:11], v[120:123]
  ds_read_b64_tr_b16 a[164:165], v18 offset:12288
  v_mfma_f32_16x16x32_bf16 v[120:123], a[140:143], a[24:27], v[120:123]
  ds_read_b64_tr_b16 a[166:167], v18 offset:14336
  v_mfma_f32_16x16x32_bf16 v[152:155], a[140:143], a[28:31], v[152:155]
  v_mfma_f32_16x16x32_bf16 v[152:155], a[136:139], a[12:15], v[152:155]
  s_waitcnt lgkmcnt(4)
  v_mfma_f32_16x16x32_bf16 v[60:63], a[144:147], a[0:3], v[60:63]
  ds_read_b64_tr_b16 a[168:169], v19 offset:8192
  v_mfma_f32_16x16x32_bf16 v[60:63], a[148:151], a[16:19], v[60:63]
  ds_read_b64_tr_b16 a[170:171], v19 offset:10240
  v_mfma_f32_16x16x32_bf16 v[92:95], a[148:151], a[20:23], v[92:95]
  v_mfma_f32_16x16x32_bf16 v[92:95], a[144:147], a[4:7], v[92:95]
  v_mfma_f32_16x16x32_bf16 v[124:127], a[144:147], a[8:11], v[124:127]
  ds_read_b64_tr_b16 a[172:173], v19 offset:12288
  v_mfma_f32_16x16x32_bf16 v[124:127], a[148:151], a[24:27], v[124:127]
  ds_read_b64_tr_b16 a[174:175], v19 offset:14336
  v_mfma_f32_16x16x32_bf16 v[156:159], a[148:151], a[28:31], v[156:159]
  v_mfma_f32_16x16x32_bf16 v[156:159], a[144:147], a[12:15], v[156:159]
  v_mfma_f32_16x16x32_bf16 v[64:67], a[152:155], a[0:3], v[64:67]
  ds_read_b64_tr_b16 a[176:177], v20 offset:8192
  v_mfma_f32_16x16x32_bf16 v[64:67], a[156:159], a[16:19], v[64:67]
  ds_read_b64_tr_b16 a[178:179], v20 offset:10240
  v_mfma_f32_16x16x32_bf16 v[96:99], a[156:159], a[20:23], v[96:99]
  v_mfma_f32_16x16x32_bf16 v[96:99], a[152:155], a[4:7], v[96:99]
  v_mfma_f32_16x16x32_bf16 v[128:131], a[152:155], a[8:11], v[128:131]
  ds_read_b64_tr_b16 a[180:181], v20 offset:12288
  v_mfma_f32_16x16x32_bf16 v[128:131], a[156:159], a[24:27], v[128:131]
  ds_read_b64_tr_b16 a[182:183], v20 offset:14336
  v_mfma_f32_16x16x32_bf16 v[160:163], a[156:159], a[28:31], v[160:163]
  v_mfma_f32_16x16x32_bf16 v[160:163], a[152:155], a[12:15], v[160:163]
  s_waitcnt lgkmcnt(4)
  v_mfma_f32_16x16x32_bf16 v[68:71], a[160:163], a[0:3], v[68:71]
  ds_read_b64_tr_b16 a[184:185], v21 offset:8192
  v_mfma_f32_16x16x32_bf16 v[68:71], a[164:167], a[16:19], v[68:71]
  ds_read_b64_tr_b16 a[186:187], v21 offset:10240
  v_mfma_f32_16x16x32_bf16 v[100:103], a[164:167], a[20:23], v[100:103]
  v_mfma_f32_16x16x32_bf16 v[100:103], a[160:163], a[4:7], v[100:103]
  v_mfma_f32_16x16x32_bf16 v[132:135], a[160:163], a[8:11], v[132:135]
  ds_read_b64_tr_b16 a[188:189], v21 offset:12288
  v_mfma_f32_16x16x32_bf16 v[132:135], a[164:167], a[24:27], v[132:135]
  ds_read_b64_tr_b16 a[190:191], v21 offset:14336
  v_mfma_f32_16x16x32_bf16 v[164:167], a[164:167], a[28:31], v[164:167]
  v_mfma_f32_16x16x32_bf16 v[164:167], a[160:163], a[12:15], v[164:167]
  s_waitcnt vmcnt(8)
  v_mfma_f32_16x16x32_bf16 v[72:75], a[168:171], a[0:3], v[72:75]
  s_barrier
  ds_read_b64_tr_b16 a[128:129], v18 offset:16384
  v_mfma_f32_16x16x32_bf16 v[72:75], a[172:175], a[16:19], v[72:75]
  ds_read_b64_tr_b16 a[130:131], v18 offset:18432
  v_mfma_f32_16x16x32_bf16 v[104:107], a[172:175], a[20:23], v[104:107]
  v_mfma_f32_16x16x32_bf16 v[104:107], a[168:171], a[4:7], v[104:107]
  v_mfma_f32_16x16x32_bf16 v[136:139], a[168:171], a[8:11], v[136:139]
  ds_read_b64_tr_b16 a[132:133], v18 offset:20480
  v_mfma_f32_16x16x32_bf16 v[136:139], a[172:175], a[24:27], v[136:139]
  ds_read_b64_tr_b16 a[134:135], v18 offset:22528
  v_mfma_f32_16x16x32_bf16 v[168:171], a[172:175], a[28:31], v[168:171]
  v_mfma_f32_16x16x32_bf16 v[168:171], a[168:171], a[12:15], v[168:171]
  s_waitcnt lgkmcnt(4)
  v_mfma_f32_16x16x32_bf16 v[76:79], a[176:179], a[0:3], v[76:79]
  ds_read_b64_tr_b16 a[136:137], v19 offset:16384
  v_mfma_f32_16x16x32_bf16 v[76:79], a[180:183], a[16:19], v[76:79]
  ds_read_b64_tr_b16 a[138:139], v19 offset:18432
  v_mfma_f32_16x16x32_bf16 v[108:111], a[180:183], a[20:23], v[108:111]
  v_mfma_f32_16x16x32_bf16 v[108:111], a[176:179], a[4:7], v[108:111]
  v_mfma_f32_16x16x32_bf16 v[140:143], a[176:179], a[8:11], v[140:143]
  ds_read_b64_tr_b16 a[140:141], v19 offset:20480
  v_mfma_f32_16x16x32_bf16 v[140:143], a[180:183], a[24:27], v[140:143]
  ds_read_b64_tr_b16 a[142:143], v19 offset:22528
  v_mfma_f32_16x16x32_bf16 v[172:175], a[180:183], a[28:31], v[172:175]
  v_mfma_f32_16x16x32_bf16 v[172:175], a[176:179], a[12:15], v[172:175]
  v_mfma_f32_16x16x32_bf16 v[80:83], a[184:187], a[0:3], v[80:83]
  ds_read_b64_tr_b16 a[144:145], v20 offset:16384
  v_mfma_f32_16x16x32_bf16 v[80:83], a[188:191], a[16:19], v[80:83]
  ds_read_b64_tr_b16 a[146:147], v20 offset:18432
  v_mfma_f32_16x16x32_bf16 v[112:115], a[188:191], a[20:23], v[112:115]
  v_mfma_f32_16x16x32_bf16 v[112:115], a[184:187], a[4:7], v[112:115]
  v_mfma_f32_16x16x32_bf16 v[144:147], a[184:187], a[8:11], v[144:147]
  ds_read_b64_tr_b16 a[148:149], v20 offset:20480
  v_mfma_f32_16x16x32_bf16 v[144:147], a[188:191], a[24:27], v[144:147]
  ds_read_b64_tr_b16 a[150:151], v20 offset:22528
  v_mfma_f32_16x16x32_bf16 v[176:179], a[188:191], a[28:31], v[176:179]
  v_mfma_f32_16x16x32_bf16 v[176:179], a[184:187], a[12:15], v[176:179]
  s_waitcnt lgkmcnt(4)
  v_mfma_f32_16x16x32_bf16 v[52:55], a[128:131], a[32:35], v[52:55]
  ds_read_b64_tr_b16 a[152:153], v21 offset:16384
  v_mfma_f32_16x16x32_bf16 v[52:55], a[132:135], a[48:51], v[52:55]
  ds_read_b64_tr_b16 a[154:155], v21 offset:18432
  v_mfma_f32_16x16x32_bf16 v[84:87], a[132:135], a[52:55], v[84:87]
  v_accvgpr_write_b32 a16, 0
  v_accvgpr_write_b32 a17, 0
  v_mfma_f32_16x16x32_bf16 v[84:87], a[128:131], a[36:39], v[84:87]
  v_accvgpr_write_b32 a18, 0
  v_accvgpr_write_b32 a19, 0
  v_mfma_f32_16x16x32_bf16 v[116:119], a[128:131], a[40:43], v[116:119]
  ds_read_b64_tr_b16 a[156:157], v21 offset:20480
  v_accvgpr_write_b32 a20, 0
  v_mfma_f32_16x16x32_bf16 v[116:119], a[132:135], a[56:59], v[116:119]
  ds_read_b64_tr_b16 a[158:159], v21 offset:22528
  v_accvgpr_write_b32 a21, 0
  v_mfma_f32_16x16x32_bf16 v[148:151], a[132:135], a[60:63], v[148:151]
  v_accvgpr_write_b32 a22, 0
  v_accvgpr_write_b32 a23, 0
  v_mfma_f32_16x16x32_bf16 v[148:151], a[128:131], a[44:47], v[148:151]
  v_accvgpr_write_b32 a24, 0
  v_accvgpr_write_b32 a25, 0
  v_mfma_f32_16x16x32_bf16 v[56:59], a[136:139], a[32:35], v[56:59]
  ds_read_b64_tr_b16 a[160:161], v18 offset:24576
  v_accvgpr_write_b32 a26, 0
  v_mfma_f32_16x16x32_bf16 v[56:59], a[140:143], a[48:51], v[56:59]
  ds_read_b64_tr_b16 a[162:163], v18 offset:26624
  v_accvgpr_write_b32 a27, 0
  v_mfma_f32_16x16x32_bf16 v[88:91], a[140:143], a[52:55], v[88:91]
  v_accvgpr_write_b32 a28, 0
  v_accvgpr_write_b32 a29, 0
  v_mfma_f32_16x16x32_bf16 v[88:91], a[136:139], a[36:39], v[88:91]
  v_accvgpr_write_b32 a30, 0
  v_accvgpr_write_b32 a31, 0
  v_mfma_f32_16x16x32_bf16 v[120:123], a[136:139], a[40:43], v[120:123]
  ds_read_b64_tr_b16 a[164:165], v18 offset:28672
  v_accvgpr_write_b32 a80, 0
  v_mfma_f32_16x16x32_bf16 v[120:123], a[140:143], a[56:59], v[120:123]
  ds_read_b64_tr_b16 a[166:167], v18 offset:30720
  v_accvgpr_write_b32 a81, 0
  v_mfma_f32_16x16x32_bf16 v[152:155], a[140:143], a[60:63], v[152:155]
  v_accvgpr_write_b32 a82, 0
  v_accvgpr_write_b32 a83, 0
  v_mfma_f32_16x16x32_bf16 v[152:155], a[136:139], a[44:47], v[152:155]
  s_waitcnt lgkmcnt(4)
  v_accvgpr_write_b32 a84, 0
  v_accvgpr_write_b32 a85, 0
  v_mfma_f32_16x16x32_bf16 v[60:63], a[144:147], a[32:35], v[60:63]
  ds_read_b64_tr_b16 a[168:169], v19 offset:24576
  v_accvgpr_write_b32 a86, 0
  v_mfma_f32_16x16x32_bf16 v[60:63], a[148:151], a[48:51], v[60:63]
  ds_read_b64_tr_b16 a[170:171], v19 offset:26624
  v_accvgpr_write_b32 a87, 0
  v_mfma_f32_16x16x32_bf16 v[92:95], a[148:151], a[52:55], v[92:95]
  v_accvgpr_write_b32 a88, 0
  v_accvgpr_write_b32 a89, 0
  v_mfma_f32_16x16x32_bf16 v[92:95], a[144:147], a[36:39], v[92:95]
  v_accvgpr_write_b32 a90, 0
  v_accvgpr_write_b32 a91, 0
  v_mfma_f32_16x16x32_bf16 v[124:127], a[144:147], a[40:43], v[124:127]
  ds_read_b64_tr_b16 a[172:173], v19 offset:28672
  v_accvgpr_write_b32 a92, 0
  v_mfma_f32_16x16x32_bf16 v[124:127], a[148:151], a[56:59], v[124:127]
  ds_read_b64_tr_b16 a[174:175], v19 offset:30720
  v_accvgpr_write_b32 a93, 0
  v_cvt_pk_bf16_f32 v180, v52, v53
  v_cvt_pk_bf16_f32 v181, v54, v55
  v_mfma_f32_16x16x32_bf16 v[156:159], a[148:151], a[60:63], v[156:159]
  v_accvgpr_write_b32 a94, 0
  v_accvgpr_write_b32 a95, 0
  v_cvt_pk_bf16_f32 v182, v56, v57
  v_cvt_pk_bf16_f32 v183, v58, v59
  v_mfma_f32_16x16x32_bf16 v[156:159], a[144:147], a[44:47], v[156:159]
  v_accvgpr_write_b32 a112, 0
  v_accvgpr_write_b32 a113, 0
  v_cvt_pk_bf16_f32 v196, v84, v85
  v_cvt_pk_bf16_f32 v197, v86, v87
  v_mfma_f32_16x16x32_bf16 v[64:67], a[152:155], a[32:35], v[64:67]
  ds_read_b64_tr_b16 a[176:177], v20 offset:24576
  v_accvgpr_write_b32 a114, 0
  v_cvt_pk_bf16_f32 v198, v88, v89
  v_cvt_pk_bf16_f32 v199, v90, v91
  v_mfma_f32_16x16x32_bf16 v[64:67], a[156:159], a[48:51], v[64:67]
  ds_read_b64_tr_b16 a[178:179], v20 offset:26624
  v_accvgpr_write_b32 a115, 0
  v_cvt_pk_bf16_f32 v212, v116, v117
  v_cvt_pk_bf16_f32 v213, v118, v119
  v_mfma_f32_16x16x32_bf16 v[96:99], a[156:159], a[52:55], v[96:99]
  v_accvgpr_write_b32 a116, 0
  v_accvgpr_write_b32 a117, 0
  v_cvt_pk_bf16_f32 v214, v120, v121
  v_cvt_pk_bf16_f32 v215, v122, v123
  v_mfma_f32_16x16x32_bf16 v[96:99], a[152:155], a[36:39], v[96:99]
  v_accvgpr_write_b32 a118, 0
  v_accvgpr_write_b32 a119, 0
  v_cvt_pk_bf16_f32 v228, v148, v149
  v_cvt_pk_bf16_f32 v229, v150, v151
  v_mfma_f32_16x16x32_bf16 v[128:131], a[152:155], a[40:43], v[128:131]
  ds_read_b64_tr_b16 a[180:181], v20 offset:28672
  v_accvgpr_write_b32 a120, 0
  v_cvt_pk_bf16_f32 v230, v152, v153
  v_cvt_pk_bf16_f32 v231, v154, v155
  v_mfma_f32_16x16x32_bf16 v[128:131], a[156:159], a[56:59], v[128:131]
  ds_read_b64_tr_b16 a[182:183], v20 offset:30720
  v_accvgpr_write_b32 a121, 0
  v_permlane16_swap_b32 v180, v182
  v_mfma_f32_16x16x32_bf16 v[160:163], a[156:159], a[60:63], v[160:163]
  v_accvgpr_write_b32 a122, 0
  v_accvgpr_write_b32 a123, 0
  v_permlane16_swap_b32 v181, v183
  v_mfma_f32_16x16x32_bf16 v[160:163], a[152:155], a[44:47], v[160:163]
  s_waitcnt lgkmcnt(4)
  v_accvgpr_write_b32 a124, 0
  v_accvgpr_write_b32 a125, 0
  v_permlane16_swap_b32 v196, v198
  v_mfma_f32_16x16x32_bf16 v[68:71], a[160:163], a[32:35], v[68:71]
  ds_read_b64_tr_b16 a[184:185], v21 offset:24576
  v_accvgpr_write_b32 a126, 0
  v_permlane16_swap_b32 v197, v199
  v_mfma_f32_16x16x32_bf16 v[68:71], a[164:167], a[48:51], v[68:71]
  ds_read_b64_tr_b16 a[186:187], v21 offset:26624
  v_accvgpr_write_b32 a127, 0
  v_permlane16_swap_b32 v212, v214
  v_mfma_f32_16x16x32_bf16 v[100:103], a[164:167], a[52:55], v[100:103]
  v_accvgpr_write_b32 a224, 0
  v_accvgpr_write_b32 a225, 0
  v_permlane16_swap_b32 v213, v215
  v_mfma_f32_16x16x32_bf16 v[100:103], a[160:163], a[36:39], v[100:103]
  v_accvgpr_write_b32 a226, 0
  v_accvgpr_write_b32 a227, 0
  v_permlane16_swap_b32 v228, v230
  v_mfma_f32_16x16x32_bf16 v[132:135], a[160:163], a[40:43], v[132:135]
  ds_read_b64_tr_b16 a[188:189], v21 offset:28672
  v_accvgpr_write_b32 a228, 0
  v_permlane16_swap_b32 v229, v231
  v_mfma_f32_16x16x32_bf16 v[132:135], a[164:167], a[56:59], v[132:135]
  ds_read_b64_tr_b16 a[190:191], v21 offset:30720
  v_accvgpr_write_b32 a229, 0
  v_cvt_pk_bf16_f32 v184, v60, v61
  v_mfma_f32_16x16x32_bf16 v[164:167], a[164:167], a[60:63], v[164:167]
  v_accvgpr_write_b32 a230, 0
  v_accvgpr_write_b32 a231, 0
  v_cvt_pk_bf16_f32 v185, v62, v63
  v_mfma_f32_16x16x32_bf16 v[164:167], a[160:163], a[44:47], v[164:167]
  s_waitcnt vmcnt(16)
  v_accvgpr_write_b32 a232, 0
  v_accvgpr_write_b32 a233, 0
  v_mfma_f32_16x16x32_bf16 v[72:75], a[168:171], a[32:35], v[72:75]
  s_barrier
  ds_read_b128 a[128:131], v8 offset:0
  v_cvt_pk_bf16_f32 v186, v64, v65
  v_mfma_f32_16x16x32_bf16 v[72:75], a[172:175], a[48:51], v[72:75]
  v_accvgpr_write_b32 a234, 0
  v_accvgpr_write_b32 a235, 0
  v_mfma_f32_16x16x32_bf16 v[104:107], a[172:175], a[52:55], v[104:107]
  v_accvgpr_write_b32 a236, 0
  v_accvgpr_write_b32 a237, 0
  v_cvt_pk_bf16_f32 v187, v66, v67
  v_mfma_f32_16x16x32_bf16 v[104:107], a[168:171], a[36:39], v[104:107]
  v_accvgpr_write_b32 a238, 0
  v_accvgpr_write_b32 a239, 0
  v_mfma_f32_16x16x32_bf16 v[136:139], a[168:171], a[40:43], v[136:139]
  ds_read_b128 a[132:135], v9 offset:0
  v_cvt_pk_bf16_f32 v200, v92, v93
  v_cvt_pk_bf16_f32 v201, v94, v95
  v_mfma_f32_16x16x32_bf16 v[136:139], a[172:175], a[56:59], v[136:139]
  v_cvt_pk_bf16_f32 v202, v96, v97
  v_cvt_pk_bf16_f32 v203, v98, v99
  v_cvt_pk_bf16_f32 v216, v124, v125
  v_mfma_f32_16x16x32_bf16 v[168:171], a[172:175], a[60:63], v[168:171]
  v_cvt_pk_bf16_f32 v217, v126, v127
  v_cvt_pk_bf16_f32 v218, v128, v129
  v_mfma_f32_16x16x32_bf16 v[168:171], a[168:171], a[44:47], v[168:171]
  s_waitcnt lgkmcnt(2)
  v_cvt_pk_bf16_f32 v219, v130, v131
  v_cvt_pk_bf16_f32 v232, v156, v157
  v_cvt_pk_bf16_f32 v233, v158, v159
  v_mfma_f32_16x16x32_bf16 v[76:79], a[176:179], a[32:35], v[76:79]
  ds_read_b128 a[136:139], v8 offset:8192
  v_cvt_pk_bf16_f32 v234, v160, v161
  v_mfma_f32_16x16x32_bf16 v[76:79], a[180:183], a[48:51], v[76:79]
  v_cvt_pk_bf16_f32 v235, v162, v163
  v_permlane16_swap_b32 v184, v186
  v_permlane16_swap_b32 v185, v187
  v_mfma_f32_16x16x32_bf16 v[108:111], a[180:183], a[52:55], v[108:111]
  v_permlane16_swap_b32 v200, v202
  v_permlane16_swap_b32 v201, v203
  v_mfma_f32_16x16x32_bf16 v[108:111], a[176:179], a[36:39], v[108:111]
  v_permlane16_swap_b32 v216, v218
  v_permlane16_swap_b32 v217, v219
  v_permlane16_swap_b32 v232, v234
  v_mfma_f32_16x16x32_bf16 v[140:143], a[176:179], a[40:43], v[140:143]
  ds_read_b128 a[140:143], v9 offset:8192
  v_permlane16_swap_b32 v233, v235
  v_mfma_f32_16x16x32_bf16 v[140:143], a[180:183], a[56:59], v[140:143]
  v_cvt_pk_bf16_f32 v188, v68, v69
  v_cvt_pk_bf16_f32 v189, v70, v71
  v_cvt_pk_bf16_f32 v190, v72, v73
  v_mfma_f32_16x16x32_bf16 v[172:175], a[180:183], a[60:63], v[172:175]
  v_cvt_pk_bf16_f32 v191, v74, v75
  v_cvt_pk_bf16_f32 v204, v100, v101
  v_mfma_f32_16x16x32_bf16 v[172:175], a[176:179], a[44:47], v[172:175]
  v_cvt_pk_bf16_f32 v205, v102, v103
  v_cvt_pk_bf16_f32 v206, v104, v105
  v_cvt_pk_bf16_f32 v207, v106, v107
  v_mfma_f32_16x16x32_bf16 v[80:83], a[184:187], a[32:35], v[80:83]
  ds_read_b128 a[144:147], v8 offset:2048
  v_cvt_pk_bf16_f32 v220, v132, v133
  v_mfma_f32_16x16x32_bf16 v[80:83], a[188:191], a[48:51], v[80:83]
  v_cvt_pk_bf16_f32 v221, v134, v135
  v_cvt_pk_bf16_f32 v222, v136, v137
  v_mfma_f32_16x16x32_bf16 v[112:115], a[188:191], a[52:55], v[112:115]
  v_cvt_pk_bf16_f32 v223, v138, v139
  v_cvt_pk_bf16_f32 v236, v164, v165
  v_cvt_pk_bf16_f32 v237, v166, v167
  v_mfma_f32_16x16x32_bf16 v[112:115], a[184:187], a[36:39], v[112:115]
  v_cvt_pk_bf16_f32 v238, v168, v169
  v_cvt_pk_bf16_f32 v239, v170, v171
  v_mfma_f32_16x16x32_bf16 v[144:147], a[184:187], a[40:43], v[144:147]
  ds_read_b128 a[148:151], v9 offset:2048
  v_permlane16_swap_b32 v188, v190
  v_mfma_f32_16x16x32_bf16 v[144:147], a[188:191], a[56:59], v[144:147]
  v_permlane16_swap_b32 v189, v191
  v_permlane16_swap_b32 v204, v206
  v_permlane16_swap_b32 v205, v207
  v_mfma_f32_16x16x32_bf16 v[176:179], a[188:191], a[60:63], v[176:179]
  v_permlane16_swap_b32 v220, v222
  v_permlane16_swap_b32 v221, v223
  v_mfma_f32_16x16x32_bf16 v[176:179], a[184:187], a[44:47], v[176:179]
  s_waitcnt lgkmcnt(2)
  v_permlane16_swap_b32 v236, v238
  v_permlane16_swap_b32 v237, v239
  v_cvt_pk_bf16_f32 v192, v76, v77
  v_cvt_pk_bf16_f32 v193, v78, v79
  v_cvt_pk_bf16_f32 v194, v80, v81
  v_cvt_pk_bf16_f32 v195, v82, v83
  v_cvt_pk_bf16_f32 v208, v108, v109
  v_cvt_pk_bf16_f32 v209, v110, v111
  v_cvt_pk_bf16_f32 v210, v112, v113
  v_cvt_pk_bf16_f32 v211, v114, v115
  v_cvt_pk_bf16_f32 v224, v140, v141
  v_cvt_pk_bf16_f32 v225, v142, v143
  v_cvt_pk_bf16_f32 v226, v144, v145
  v_cvt_pk_bf16_f32 v227, v146, v147
  v_cvt_pk_bf16_f32 v240, v172, v173
  v_cvt_pk_bf16_f32 v241, v174, v175
  v_cvt_pk_bf16_f32 v242, v176, v177
  v_cvt_pk_bf16_f32 v243, v178, v179
  v_permlane16_swap_b32 v192, v194
  v_permlane16_swap_b32 v193, v195
  v_permlane16_swap_b32 v208, v210
  v_permlane16_swap_b32 v209, v211
  v_permlane16_swap_b32 v224, v226
  v_permlane16_swap_b32 v225, v227
  v_permlane16_swap_b32 v240, v242
  v_permlane16_swap_b32 v241, v243
  s_mov_b32 s32, 65536
  s_mov_b32 s33, 32768
  s_mov_b32 s34, 73728
  s_mov_b32 s35, 40960
  s_mov_b32 s36, 8
  v_mfma_f32_16x16x32_bf16 v[52:55], a[128:131], v[180:183], 0
  ds_read_b128 a[152:155], v8 offset:10240
  v_accvgpr_write_b32 a48, 0
  v_mfma_f32_16x16x32_bf16 v[52:55], a[132:135], v[184:187], v[52:55]
  s_mov_b32 s38, 32768
  v_accvgpr_write_b32 a49, 0
  v_accvgpr_write_b32 a50, 0
  v_mfma_f32_16x16x32_bf16 v[52:55], a[136:139], v[188:191], v[52:55]
  s_add_u32 m0, s29, 32768
  v_accvgpr_write_b32 a51, 0
  v_accvgpr_write_b32 a52, 0
  v_mfma_f32_16x16x32_bf16 v[52:55], a[140:143], v[192:195], v[52:55]
  buffer_load_dwordx4 v22, s[8:11], s38 offen lds
  v_mfma_f32_16x16x32_bf16 v[60:63], a[140:143], v[208:211], 0
  s_mov_b32 s38, 32768
  ds_read_b128 a[156:159], v9 offset:10240
  v_accvgpr_write_b32 a53, 0
  v_mfma_f32_16x16x32_bf16 v[60:63], a[136:139], v[204:207], v[60:63]
  s_add_u32 m0, s29, 40832
  v_accvgpr_write_b32 a54, 0
  v_accvgpr_write_b32 a55, 0
  v_mfma_f32_16x16x32_bf16 v[60:63], a[132:135], v[200:203], v[60:63]
  buffer_load_dwordx4 v22, s[8:11], s38 offen offset:128 lds
  v_mfma_f32_16x16x32_bf16 v[60:63], a[128:131], v[196:199], v[60:63]
  s_mov_b32 s38, 40960
  v_accvgpr_write_b32 a56, 0
  v_accvgpr_write_b32 a57, 0
  v_mfma_f32_16x16x32_bf16 v[68:71], a[128:131], v[212:215], 0
  s_add_u32 m0, s29, 36864
  ds_read_b128 a[160:163], v8 offset:4096
  v_accvgpr_write_b32 a58, 0
  v_mfma_f32_16x16x32_bf16 v[68:71], a[132:135], v[216:219], v[68:71]
  buffer_load_dwordx4 v22, s[8:11], s38 offen lds
  v_mfma_f32_16x16x32_bf16 v[68:71], a[136:139], v[220:223], v[68:71]
  v_accvgpr_write_b32 a59, 0
  v_accvgpr_write_b32 a60, 0
  v_mfma_f32_16x16x32_bf16 v[68:71], a[140:143], v[224:227], v[68:71]
  s_mov_b32 s38, 40960
  v_accvgpr_write_b32 a61, 0
  v_accvgpr_write_b32 a62, 0
  v_mfma_f32_16x16x32_bf16 v[76:79], a[140:143], v[240:243], 0
  s_add_u32 m0, s29, 44928
  ds_read_b128 a[164:167], v9 offset:4096
  v_accvgpr_write_b32 a63, 0
  v_mfma_f32_16x16x32_bf16 v[76:79], a[136:139], v[236:239], v[76:79]
  buffer_load_dwordx4 v22, s[8:11], s38 offen offset:128 lds
  v_mfma_f32_16x16x32_bf16 v[76:79], a[132:135], v[232:235], v[76:79]
  s_mov_b32 s38, 16384
  v_mfma_f32_16x16x32_bf16 v[76:79], a[128:131], v[228:231], v[76:79]
  s_waitcnt lgkmcnt(2)
  v_mfma_f32_16x16x32_bf16 v[80:83], a[144:147], v[228:231], 0
  s_add_u32 m0, s29, 81920
  ds_read_b128 a[168:171], v8 offset:12288
  v_mfma_f32_16x16x32_bf16 v[80:83], a[148:151], v[232:235], v[80:83]
  buffer_load_dwordx4 v23, s[12:15], s38 offen lds
  v_mfma_f32_16x16x32_bf16 v[80:83], a[152:155], v[236:239], v[80:83]
  v_mfma_f32_16x16x32_bf16 v[80:83], a[156:159], v[240:243], v[80:83]
  s_mov_b32 s38, 16384
  v_mfma_f32_16x16x32_bf16 v[72:75], a[156:159], v[224:227], 0
  s_add_u32 m0, s29, 89984
  ds_read_b128 a[172:175], v9 offset:12288
  v_mfma_f32_16x16x32_bf16 v[72:75], a[152:155], v[220:223], v[72:75]
  buffer_load_dwordx4 v23, s[12:15], s38 offen offset:128 lds
  v_mfma_f32_16x16x32_bf16 v[72:75], a[148:151], v[216:219], v[72:75]
  v_mfma_f32_16x16x32_bf16 v[72:75], a[144:147], v[212:215], v[72:75]
  s_mov_b32 s38, 24576
  v_mfma_f32_16x16x32_bf16 v[64:67], a[144:147], v[196:199], 0
  s_add_u32 m0, s29, 86016
  ds_read_b128 a[176:179], v8 offset:6144
  v_mfma_f32_16x16x32_bf16 v[64:67], a[148:151], v[200:203], v[64:67]
  buffer_load_dwordx4 v23, s[12:15], s38 offen lds
  v_mfma_f32_16x16x32_bf16 v[64:67], a[152:155], v[204:207], v[64:67]
  v_mfma_f32_16x16x32_bf16 v[64:67], a[156:159], v[208:211], v[64:67]
  s_mov_b32 s38, 24576
  v_mfma_f32_16x16x32_bf16 v[56:59], a[156:159], v[192:195], 0
  s_add_u32 m0, s29, 94080
  ds_read_b128 a[180:183], v9 offset:6144
  v_mfma_f32_16x16x32_bf16 v[56:59], a[152:155], v[188:191], v[56:59]
  buffer_load_dwordx4 v23, s[12:15], s38 offen offset:128 lds
  v_mfma_f32_16x16x32_bf16 v[56:59], a[148:151], v[184:187], v[56:59]
  v_mfma_f32_16x16x32_bf16 v[56:59], a[144:147], v[180:183], v[56:59]
  s_waitcnt lgkmcnt(2)
  v_mfma_f32_16x16x32_bf16 v[84:87], a[160:163], v[180:183], 0
  ds_read_b128 a[184:187], v8 offset:14336
  v_mfma_f32_16x16x32_bf16 v[84:87], a[164:167], v[184:187], v[84:87]
  s_mov_b32 s38, 49152
  v_mfma_f32_16x16x32_bf16 v[84:87], a[168:171], v[188:191], v[84:87]
  s_add_u32 m0, s29, 49152
  v_mfma_f32_16x16x32_bf16 v[84:87], a[172:175], v[192:195], v[84:87]
  buffer_load_dwordx4 v22, s[8:11], s38 offen lds
  v_mfma_f32_16x16x32_bf16 v[92:95], a[172:175], v[208:211], 0
  s_mov_b32 s38, 49152
  ds_read_b128 a[188:191], v9 offset:14336
  v_mfma_f32_16x16x32_bf16 v[92:95], a[168:171], v[204:207], v[92:95]
  s_add_u32 m0, s29, 57216
  v_max3_f32 v1, v52, v53, v54
  v_max3_f32 v2, v60, v61, v62
  v_max3_f32 v3, v68, v69, v70
  v_max3_f32 v4, v76, v77, v78
  v_max3_f32 v1, v1, v55, v56
  v_mfma_f32_16x16x32_bf16 v[92:95], a[164:167], v[200:203], v[92:95]
  buffer_load_dwordx4 v22, s[8:11], s38 offen offset:128 lds
  v_max3_f32 v2, v2, v63, v64
  v_max3_f32 v3, v3, v71, v72
  v_max3_f32 v4, v4, v79, v80
  v_mfma_f32_16x16x32_bf16 v[92:95], a[160:163], v[196:199], v[92:95]
  s_waitcnt vmcnt(10)
  v_max3_f32 v1, v1, v57, v58
  v_max3_f32 v2, v2, v65, v66
  v_max3_f32 v3, v3, v73, v74
  v_max3_f32 v4, v4, v81, v82
  v_max_f32 v1, v1, v59
  v_mfma_f32_16x16x32_bf16 v[100:103], a[160:163], v[212:215], 0
  s_waitcnt lgkmcnt(0)
  s_barrier
  s_add_u32 m0, s29, 53248
  s_mov_b32 s38, 57344
  ds_read_b128 a[128:131], v8 offset:16384
  v_max_f32 v2, v2, v67
  v_max_f32 v3, v3, v75
  v_max_f32 v4, v4, v83
  v_mfma_f32_16x16x32_bf16 v[100:103], a[164:167], v[216:219], v[100:103]
  buffer_load_dwordx4 v22, s[8:11], s38 offen lds
  v_mov_b32 v28, v1
  v_mov_b32 v29, v2
  v_mov_b32 v30, v3
  v_mfma_f32_16x16x32_bf16 v[100:103], a[168:171], v[220:223], v[100:103]
  v_mov_b32 v31, v4
  v_permlane16_swap_b32 v1, v28
  v_permlane16_swap_b32 v2, v29
  v_permlane16_swap_b32 v3, v30
  v_permlane16_swap_b32 v4, v31
  v_mfma_f32_16x16x32_bf16 v[100:103], a[172:175], v[224:227], v[100:103]
  s_mov_b32 s38, 57344
  v_max_f32 v1, v1, v28
  v_max_f32 v2, v2, v29
  v_max_f32 v3, v3, v30
  v_max_f32 v4, v4, v31
  v_mfma_f32_16x16x32_bf16 v[108:111], a[172:175], v[240:243], 0
  s_add_u32 m0, s29, 61312
  ds_read_b128 a[132:135], v9 offset:16384
  v_mov_b32 v28, v1
  v_mov_b32 v29, v2
  v_mov_b32 v30, v3
  v_mfma_f32_16x16x32_bf16 v[108:111], a[168:171], v[236:239], v[108:111]
  buffer_load_dwordx4 v22, s[8:11], s38 offen offset:128 lds
  v_mov_b32 v31, v4
  v_permlane32_swap_b32 v1, v28
  v_mfma_f32_16x16x32_bf16 v[108:111], a[164:167], v[232:235], v[108:111]
  v_permlane32_swap_b32 v2, v29
  v_permlane32_swap_b32 v3, v30
  v_permlane32_swap_b32 v4, v31
  v_max_f32 v1, v1, v28
  v_mfma_f32_16x16x32_bf16 v[108:111], a[160:163], v[228:231], v[108:111]
  s_waitcnt lgkmcnt(2)
  v_max_f32 v2, v2, v29
  v_max_f32 v3, v3, v30
  v_max_f32 v4, v4, v31
  v_add_f32 v1, v7, v1
  v_mfma_f32_16x16x32_bf16 v[112:115], a[176:179], v[228:231], 0
  ds_read_b128 a[136:139], v8 offset:24576
  v_add_f32 v2, v7, v2
  v_add_f32 v3, v7, v3
  v_add_f32 v4, v7, v4
  v_mfma_f32_16x16x32_bf16 v[112:115], a[180:183], v[232:235], v[112:115]
  v_sub_f32 v52, v52, v1
  v_sub_f32 v53, v53, v1
  v_sub_f32 v54, v54, v1
  v_sub_f32 v55, v55, v1
  v_mfma_f32_16x16x32_bf16 v[112:115], a[184:187], v[236:239], v[112:115]
  v_sub_f32 v56, v56, v1
  v_sub_f32 v57, v57, v1
  v_sub_f32 v58, v58, v1
  v_sub_f32 v59, v59, v1
  v_mfma_f32_16x16x32_bf16 v[112:115], a[188:191], v[240:243], v[112:115]
  s_mov_b32 s38, 0
  v_sub_f32 v60, v60, v2
  v_sub_f32 v61, v61, v2
  v_sub_f32 v62, v62, v2
  v_sub_f32 v63, v63, v2
  v_mfma_f32_16x16x32_bf16 v[104:107], a[188:191], v[224:227], 0
  s_add_u32 m0, s41, 131072
  ds_read_b128 a[140:143], v9 offset:24576
  v_sub_f32 v64, v64, v2
  v_sub_f32 v65, v65, v2
  v_sub_f32 v66, v66, v2
  v_mfma_f32_16x16x32_bf16 v[104:107], a[184:187], v[220:223], v[104:107]
  buffer_load_dwordx4 v244, s[68:71], s38 offen lds
  v_sub_f32 v67, v67, v2
  v_sub_f32 v68, v68, v3
  v_mfma_f32_16x16x32_bf16 v[104:107], a[180:183], v[216:219], v[104:107]
  v_sub_f32 v69, v69, v3
  v_sub_f32 v70, v70, v3
  v_sub_f32 v71, v71, v3
  v_sub_f32 v72, v72, v3
  v_mfma_f32_16x16x32_bf16 v[104:107], a[176:179], v[212:215], v[104:107]
  s_mov_b32 s38, 10240
  v_sub_f32 v73, v73, v3
  v_sub_f32 v74, v74, v3
  v_sub_f32 v75, v75, v3
  v_sub_f32 v76, v76, v4
  v_mfma_f32_16x16x32_bf16 v[96:99], a[176:179], v[196:199], 0
  s_add_u32 m0, s41, 132096
  ds_read_b128 a[144:147], v8 offset:18432
  v_sub_f32 v77, v77, v4
  v_sub_f32 v78, v78, v4
  v_sub_f32 v79, v79, v4
  v_mfma_f32_16x16x32_bf16 v[96:99], a[180:183], v[200:203], v[96:99]
  buffer_load_dwordx4 v244, s[68:71], s38 offen lds
  v_sub_f32 v80, v80, v4
  v_sub_f32 v81, v81, v4
  v_mfma_f32_16x16x32_bf16 v[96:99], a[184:187], v[204:207], v[96:99]
  v_sub_f32 v82, v82, v4
  v_sub_f32 v83, v83, v4
  v_sub_f32 v116, 0, v1
  v_sub_f32 v117, 0, v1
  v_mfma_f32_16x16x32_bf16 v[96:99], a[188:191], v[208:211], v[96:99]
  s_mov_b32 s38, 20480
  v_sub_f32 v118, 0, v1
  v_sub_f32 v119, 0, v1
  v_sub_f32 v120, 0, v2
  v_sub_f32 v121, 0, v2
  v_mfma_f32_16x16x32_bf16 v[88:91], a[188:191], v[192:195], 0
  s_add_u32 m0, s41, 133120
  ds_read_b128 a[148:151], v9 offset:18432
  v_sub_f32 v122, 0, v2
  v_sub_f32 v123, 0, v2
  v_sub_f32 v124, 0, v3
  v_mfma_f32_16x16x32_bf16 v[88:91], a[184:187], v[188:191], v[88:91]
  buffer_load_dwordx4 v244, s[68:71], s38 offen lds
  v_sub_f32 v125, 0, v3
  v_sub_f32 v126, 0, v3
  v_mfma_f32_16x16x32_bf16 v[88:91], a[180:183], v[184:187], v[88:91]
  s_add_u32 m0, s41, 134144
  s_mov_b32 s38, 30720
  v_sub_f32 v127, 0, v3
  v_sub_f32 v128, 0, v4
  v_sub_f32 v129, 0, v4
  v_mfma_f32_16x16x32_bf16 v[88:91], a[176:179], v[180:183], v[88:91]
  s_waitcnt lgkmcnt(2)
  buffer_load_dwordx4 v244, s[68:71], s38 offen lds
  s_add_u32 m0, s41, 135168
  s_mov_b32 s38, 0
  buffer_load_dwordx4 v244, s[72:75], s38 offen lds
  s_add_u32 m0, s41, 136192
  s_mov_b32 s38, 10240
  buffer_load_dwordx4 v244, s[72:75], s38 offen lds
  s_add_u32 m0, s41, 137216
  s_mov_b32 s38, 20480
  buffer_load_dwordx4 v244, s[72:75], s38 offen lds
  s_add_u32 m0, s41, 138240
  s_mov_b32 s38, 30720
  buffer_load_dwordx4 v244, s[72:75], s38 offen lds
  v_sub_f32 v130, 0, v4
  v_sub_f32 v131, 0, v4
  v_add_u32 v18, s41, v18
  v_add_u32 v19, s41, v19
  v_add_u32 v20, s41, v20
  v_add_u32 v21, s41, v21
  v_exp_f32 v28, v52
  v_exp_f32 v29, v53
  v_exp_f32 v30, v54
  v_exp_f32 v31, v55
  v_cvt_pk_bf16_f32 v132, v28, v29
  v_exp_f32 v32, v56
  v_exp_f32 v33, v57
  v_cvt_pk_bf16_f32 v133, v30, v31
  v_exp_f32 v34, v58
  v_exp_f32 v35, v59
  v_cvt_pk_bf16_f32 v134, v32, v33
  v_exp_f32 v28, v60
  v_exp_f32 v29, v61
  v_cvt_pk_bf16_f32 v135, v34, v35
  v_exp_f32 v30, v62
  v_exp_f32 v31, v63
  v_cvt_pk_bf16_f32 v136, v28, v29
  v_exp_f32 v32, v64
  v_exp_f32 v33, v65
  v_cvt_pk_bf16_f32 v137, v30, v31
  v_exp_f32 v34, v66
  v_exp_f32 v35, v67
  v_cvt_pk_bf16_f32 v138, v32, v33
  v_exp_f32 v28, v68
  v_exp_f32 v29, v69
  v_cvt_pk_bf16_f32 v139, v34, v35
  v_exp_f32 v30, v70
  v_exp_f32 v31, v71
  v_cvt_pk_bf16_f32 v140, v28, v29
  v_exp_f32 v32, v72
  v_exp_f32 v33, v73
  v_cvt_pk_bf16_f32 v141, v30, v31
  v_exp_f32 v34, v74
  v_exp_f32 v35, v75
  v_cvt_pk_bf16_f32 v142, v32, v33
  v_exp_f32 v28, v76
  v_exp_f32 v29, v77
  v_cvt_pk_bf16_f32 v143, v34, v35
  v_exp_f32 v30, v78
  v_exp_f32 v31, v79
  v_cvt_pk_bf16_f32 v144, v28, v29
  v_exp_f32 v32, v80
  v_exp_f32 v33, v81
  v_cvt_pk_bf16_f32 v145, v30, v31
  v_exp_f32 v34, v82
  v_exp_f32 v35, v83
  v_cvt_pk_bf16_f32 v146, v32, v33
  v_cvt_pk_bf16_f32 v147, v34, v35
  v_sub_f32 v84, v84, v1
  v_sub_f32 v85, v85, v1
  v_sub_f32 v86, v86, v1
  v_sub_f32 v87, v87, v1
  v_sub_f32 v88, v88, v1
  v_sub_f32 v89, v89, v1
  v_sub_f32 v90, v90, v1
  v_sub_f32 v91, v91, v1
  v_sub_f32 v92, v92, v2
  v_sub_f32 v93, v93, v2
  v_sub_f32 v94, v94, v2
  v_sub_f32 v95, v95, v2
  v_sub_f32 v96, v96, v2
  v_sub_f32 v97, v97, v2
  v_sub_f32 v98, v98, v2
  v_sub_f32 v99, v99, v2
  v_sub_f32 v100, v100, v3
  v_sub_f32 v101, v101, v3
  v_sub_f32 v102, v102, v3
  v_sub_f32 v103, v103, v3
  v_sub_f32 v104, v104, v3
  v_sub_f32 v105, v105, v3
  v_sub_f32 v106, v106, v3
  v_sub_f32 v107, v107, v3
  v_sub_f32 v108, v108, v4
  v_sub_f32 v109, v109, v4
  v_sub_f32 v110, v110, v4
  v_sub_f32 v111, v111, v4
  v_sub_f32 v112, v112, v4
  v_sub_f32 v113, v113, v4
  v_sub_f32 v114, v114, v4
  v_sub_f32 v115, v115, v4
  v_mfma_f32_16x16x32_bf16 v[52:55], a[128:131], v[180:183], v[116:119]
  ds_read_b128 a[152:155], v8 offset:26624
  v_exp_f32 v28, v84
  v_exp_f32 v29, v85
  v_mfma_f32_16x16x32_bf16 v[52:55], a[132:135], v[184:187], v[52:55]
  v_exp_f32 v30, v86
  v_exp_f32 v31, v87
  v_mfma_f32_16x16x32_bf16 v[52:55], a[136:139], v[188:191], v[52:55]
  s_add_u32 m0, s29, 0
  v_cvt_pk_bf16_f32 v148, v28, v29
  v_exp_f32 v32, v88
  v_cvt_pk_bf16_f32 v149, v30, v31
  v_mfma_f32_16x16x32_bf16 v[52:55], a[140:143], v[192:195], v[52:55]
  buffer_load_dwordx4 v22, s[8:11], s32 offen lds
  v_exp_f32 v33, v89
  v_mfma_f32_16x16x32_bf16 v[60:63], a[140:143], v[208:211], v[120:123]
  ds_read_b128 a[156:159], v9 offset:26624
  v_or_b32 v3, v148, v149
  v_exp_f32 v34, v90
  v_mfma_f32_16x16x32_bf16 v[60:63], a[136:139], v[204:207], v[60:63]
  v_exp_f32 v35, v91
  v_exp_f32 v28, v92
  v_mfma_f32_16x16x32_bf16 v[60:63], a[132:135], v[200:203], v[60:63]
  v_cvt_pk_bf16_f32 v150, v32, v33
  v_exp_f32 v29, v93
  v_cvt_pk_bf16_f32 v151, v34, v35
  v_mfma_f32_16x16x32_bf16 v[60:63], a[128:131], v[196:199], v[60:63]
  v_or_b32 v1, v150, v151
  v_exp_f32 v30, v94
  v_cvt_pk_bf16_f32 v152, v28, v29
  v_mfma_f32_16x16x32_bf16 v[68:71], a[128:131], v[212:215], v[124:127]
  ds_read_b128 a[160:163], v8 offset:20480
  v_exp_f32 v31, v95
  v_exp_f32 v32, v96
  v_mfma_f32_16x16x32_bf16 v[68:71], a[132:135], v[216:219], v[68:71]
  v_exp_f32 v33, v97
  v_exp_f32 v34, v98
  v_mfma_f32_16x16x32_bf16 v[68:71], a[136:139], v[220:223], v[68:71]
  s_add_u32 m0, s29, 8064
  v_cvt_pk_bf16_f32 v153, v30, v31
  v_or3_b32 v3, v3, v152, v153
  v_exp_f32 v35, v99
  v_mfma_f32_16x16x32_bf16 v[68:71], a[140:143], v[224:227], v[68:71]
  buffer_load_dwordx4 v22, s[8:11], s32 offen offset:128 lds
  v_cvt_pk_bf16_f32 v154, v32, v33
  v_cvt_pk_bf16_f32 v155, v34, v35
  v_mfma_f32_16x16x32_bf16 v[76:79], a[140:143], v[240:243], v[128:131]
  ds_read_b128 a[164:167], v9 offset:20480
  v_exp_f32 v28, v100
  v_or3_b32 v1, v1, v154, v155
  v_mfma_f32_16x16x32_bf16 v[76:79], a[136:139], v[236:239], v[76:79]
  v_exp_f32 v29, v101
  v_exp_f32 v30, v102
  v_mfma_f32_16x16x32_bf16 v[76:79], a[132:135], v[232:235], v[76:79]
  v_exp_f32 v31, v103
  v_cvt_pk_bf16_f32 v156, v28, v29
  v_mfma_f32_16x16x32_bf16 v[76:79], a[128:131], v[228:231], v[76:79]
  s_waitcnt lgkmcnt(2)
  v_exp_f32 v32, v104
  v_cvt_pk_bf16_f32 v157, v30, v31
  v_mfma_f32_16x16x32_bf16 v[80:83], a[144:147], v[228:231], v[128:131]
  ds_read_b128 a[168:171], v8 offset:28672
  v_exp_f32 v33, v105
  v_mfma_f32_16x16x32_bf16 v[80:83], a[148:151], v[232:235], v[80:83]
  v_or3_b32 v3, v3, v156, v157
  v_exp_f32 v34, v106
  v_mfma_f32_16x16x32_bf16 v[80:83], a[152:155], v[236:239], v[80:83]
  v_exp_f32 v35, v107
  v_cvt_pk_bf16_f32 v158, v32, v33
  v_mfma_f32_16x16x32_bf16 v[80:83], a[156:159], v[240:243], v[80:83]
  v_exp_f32 v28, v108
  v_cvt_pk_bf16_f32 v159, v34, v35
  v_mfma_f32_16x16x32_bf16 v[72:75], a[156:159], v[224:227], v[124:127]
  s_add_u32 m0, s29, 4096
  ds_read_b128 a[172:175], v9 offset:28672
  v_exp_f32 v29, v109
  v_mfma_f32_16x16x32_bf16 v[72:75], a[152:155], v[220:223], v[72:75]
  buffer_load_dwordx4 v22, s[8:11], s34 offen lds
  v_or3_b32 v1, v1, v158, v159
  v_mfma_f32_16x16x32_bf16 v[72:75], a[148:151], v[216:219], v[72:75]
  v_exp_f32 v30, v110
  v_cvt_pk_bf16_f32 v160, v28, v29
  v_mfma_f32_16x16x32_bf16 v[72:75], a[144:147], v[212:215], v[72:75]
  v_exp_f32 v31, v111
  v_exp_f32 v32, v112
  v_mfma_f32_16x16x32_bf16 v[64:67], a[144:147], v[196:199], v[120:123]
  ds_read_b128 a[176:179], v8 offset:22528
  v_cvt_pk_bf16_f32 v161, v30, v31
  v_mfma_f32_16x16x32_bf16 v[64:67], a[148:151], v[200:203], v[64:67]
  v_exp_f32 v33, v113
  v_or3_b32 v3, v3, v160, v161
  v_mfma_f32_16x16x32_bf16 v[64:67], a[152:155], v[204:207], v[64:67]
  v_exp_f32 v34, v114
  v_cvt_pk_bf16_f32 v162, v32, v33
  v_mfma_f32_16x16x32_bf16 v[64:67], a[156:159], v[208:211], v[64:67]
  v_exp_f32 v35, v115
  v_mfma_f32_16x16x32_bf16 v[56:59], a[156:159], v[192:195], v[116:119]
  s_add_u32 m0, s29, 12160
  ds_read_b128 a[180:183], v9 offset:22528
  v_cvt_pk_bf16_f32 v163, v34, v35
  v_or3_b32 v1, v1, v162, v163
  v_bitop3_b32 v1, v1, v3, v6 bitop3:0xa8
  v_mfma_f32_16x16x32_bf16 v[56:59], a[152:155], v[188:191], v[56:59]
  buffer_load_dwordx4 v22, s[8:11], s34 offen offset:128 lds
  v_cmp_ne_u32 vcc, 0, v1
  v_mfma_f32_16x16x32_bf16 v[56:59], a[148:151], v[184:187], v[56:59]
  s_waitcnt lgkmcnt(2)
  v_mfma_f32_16x16x32_bf16 v[56:59], a[144:147], v[180:183], v[56:59]
  s_cbranch_vccnz L_rarez0a
L_retz0a:
  v_mfma_f32_16x16x32_bf16 v[84:87], a[160:163], v[180:183], v[116:119]
  ds_read_b128 a[184:187], v8 offset:30720
  v_mfma_f32_16x16x32_bf16 v[84:87], a[164:167], v[184:187], v[84:87]
  v_exp_f32 v28, v52
  v_mfma_f32_16x16x32_bf16 v[84:87], a[168:171], v[188:191], v[84:87]
  v_exp_f32 v29, v53
  v_mfma_f32_16x16x32_bf16 v[84:87], a[172:175], v[192:195], v[84:87]
  v_exp_f32 v30, v54
  v_mfma_f32_16x16x32_bf16 v[92:95], a[172:175], v[208:211], v[120:123]
  ds_read_b128 a[188:191], v9 offset:30720
  v_cvt_pk_bf16_f32 v164, v28, v29
  v_mfma_f32_16x16x32_bf16 v[92:95], a[168:171], v[204:207], v[92:95]
  s_add_u32 m0, s29, 98304
  v_exp_f32 v31, v55
  v_mfma_f32_16x16x32_bf16 v[92:95], a[164:167], v[200:203], v[92:95]
  buffer_load_dwordx4 v23, s[12:15], s33 offen lds
  v_mfma_f32_16x16x32_bf16 v[92:95], a[160:163], v[196:199], v[92:95]
  v_exp_f32 v32, v56
  v_mfma_f32_16x16x32_bf16 v[100:103], a[160:163], v[212:215], v[124:127]
  ds_read_b64_tr_b16 a[128:129], v10 offset:0
  v_cvt_pk_bf16_f32 v165, v30, v31
  v_mfma_f32_16x16x32_bf16 v[100:103], a[164:167], v[216:219], v[100:103]
  ds_read_b64_tr_b16 a[130:131], v10 offset:2048
  v_or_b32 v3, v164, v165
  v_mfma_f32_16x16x32_bf16 v[100:103], a[168:171], v[220:223], v[100:103]
  v_exp_f32 v33, v57
  v_mfma_f32_16x16x32_bf16 v[100:103], a[172:175], v[224:227], v[100:103]
  v_exp_f32 v34, v58
  v_mfma_f32_16x16x32_bf16 v[108:111], a[172:175], v[240:243], v[128:131]
  ds_read_b64_tr_b16 a[132:133], v10 offset:4096
  v_cvt_pk_bf16_f32 v166, v32, v33
  v_mfma_f32_16x16x32_bf16 v[108:111], a[168:171], v[236:239], v[108:111]
  ds_read_b64_tr_b16 a[134:135], v10 offset:6144
  v_mfma_f32_16x16x32_bf16 v[108:111], a[164:167], v[232:235], v[108:111]
  s_add_u32 m0, s29, 106368
  v_exp_f32 v35, v59
  v_mfma_f32_16x16x32_bf16 v[108:111], a[160:163], v[228:231], v[108:111]
  s_waitcnt lgkmcnt(4)
  buffer_load_dwordx4 v23, s[12:15], s33 offen offset:128 lds
  v_mfma_f32_16x16x32_bf16 v[112:115], a[176:179], v[228:231], v[128:131]
  ds_read_b64_tr_b16 a[136:137], v11 offset:0
  v_cvt_pk_bf16_f32 v167, v34, v35
  v_mfma_f32_16x16x32_bf16 v[112:115], a[180:183], v[232:235], v[112:115]
  ds_read_b64_tr_b16 a[138:139], v11 offset:2048
  v_or_b32 v1, v166, v167
  v_mfma_f32_16x16x32_bf16 v[112:115], a[184:187], v[236:239], v[112:115]
  v_exp_f32 v28, v60
  v_mfma_f32_16x16x32_bf16 v[112:115], a[188:191], v[240:243], v[112:115]
  v_exp_f32 v29, v61
  v_mfma_f32_16x16x32_bf16 v[104:107], a[188:191], v[224:227], v[124:127]
  ds_read_b64_tr_b16 a[140:141], v11 offset:4096
  v_cvt_pk_bf16_f32 v168, v28, v29
  v_mfma_f32_16x16x32_bf16 v[104:107], a[184:187], v[220:223], v[104:107]
  ds_read_b64_tr_b16 a[142:143], v11 offset:6144
  v_mfma_f32_16x16x32_bf16 v[104:107], a[180:183], v[216:219], v[104:107]
  v_exp_f32 v30, v62
  v_mfma_f32_16x16x32_bf16 v[104:107], a[176:179], v[212:215], v[104:107]
  v_exp_f32 v31, v63
  v_mfma_f32_16x16x32_bf16 v[96:99], a[176:179], v[196:199], v[120:123]
  ds_read_b64_tr_b16 a[144:145], v12 offset:0
  v_cvt_pk_bf16_f32 v169, v30, v31
  v_mfma_f32_16x16x32_bf16 v[96:99], a[180:183], v[200:203], v[96:99]
  s_add_u32 m0, s29, 102400
  ds_read_b64_tr_b16 a[146:147], v12 offset:2048
  v_or3_b32 v3, v3, v168, v169
  v_mfma_f32_16x16x32_bf16 v[96:99], a[184:187], v[204:207], v[96:99]
  buffer_load_dwordx4 v23, s[12:15], s35 offen lds
  v_mfma_f32_16x16x32_bf16 v[96:99], a[188:191], v[208:211], v[96:99]
  v_exp_f32 v32, v64
  v_mfma_f32_16x16x32_bf16 v[88:91], a[188:191], v[192:195], v[116:119]
  ds_read_b64_tr_b16 a[148:149], v12 offset:4096
  v_mfma_f32_16x16x32_bf16 v[88:91], a[184:187], v[188:191], v[88:91]
  ds_read_b64_tr_b16 a[150:151], v12 offset:6144
  v_mfma_f32_16x16x32_bf16 v[88:91], a[180:183], v[184:187], v[88:91]
  v_exp_f32 v33, v65
  v_mfma_f32_16x16x32_bf16 v[88:91], a[176:179], v[180:183], v[88:91]
  s_waitcnt lgkmcnt(4)
  v_exp_f32 v34, v66
  v_mfma_f32_16x16x32_bf16 a[0:3], a[128:131], v[132:135], 0
  ds_read_b64_tr_b16 a[152:153], v13 offset:0
  v_cvt_pk_bf16_f32 v170, v32, v33
  v_mfma_f32_16x16x32_bf16 a[0:3], a[132:135], v[148:151], a[0:3]
  s_add_u32 m0, s29, 110464
  ds_read_b64_tr_b16 a[154:155], v13 offset:2048
  v_mfma_f32_16x16x32_bf16 a[32:35], a[132:135], v[152:155], 0
  buffer_load_dwordx4 v23, s[12:15], s35 offen offset:128 lds
  v_mfma_f32_16x16x32_bf16 a[32:35], a[128:131], v[136:139], a[32:35]
  v_exp_f32 v35, v67
  v_mfma_f32_16x16x32_bf16 a[64:67], a[128:131], v[140:143], 0
  ds_read_b64_tr_b16 a[156:157], v13 offset:4096
  v_cvt_pk_bf16_f32 v171, v34, v35
  v_mfma_f32_16x16x32_bf16 a[64:67], a[132:135], v[156:159], a[64:67]
  ds_read_b64_tr_b16 a[158:159], v13 offset:6144
  v_or3_b32 v1, v1, v170, v171
  v_mfma_f32_16x16x32_bf16 a[96:99], a[132:135], v[160:163], 0
  v_exp_f32 v28, v68
  v_mfma_f32_16x16x32_bf16 a[96:99], a[128:131], v[144:147], a[96:99]
  v_exp_f32 v29, v69
  v_mfma_f32_16x16x32_bf16 a[100:103], a[136:139], v[144:147], 0
  v_exp_f32 v30, v70
  v_mfma_f32_16x16x32_bf16 a[100:103], a[140:143], v[160:163], a[100:103]
  v_exp_f32 v31, v71
  v_mfma_f32_16x16x32_bf16 a[68:71], a[140:143], v[156:159], 0
  v_cvt_pk_bf16_f32 v172, v28, v29
  v_cvt_pk_bf16_f32 v173, v30, v31
  v_mfma_f32_16x16x32_bf16 a[68:71], a[136:139], v[140:143], a[68:71]
  s_waitcnt vmcnt(8)
  v_exp_f32 v32, v72
  v_mfma_f32_16x16x32_bf16 a[36:39], a[136:139], v[136:139], 0
  s_barrier
  ds_read_b128 a[160:163], v8 offset:32768
  v_mfma_f32_16x16x32_bf16 a[36:39], a[140:143], v[152:155], a[36:39]
  v_exp_f32 v33, v73
  v_mfma_f32_16x16x32_bf16 a[4:7], a[140:143], v[148:151], 0
  v_or3_b32 v3, v3, v172, v173
  v_cvt_pk_bf16_f32 v174, v32, v33
  v_mfma_f32_16x16x32_bf16 a[4:7], a[136:139], v[132:135], a[4:7]
  s_waitcnt lgkmcnt(1)
  v_exp_f32 v34, v74
  v_mfma_f32_16x16x32_bf16 a[8:11], a[144:147], v[132:135], 0
  ds_read_b128 a[164:167], v9 offset:32768
  v_mfma_f32_16x16x32_bf16 a[8:11], a[148:151], v[148:151], a[8:11]
  v_exp_f32 v35, v75
  v_mfma_f32_16x16x32_bf16 a[40:43], a[148:151], v[152:155], 0
  v_exp_f32 v28, v76
  v_mfma_f32_16x16x32_bf16 a[40:43], a[144:147], v[136:139], a[40:43]
  v_exp_f32 v29, v77
  v_mfma_f32_16x16x32_bf16 a[72:75], a[144:147], v[140:143], 0
  ds_read_b128 a[168:171], v8 offset:40960
  v_cvt_pk_bf16_f32 v175, v34, v35
  v_mfma_f32_16x16x32_bf16 a[72:75], a[148:151], v[156:159], a[72:75]
  v_or3_b32 v1, v1, v174, v175
  v_cvt_pk_bf16_f32 v176, v28, v29
  v_mfma_f32_16x16x32_bf16 a[104:107], a[148:151], v[160:163], 0
  v_exp_f32 v30, v78
  v_mfma_f32_16x16x32_bf16 a[104:107], a[144:147], v[144:147], a[104:107]
  v_exp_f32 v31, v79
  v_mfma_f32_16x16x32_bf16 a[108:111], a[152:155], v[144:147], 0
  ds_read_b128 a[172:175], v9 offset:40960
  v_cvt_pk_bf16_f32 v177, v30, v31
  v_mfma_f32_16x16x32_bf16 a[108:111], a[156:159], v[160:163], a[108:111]
  v_exp_f32 v32, v80
  v_mfma_f32_16x16x32_bf16 a[76:79], a[156:159], v[156:159], 0
  v_exp_f32 v33, v81
  v_mfma_f32_16x16x32_bf16 a[76:79], a[152:155], v[140:143], a[76:79]
  v_or3_b32 v3, v3, v176, v177
  v_cvt_pk_bf16_f32 v178, v32, v33
  v_mfma_f32_16x16x32_bf16 a[44:47], a[152:155], v[136:139], 0
  ds_read_b128 a[176:179], v8 offset:34816
  v_mfma_f32_16x16x32_bf16 a[44:47], a[156:159], v[152:155], a[44:47]
  v_exp_f32 v34, v82
  v_mfma_f32_16x16x32_bf16 a[12:15], a[156:159], v[148:151], 0
  s_add_u32 s35, s35, 16384
  v_exp_f32 v35, v83
  v_mfma_f32_16x16x32_bf16 a[12:15], a[152:155], v[132:135], a[12:15]
  s_add_u32 s34, s34, 16384
  v_cvt_pk_bf16_f32 v179, v34, v35
  v_or3_b32 v1, v1, v178, v179
  v_mfma_f32_16x16x32_bf16 a[224:227], a[240:243], v[132:135], a[224:227]
  s_add_u32 s33, s33, 16384
  ds_read_b128 a[180:183], v9 offset:34816
  v_bitop3_b32 v1, v1, v3, v6 bitop3:0xa8
  v_mfma_f32_16x16x32_bf16 a[224:227], a[240:243], v[148:151], a[224:227]
  s_add_u32 s32, s32, 16384
  v_cmp_ne_u32 vcc, 0, v1
  v_mfma_f32_16x16x32_bf16 a[228:231], a[240:243], v[136:139], a[228:231]
  s_waitcnt lgkmcnt(2)
  v_mfma_f32_16x16x32_bf16 a[228:231], a[240:243], v[152:155], a[228:231]
  s_cbranch_vccnz L_rarez0b
L_retz0b:
L_loop:
  s_bitcmp1_b32 s91, s36
  s_cbranch_scc1 L_sidejob
L_sideret:
  v_mfma_f32_16x16x32_bf16 v[52:55], a[160:163], v[180:183], v[116:119]
  ds_read_b128 a[184:187], v8 offset:43008
  v_mfma_f32_16x16x32_bf16 v[52:55], a[164:167], v[184:187], v[52:55]
  v_exp_f32 v28, v84
  v_mfma_f32_16x16x32_bf16 v[52:55], a[168:171], v[188:191], v[52:55]
  s_add_u32 m0, s29, 16384
  v_exp_f32 v29, v85
  v_mfma_f32_16x16x32_bf16 v[52:55], a[172:175], v[192:195], v[52:55]
  buffer_load_dwordx4 v22, s[8:11], s32 offen lds
  v_mfma_f32_16x16x32_bf16 v[60:63], a[172:175], v[208:211], v[120:123]
  ds_read_b128 a[188:191], v9 offset:43008
  v_cvt_pk_bf16_f32 v36, v28, v29
  v_mfma_f32_16x16x32_bf16 v[60:63], a[168:171], v[204:207], v[60:63]
  v_exp_f32 v30, v86
  v_mfma_f32_16x16x32_bf16 v[60:63], a[164:167], v[200:203], v[60:63]
  v_exp_f32 v31, v87
  v_mfma_f32_16x16x32_bf16 v[60:63], a[160:163], v[196:199], v[60:63]
  v_exp_f32 v32, v88
  v_mfma_f32_16x16x32_bf16 v[68:71], a[160:163], v[212:215], v[124:127]
  ds_read_b64_tr_b16 a[128:129], v10 offset:8192
  v_cvt_pk_bf16_f32 v37, v30, v31
  v_mfma_f32_16x16x32_bf16 v[68:71], a[164:167], v[216:219], v[68:71]
  ds_read_b64_tr_b16 a[130:131], v10 offset:10240
  v_or_b32 v3, v36, v37
  v_mfma_f32_16x16x32_bf16 v[68:71], a[168:171], v[220:223], v[68:71]
  v_exp_f32 v33, v89
  v_mfma_f32_16x16x32_bf16 v[68:71], a[172:175], v[224:227], v[68:71]
  v_exp_f32 v34, v90
  v_mfma_f32_16x16x32_bf16 v[76:79], a[172:175], v[240:243], v[128:131]
  ds_read_b64_tr_b16 a[132:133], v10 offset:12288
  v_cvt_pk_bf16_f32 v38, v32, v33
  v_mfma_f32_16x16x32_bf16 v[76:79], a[168:171], v[236:239], v[76:79]
  ds_read_b64_tr_b16 a[134:135], v10 offset:14336
  v_mfma_f32_16x16x32_bf16 v[76:79], a[164:167], v[232:235], v[76:79]
  s_add_u32 m0, s29, 24448
  v_exp_f32 v35, v91
  v_mfma_f32_16x16x32_bf16 v[76:79], a[160:163], v[228:231], v[76:79]
  s_waitcnt lgkmcnt(4)
  buffer_load_dwordx4 v22, s[8:11], s32 offen offset:128 lds
  v_mfma_f32_16x16x32_bf16 v[80:83], a[176:179], v[228:231], v[128:131]
  ds_read_b64_tr_b16 a[136:137], v11 offset:8192
  v_cvt_pk_bf16_f32 v39, v34, v35
  v_mfma_f32_16x16x32_bf16 v[80:83], a[180:183], v[232:235], v[80:83]
  ds_read_b64_tr_b16 a[138:139], v11 offset:10240
  v_or_b32 v1, v38, v39
  v_mfma_f32_16x16x32_bf16 v[80:83], a[184:187], v[236:239], v[80:83]
  v_exp_f32 v28, v92
  v_mfma_f32_16x16x32_bf16 v[80:83], a[188:191], v[240:243], v[80:83]
  v_exp_f32 v29, v93
  v_mfma_f32_16x16x32_bf16 v[72:75], a[188:191], v[224:227], v[124:127]
  ds_read_b64_tr_b16 a[140:141], v11 offset:12288
  v_cvt_pk_bf16_f32 v40, v28, v29
  v_mfma_f32_16x16x32_bf16 v[72:75], a[184:187], v[220:223], v[72:75]
  ds_read_b64_tr_b16 a[142:143], v11 offset:14336
  v_mfma_f32_16x16x32_bf16 v[72:75], a[180:183], v[216:219], v[72:75]
  v_exp_f32 v30, v94
  v_mfma_f32_16x16x32_bf16 v[72:75], a[176:179], v[212:215], v[72:75]
  v_exp_f32 v31, v95
  v_mfma_f32_16x16x32_bf16 v[64:67], a[176:179], v[196:199], v[120:123]
  ds_read_b64_tr_b16 a[144:145], v12 offset:8192
  v_cvt_pk_bf16_f32 v41, v30, v31
  v_mfma_f32_16x16x32_bf16 v[64:67], a[180:183], v[200:203], v[64:67]
  ds_read_b64_tr_b16 a[146:147], v12 offset:10240
  v_or3_b32 v3, v3, v40, v41
  v_mfma_f32_16x16x32_bf16 v[64:67], a[184:187], v[204:207], v[64:67]
  v_exp_f32 v32, v96
  v_mfma_f32_16x16x32_bf16 v[64:67], a[188:191], v[208:211], v[64:67]
  v_exp_f32 v33, v97
  v_mfma_f32_16x16x32_bf16 v[56:59], a[188:191], v[192:195], v[116:119]
  ds_read_b64_tr_b16 a[148:149], v12 offset:12288
  v_cvt_pk_bf16_f32 v42, v32, v33
  v_mfma_f32_16x16x32_bf16 v[56:59], a[184:187], v[188:191], v[56:59]
  s_add_u32 m0, s29, 20480
  ds_read_b64_tr_b16 a[150:151], v12 offset:14336
  v_mfma_f32_16x16x32_bf16 v[56:59], a[180:183], v[184:187], v[56:59]
  buffer_load_dwordx4 v22, s[8:11], s34 offen lds
  v_mfma_f32_16x16x32_bf16 v[56:59], a[176:179], v[180:183], v[56:59]
  s_waitcnt lgkmcnt(4)
  v_exp_f32 v34, v98
  v_mfma_f32_16x16x32_bf16 a[16:19], a[128:131], v[132:135], a[16:19]
  ds_read_b64_tr_b16 a[152:153], v13 offset:8192
  v_mfma_f32_16x16x32_bf16 a[16:19], a[132:135], v[148:151], a[16:19]
  ds_read_b64_tr_b16 a[154:155], v13 offset:10240
  v_mfma_f32_16x16x32_bf16 a[48:51], a[132:135], v[152:155], a[48:51]
  v_exp_f32 v35, v99
  v_mfma_f32_16x16x32_bf16 a[48:51], a[128:131], v[136:139], a[48:51]
  v_exp_f32 v28, v100
  v_mfma_f32_16x16x32_bf16 a[80:83], a[128:131], v[140:143], a[80:83]
  ds_read_b64_tr_b16 a[156:157], v13 offset:12288
  v_cvt_pk_bf16_f32 v43, v34, v35
  v_mfma_f32_16x16x32_bf16 a[80:83], a[132:135], v[156:159], a[80:83]
  ds_read_b64_tr_b16 a[158:159], v13 offset:14336
  v_or3_b32 v1, v1, v42, v43
  v_mfma_f32_16x16x32_bf16 a[112:115], a[132:135], v[160:163], a[112:115]
  v_exp_f32 v29, v101
  v_mfma_f32_16x16x32_bf16 a[112:115], a[128:131], v[144:147], a[112:115]
  v_exp_f32 v30, v102
  v_mfma_f32_16x16x32_bf16 a[116:119], a[136:139], v[144:147], a[116:119]
  v_exp_f32 v31, v103
  v_mfma_f32_16x16x32_bf16 a[116:119], a[140:143], v[160:163], a[116:119]
  s_add_u32 m0, s29, 28544
  v_cvt_pk_bf16_f32 v44, v28, v29
  v_cvt_pk_bf16_f32 v45, v30, v31
  v_mfma_f32_16x16x32_bf16 a[84:87], a[140:143], v[156:159], a[84:87]
  buffer_load_dwordx4 v22, s[8:11], s34 offen offset:128 lds
  v_mfma_f32_16x16x32_bf16 a[84:87], a[136:139], v[140:143], a[84:87]
  v_exp_f32 v32, v104
  v_mfma_f32_16x16x32_bf16 a[52:55], a[136:139], v[136:139], a[52:55]
  ds_read_b128 a[160:163], v8 offset:36864
  v_or3_b32 v3, v3, v44, v45
  v_mfma_f32_16x16x32_bf16 a[52:55], a[140:143], v[152:155], a[52:55]
  v_exp_f32 v33, v105
  v_mfma_f32_16x16x32_bf16 a[20:23], a[140:143], v[148:151], a[20:23]
  v_exp_f32 v34, v106
  v_mfma_f32_16x16x32_bf16 a[20:23], a[136:139], v[132:135], a[20:23]
  s_waitcnt lgkmcnt(1)
  v_exp_f32 v35, v107
  v_mfma_f32_16x16x32_bf16 a[24:27], a[144:147], v[132:135], a[24:27]
  ds_read_b128 a[164:167], v9 offset:36864
  v_cvt_pk_bf16_f32 v46, v32, v33
  v_mfma_f32_16x16x32_bf16 a[24:27], a[148:151], v[148:151], a[24:27]
  v_exp_f32 v28, v108
  v_mfma_f32_16x16x32_bf16 a[56:59], a[148:151], v[152:155], a[56:59]
  v_exp_f32 v29, v109
  v_mfma_f32_16x16x32_bf16 a[56:59], a[144:147], v[136:139], a[56:59]
  v_cvt_pk_bf16_f32 v47, v34, v35
  v_or3_b32 v1, v1, v46, v47
  v_mfma_f32_16x16x32_bf16 a[88:91], a[144:147], v[140:143], a[88:91]
  ds_read_b128 a[168:171], v8 offset:45056
  v_cvt_pk_bf16_f32 v14, v28, v29
  v_mfma_f32_16x16x32_bf16 a[88:91], a[148:151], v[156:159], a[88:91]
  v_exp_f32 v30, v110
  v_mfma_f32_16x16x32_bf16 a[120:123], a[148:151], v[160:163], a[120:123]
  v_exp_f32 v31, v111
  v_mfma_f32_16x16x32_bf16 a[120:123], a[144:147], v[144:147], a[120:123]
  v_exp_f32 v32, v112
  v_mfma_f32_16x16x32_bf16 a[124:127], a[152:155], v[144:147], a[124:127]
  s_add_u32 m0, s29, 114688
  ds_read_b128 a[172:175], v9 offset:45056
  v_cvt_pk_bf16_f32 v15, v30, v31
  v_mfma_f32_16x16x32_bf16 a[124:127], a[156:159], v[160:163], a[124:127]
  buffer_load_dwordx4 v23, s[12:15], s33 offen lds
  v_mfma_f32_16x16x32_bf16 a[92:95], a[156:159], v[156:159], a[92:95]
  v_exp_f32 v33, v113
  v_mfma_f32_16x16x32_bf16 a[92:95], a[152:155], v[140:143], a[92:95]
  v_or3_b32 v3, v3, v14, v15
  v_cvt_pk_bf16_f32 v16, v32, v33
  v_mfma_f32_16x16x32_bf16 a[60:63], a[152:155], v[136:139], a[60:63]
  ds_read_b128 a[176:179], v8 offset:38912
  v_mfma_f32_16x16x32_bf16 a[60:63], a[156:159], v[152:155], a[60:63]
  v_exp_f32 v34, v114
  v_mfma_f32_16x16x32_bf16 a[28:31], a[156:159], v[148:151], a[28:31]
  v_exp_f32 v35, v115
  v_mfma_f32_16x16x32_bf16 a[28:31], a[152:155], v[132:135], a[28:31]
  v_cvt_pk_bf16_f32 v17, v34, v35
  v_or3_b32 v1, v1, v16, v17
  v_mfma_f32_16x16x32_bf16 a[232:235], a[240:243], v[140:143], a[232:235]
  ds_read_b128 a[180:183], v9 offset:38912
  v_bitop3_b32 v1, v1, v3, v6 bitop3:0xa8
  v_mfma_f32_16x16x32_bf16 a[232:235], a[240:243], v[156:159], a[232:235]
  v_cmp_ne_u32 vcc, 0, v1
  v_mfma_f32_16x16x32_bf16 a[236:239], a[240:243], v[144:147], a[236:239]
  s_waitcnt lgkmcnt(2)
  v_mfma_f32_16x16x32_bf16 a[236:239], a[240:243], v[160:163], a[236:239]
  s_cbranch_vccnz L_rareb1a
L_retb1a:
  v_mfma_f32_16x16x32_bf16 v[84:87], a[160:163], v[180:183], v[116:119]
  s_add_u32 m0, s29, 122752
  ds_read_b128 a[184:187], v8 offset:47104
  v_mfma_f32_16x16x32_bf16 v[84:87], a[164:167], v[184:187], v[84:87]
  buffer_load_dwordx4 v23, s[12:15], s33 offen offset:128 lds
  v_mfma_f32_16x16x32_bf16 v[84:87], a[168:171], v[188:191], v[84:87]
  v_exp_f32 v28, v52
  v_mfma_f32_16x16x32_bf16 v[84:87], a[172:175], v[192:195], v[84:87]
  v_exp_f32 v29, v53
  v_mfma_f32_16x16x32_bf16 v[92:95], a[172:175], v[208:211], v[120:123]
  ds_read_b128 a[188:191], v9 offset:47104
  v_cvt_pk_bf16_f32 v132, v28, v29
  v_mfma_f32_16x16x32_bf16 v[92:95], a[168:171], v[204:207], v[92:95]
  v_exp_f32 v30, v54
  v_mfma_f32_16x16x32_bf16 v[92:95], a[164:167], v[200:203], v[92:95]
  v_exp_f32 v31, v55
  v_mfma_f32_16x16x32_bf16 v[92:95], a[160:163], v[196:199], v[92:95]
  v_exp_f32 v32, v56
  v_mfma_f32_16x16x32_bf16 v[100:103], a[160:163], v[212:215], v[124:127]
  ds_read_b64_tr_b16 a[128:129], v10 offset:16384
  v_cvt_pk_bf16_f32 v133, v30, v31
  v_mfma_f32_16x16x32_bf16 v[100:103], a[164:167], v[216:219], v[100:103]
  ds_read_b64_tr_b16 a[130:131], v10 offset:18432
  v_or_b32 v3, v132, v133
  v_mfma_f32_16x16x32_bf16 v[100:103], a[168:171], v[220:223], v[100:103]
  v_exp_f32 v33, v57
  v_mfma_f32_16x16x32_bf16 v[100:103], a[172:175], v[224:227], v[100:103]
  v_exp_f32 v34, v58
  v_mfma_f32_16x16x32_bf16 v[108:111], a[172:175], v[240:243], v[128:131]
  ds_read_b64_tr_b16 a[132:133], v10 offset:20480
  v_cvt_pk_bf16_f32 v134, v32, v33
  v_mfma_f32_16x16x32_bf16 v[108:111], a[168:171], v[236:239], v[108:111]
  ds_read_b64_tr_b16 a[134:135], v10 offset:22528
  v_mfma_f32_16x16x32_bf16 v[108:111], a[164:167], v[232:235], v[108:111]
  s_add_u32 m0, s29, 118784
  v_exp_f32 v35, v59
  v_mfma_f32_16x16x32_bf16 v[108:111], a[160:163], v[228:231], v[108:111]
  s_waitcnt lgkmcnt(4)
  buffer_load_dwordx4 v23, s[12:15], s35 offen lds
  v_mfma_f32_16x16x32_bf16 v[112:115], a[176:179], v[228:231], v[128:131]
  ds_read_b64_tr_b16 a[136:137], v11 offset:16384
  v_cvt_pk_bf16_f32 v135, v34, v35
  v_mfma_f32_16x16x32_bf16 v[112:115], a[180:183], v[232:235], v[112:115]
  ds_read_b64_tr_b16 a[138:139], v11 offset:18432
  v_or_b32 v1, v134, v135
  v_mfma_f32_16x16x32_bf16 v[112:115], a[184:187], v[236:239], v[112:115]
  v_exp_f32 v28, v60
  v_mfma_f32_16x16x32_bf16 v[112:115], a[188:191], v[240:243], v[112:115]
  v_exp_f32 v29, v61
  v_mfma_f32_16x16x32_bf16 v[104:107], a[188:191], v[224:227], v[124:127]
  ds_read_b64_tr_b16 a[140:141], v11 offset:20480
  v_cvt_pk_bf16_f32 v136, v28, v29
  v_mfma_f32_16x16x32_bf16 v[104:107], a[184:187], v[220:223], v[104:107]
  ds_read_b64_tr_b16 a[142:143], v11 offset:22528
  v_mfma_f32_16x16x32_bf16 v[104:107], a[180:183], v[216:219], v[104:107]
  v_exp_f32 v30, v62
  v_mfma_f32_16x16x32_bf16 v[104:107], a[176:179], v[212:215], v[104:107]
  v_exp_f32 v31, v63
  v_mfma_f32_16x16x32_bf16 v[96:99], a[176:179], v[196:199], v[120:123]
  ds_read_b64_tr_b16 a[144:145], v12 offset:16384
  v_cvt_pk_bf16_f32 v137, v30, v31
  v_mfma_f32_16x16x32_bf16 v[96:99], a[180:183], v[200:203], v[96:99]
  ds_read_b64_tr_b16 a[146:147], v12 offset:18432
  v_or3_b32 v3, v3, v136, v137
  v_mfma_f32_16x16x32_bf16 v[96:99], a[184:187], v[204:207], v[96:99]
  v_exp_f32 v32, v64
  v_mfma_f32_16x16x32_bf16 v[96:99], a[188:191], v[208:211], v[96:99]
  v_exp_f32 v33, v65
  v_mfma_f32_16x16x32_bf16 v[88:91], a[188:191], v[192:195], v[116:119]
  ds_read_b64_tr_b16 a[148:149], v12 offset:20480
  v_cvt_pk_bf16_f32 v138, v32, v33
  v_mfma_f32_16x16x32_bf16 v[88:91], a[184:187], v[188:191], v[88:91]
  s_add_u32 m0, s29, 126848
  ds_read_b64_tr_b16 a[150:151], v12 offset:22528
  v_mfma_f32_16x16x32_bf16 v[88:91], a[180:183], v[184:187], v[88:91]
  buffer_load_dwordx4 v23, s[12:15], s35 offen offset:128 lds
  v_mfma_f32_16x16x32_bf16 v[88:91], a[176:179], v[180:183], v[88:91]
  s_waitcnt lgkmcnt(4)
  v_exp_f32 v34, v66
  v_mfma_f32_16x16x32_bf16 a[0:3], a[128:131], v[164:167], a[0:3]
  ds_read_b64_tr_b16 a[152:153], v13 offset:16384
  v_mfma_f32_16x16x32_bf16 a[0:3], a[132:135], v[36:39], a[0:3]
  ds_read_b64_tr_b16 a[154:155], v13 offset:18432
  v_mfma_f32_16x16x32_bf16 a[32:35], a[132:135], v[40:43], a[32:35]
  v_exp_f32 v35, v67
  v_mfma_f32_16x16x32_bf16 a[32:35], a[128:131], v[168:171], a[32:35]
  v_exp_f32 v28, v68
  v_mfma_f32_16x16x32_bf16 a[64:67], a[128:131], v[172:175], a[64:67]
  ds_read_b64_tr_b16 a[156:157], v13 offset:20480
  v_cvt_pk_bf16_f32 v139, v34, v35
  v_mfma_f32_16x16x32_bf16 a[64:67], a[132:135], v[44:47], a[64:67]
  ds_read_b64_tr_b16 a[158:159], v13 offset:22528
  v_or3_b32 v1, v1, v138, v139
  v_mfma_f32_16x16x32_bf16 a[96:99], a[132:135], v[14:17], a[96:99]
  v_exp_f32 v29, v69
  v_mfma_f32_16x16x32_bf16 a[96:99], a[128:131], v[176:179], a[96:99]
  v_exp_f32 v30, v70
  v_mfma_f32_16x16x32_bf16 a[100:103], a[136:139], v[176:179], a[100:103]
  v_exp_f32 v31, v71
  v_mfma_f32_16x16x32_bf16 a[100:103], a[140:143], v[14:17], a[100:103]
  v_cvt_pk_bf16_f32 v140, v28, v29
  v_cvt_pk_bf16_f32 v141, v30, v31
  v_mfma_f32_16x16x32_bf16 a[68:71], a[140:143], v[44:47], a[68:71]
  v_exp_f32 v32, v72
  v_mfma_f32_16x16x32_bf16 a[68:71], a[136:139], v[172:175], a[68:71]
  s_waitcnt vmcnt(8)
  v_exp_f32 v33, v73
  v_mfma_f32_16x16x32_bf16 a[36:39], a[136:139], v[168:171], a[36:39]
  s_barrier
  ds_read_b128 a[160:163], v8 offset:49152
  v_mfma_f32_16x16x32_bf16 a[36:39], a[140:143], v[40:43], a[36:39]
  v_or3_b32 v3, v3, v140, v141
  v_cvt_pk_bf16_f32 v142, v32, v33
  v_mfma_f32_16x16x32_bf16 a[4:7], a[140:143], v[36:39], a[4:7]
  v_exp_f32 v34, v74
  v_mfma_f32_16x16x32_bf16 a[4:7], a[136:139], v[164:167], a[4:7]
  s_waitcnt lgkmcnt(1)
  v_exp_f32 v35, v75
  v_mfma_f32_16x16x32_bf16 a[8:11], a[144:147], v[164:167], a[8:11]
  ds_read_b128 a[164:167], v9 offset:49152
  v_cvt_pk_bf16_f32 v143, v34, v35
  v_mfma_f32_16x16x32_bf16 a[8:11], a[148:151], v[36:39], a[8:11]
  v_exp_f32 v28, v76
  v_mfma_f32_16x16x32_bf16 a[40:43], a[148:151], v[40:43], a[40:43]
  v_exp_f32 v29, v77
  v_mfma_f32_16x16x32_bf16 a[40:43], a[144:147], v[168:171], a[40:43]
  v_or3_b32 v1, v1, v142, v143
  v_cvt_pk_bf16_f32 v144, v28, v29
  v_mfma_f32_16x16x32_bf16 a[72:75], a[144:147], v[172:175], a[72:75]
  ds_read_b128 a[168:171], v8 offset:57344
  v_mfma_f32_16x16x32_bf16 a[72:75], a[148:151], v[44:47], a[72:75]
  v_exp_f32 v30, v78
  v_mfma_f32_16x16x32_bf16 a[104:107], a[148:151], v[14:17], a[104:107]
  v_exp_f32 v31, v79
  v_mfma_f32_16x16x32_bf16 a[104:107], a[144:147], v[176:179], a[104:107]
  v_exp_f32 v32, v80
  v_mfma_f32_16x16x32_bf16 a[108:111], a[152:155], v[176:179], a[108:111]
  ds_read_b128 a[172:175], v9 offset:57344
  v_cvt_pk_bf16_f32 v145, v30, v31
  v_mfma_f32_16x16x32_bf16 a[108:111], a[156:159], v[14:17], a[108:111]
  v_exp_f32 v33, v81
  v_mfma_f32_16x16x32_bf16 a[76:79], a[156:159], v[44:47], a[76:79]
  v_or3_b32 v3, v3, v144, v145
  v_cvt_pk_bf16_f32 v146, v32, v33
  v_mfma_f32_16x16x32_bf16 a[76:79], a[152:155], v[172:175], a[76:79]
  v_exp_f32 v34, v82
  v_mfma_f32_16x16x32_bf16 a[44:47], a[152:155], v[168:171], a[44:47]
  ds_read_b128 a[176:179], v8 offset:51200
  v_mfma_f32_16x16x32_bf16 a[44:47], a[156:159], v[40:43], a[44:47]
  v_exp_f32 v35, v83
  v_mfma_f32_16x16x32_bf16 a[12:15], a[156:159], v[36:39], a[12:15]
  s_add_u32 s35, s35, 16384
  v_cvt_pk_bf16_f32 v147, v34, v35
  v_or3_b32 v1, v1, v146, v147
  v_mfma_f32_16x16x32_bf16 a[12:15], a[152:155], v[164:167], a[12:15]
  s_add_u32 s34, s34, 16384
  v_bitop3_b32 v1, v1, v3, v6 bitop3:0xa8
  v_cmp_ne_u32 vcc, 0, v1
  v_mfma_f32_16x16x32_bf16 a[224:227], a[240:243], v[164:167], a[224:227]
  s_add_u32 s33, s33, 16384
  ds_read_b128 a[180:183], v9 offset:51200
  v_mfma_f32_16x16x32_bf16 a[224:227], a[240:243], v[36:39], a[224:227]
  s_add_u32 s32, s32, 16384
  v_mfma_f32_16x16x32_bf16 a[228:231], a[240:243], v[168:171], a[228:231]
  s_waitcnt lgkmcnt(2)
  v_mfma_f32_16x16x32_bf16 a[228:231], a[240:243], v[40:43], a[228:231]
  s_cbranch_vccnz L_rareb1b
L_retb1b:
  v_mfma_f32_16x16x32_bf16 v[52:55], a[160:163], v[180:183], v[116:119]
  ds_read_b128 a[184:187], v8 offset:59392
  v_mfma_f32_16x16x32_bf16 v[52:55], a[164:167], v[184:187], v[52:55]
  v_exp_f32 v28, v84
  v_mfma_f32_16x16x32_bf16 v[52:55], a[168:171], v[188:191], v[52:55]
  s_add_u32 m0, s29, 32768
  v_exp_f32 v29, v85
  v_mfma_f32_16x16x32_bf16 v[52:55], a[172:175], v[192:195], v[52:55]
  buffer_load_dwordx4 v22, s[8:11], s32 offen lds
  v_mfma_f32_16x16x32_bf16 v[60:63], a[172:175], v[208:211], v[120:123]
  ds_read_b128 a[188:191], v9 offset:59392
  v_cvt_pk_bf16_f32 v148, v28, v29
  v_mfma_f32_16x16x32_bf16 v[60:63], a[168:171], v[204:207], v[60:63]
  v_exp_f32 v30, v86
  v_mfma_f32_16x16x32_bf16 v[60:63], a[164:167], v[200:203], v[60:63]
  v_exp_f32 v31, v87
  v_mfma_f32_16x16x32_bf16 v[60:63], a[160:163], v[196:199], v[60:63]
  v_exp_f32 v32, v88
  v_mfma_f32_16x16x32_bf16 v[68:71], a[160:163], v[212:215], v[124:127]
  ds_read_b64_tr_b16 a[128:129], v10 offset:24576
  v_cvt_pk_bf16_f32 v149, v30, v31
  v_mfma_f32_16x16x32_bf16 v[68:71], a[164:167], v[216:219], v[68:71]
  ds_read_b64_tr_b16 a[130:131], v10 offset:26624
  v_or_b32 v3, v148, v149
  v_mfma_f32_16x16x32_bf16 v[68:71], a[168:171], v[220:223], v[68:71]
  v_exp_f32 v33, v89
  v_mfma_f32_16x16x32_bf16 v[68:71], a[172:175], v[224:227], v[68:71]
  v_exp_f32 v34, v90
  v_mfma_f32_16x16x32_bf16 v[76:79], a[172:175], v[240:243], v[128:131]
  ds_read_b64_tr_b16 a[132:133], v10 offset:28672
  v_cvt_pk_bf16_f32 v150, v32, v33
  v_mfma_f32_16x16x32_bf16 v[76:79], a[168:171], v[236:239], v[76:79]
  ds_read_b64_tr_b16 a[134:135], v10 offset:30720
  v_mfma_f32_16x16x32_bf16 v[76:79], a[164:167], v[232:235], v[76:79]
  s_add_u32 m0, s29, 40832
  v_exp_f32 v35, v91
  v_mfma_f32_16x16x32_bf16 v[76:79], a[160:163], v[228:231], v[76:79]
  s_waitcnt lgkmcnt(4)
  buffer_load_dwordx4 v22, s[8:11], s32 offen offset:128 lds
  v_mfma_f32_16x16x32_bf16 v[80:83], a[176:179], v[228:231], v[128:131]
  ds_read_b64_tr_b16 a[136:137], v11 offset:24576
  v_cvt_pk_bf16_f32 v151, v34, v35
  v_mfma_f32_16x16x32_bf16 v[80:83], a[180:183], v[232:235], v[80:83]
  ds_read_b64_tr_b16 a[138:139], v11 offset:26624
  v_or_b32 v1, v150, v151
  v_mfma_f32_16x16x32_bf16 v[80:83], a[184:187], v[236:239], v[80:83]
  v_exp_f32 v28, v92
  v_mfma_f32_16x16x32_bf16 v[80:83], a[188:191], v[240:243], v[80:83]
  v_exp_f32 v29, v93
  v_mfma_f32_16x16x32_bf16 v[72:75], a[188:191], v[224:227], v[124:127]
  ds_read_b64_tr_b16 a[140:141], v11 offset:28672
  v_cvt_pk_bf16_f32 v152, v28, v29
  v_mfma_f32_16x16x32_bf16 v[72:75], a[184:187], v[220:223], v[72:75]
  ds_read_b64_tr_b16 a[142:143], v11 offset:30720
  v_mfma_f32_16x16x32_bf16 v[72:75], a[180:183], v[216:219], v[72:75]
  v_exp_f32 v30, v94
  v_mfma_f32_16x16x32_bf16 v[72:75], a[176:179], v[212:215], v[72:75]
  v_exp_f32 v31, v95
  v_mfma_f32_16x16x32_bf16 v[64:67], a[176:179], v[196:199], v[120:123]
  ds_read_b64_tr_b16 a[144:145], v12 offset:24576
  v_cvt_pk_bf16_f32 v153, v30, v31
  v_mfma_f32_16x16x32_bf16 v[64:67], a[180:183], v[200:203], v[64:67]
  ds_read_b64_tr_b16 a[146:147], v12 offset:26624
  v_or3_b32 v3, v3, v152, v153
  v_mfma_f32_16x16x32_bf16 v[64:67], a[184:187], v[204:207], v[64:67]
  v_exp_f32 v32, v96
  v_mfma_f32_16x16x32_bf16 v[64:67], a[188:191], v[208:211], v[64:67]
  v_exp_f32 v33, v97
  v_mfma_f32_16x16x32_bf16 v[56:59], a[188:191], v[192:195], v[116:119]
  ds_read_b64_tr_b16 a[148:149], v12 offset:28672
  v_cvt_pk_bf16_f32 v154, v32, v33
  v_mfma_f32_16x16x32_bf16 v[56:59], a[184:187], v[188:191], v[56:59]
  s_add_u32 m0, s29, 36864
  ds_read_b64_tr_b16 a[150:151], v12 offset:30720
  v_mfma_f32_16x16x32_bf16 v[56:59], a[180:183], v[184:187], v[56:59]
  buffer_load_dwordx4 v22, s[8:11], s34 offen lds
  v_mfma_f32_16x16x32_bf16 v[56:59], a[176:179], v[180:183], v[56:59]
  s_waitcnt lgkmcnt(4)
  v_exp_f32 v34, v98
  v_mfma_f32_16x16x32_bf16 a[16:19], a[128:131], v[164:167], a[16:19]
  ds_read_b64_tr_b16 a[152:153], v13 offset:24576
  v_mfma_f32_16x16x32_bf16 a[16:19], a[132:135], v[36:39], a[16:19]
  ds_read_b64_tr_b16 a[154:155], v13 offset:26624
  v_mfma_f32_16x16x32_bf16 a[48:51], a[132:135], v[40:43], a[48:51]
  v_exp_f32 v35, v99
  v_mfma_f32_16x16x32_bf16 a[48:51], a[128:131], v[168:171], a[48:51]
  v_exp_f32 v28, v100
  v_mfma_f32_16x16x32_bf16 a[80:83], a[128:131], v[172:175], a[80:83]
  ds_read_b64_tr_b16 a[156:157], v13 offset:28672
  v_cvt_pk_bf16_f32 v155, v34, v35
  v_mfma_f32_16x16x32_bf16 a[80:83], a[132:135], v[44:47], a[80:83]
  ds_read_b64_tr_b16 a[158:159], v13 offset:30720
  v_or3_b32 v1, v1, v154, v155
  v_mfma_f32_16x16x32_bf16 a[112:115], a[132:135], v[14:17], a[112:115]
  v_exp_f32 v29, v101
  v_mfma_f32_16x16x32_bf16 a[112:115], a[128:131], v[176:179], a[112:115]
  v_exp_f32 v30, v102
  v_mfma_f32_16x16x32_bf16 a[116:119], a[136:139], v[176:179], a[116:119]
  v_exp_f32 v31, v103
  v_mfma_f32_16x16x32_bf16 a[116:119], a[140:143], v[14:17], a[116:119]
  s_add_u32 m0, s29, 44928
  v_cvt_pk_bf16_f32 v156, v28, v29
  v_cvt_pk_bf16_f32 v157, v30, v31
  v_mfma_f32_16x16x32_bf16 a[84:87], a[140:143], v[44:47], a[84:87]
  buffer_load_dwordx4 v22, s[8:11], s34 offen offset:128 lds
  v_mfma_f32_16x16x32_bf16 a[84:87], a[136:139], v[172:175], a[84:87]
  v_exp_f32 v32, v104
  v_mfma_f32_16x16x32_bf16 a[52:55], a[136:139], v[168:171], a[52:55]
  ds_read_b128 a[160:163], v8 offset:53248
  v_or3_b32 v3, v3, v156, v157
  v_mfma_f32_16x16x32_bf16 a[52:55], a[140:143], v[40:43], a[52:55]
  v_exp_f32 v33, v105
  v_mfma_f32_16x16x32_bf16 a[20:23], a[140:143], v[36:39], a[20:23]
  v_exp_f32 v34, v106
  v_mfma_f32_16x16x32_bf16 a[20:23], a[136:139], v[164:167], a[20:23]
  s_waitcnt lgkmcnt(1)
  v_exp_f32 v35, v107
  v_mfma_f32_16x16x32_bf16 a[24:27], a[144:147], v[164:167], a[24:27]
  ds_read_b128 a[164:167], v9 offset:53248
  v_cvt_pk_bf16_f32 v158, v32, v33
  v_mfma_f32_16x16x32_bf16 a[24:27], a[148:151], v[36:39], a[24:27]
  v_exp_f32 v28, v108
  v_mfma_f32_16x16x32_bf16 a[56:59], a[148:151], v[40:43], a[56:59]
  v_exp_f32 v29, v109
  v_mfma_f32_16x16x32_bf16 a[56:59], a[144:147], v[168:171], a[56:59]
  v_cvt_pk_bf16_f32 v159, v34, v35
  v_or3_b32 v1, v1, v158, v159
  v_mfma_f32_16x16x32_bf16 a[88:91], a[144:147], v[172:175], a[88:91]
  ds_read_b128 a[168:171], v8 offset:61440
  v_cvt_pk_bf16_f32 v160, v28, v29
  v_mfma_f32_16x16x32_bf16 a[88:91], a[148:151], v[44:47], a[88:91]
  v_exp_f32 v30, v110
  v_mfma_f32_16x16x32_bf16 a[120:123], a[148:151], v[14:17], a[120:123]
  v_exp_f32 v31, v111
  v_mfma_f32_16x16x32_bf16 a[120:123], a[144:147], v[176:179], a[120:123]
  v_exp_f32 v32, v112
  v_mfma_f32_16x16x32_bf16 a[124:127], a[152:155], v[176:179], a[124:127]
  s_add_u32 m0, s29, 65536
  ds_read_b128 a[172:175], v9 offset:61440
  v_cvt_pk_bf16_f32 v161, v30, v31
  v_mfma_f32_16x16x32_bf16 a[124:127], a[156:159], v[14:17], a[124:127]
  buffer_load_dwordx4 v23, s[12:15], s33 offen lds
  v_mfma_f32_16x16x32_bf16 a[92:95], a[156:159], v[44:47], a[92:95]
  v_exp_f32 v33, v113
  v_mfma_f32_16x16x32_bf16 a[92:95], a[152:155], v[172:175], a[92:95]
  v_or3_b32 v3, v3, v160, v161
  v_cvt_pk_bf16_f32 v162, v32, v33
  v_mfma_f32_16x16x32_bf16 a[60:63], a[152:155], v[168:171], a[60:63]
  ds_read_b128 a[176:179], v8 offset:55296
  v_mfma_f32_16x16x32_bf16 a[60:63], a[156:159], v[40:43], a[60:63]
  v_exp_f32 v34, v114
  v_mfma_f32_16x16x32_bf16 a[28:31], a[156:159], v[36:39], a[28:31]
  v_exp_f32 v35, v115
  v_mfma_f32_16x16x32_bf16 a[28:31], a[152:155], v[164:167], a[28:31]
  v_cvt_pk_bf16_f32 v163, v34, v35
  v_or3_b32 v1, v1, v162, v163
  v_mfma_f32_16x16x32_bf16 a[232:235], a[240:243], v[172:175], a[232:235]
  ds_read_b128 a[180:183], v9 offset:55296
  v_bitop3_b32 v1, v1, v3, v6 bitop3:0xa8
  v_mfma_f32_16x16x32_bf16 a[232:235], a[240:243], v[44:47], a[232:235]
  v_cmp_ne_u32 vcc, 0, v1
  v_mfma_f32_16x16x32_bf16 a[236:239], a[240:243], v[176:179], a[236:239]
  s_waitcnt lgkmcnt(2)
  v_mfma_f32_16x16x32_bf16 a[236:239], a[240:243], v[14:17], a[236:239]
  s_cbranch_vccnz L_rareb2a
L_retb2a:
  v_mfma_f32_16x16x32_bf16 v[84:87], a[160:163], v[180:183], v[116:119]
  s_add_u32 m0, s29, 73600
  ds_read_b128 a[184:187], v8 offset:63488
  v_mfma_f32_16x16x32_bf16 v[84:87], a[164:167], v[184:187], v[84:87]
  buffer_load_dwordx4 v23, s[12:15], s33 offen offset:128 lds
  v_mfma_f32_16x16x32_bf16 v[84:87], a[168:171], v[188:191], v[84:87]
  v_exp_f32 v28, v52
  v_mfma_f32_16x16x32_bf16 v[84:87], a[172:175], v[192:195], v[84:87]
  v_exp_f32 v29, v53
  v_mfma_f32_16x16x32_bf16 v[92:95], a[172:175], v[208:211], v[120:123]
  ds_read_b128 a[188:191], v9 offset:63488
  v_cvt_pk_bf16_f32 v164, v28, v29
  v_mfma_f32_16x16x32_bf16 v[92:95], a[168:171], v[204:207], v[92:95]
  v_exp_f32 v30, v54
  v_mfma_f32_16x16x32_bf16 v[92:95], a[164:167], v[200:203], v[92:95]
  v_exp_f32 v31, v55
  v_mfma_f32_16x16x32_bf16 v[92:95], a[160:163], v[196:199], v[92:95]
  v_exp_f32 v32, v56
  v_mfma_f32_16x16x32_bf16 v[100:103], a[160:163], v[212:215], v[124:127]
  ds_read_b64_tr_b16 a[128:129], v10 offset:32768
  v_cvt_pk_bf16_f32 v165, v30, v31
  v_mfma_f32_16x16x32_bf16 v[100:103], a[164:167], v[216:219], v[100:103]
  ds_read_b64_tr_b16 a[130:131], v10 offset:34816
  v_or_b32 v3, v164, v165
  v_mfma_f32_16x16x32_bf16 v[100:103], a[168:171], v[220:223], v[100:103]
  v_exp_f32 v33, v57
  v_mfma_f32_16x16x32_bf16 v[100:103], a[172:175], v[224:227], v[100:103]
  v_exp_f32 v34, v58
  v_mfma_f32_16x16x32_bf16 v[108:111], a[172:175], v[240:243], v[128:131]
  ds_read_b64_tr_b16 a[132:133], v10 offset:36864
  v_cvt_pk_bf16_f32 v166, v32, v33
  v_mfma_f32_16x16x32_bf16 v[108:111], a[168:171], v[236:239], v[108:111]
  ds_read_b64_tr_b16 a[134:135], v10 offset:38912
  v_mfma_f32_16x16x32_bf16 v[108:111], a[164:167], v[232:235], v[108:111]
  s_add_u32 m0, s29, 69632
  v_exp_f32 v35, v59
  v_mfma_f32_16x16x32_bf16 v[108:111], a[160:163], v[228:231], v[108:111]
  s_waitcnt lgkmcnt(4)
  buffer_load_dwordx4 v23, s[12:15], s35 offen lds
  v_mfma_f32_16x16x32_bf16 v[112:115], a[176:179], v[228:231], v[128:131]
  ds_read_b64_tr_b16 a[136:137], v11 offset:32768
  v_cvt_pk_bf16_f32 v167, v34, v35
  v_mfma_f32_16x16x32_bf16 v[112:115], a[180:183], v[232:235], v[112:115]
  ds_read_b64_tr_b16 a[138:139], v11 offset:34816
  v_or_b32 v1, v166, v167
  v_mfma_f32_16x16x32_bf16 v[112:115], a[184:187], v[236:239], v[112:115]
  v_exp_f32 v28, v60
  v_mfma_f32_16x16x32_bf16 v[112:115], a[188:191], v[240:243], v[112:115]
  v_exp_f32 v29, v61
  v_mfma_f32_16x16x32_bf16 v[104:107], a[188:191], v[224:227], v[124:127]
  ds_read_b64_tr_b16 a[140:141], v11 offset:36864
  v_cvt_pk_bf16_f32 v168, v28, v29
  v_mfma_f32_16x16x32_bf16 v[104:107], a[184:187], v[220:223], v[104:107]
  ds_read_b64_tr_b16 a[142:143], v11 offset:38912
  v_mfma_f32_16x16x32_bf16 v[104:107], a[180:183], v[216:219], v[104:107]
  v_exp_f32 v30, v62
  v_mfma_f32_16x16x32_bf16 v[104:107], a[176:179], v[212:215], v[104:107]
  v_exp_f32 v31, v63
  v_mfma_f32_16x16x32_bf16 v[96:99], a[176:179], v[196:199], v[120:123]
  ds_read_b64_tr_b16 a[144:145], v12 offset:32768
  v_cvt_pk_bf16_f32 v169, v30, v31
  v_mfma_f32_16x16x32_bf16 v[96:99], a[180:183], v[200:203], v[96:99]
  ds_read_b64_tr_b16 a[146:147], v12 offset:34816
  v_or3_b32 v3, v3, v168, v169
  v_mfma_f32_16x16x32_bf16 v[96:99], a[184:187], v[204:207], v[96:99]
  v_exp_f32 v32, v64
  v_mfma_f32_16x16x32_bf16 v[96:99], a[188:191], v[208:211], v[96:99]
  v_exp_f32 v33, v65
  v_mfma_f32_16x16x32_bf16 v[88:91], a[188:191], v[192:195], v[116:119]
  ds_read_b64_tr_b16 a[148:149], v12 offset:36864
  v_cvt_pk_bf16_f32 v170, v32, v33
  v_mfma_f32_16x16x32_bf16 v[88:91], a[184:187], v[188:191], v[88:91]
  s_add_u32 m0, s29, 77696
  ds_read_b64_tr_b16 a[150:151], v12 offset:38912
  v_mfma_f32_16x16x32_bf16 v[88:91], a[180:183], v[184:187], v[88:91]
  buffer_load_dwordx4 v23, s[12:15], s35 offen offset:128 lds
  v_mfma_f32_16x16x32_bf16 v[88:91], a[176:179], v[180:183], v[88:91]
  s_waitcnt lgkmcnt(4)
  v_exp_f32 v34, v66
  v_mfma_f32_16x16x32_bf16 a[0:3], a[128:131], v[132:135], a[0:3]
  ds_read_b64_tr_b16 a[152:153], v13 offset:32768
  v_mfma_f32_16x16x32_bf16 a[0:3], a[132:135], v[148:151], a[0:3]
  ds_read_b64_tr_b16 a[154:155], v13 offset:34816
  v_mfma_f32_16x16x32_bf16 a[32:35], a[132:135], v[152:155], a[32:35]
  v_exp_f32 v35, v67
  v_mfma_f32_16x16x32_bf16 a[32:35], a[128:131], v[136:139], a[32:35]
  v_exp_f32 v28, v68
  v_mfma_f32_16x16x32_bf16 a[64:67], a[128:131], v[140:143], a[64:67]
  ds_read_b64_tr_b16 a[156:157], v13 offset:36864
  v_cvt_pk_bf16_f32 v171, v34, v35
  v_mfma_f32_16x16x32_bf16 a[64:67], a[132:135], v[156:159], a[64:67]
  ds_read_b64_tr_b16 a[158:159], v13 offset:38912
  v_or3_b32 v1, v1, v170, v171
  v_mfma_f32_16x16x32_bf16 a[96:99], a[132:135], v[160:163], a[96:99]
  v_exp_f32 v29, v69
  v_mfma_f32_16x16x32_bf16 a[96:99], a[128:131], v[144:147], a[96:99]
  v_exp_f32 v30, v70
  v_mfma_f32_16x16x32_bf16 a[100:103], a[136:139], v[144:147], a[100:103]
  v_exp_f32 v31, v71
  v_mfma_f32_16x16x32_bf16 a[100:103], a[140:143], v[160:163], a[100:103]
  v_cvt_pk_bf16_f32 v172, v28, v29
  v_cvt_pk_bf16_f32 v173, v30, v31
  v_mfma_f32_16x16x32_bf16 a[68:71], a[140:143], v[156:159], a[68:71]
  v_exp_f32 v32, v72
  v_mfma_f32_16x16x32_bf16 a[68:71], a[136:139], v[140:143], a[68:71]
  s_waitcnt vmcnt(8)
  v_exp_f32 v33, v73
  v_mfma_f32_16x16x32_bf16 a[36:39], a[136:139], v[136:139], a[36:39]
  s_barrier
  ds_read_b128 a[160:163], v8 offset:0
  v_mfma_f32_16x16x32_bf16 a[36:39], a[140:143], v[152:155], a[36:39]
  v_or3_b32 v3, v3, v172, v173
  v_cvt_pk_bf16_f32 v174, v32, v33
  v_mfma_f32_16x16x32_bf16 a[4:7], a[140:143], v[148:151], a[4:7]
  v_exp_f32 v34, v74
  v_mfma_f32_16x16x32_bf16 a[4:7], a[136:139], v[132:135], a[4:7]
  s_waitcnt lgkmcnt(1)
  v_exp_f32 v35, v75
  v_mfma_f32_16x16x32_bf16 a[8:11], a[144:147], v[132:135], a[8:11]
  ds_read_b128 a[164:167], v9 offset:0
  v_cvt_pk_bf16_f32 v175, v34, v35
  v_mfma_f32_16x16x32_bf16 a[8:11], a[148:151], v[148:151], a[8:11]
  v_exp_f32 v28, v76
  v_mfma_f32_16x16x32_bf16 a[40:43], a[148:151], v[152:155], a[40:43]
  v_exp_f32 v29, v77
  v_mfma_f32_16x16x32_bf16 a[40:43], a[144:147], v[136:139], a[40:43]
  v_or3_b32 v1, v1, v174, v175
  v_cvt_pk_bf16_f32 v176, v28, v29
  v_mfma_f32_16x16x32_bf16 a[72:75], a[144:147], v[140:143], a[72:75]
  ds_read_b128 a[168:171], v8 offset:8192
  v_mfma_f32_16x16x32_bf16 a[72:75], a[148:151], v[156:159], a[72:75]
  v_exp_f32 v30, v78
  v_mfma_f32_16x16x32_bf16 a[104:107], a[148:151], v[160:163], a[104:107]
  v_exp_f32 v31, v79
  v_mfma_f32_16x16x32_bf16 a[104:107], a[144:147], v[144:147], a[104:107]
  v_exp_f32 v32, v80
  v_mfma_f32_16x16x32_bf16 a[108:111], a[152:155], v[144:147], a[108:111]
  ds_read_b128 a[172:175], v9 offset:8192
  v_cvt_pk_bf16_f32 v177, v30, v31
  v_mfma_f32_16x16x32_bf16 a[108:111], a[156:159], v[160:163], a[108:111]
  v_exp_f32 v33, v81
  v_mfma_f32_16x16x32_bf16 a[76:79], a[156:159], v[156:159], a[76:79]
  v_or3_b32 v3, v3, v176, v177
  v_cvt_pk_bf16_f32 v178, v32, v33
  v_mfma_f32_16x16x32_bf16 a[76:79], a[152:155], v[140:143], a[76:79]
  v_exp_f32 v34, v82
  v_mfma_f32_16x16x32_bf16 a[44:47], a[152:155], v[136:139], a[44:47]
  ds_read_b128 a[176:179], v8 offset:2048
  v_mfma_f32_16x16x32_bf16 a[44:47], a[156:159], v[152:155], a[44:47]
  v_exp_f32 v35, v83
  v_mfma_f32_16x16x32_bf16 a[12:15], a[156:159], v[148:151], a[12:15]
  s_add_u32 s35, s35, 16384
  v_cvt_pk_bf16_f32 v179, v34, v35
  v_or3_b32 v1, v1, v178, v179
  v_mfma_f32_16x16x32_bf16 a[12:15], a[152:155], v[132:135], a[12:15]
  s_add_u32 s34, s34, 16384
  v_bitop3_b32 v1, v1, v3, v6 bitop3:0xa8
  v_cmp_ne_u32 vcc, 0, v1
  v_mfma_f32_16x16x32_bf16 a[224:227], a[240:243], v[132:135], a[224:227]
  s_add_u32 s33, s33, 16384
  ds_read_b128 a[180:183], v9 offset:2048
  v_mfma_f32_16x16x32_bf16 a[224:227], a[240:243], v[148:151], a[224:227]
  s_add_u32 s32, s32, 16384
  v_mfma_f32_16x16x32_bf16 a[228:231], a[240:243], v[136:139], a[228:231]
  s_waitcnt lgkmcnt(2)
  v_mfma_f32_16x16x32_bf16 a[228:231], a[240:243], v[152:155], a[228:231]
  s_cbranch_vccnz L_rareb2b
L_retb2b:
  s_sub_u32 s36, s36, 1
  s_cmp_eq_u32 s36, 0
  s_cbranch_scc1 L_tail
  v_mfma_f32_16x16x32_bf16 v[52:55], a[160:163], v[180:183], v[116:119]
  ds_read_b128 a[184:187], v8 offset:10240
  v_mfma_f32_16x16x32_bf16 v[52:55], a[164:167], v[184:187], v[52:55]
  v_exp_f32 v28, v84
  v_mfma_f32_16x16x32_bf16 v[52:55], a[168:171], v[188:191], v[52:55]
  s_add_u32 m0, s29, 49152
  v_exp_f32 v29, v85
  v_mfma_f32_16x16x32_bf16 v[52:55], a[172:175], v[192:195], v[52:55]
  buffer_load_dwordx4 v22, s[8:11], s32 offen lds
  v_mfma_f32_16x16x32_bf16 v[60:63], a[172:175], v[208:211], v[120:123]
  ds_read_b128 a[188:191], v9 offset:10240
  v_cvt_pk_bf16_f32 v36, v28, v29
  v_mfma_f32_16x16x32_bf16 v[60:63], a[168:171], v[204:207], v[60:63]
  v_exp_f32 v30, v86
  v_mfma_f32_16x16x32_bf16 v[60:63], a[164:167], v[200:203], v[60:63]
  v_exp_f32 v31, v87
  v_mfma_f32_16x16x32_bf16 v[60:63], a[160:163], v[196:199], v[60:63]
  v_exp_f32 v32, v88
  v_mfma_f32_16x16x32_bf16 v[68:71], a[160:163], v[212:215], v[124:127]
  ds_read_b64_tr_b16 a[128:129], v10 offset:40960
  v_cvt_pk_bf16_f32 v37, v30, v31
  v_mfma_f32_16x16x32_bf16 v[68:71], a[164:167], v[216:219], v[68:71]
  ds_read_b64_tr_b16 a[130:131], v10 offset:43008
  v_or_b32 v3, v36, v37
  v_mfma_f32_16x16x32_bf16 v[68:71], a[168:171], v[220:223], v[68:71]
  v_exp_f32 v33, v89
  v_mfma_f32_16x16x32_bf16 v[68:71], a[172:175], v[224:227], v[68:71]
  v_exp_f32 v34, v90
  v_mfma_f32_16x16x32_bf16 v[76:79], a[172:175], v[240:243], v[128:131]
  ds_read_b64_tr_b16 a[132:133], v10 offset:45056
  v_cvt_pk_bf16_f32 v38, v32, v33
  v_mfma_f32_16x16x32_bf16 v[76:79], a[168:171], v[236:239], v[76:79]
  ds_read_b64_tr_b16 a[134:135], v10 offset:47104
  v_mfma_f32_16x16x32_bf16 v[76:79], a[164:167], v[232:235], v[76:79]
  s_add_u32 m0, s29, 57216
  v_exp_f32 v35, v91
  v_mfma_f32_16x16x32_bf16 v[76:79], a[160:163], v[228:231], v[76:79]
  s_waitcnt lgkmcnt(4)
  buffer_load_dwordx4 v22, s[8:11], s32 offen offset:128 lds
  v_mfma_f32_16x16x32_bf16 v[80:83], a[176:179], v[228:231], v[128:131]
  ds_read_b64_tr_b16 a[136:137], v11 offset:40960
  v_cvt_pk_bf16_f32 v39, v34, v35
  v_mfma_f32_16x16x32_bf16 v[80:83], a[180:183], v[232:235], v[80:83]
  ds_read_b64_tr_b16 a[138:139], v11 offset:43008
  v_or_b32 v1, v38, v39
  v_mfma_f32_16x16x32_bf16 v[80:83], a[184:187], v[236:239], v[80:83]
  v_exp_f32 v28, v92
  v_mfma_f32_16x16x32_bf16 v[80:83], a[188:191], v[240:243], v[80:83]
  v_exp_f32 v29, v93
  v_mfma_f32_16x16x32_bf16 v[72:75], a[188:191], v[224:227], v[124:127]
  ds_read_b64_tr_b16 a[140:141], v11 offset:45056
  v_cvt_pk_bf16_f32 v40, v28, v29
  v_mfma_f32_16x16x32_bf16 v[72:75], a[184:187], v[220:223], v[72:75]
  ds_read_b64_tr_b16 a[142:143], v11 offset:47104
  v_mfma_f32_16x16x32_bf16 v[72:75], a[180:183], v[216:219], v[72:75]
  v_exp_f32 v30, v94
  v_mfma_f32_16x16x32_bf16 v[72:75], a[176:179], v[212:215], v[72:75]
  v_exp_f32 v31, v95
  v_mfma_f32_16x16x32_bf16 v[64:67], a[176:179], v[196:199], v[120:123]
  ds_read_b64_tr_b16 a[144:145], v12 offset:40960
  v_cvt_pk_bf16_f32 v41, v30, v31
  v_mfma_f32_16x16x32_bf16 v[64:67], a[180:183], v[200:203], v[64:67]
  ds_read_b64_tr_b16 a[146:147], v12 offset:43008
  v_or3_b32 v3, v3, v40, v41
  v_mfma_f32_16x16x32_bf16 v[64:67], a[184:187], v[204:207], v[64:67]
  v_exp_f32 v32, v96
  v_mfma_f32_16x16x32_bf16 v[64:67], a[188:191], v[208:211], v[64:67]
  v_exp_f32 v33, v97
  v_mfma_f32_16x16x32_bf16 v[56:59], a[188:191], v[192:195], v[116:119]
  ds_read_b64_tr_b16 a[148:149], v12 offset:45056
  v_cvt_pk_bf16_f32 v42, v32, v33
  v_mfma_f32_16x16x32_bf16 v[56:59], a[184:187], v[188:191], v[56:59]
  s_add_u32 m0, s29, 53248
  ds_read_b64_tr_b16 a[150:151], v12 offset:47104
  v_mfma_f32_16x16x32_bf16 v[56:59], a[180:183], v[184:187], v[56:59]
  buffer_load_dwordx4 v22, s[8:11], s34 offen lds
  v_mfma_f32_16x16x32_bf16 v[56:59], a[176:179], v[180:183], v[56:59]
  s_waitcnt lgkmcnt(4)
  v_exp_f32 v34, v98
  v_mfma_f32_16x16x32_bf16 a[16:19], a[128:131], v[132:135], a[16:19]
  ds_read_b64_tr_b16 a[152:153], v13 offset:40960
  v_mfma_f32_16x16x32_bf16 a[16:19], a[132:135], v[148:151], a[16:19]
  ds_read_b64_tr_b16 a[154:155], v13 offset:43008
  v_mfma_f32_16x16x32_bf16 a[48:51], a[132:135], v[152:155], a[48:51]
  v_exp_f32 v35, v99
  v_mfma_f32_16x16x32_bf16 a[48:51], a[128:131], v[136:139], a[48:51]
  v_exp_f32 v28, v100
  v_mfma_f32_16x16x32_bf16 a[80:83], a[128:131], v[140:143], a[80:83]
  ds_read_b64_tr_b16 a[156:157], v13 offset:45056
  v_cvt_pk_bf16_f32 v43, v34, v35
  v_mfma_f32_16x16x32_bf16 a[80:83], a[132:135], v[156:159], a[80:83]
  ds_read_b64_tr_b16 a[158:159], v13 offset:47104
  v_or3_b32 v1, v1, v42, v43
  v_mfma_f32_16x16x32_bf16 a[112:115], a[132:135], v[160:163], a[112:115]
  v_exp_f32 v29, v101
  v_mfma_f32_16x16x32_bf16 a[112:115], a[128:131], v[144:147], a[112:115]
  v_exp_f32 v30, v102
  v_mfma_f32_16x16x32_bf16 a[116:119], a[136:139], v[144:147], a[116:119]
  v_exp_f32 v31, v103
  v_mfma_f32_16x16x32_bf16 a[116:119], a[140:143], v[160:163], a[116:119]
  s_add_u32 m0, s29, 61312
  v_cvt_pk_bf16_f32 v44, v28, v29
  v_cvt_pk_bf16_f32 v45, v30, v31
  v_mfma_f32_16x16x32_bf16 a[84:87], a[140:143], v[156:159], a[84:87]
  buffer_load_dwordx4 v22, s[8:11], s34 offen offset:128 lds
  v_mfma_f32_16x16x32_bf16 a[84:87], a[136:139], v[140:143], a[84:87]
  v_exp_f32 v32, v104
  v_mfma_f32_16x16x32_bf16 a[52:55], a[136:139], v[136:139], a[52:55]
  ds_read_b128 a[160:163], v8 offset:4096
  v_or3_b32 v3, v3, v44, v45
  v_mfma_f32_16x16x32_bf16 a[52:55], a[140:143], v[152:155], a[52:55]
  v_exp_f32 v33, v105
  v_mfma_f32_16x16x32_bf16 a[20:23], a[140:143], v[148:151], a[20:23]
  v_exp_f32 v34, v106
  v_mfma_f32_16x16x32_bf16 a[20:23], a[136:139], v[132:135], a[20:23]
  s_waitcnt lgkmcnt(1)
  v_exp_f32 v35, v107
  v_mfma_f32_16x16x32_bf16 a[24:27], a[144:147], v[132:135], a[24:27]
  ds_read_b128 a[164:167], v9 offset:4096
  v_cvt_pk_bf16_f32 v46, v32, v33
  v_mfma_f32_16x16x32_bf16 a[24:27], a[148:151], v[148:151], a[24:27]
  v_exp_f32 v28, v108
  v_mfma_f32_16x16x32_bf16 a[56:59], a[148:151], v[152:155], a[56:59]
  v_exp_f32 v29, v109
  v_mfma_f32_16x16x32_bf16 a[56:59], a[144:147], v[136:139], a[56:59]
  v_cvt_pk_bf16_f32 v47, v34, v35
  v_or3_b32 v1, v1, v46, v47
  v_mfma_f32_16x16x32_bf16 a[88:91], a[144:147], v[140:143], a[88:91]
  ds_read_b128 a[168:171], v8 offset:12288
  v_cvt_pk_bf16_f32 v14, v28, v29
  v_mfma_f32_16x16x32_bf16 a[88:91], a[148:151], v[156:159], a[88:91]
  v_exp_f32 v30, v110
  v_mfma_f32_16x16x32_bf16 a[120:123], a[148:151], v[160:163], a[120:123]
  v_exp_f32 v31, v111
  v_mfma_f32_16x16x32_bf16 a[120:123], a[144:147], v[144:147], a[120:123]
  v_exp_f32 v32, v112
  v_mfma_f32_16x16x32_bf16 a[124:127], a[152:155], v[144:147], a[124:127]
  s_add_u32 m0, s29, 81920
  ds_read_b128 a[172:175], v9 offset:12288
  v_cvt_pk_bf16_f32 v15, v30, v31
  v_mfma_f32_16x16x32_bf16 a[124:127], a[156:159], v[160:163], a[124:127]
  buffer_load_dwordx4 v23, s[12:15], s33 offen lds
  v_mfma_f32_16x16x32_bf16 a[92:95], a[156:159], v[156:159], a[92:95]
  v_exp_f32 v33, v113
  v_mfma_f32_16x16x32_bf16 a[92:95], a[152:155], v[140:143], a[92:95]
  v_or3_b32 v3, v3, v14, v15
  v_cvt_pk_bf16_f32 v16, v32, v33
  v_mfma_f32_16x16x32_bf16 a[60:63], a[152:155], v[136:139], a[60:63]
  ds_read_b128 a[176:179], v8 offset:6144
  v_mfma_f32_16x16x32_bf16 a[60:63], a[156:159], v[152:155], a[60:63]
  v_exp_f32 v34, v114
  v_mfma_f32_16x16x32_bf16 a[28:31], a[156:159], v[148:151], a[28:31]
  v_exp_f32 v35, v115
  v_mfma_f32_16x16x32_bf16 a[28:31], a[152:155], v[132:135], a[28:31]
  v_cvt_pk_bf16_f32 v17, v34, v35
  v_or3_b32 v1, v1, v16, v17
  v_mfma_f32_16x16x32_bf16 a[232:235], a[240:243], v[140:143], a[232:235]
  ds_read_b128 a[180:183], v9 offset:6144
  v_bitop3_b32 v1, v1, v3, v6 bitop3:0xa8
  v_mfma_f32_16x16x32_bf16 a[232:235], a[240:243], v[156:159], a[232:235]
  v_cmp_ne_u32 vcc, 0, v1
  v_mfma_f32_16x16x32_bf16 a[236:239], a[240:243], v[144:147], a[236:239]
  s_waitcnt lgkmcnt(2)
  v_mfma_f32_16x16x32_bf16 a[236:239], a[240:243], v[160:163], a[236:239]
  s_cbranch_vccnz L_rareb3a
L_retb3a:
  v_mfma_f32_16x16x32_bf16 v[84:87], a[160:163], v[180:183], v[116:119]
  s_add_u32 m0, s29, 89984
  ds_read_b128 a[184:187], v8 offset:14336
  v_mfma_f32_16x16x32_bf16 v[84:87], a[164:167], v[184:187], v[84:87]
  buffer_load_dwordx4 v23, s[12:15], s33 offen offset:128 lds
  v_mfma_f32_16x16x32_bf16 v[84:87], a[168:171], v[188:191], v[84:87]
  v_exp_f32 v28, v52
  v_mfma_f32_16x16x32_bf16 v[84:87], a[172:175], v[192:195], v[84:87]
  v_exp_f32 v29, v53
  v_mfma_f32_16x16x32_bf16 v[92:95], a[172:175], v[208:211], v[120:123]
  ds_read_b128 a[188:191], v9 offset:14336
  v_cvt_pk_bf16_f32 v132, v28, v29
  v_mfma_f32_16x16x32_bf16 v[92:95], a[168:171], v[204:207], v[92:95]
  v_exp_f32 v30, v54
  v_mfma_f32_16x16x32_bf16 v[92:95], a[164:167], v[200:203], v[92:95]
  v_exp_f32 v31, v55
  v_mfma_f32_16x16x32_bf16 v[92:95], a[160:163], v[196:199], v[92:95]
  v_exp_f32 v32, v56
  v_mfma_f32_16x16x32_bf16 v[100:103], a[160:163], v[212:215], v[124:127]
  ds_read_b64_tr_b16 a[128:129], v10 offset:49152
  v_cvt_pk_bf16_f32 v133, v30, v31
  v_mfma_f32_16x16x32_bf16 v[100:103], a[164:167], v[216:219], v[100:103]
  ds_read_b64_tr_b16 a[130:131], v10 offset:51200
  v_or_b32 v3, v132, v133
  v_mfma_f32_16x16x32_bf16 v[100:103], a[168:171], v[220:223], v[100:103]
  v_exp_f32 v33, v57
  v_mfma_f32_16x16x32_bf16 v[100:103], a[172:175], v[224:227], v[100:103]
  v_exp_f32 v34, v58
  v_mfma_f32_16x16x32_bf16 v[108:111], a[172:175], v[240:243], v[128:131]
  ds_read_b64_tr_b16 a[132:133], v10 offset:53248
  v_cvt_pk_bf16_f32 v134, v32, v33
  v_mfma_f32_16x16x32_bf16 v[108:111], a[168:171], v[236:239], v[108:111]
  ds_read_b64_tr_b16 a[134:135], v10 offset:55296
  v_mfma_f32_16x16x32_bf16 v[108:111], a[164:167], v[232:235], v[108:111]
  s_add_u32 m0, s29, 86016
  v_exp_f32 v35, v59
  v_mfma_f32_16x16x32_bf16 v[108:111], a[160:163], v[228:231], v[108:111]
  s_waitcnt lgkmcnt(4)
  buffer_load_dwordx4 v23, s[12:15], s35 offen lds
  v_mfma_f32_16x16x32_bf16 v[112:115], a[176:179], v[228:231], v[128:131]
  ds_read_b64_tr_b16 a[136:137], v11 offset:49152
  v_cvt_pk_bf16_f32 v135, v34, v35
  v_mfma_f32_16x16x32_bf16 v[112:115], a[180:183], v[232:235], v[112:115]
  ds_read_b64_tr_b16 a[138:139], v11 offset:51200
  v_or_b32 v1, v134, v135
  v_mfma_f32_16x16x32_bf16 v[112:115], a[184:187], v[236:239], v[112:115]
  v_exp_f32 v28, v60
  v_mfma_f32_16x16x32_bf16 v[112:115], a[188:191], v[240:243], v[112:115]
  v_exp_f32 v29, v61
  v_mfma_f32_16x16x32_bf16 v[104:107], a[188:191], v[224:227], v[124:127]
  ds_read_b64_tr_b16 a[140:141], v11 offset:53248
  v_cvt_pk_bf16_f32 v136, v28, v29
  v_mfma_f32_16x16x32_bf16 v[104:107], a[184:187], v[220:223], v[104:107]
  ds_read_b64_tr_b16 a[142:143], v11 offset:55296
  v_mfma_f32_16x16x32_bf16 v[104:107], a[180:183], v[216:219], v[104:107]
  v_exp_f32 v30, v62
  v_mfma_f32_16x16x32_bf16 v[104:107], a[176:179], v[212:215], v[104:107]
  v_exp_f32 v31, v63
  v_mfma_f32_16x16x32_bf16 v[96:99], a[176:179], v[196:199], v[120:123]
  ds_read_b64_tr_b16 a[144:145], v12 offset:49152
  v_cvt_pk_bf16_f32 v137, v30, v31
  v_mfma_f32_16x16x32_bf16 v[96:99], a[180:183], v[200:203], v[96:99]
  ds_read_b64_tr_b16 a[146:147], v12 offset:51200
  v_or3_b32 v3, v3, v136, v137
  v_mfma_f32_16x16x32_bf16 v[96:99], a[184:187], v[204:207], v[96:99]
  v_exp_f32 v32, v64
  v_mfma_f32_16x16x32_bf16 v[96:99], a[188:191], v[208:211], v[96:99]
  v_exp_f32 v33, v65
  v_mfma_f32_16x16x32_bf16 v[88:91], a[188:191], v[192:195], v[116:119]
  ds_read_b64_tr_b16 a[148:149], v12 offset:53248
  v_cvt_pk_bf16_f32 v138, v32, v33
  v_mfma_f32_16x16x32_bf16 v[88:91], a[184:187], v[188:191], v[88:91]
  s_add_u32 m0, s29, 94080
  ds_read_b64_tr_b16 a[150:151], v12 offset:55296
  v_mfma_f32_16x16x32_bf16 v[88:91], a[180:183], v[184:187], v[88:91]
  buffer_load_dwordx4 v23, s[12:15], s35 offen offset:128 lds
  v_mfma_f32_16x16x32_bf16 v[88:91], a[176:179], v[180:183], v[88:91]
  s_waitcnt lgkmcnt(4)
  v_exp_f32 v34, v66
  v_mfma_f32_16x16x32_bf16 a[0:3], a[128:131], v[164:167], a[0:3]
  ds_read_b64_tr_b16 a[152:153], v13 offset:49152
  v_mfma_f32_16x16x32_bf16 a[0:3], a[132:135], v[36:39], a[0:3]
  ds_read_b64_tr_b16 a[154:155], v13 offset:51200
  v_mfma_f32_16x16x32_bf16 a[32:35], a[132:135], v[40:43], a[32:35]
  v_exp_f32 v35, v67
  v_mfma_f32_16x16x32_bf16 a[32:35], a[128:131], v[168:171], a[32:35]
  v_exp_f32 v28, v68
  v_mfma_f32_16x16x32_bf16 a[64:67], a[128:131], v[172:175], a[64:67]
  ds_read_b64_tr_b16 a[156:157], v13 offset:53248
  v_cvt_pk_bf16_f32 v139, v34, v35
  v_mfma_f32_16x16x32_bf16 a[64:67], a[132:135], v[44:47], a[64:67]
  ds_read_b64_tr_b16 a[158:159], v13 offset:55296
  v_or3_b32 v1, v1, v138, v139
  v_mfma_f32_16x16x32_bf16 a[96:99], a[132:135], v[14:17], a[96:99]
  v_exp_f32 v29, v69
  v_mfma_f32_16x16x32_bf16 a[96:99], a[128:131], v[176:179], a[96:99]
  v_exp_f32 v30, v70
  v_mfma_f32_16x16x32_bf16 a[100:103], a[136:139], v[176:179], a[100:103]
  v_exp_f32 v31, v71
  v_mfma_f32_16x16x32_bf16 a[100:103], a[140:143], v[14:17], a[100:103]
  v_cvt_pk_bf16_f32 v140, v28, v29
  v_cvt_pk_bf16_f32 v141, v30, v31
  v_mfma_f32_16x16x32_bf16 a[68:71], a[140:143], v[44:47], a[68:71]
  v_exp_f32 v32, v72
  v_mfma_f32_16x16x32_bf16 a[68:71], a[136:139], v[172:175], a[68:71]
  s_waitcnt vmcnt(8)
  v_exp_f32 v33, v73
  v_mfma_f32_16x16x32_bf16 a[36:39], a[136:139], v[168:171], a[36:39]
  s_barrier
  ds_read_b128 a[160:163], v8 offset:16384
  v_mfma_f32_16x16x32_bf16 a[36:39], a[140:143], v[40:43], a[36:39]
  v_or3_b32 v3, v3, v140, v141
  v_cvt_pk_bf16_f32 v142, v32, v33
  v_mfma_f32_16x16x32_bf16 a[4:7], a[140:143], v[36:39], a[4:7]
  v_exp_f32 v34, v74
  v_mfma_f32_16x16x32_bf16 a[4:7], a[136:139], v[164:167], a[4:7]
  s_waitcnt lgkmcnt(1)
  v_exp_f32 v35, v75
  v_mfma_f32_16x16x32_bf16 a[8:11], a[144:147], v[164:167], a[8:11]
  ds_read_b128 a[164:167], v9 offset:16384
  v_cvt_pk_bf16_f32 v143, v34, v35
  v_mfma_f32_16x16x32_bf16 a[8:11], a[148:151], v[36:39], a[8:11]
  v_exp_f32 v28, v76
  v_mfma_f32_16x16x32_bf16 a[40:43], a[148:151], v[40:43], a[40:43]
  v_exp_f32 v29, v77
  v_mfma_f32_16x16x32_bf16 a[40:43], a[144:147], v[168:171], a[40:43]
  v_or3_b32 v1, v1, v142, v143
  v_cvt_pk_bf16_f32 v144, v28, v29
  v_mfma_f32_16x16x32_bf16 a[72:75], a[144:147], v[172:175], a[72:75]
  ds_read_b128 a[168:171], v8 offset:24576
  v_mfma_f32_16x16x32_bf16 a[72:75], a[148:151], v[44:47], a[72:75]
  v_exp_f32 v30, v78
  v_mfma_f32_16x16x32_bf16 a[104:107], a[148:151], v[14:17], a[104:107]
  v_exp_f32 v31, v79
  v_mfma_f32_16x16x32_bf16 a[104:107], a[144:147], v[176:179], a[104:107]
  v_exp_f32 v32, v80
  v_mfma_f32_16x16x32_bf16 a[108:111], a[152:155], v[176:179], a[108:111]
  ds_read_b128 a[172:175], v9 offset:24576
  v_cvt_pk_bf16_f32 v145, v30, v31
  v_mfma_f32_16x16x32_bf16 a[108:111], a[156:159], v[14:17], a[108:111]
  v_exp_f32 v33, v81
  v_mfma_f32_16x16x32_bf16 a[76:79], a[156:159], v[44:47], a[76:79]
  v_or3_b32 v3, v3, v144, v145
  v_cvt_pk_bf16_f32 v146, v32, v33
  v_mfma_f32_16x16x32_bf16 a[76:79], a[152:155], v[172:175], a[76:79]
  v_exp_f32 v34, v82
  v_mfma_f32_16x16x32_bf16 a[44:47], a[152:155], v[168:171], a[44:47]
  ds_read_b128 a[176:179], v8 offset:18432
  v_mfma_f32_16x16x32_bf16 a[44:47], a[156:159], v[40:43], a[44:47]
  v_exp_f32 v35, v83
  v_mfma_f32_16x16x32_bf16 a[12:15], a[156:159], v[36:39], a[12:15]
  s_add_u32 s35, s35, 16384
  v_cvt_pk_bf16_f32 v147, v34, v35
  v_or3_b32 v1, v1, v146, v147
  v_mfma_f32_16x16x32_bf16 a[12:15], a[152:155], v[164:167], a[12:15]
  s_add_u32 s34, s34, 16384
  v_bitop3_b32 v1, v1, v3, v6 bitop3:0xa8
  v_cmp_ne_u32 vcc, 0, v1
  v_mfma_f32_16x16x32_bf16 a[224:227], a[240:243], v[164:167], a[224:227]
  s_add_u32 s33, s33, 16384
  ds_read_b128 a[180:183], v9 offset:18432
  v_mfma_f32_16x16x32_bf16 a[224:227], a[240:243], v[36:39], a[224:227]
  s_add_u32 s32, s32, 16384
  v_mfma_f32_16x16x32_bf16 a[228:231], a[240:243], v[168:171], a[228:231]
  s_waitcnt lgkmcnt(2)
  v_mfma_f32_16x16x32_bf16 a[228:231], a[240:243], v[40:43], a[228:231]
  s_cbranch_vccnz L_rareb3b
L_retb3b:
  v_mfma_f32_16x16x32_bf16 v[52:55], a[160:163], v[180:183], v[116:119]
  ds_read_b128 a[184:187], v8 offset:26624
  v_mfma_f32_16x16x32_bf16 v[52:55], a[164:167], v[184:187], v[52:55]
  v_exp_f32 v28, v84
  v_mfma_f32_16x16x32_bf16 v[52:55], a[168:171], v[188:191], v[52:55]
  s_add_u32 m0, s29, 0
  v_exp_f32 v29, v85
  v_mfma_f32_16x16x32_bf16 v[52:55], a[172:175], v[192:195], v[52:55]
  buffer_load_dwordx4 v22, s[8:11], s32 offen lds
  v_mfma_f32_16x16x32_bf16 v[60:63], a[172:175], v[208:211], v[120:123]
  ds_read_b128 a[188:191], v9 offset:26624
  v_cvt_pk_bf16_f32 v148, v28, v29
  v_mfma_f32_16x16x32_bf16 v[60:63], a[168:171], v[204:207], v[60:63]
  v_exp_f32 v30, v86
  v_mfma_f32_16x16x32_bf16 v[60:63], a[164:167], v[200:203], v[60:63]
  v_exp_f32 v31, v87
  v_mfma_f32_16x16x32_bf16 v[60:63], a[160:163], v[196:199], v[60:63]
  v_exp_f32 v32, v88
  v_mfma_f32_16x16x32_bf16 v[68:71], a[160:163], v[212:215], v[124:127]
  ds_read_b64_tr_b16 a[128:129], v10 offset:57344
  v_cvt_pk_bf16_f32 v149, v30, v31
  v_mfma_f32_16x16x32_bf16 v[68:71], a[164:167], v[216:219], v[68:71]
  ds_read_b64_tr_b16 a[130:131], v10 offset:59392
  v_or_b32 v3, v148, v149
  v_mfma_f32_16x16x32_bf16 v[68:71], a[168:171], v[220:223], v[68:71]
  v_exp_f32 v33, v89
  v_mfma_f32_16x16x32_bf16 v[68:71], a[172:175], v[224:227], v[68:71]
  v_exp_f32 v34, v90
  v_mfma_f32_16x16x32_bf16 v[76:79], a[172:175], v[240:243], v[128:131]
  ds_read_b64_tr_b16 a[132:133], v10 offset:61440
  v_cvt_pk_bf16_f32 v150, v32, v33
  v_mfma_f32_16x16x32_bf16 v[76:79], a[168:171], v[236:239], v[76:79]
  ds_read_b64_tr_b16 a[134:135], v10 offset:63488
  v_mfma_f32_16x16x32_bf16 v[76:79], a[164:167], v[232:235], v[76:79]
  s_add_u32 m0, s29, 8064
  v_exp_f32 v35, v91
  v_mfma_f32_16x16x32_bf16 v[76:79], a[160:163], v[228:231], v[76:79]
  s_waitcnt lgkmcnt(4)
  buffer_load_dwordx4 v22, s[8:11], s32 offen offset:128 lds
  v_mfma_f32_16x16x32_bf16 v[80:83], a[176:179], v[228:231], v[128:131]
  ds_read_b64_tr_b16 a[136:137], v11 offset:57344
  v_cvt_pk_bf16_f32 v151, v34, v35
  v_mfma_f32_16x16x32_bf16 v[80:83], a[180:183], v[232:235], v[80:83]
  ds_read_b64_tr_b16 a[138:139], v11 offset:59392
  v_or_b32 v1, v150, v151
  v_mfma_f32_16x16x32_bf16 v[80:83], a[184:187], v[236:239], v[80:83]
  v_exp_f32 v28, v92
  v_mfma_f32_16x16x32_bf16 v[80:83], a[188:191], v[240:243], v[80:83]
  v_exp_f32 v29, v93
  v_mfma_f32_16x16x32_bf16 v[72:75], a[188:191], v[224:227], v[124:127]
  ds_read_b64_tr_b16 a[140:141], v11 offset:61440
  v_cvt_pk_bf16_f32 v152, v28, v29
  v_mfma_f32_16x16x32_bf16 v[72:75], a[184:187], v[220:223], v[72:75]
  ds_read_b64_tr_b16 a[142:143], v11 offset:63488
  v_mfma_f32_16x16x32_bf16 v[72:75], a[180:183], v[216:219], v[72:75]
  v_exp_f32 v30, v94
  v_mfma_f32_16x16x32_bf16 v[72:75], a[176:179], v[212:215], v[72:75]
  v_exp_f32 v31, v95
  v_mfma_f32_16x16x32_bf16 v[64:67], a[176:179], v[196:199], v[120:123]
  ds_read_b64_tr_b16 a[144:145], v12 offset:57344
  v_cvt_pk_bf16_f32 v153, v30, v31
  v_mfma_f32_16x16x32_bf16 v[64:67], a[180:183], v[200:203], v[64:67]
  ds_read_b64_tr_b16 a[146:147], v12 offset:59392
  v_or3_b32 v3, v3, v152, v153
  v_mfma_f32_16x16x32_bf16 v[64:67], a[184:187], v[204:207], v[64:67]
  v_exp_f32 v32, v96
  v_mfma_f32_16x16x32_bf16 v[64:67], a[188:191], v[208:211], v[64:67]
  v_exp_f32 v33, v97
  v_mfma_f32_16x16x32_bf16 v[56:59], a[188:191], v[192:195], v[116:119]
  ds_read_b64_tr_b16 a[148:149], v12 offset:61440
  v_cvt_pk_bf16_f32 v154, v32, v33
  v_mfma_f32_16x16x32_bf16 v[56:59], a[184:187], v[188:191], v[56:59]
  s_add_u32 m0, s29, 4096
  ds_read_b64_tr_b16 a[150:151], v12 offset:63488
  v_mfma_f32_16x16x32_bf16 v[56:59], a[180:183], v[184:187], v[56:59]
  buffer_load_dwordx4 v22, s[8:11], s34 offen lds
  v_mfma_f32_16x16x32_bf16 v[56:59], a[176:179], v[180:183], v[56:59]
  s_waitcnt lgkmcnt(4)
  v_exp_f32 v34, v98
  v_mfma_f32_16x16x32_bf16 a[16:19], a[128:131], v[164:167], a[16:19]
  ds_read_b64_tr_b16 a[152:153], v13 offset:57344
  v_mfma_f32_16x16x32_bf16 a[16:19], a[132:135], v[36:39], a[16:19]
  ds_read_b64_tr_b16 a[154:155], v13 offset:59392
  v_mfma_f32_16x16x32_bf16 a[48:51], a[132:135], v[40:43], a[48:51]
  v_exp_f32 v35, v99
  v_mfma_f32_16x16x32_bf16 a[48:51], a[128:131], v[168:171], a[48:51]
  v_exp_f32 v28, v100
  v_mfma_f32_16x16x32_bf16 a[80:83], a[128:131], v[172:175], a[80:83]
  ds_read_b64_tr_b16 a[156:157], v13 offset:61440
  v_cvt_pk_bf16_f32 v155, v34, v35
  v_mfma_f32_16x16x32_bf16 a[80:83], a[132:135], v[44:47], a[80:83]
  ds_read_b64_tr_b16 a[158:159], v13 offset:63488
  v_or3_b32 v1, v1, v154, v155
  v_mfma_f32_16x16x32_bf16 a[112:115], a[132:135], v[14:17], a[112:115]
  v_exp_f32 v29, v101
  v_mfma_f32_16x16x32_bf16 a[112:115], a[128:131], v[176:179], a[112:115]
  v_exp_f32 v30, v102
  v_mfma_f32_16x16x32_bf16 a[116:119], a[136:139], v[176:179], a[116:119]
  v_exp_f32 v31, v103
  v_mfma_f32_16x16x32_bf16 a[116:119], a[140:143], v[14:17], a[116:119]
  s_add_u32 m0, s29, 12160
  v_cvt_pk_bf16_f32 v156, v28, v29
  v_cvt_pk_bf16_f32 v157, v30, v31
  v_mfma_f32_16x16x32_bf16 a[84:87], a[140:143], v[44:47], a[84:87]
  buffer_load_dwordx4 v22, s[8:11], s34 offen offset:128 lds
  v_mfma_f32_16x16x32_bf16 a[84:87], a[136:139], v[172:175], a[84:87]
  v_exp_f32 v32, v104
  v_mfma_f32_16x16x32_bf16 a[52:55], a[136:139], v[168:171], a[52:55]
  ds_read_b128 a[160:163], v8 offset:20480
  v_or3_b32 v3, v3, v156, v157
  v_mfma_f32_16x16x32_bf16 a[52:55], a[140:143], v[40:43], a[52:55]
  v_exp_f32 v33, v105
  v_mfma_f32_16x16x32_bf16 a[20:23], a[140:143], v[36:39], a[20:23]
  v_exp_f32 v34, v106
  v_mfma_f32_16x16x32_bf16 a[20:23], a[136:139], v[164:167], a[20:23]
  s_waitcnt lgkmcnt(1)
  v_exp_f32 v35, v107
  v_mfma_f32_16x16x32_bf16 a[24:27], a[144:147], v[164:167], a[24:27]
  ds_read_b128 a[164:167], v9 offset:20480
  v_cvt_pk_bf16_f32 v158, v32, v33
  v_mfma_f32_16x16x32_bf16 a[24:27], a[148:151], v[36:39], a[24:27]
  v_exp_f32 v28, v108
  v_mfma_f32_16x16x32_bf16 a[56:59], a[148:151], v[40:43], a[56:59]
  v_exp_f32 v29, v109
  v_mfma_f32_16x16x32_bf16 a[56:59], a[144:147], v[168:171], a[56:59]
  v_cvt_pk_bf16_f32 v159, v34, v35
  v_or3_b32 v1, v1, v158, v159
  v_mfma_f32_16x16x32_bf16 a[88:91], a[144:147], v[172:175], a[88:91]
  ds_read_b128 a[168:171], v8 offset:28672
  v_cvt_pk_bf16_f32 v160, v28, v29
  v_mfma_f32_16x16x32_bf16 a[88:91], a[148:151], v[44:47], a[88:91]
  v_exp_f32 v30, v110
  v_mfma_f32_16x16x32_bf16 a[120:123], a[148:151], v[14:17], a[120:123]
  v_exp_f32 v31, v111
  v_mfma_f32_16x16x32_bf16 a[120:123], a[144:147], v[176:179], a[120:123]
  v_exp_f32 v32, v112
  v_mfma_f32_16x16x32_bf16 a[124:127], a[152:155], v[176:179], a[124:127]
  s_add_u32 m0, s29, 98304
  ds_read_b128 a[172:175], v9 offset:28672
  v_cvt_pk_bf16_f32 v161, v30, v31
  v_mfma_f32_16x16x32_bf16 a[124:127], a[156:159], v[14:17], a[124:127]
  buffer_load_dwordx4 v23, s[12:15], s33 offen lds
  v_mfma_f32_16x16x32_bf16 a[92:95], a[156:159], v[44:47], a[92:95]
  v_exp_f32 v33, v113
  v_mfma_f32_16x16x32_bf16 a[92:95], a[152:155], v[172:175], a[92:95]
  v_or3_b32 v3, v3, v160, v161
  v_cvt_pk_bf16_f32 v162, v32, v33
  v_mfma_f32_16x16x32_bf16 a[60:63], a[152:155], v[168:171], a[60:63]
  ds_read_b128 a[176:179], v8 offset:22528
  v_mfma_f32_16x16x32_bf16 a[60:63], a[156:159], v[40:43], a[60:63]
  v_exp_f32 v34, v114
  v_mfma_f32_16x16x32_bf16 a[28:31], a[156:159], v[36:39], a[28:31]
  v_exp_f32 v35, v115
  v_mfma_f32_16x16x32_bf16 a[28:31], a[152:155], v[164:167], a[28:31]
  v_cvt_pk_bf16_f32 v163, v34, v35
  v_or3_b32 v1, v1, v162, v163
  v_mfma_f32_16x16x32_bf16 a[232:235], a[240:243], v[172:175], a[232:235]
  ds_read_b128 a[180:183], v9 offset:22528
  v_bitop3_b32 v1, v1, v3, v6 bitop3:0xa8
  v_mfma_f32_16x16x32_bf16 a[232:235], a[240:243], v[44:47], a[232:235]
  v_cmp_ne_u32 vcc, 0, v1
  v_mfma_f32_16x16x32_bf16 a[236:239], a[240:243], v[176:179], a[236:239]
  s_waitcnt lgkmcnt(2)
  v_mfma_f32_16x16x32_bf16 a[236:239], a[240:243], v[14:17], a[236:239]
  s_cbranch_vccnz L_rareb0a
L_retb0a:
  v_mfma_f32_16x16x32_bf16 v[84:87], a[160:163], v[180:183], v[116:119]
  s_add_u32 m0, s29, 106368
  ds_read_b128 a[184:187], v8 offset:30720
  v_mfma_f32_16x16x32_bf16 v[84:87], a[164:167], v[184:187], v[84:87]
  buffer_load_dwordx4 v23, s[12:15], s33 offen offset:128 lds
  v_mfma_f32_16x16x32_bf16 v[84:87], a[168:171], v[188:191], v[84:87]
  v_exp_f32 v28, v52
  v_mfma_f32_16x16x32_bf16 v[84:87], a[172:175], v[192:195], v[84:87]
  v_exp_f32 v29, v53
  v_mfma_f32_16x16x32_bf16 v[92:95], a[172:175], v[208:211], v[120:123]
  ds_read_b128 a[188:191], v9 offset:30720
  v_cvt_pk_bf16_f32 v164, v28, v29
  v_mfma_f32_16x16x32_bf16 v[92:95], a[168:171], v[204:207], v[92:95]
  v_exp_f32 v30, v54
  v_mfma_f32_16x16x32_bf16 v[92:95], a[164:167], v[200:203], v[92:95]
  v_exp_f32 v31, v55
  v_mfma_f32_16x16x32_bf16 v[92:95], a[160:163], v[196:199], v[92:95]
  v_exp_f32 v32, v56
  v_mfma_f32_16x16x32_bf16 v[100:103], a[160:163], v[212:215], v[124:127]
  ds_read_b64_tr_b16 a[128:129], v10 offset:0
  v_cvt_pk_bf16_f32 v165, v30, v31
  v_mfma_f32_16x16x32_bf16 v[100:103], a[164:167], v[216:219], v[100:103]
  ds_read_b64_tr_b16 a[130:131], v10 offset:2048
  v_or_b32 v3, v164, v165
  v_mfma_f32_16x16x32_bf16 v[100:103], a[168:171], v[220:223], v[100:103]
  v_exp_f32 v33, v57
  v_mfma_f32_16x16x32_bf16 v[100:103], a[172:175], v[224:227], v[100:103]
  v_exp_f32 v34, v58
  v_mfma_f32_16x16x32_bf16 v[108:111], a[172:175], v[240:243], v[128:131]
  ds_read_b64_tr_b16 a[132:133], v10 offset:4096
  v_cvt_pk_bf16_f32 v166, v32, v33
  v_mfma_f32_16x16x32_bf16 v[108:111], a[168:171], v[236:239], v[108:111]
  ds_read_b64_tr_b16 a[134:135], v10 offset:6144
  v_mfma_f32_16x16x32_bf16 v[108:111], a[164:167], v[232:235], v[108:111]
  s_add_u32 m0, s29, 102400
  v_exp_f32 v35, v59
  v_mfma_f32_16x16x32_bf16 v[108:111], a[160:163], v[228:231], v[108:111]
  s_waitcnt lgkmcnt(4)
  buffer_load_dwordx4 v23, s[12:15], s35 offen lds
  v_mfma_f32_16x16x32_bf16 v[112:115], a[176:179], v[228:231], v[128:131]
  ds_read_b64_tr_b16 a[136:137], v11 offset:0
  v_cvt_pk_bf16_f32 v167, v34, v35
  v_mfma_f32_16x16x32_bf16 v[112:115], a[180:183], v[232:235], v[112:115]
  ds_read_b64_tr_b16 a[138:139], v11 offset:2048
  v_or_b32 v1, v166, v167
  v_mfma_f32_16x16x32_bf16 v[112:115], a[184:187], v[236:239], v[112:115]
  v_exp_f32 v28, v60
  v_mfma_f32_16x16x32_bf16 v[112:115], a[188:191], v[240:243], v[112:115]
  v_exp_f32 v29, v61
  v_mfma_f32_16x16x32_bf16 v[104:107], a[188:191], v[224:227], v[124:127]
  ds_read_b64_tr_b16 a[140:141], v11 offset:4096
  v_cvt_pk_bf16_f32 v168, v28, v29
  v_mfma_f32_16x16x32_bf16 v[104:107], a[184:187], v[220:223], v[104:107]
  ds_read_b64_tr_b16 a[142:143], v11 offset:6144
  v_mfma_f32_16x16x32_bf16 v[104:107], a[180:183], v[216:219], v[104:107]
  v_exp_f32 v30, v62
  v_mfma_f32_16x16x32_bf16 v[104:107], a[176:179], v[212:215], v[104:107]
  v_exp_f32 v31, v63
  v_mfma_f32_16x16x32_bf16 v[96:99], a[176:179], v[196:199], v[120:123]
  ds_read_b64_tr_b16 a[144:145], v12 offset:0
  v_cvt_pk_bf16_f32 v169, v30, v31
  v_mfma_f32_16x16x32_bf16 v[96:99], a[180:183], v[200:203], v[96:99]
  ds_read_b64_tr_b16 a[146:147], v12 offset:2048
  v_or3_b32 v3, v3, v168, v169
  v_mfma_f32_16x16x32_bf16 v[96:99], a[184:187], v[204:207], v[96:99]
  v_exp_f32 v32, v64
  v_mfma_f32_16x16x32_bf16 v[96:99], a[188:191], v[208:211], v[96:99]
  v_exp_f32 v33, v65
  v_mfma_f32_16x16x32_bf16 v[88:91], a[188:191], v[192:195], v[116:119]
  ds_read_b64_tr_b16 a[148:149], v12 offset:4096
  v_cvt_pk_bf16_f32 v170, v32, v33
  v_mfma_f32_16x16x32_bf16 v[88:91], a[184:187], v[188:191], v[88:91]
  s_add_u32 m0, s29, 110464
  ds_read_b64_tr_b16 a[150:151], v12 offset:6144
  v_mfma_f32_16x16x32_bf16 v[88:91], a[180:183], v[184:187], v[88:91]
  buffer_load_dwordx4 v23, s[12:15], s35 offen offset:128 lds
  v_mfma_f32_16x16x32_bf16 v[88:91], a[176:179], v[180:183], v[88:91]
  s_waitcnt lgkmcnt(4)
  v_exp_f32 v34, v66
  v_mfma_f32_16x16x32_bf16 a[0:3], a[128:131], v[132:135], a[0:3]
  ds_read_b64_tr_b16 a[152:153], v13 offset:0
  v_mfma_f32_16x16x32_bf16 a[0:3], a[132:135], v[148:151], a[0:3]
  ds_read_b64_tr_b16 a[154:155], v13 offset:2048
  v_mfma_f32_16x16x32_bf16 a[32:35], a[132:135], v[152:155], a[32:35]
  v_exp_f32 v35, v67
  v_mfma_f32_16x16x32_bf16 a[32:35], a[128:131], v[136:139], a[32:35]
  v_exp_f32 v28, v68
  v_mfma_f32_16x16x32_bf16 a[64:67], a[128:131], v[140:143], a[64:67]
  ds_read_b64_tr_b16 a[156:157], v13 offset:4096
  v_cvt_pk_bf16_f32 v171, v34, v35
  v_mfma_f32_16x16x32_bf16 a[64:67], a[132:135], v[156:159], a[64:67]
  ds_read_b64_tr_b16 a[158:159], v13 offset:6144
  v_or3_b32 v1, v1, v170, v171
  v_mfma_f32_16x16x32_bf16 a[96:99], a[132:135], v[160:163], a[96:99]
  v_exp_f32 v29, v69
  v_mfma_f32_16x16x32_bf16 a[96:99], a[128:131], v[144:147], a[96:99]
  v_exp_f32 v30, v70
  v_mfma_f32_16x16x32_bf16 a[100:103], a[136:139], v[144:147], a[100:103]
  v_exp_f32 v31, v71
  v_mfma_f32_16x16x32_bf16 a[100:103], a[140:143], v[160:163], a[100:103]
  v_cvt_pk_bf16_f32 v172, v28, v29
  v_cvt_pk_bf16_f32 v173, v30, v31
  v_mfma_f32_16x16x32_bf16 a[68:71], a[140:143], v[156:159], a[68:71]
  v_exp_f32 v32, v72
  v_mfma_f32_16x16x32_bf16 a[68:71], a[136:139], v[140:143], a[68:71]
  s_waitcnt vmcnt(8)
  v_exp_f32 v33, v73
  v_mfma_f32_16x16x32_bf16 a[36:39], a[136:139], v[136:139], a[36:39]
  s_barrier
  ds_read_b128 a[160:163], v8 offset:32768
  v_mfma_f32_16x16x32_bf16 a[36:39], a[140:143], v[152:155], a[36:39]
  v_or3_b32 v3, v3, v172, v173
  v_cvt_pk_bf16_f32 v174, v32, v33
  v_mfma_f32_16x16x32_bf16 a[4:7], a[140:143], v[148:151], a[4:7]
  v_exp_f32 v34, v74
  v_mfma_f32_16x16x32_bf16 a[4:7], a[136:139], v[132:135], a[4:7]
  s_waitcnt lgkmcnt(1)
  v_exp_f32 v35, v75
  v_mfma_f32_16x16x32_bf16 a[8:11], a[144:147], v[132:135], a[8:11]
  ds_read_b128 a[164:167], v9 offset:32768
  v_cvt_pk_bf16_f32 v175, v34, v35
  v_mfma_f32_16x16x32_bf16 a[8:11], a[148:151], v[148:151], a[8:11]
  v_exp_f32 v28, v76
  v_mfma_f32_16x16x32_bf16 a[40:43], a[148:151], v[152:155], a[40:43]
  v_exp_f32 v29, v77
  v_mfma_f32_16x16x32_bf16 a[40:43], a[144:147], v[136:139], a[40:43]
  v_or3_b32 v1, v1, v174, v175
  v_cvt_pk_bf16_f32 v176, v28, v29
  v_mfma_f32_16x16x32_bf16 a[72:75], a[144:147], v[140:143], a[72:75]
  ds_read_b128 a[168:171], v8 offset:40960
  v_mfma_f32_16x16x32_bf16 a[72:75], a[148:151], v[156:159], a[72:75]
  v_exp_f32 v30, v78
  v_mfma_f32_16x16x32_bf16 a[104:107], a[148:151], v[160:163], a[104:107]
  v_exp_f32 v31, v79
  v_mfma_f32_16x16x32_bf16 a[104:107], a[144:147], v[144:147], a[104:107]
  v_exp_f32 v32, v80
  v_mfma_f32_16x16x32_bf16 a[108:111], a[152:155], v[144:147], a[108:111]
  ds_read_b128 a[172:175], v9 offset:40960
  v_cvt_pk_bf16_f32 v177, v30, v31
  v_mfma_f32_16x16x32_bf16 a[108:111], a[156:159], v[160:163], a[108:111]
  v_exp_f32 v33, v81
  v_mfma_f32_16x16x32_bf16 a[76:79], a[156:159], v[156:159], a[76:79]
  v_or3_b32 v3, v3, v176, v177
  v_cvt_pk_bf16_f32 v178, v32, v33
  v_mfma_f32_16x16x32_bf16 a[76:79], a[152:155], v[140:143], a[76:79]
  v_exp_f32 v34, v82
  v_mfma_f32_16x16x32_bf16 a[44:47], a[152:155], v[136:139], a[44:47]
  ds_read_b128 a[176:179], v8 offset:34816
  v_mfma_f32_16x16x32_bf16 a[44:47], a[156:159], v[152:155], a[44:47]
  v_exp_f32 v35, v83
  v_mfma_f32_16x16x32_bf16 a[12:15], a[156:159], v[148:151], a[12:15]
  s_add_u32 s35, s35, 16384
  v_cvt_pk_bf16_f32 v179, v34, v35
  v_or3_b32 v1, v1, v178, v179
  v_mfma_f32_16x16x32_bf16 a[12:15], a[152:155], v[132:135], a[12:15]
  s_add_u32 s34, s34, 16384
  v_bitop3_b32 v1, v1, v3, v6 bitop3:0xa8
  v_cmp_ne_u32 vcc, 0, v1
  v_mfma_f32_16x16x32_bf16 a[224:227], a[240:243], v[132:135], a[224:227]
  s_add_u32 s33, s33, 16384
  ds_read_b128 a[180:183], v9 offset:34816
  v_mfma_f32_16x16x32_bf16 a[224:227], a[240:243], v[148:151], a[224:227]
  s_add_u32 s32, s32, 16384
  v_mfma_f32_16x16x32_bf16 a[228:231], a[240:243], v[136:139], a[228:231]
  s_waitcnt lgkmcnt(2)
  v_mfma_f32_16x16x32_bf16 a[228:231], a[240:243], v[152:155], a[228:231]
  s_cbranch_vccnz L_rareb0b
L_retb0b:
  s_branch L_loop
L_sidejob:
  s_cmp_ge_u32 s36, 6
  s_cbranch_scc1 L_sidework
  s_cmp_lg_u32 s36, 1
  s_cbranch_scc1 L_sidesig
  buffer_load_dword v250, v251, s[84:87], 0 offen sc1
  s_branch L_sideret
L_sidesig:
  s_and_b32 s38, s2, 1
  s_cmp_eq_u32 s38, 0
  s_cselect_b32 s16, s60, s62
  s_cselect_b32 s17, s61, s63
  s_mov_b32 s18, 2211840
  s_lshr_b32 s38, s2, 1
  s_lshl_b32 s38, s38, 2
  s_add_u32 s38, s38, s28
  s_mul_i32 s38, s38, 5120
  v_lshlrev_b32 v3, 7, v0
  v_min_u32 v3, 4992, v3
  buffer_load_dword a192, v3, s[16:19], s38 offen
  s_cmp_lg_u32 s28, 0
  s_cbranch_scc1 L_sideret
  s_mov_b64 exec, 1
  v_mov_b32 v3, s89
  v_mov_b32 v4, 1
  buffer_atomic_add v4, v3, s[84:87], 0 offen sc1
  s_mov_b64 exec, -1
  s_branch L_sideret
L_sidework:
  s_waitcnt lgkmcnt(4)
  ds_read_b64_tr_b16 a[192:193], v18 offset:0
  ds_read_b64_tr_b16 a[194:195], v18 offset:2048
  ds_read_b64_tr_b16 a[196:197], v19 offset:0
  ds_read_b64_tr_b16 a[198:199], v19 offset:2048
  ds_read_b64_tr_b16 a[200:201], v20 offset:0
  ds_read_b64_tr_b16 a[202:203], v20 offset:2048
  ds_read_b64_tr_b16 a[204:205], v21 offset:0
  ds_read_b64_tr_b16 a[206:207], v21 offset:2048
  s_waitcnt lgkmcnt(0)
  buffer_store_dwordx4 a[192:195], v25, s[76:79], s42 offen offset:0 sc1
  buffer_store_dwordx4 a[196:199], v25, s[76:79], s42 offen offset:1024 sc1
  buffer_store_dwordx4 a[200:203], v25, s[76:79], s42 offen offset:2048 sc1
  buffer_store_dwordx4 a[204:207], v25, s[76:79], s42 offen offset:3072 sc1
  ds_read_b64_tr_b16 a[208:209], v18 offset:4096
  ds_read_b64_tr_b16 a[210:211], v18 offset:6144
  ds_read_b64_tr_b16 a[212:213], v19 offset:4096
  ds_read_b64_tr_b16 a[214:215], v19 offset:6144
  ds_read_b64_tr_b16 a[216:217], v20 offset:4096
  ds_read_b64_tr_b16 a[218:219], v20 offset:6144
  ds_read_b64_tr_b16 a[220:221], v21 offset:4096
  ds_read_b64_tr_b16 a[222:223], v21 offset:6144
  s_waitcnt lgkmcnt(0)
  buffer_store_dwordx4 a[208:211], v25, s[76:79], s43 offen offset:0 sc1
  buffer_store_dwordx4 a[212:215], v25, s[76:79], s43 offen offset:1024 sc1
  buffer_store_dwordx4 a[216:219], v25, s[76:79], s43 offen offset:2048 sc1
  buffer_store_dwordx4 a[220:223], v25, s[76:79], s43 offen offset:3072 sc1
  s_cmp_eq_u32 s36, 6
  s_cbranch_scc1 L_sideret
  s_bitcmp0_b32 s91, 6
  s_cbranch_scc1 L_sideret
  s_add_u32 s38, s90, 512
  s_lshl_b32 s42, s38, 12
  s_mul_i32 s39, s38, 6554
  s_lshr_b32 s39, s39, 16
  s_mul_i32 s66, s39, 10
  s_sub_u32 s66, s38, s66
  s_lshl_b32 s66, s66, 7
  s_cmp_lt_u32 s38, 1820
  s_cselect_b32 s70, 39808, 0
  s_cmp_lt_u32 s39, 128
  s_cselect_b32 s68, s56, s64
  s_cselect_b32 s69, s57, s65
  s_cselect_b32 s67, 0, 128
  s_sub_u32 s39, s39, s67
  s_min_u32 s39, s39, 127
  s_mul_i32 s39, s39, 40960
  s_add_u32 s39, s39, s66
  s_add_u32 s68, s68, s39
  s_addc_u32 s69, s69, 0
  s_mov_b32 s71, 0x20000
  s_add_u32 s38, s90, 768
  s_lshl_b32 s43, s38, 12
  s_mul_i32 s39, s38, 6554
  s_lshr_b32 s39, s39, 16
  s_mul_i32 s66, s39, 10
  s_sub_u32 s66, s38, s66
  s_lshl_b32 s66, s66, 7
  s_cmp_lt_u32 s38, 1820
  s_cselect_b32 s74, 39808, 0
  s_cmp_lt_u32 s39, 128
  s_cselect_b32 s72, s56, s64
  s_cselect_b32 s73, s57, s65
  s_cselect_b32 s67, 0, 128
  s_sub_u32 s39, s39, s67
  s_min_u32 s39, s39, 127
  s_mul_i32 s39, s39, 40960
  s_add_u32 s39, s39, s66
  s_add_u32 s72, s72, s39
  s_addc_u32 s73, s73, 0
  s_mov_b32 s75, 0x20000
  s_add_u32 m0, s41, 131072
  s_mov_b32 s38, 0
  buffer_load_dwordx4 v244, s[68:71], s38 offen lds
  s_add_u32 m0, s41, 132096
  s_mov_b32 s38, 10240
  buffer_load_dwordx4 v244, s[68:71], s38 offen lds
  s_add_u32 m0, s41, 133120
  s_mov_b32 s38, 20480
  buffer_load_dwordx4 v244, s[68:71], s38 offen lds
  s_add_u32 m0, s41, 134144
  s_mov_b32 s38, 30720
  buffer_load_dwordx4 v244, s[68:71], s38 offen lds
  s_add_u32 m0, s41, 135168
  s_mov_b32 s38, 0
  buffer_load_dwordx4 v244, s[72:75], s38 offen lds
  s_add_u32 m0, s41, 136192
  s_mov_b32 s38, 10240
  buffer_load_dwordx4 v244, s[72:75], s38 offen lds
  s_add_u32 m0, s41, 137216
  s_mov_b32 s38, 20480
  buffer_load_dwordx4 v244, s[72:75], s38 offen lds
  s_add_u32 m0, s41, 138240
  s_mov_b32 s38, 30720
  buffer_load_dwordx4 v244, s[72:75], s38 offen lds
  s_branch L_sideret
L_tail:
  s_mov_b32 s32, 131072
L_sidepoll:
  v_cmp_gt_u32 vcc, 32, v250
  s_cbranch_vccz L_sideok
  s_sub_u32 s32, s32, 1
  s_cmp_eq_u32 s32, 0
  s_cbranch_scc1 L_sideok
  buffer_load_dword v250, v251, s[84:87], 0 offen sc1
  s_waitcnt vmcnt(0)
  s_branch L_sidepoll
L_sideok:
  s_mov_b32 s8, s44
  s_mov_b32 s9, s45
  s_mov_b32 s10, s46
  global_load_dwordx4 v[240:243], v[252:253], off
  ds_read_b64_tr_b16 a[184:185], v10 offset:40960
  ds_read_b64_tr_b16 a[186:187], v10 offset:43008
  ds_read_b64_tr_b16 a[188:189], v10 offset:45056
  ds_read_b64_tr_b16 a[190:191], v10 offset:47104
  ds_read_b64_tr_b16 a[128:129], v11 offset:40960
  ds_read_b64_tr_b16 a[130:131], v11 offset:43008
  ds_read_b64_tr_b16 a[132:133], v11 offset:45056
  ds_read_b64_tr_b16 a[134:135], v11 offset:47104
  ds_read_b64_tr_b16 a[136:137], v12 offset:40960
  ds_read_b64_tr_b16 a[138:139], v12 offset:43008
  ds_read_b64_tr_b16 a[140:141], v12 offset:45056
  ds_read_b64_tr_b16 a[142:143], v12 offset:47104
  s_waitcnt lgkmcnt(4)
  v_mfma_f32_16x16x32_bf16 a[16:19], a[184:187], v[132:135], a[16:19]
  ds_read_b64_tr_b16 a[144:145], v13 offset:40960
  v_exp_f32 v28, v84
  v_exp_f32 v29, v85
  v_mfma_f32_16x16x32_bf16 a[16:19], a[188:191], v[148:151], a[16:19]
  ds_read_b64_tr_b16 a[146:147], v13 offset:43008
  v_exp_f32 v30, v86
  v_cvt_pk_bf16_f32 v36, v28, v29
  v_mfma_f32_16x16x32_bf16 a[48:51], a[188:191], v[152:155], a[48:51]
  v_exp_f32 v31, v87
  v_exp_f32 v32, v88
  v_mfma_f32_16x16x32_bf16 a[48:51], a[184:187], v[136:139], a[48:51]
  v_exp_f32 v33, v89
  v_exp_f32 v34, v90
  v_mfma_f32_16x16x32_bf16 a[80:83], a[184:187], v[140:143], a[80:83]
  s_mov_b32 s38, 0
  ds_read_b64_tr_b16 a[148:149], v13 offset:45056
  v_cvt_pk_bf16_f32 v37, v30, v31
  v_or_b32 v3, v36, v37
  v_cvt_pk_bf16_f32 v38, v32, v33
  v_mfma_f32_16x16x32_bf16 a[80:83], a[188:191], v[156:159], a[80:83]
  s_add_u32 m0, s29, 0
  ds_read_b64_tr_b16 a[150:151], v13 offset:47104
  v_exp_f32 v35, v91
  v_exp_f32 v28, v92
  v_mfma_f32_16x16x32_bf16 a[112:115], a[188:191], v[160:163], a[112:115]
  buffer_load_dwordx4 v245, s[8:11], s38 offen sc1 lds
  v_exp_f32 v29, v93
  v_mfma_f32_16x16x32_bf16 a[112:115], a[184:187], v[144:147], a[112:115]
  s_add_u32 m0, s29, 4096
  v_cvt_pk_bf16_f32 v39, v34, v35
  v_or_b32 v1, v38, v39
  v_exp_f32 v30, v94
  v_mfma_f32_16x16x32_bf16 a[116:119], a[128:131], v[144:147], a[116:119]
  buffer_load_dwordx4 v246, s[8:11], s38 offen sc1 lds
  v_exp_f32 v31, v95
  v_mfma_f32_16x16x32_bf16 a[116:119], a[132:135], v[160:163], a[116:119]
  s_add_u32 m0, s29, 8192
  v_cvt_pk_bf16_f32 v40, v28, v29
  v_exp_f32 v32, v96
  v_cvt_pk_bf16_f32 v41, v30, v31
  v_mfma_f32_16x16x32_bf16 a[84:87], a[132:135], v[156:159], a[84:87]
  buffer_load_dwordx4 v247, s[8:11], s38 offen sc1 lds
  v_or3_b32 v3, v3, v40, v41
  v_mfma_f32_16x16x32_bf16 a[84:87], a[128:131], v[140:143], a[84:87]
  s_add_u32 m0, s29, 12288
  v_exp_f32 v33, v97
  v_exp_f32 v34, v98
  v_mfma_f32_16x16x32_bf16 a[52:55], a[128:131], v[136:139], a[52:55]
  buffer_load_dwordx4 v248, s[8:11], s38 offen sc1 lds
  v_mfma_f32_16x16x32_bf16 a[52:55], a[132:135], v[152:155], a[52:55]
  s_add_u32 m0, s29, 16384
  v_exp_f32 v35, v99
  v_cvt_pk_bf16_f32 v42, v32, v33
  v_mfma_f32_16x16x32_bf16 a[20:23], a[132:135], v[148:151], a[20:23]
  buffer_load_dwordx4 v249, s[8:11], s38 offen sc1 lds
  v_cvt_pk_bf16_f32 v43, v34, v35
  v_mfma_f32_16x16x32_bf16 a[20:23], a[128:131], v[132:135], a[20:23]
  s_waitcnt lgkmcnt(0)
  v_exp_f32 v28, v100
  v_or3_b32 v1, v1, v42, v43
  v_mfma_f32_16x16x32_bf16 a[24:27], a[136:139], v[132:135], a[24:27]
  s_mov_b32 s38, 81920
  v_exp_f32 v29, v101
  v_exp_f32 v30, v102
  v_mfma_f32_16x16x32_bf16 a[24:27], a[140:143], v[148:151], a[24:27]
  s_add_u32 m0, s29, 143360
  v_exp_f32 v31, v103
  v_mfma_f32_16x16x32_bf16 a[56:59], a[140:143], v[152:155], a[56:59]
  buffer_load_dwordx4 v245, s[8:11], s38 offen sc1 lds
  v_cvt_pk_bf16_f32 v44, v28, v29
  v_mfma_f32_16x16x32_bf16 a[56:59], a[136:139], v[136:139], a[56:59]
  v_exp_f32 v32, v104
  v_cvt_pk_bf16_f32 v45, v30, v31
  v_mfma_f32_16x16x32_bf16 a[88:91], a[136:139], v[140:143], a[88:91]
  s_add_u32 m0, s29, 147456
  v_exp_f32 v33, v105
  v_or3_b32 v3, v3, v44, v45
  v_mfma_f32_16x16x32_bf16 a[88:91], a[140:143], v[156:159], a[88:91]
  buffer_load_dwordx4 v246, s[8:11], s38 offen sc1 lds
  v_cvt_pk_bf16_f32 v46, v32, v33
  v_mfma_f32_16x16x32_bf16 a[120:123], a[140:143], v[160:163], a[120:123]
  v_exp_f32 v34, v106
  v_exp_f32 v35, v107
  v_mfma_f32_16x16x32_bf16 a[120:123], a[136:139], v[144:147], a[120:123]
  s_add_u32 m0, s29, 151552
  v_exp_f32 v28, v108
  v_mfma_f32_16x16x32_bf16 a[124:127], a[144:147], v[144:147], a[124:127]
  buffer_load_dwordx4 v247, s[8:11], s38 offen sc1 lds
  v_cvt_pk_bf16_f32 v47, v34, v35
  v_mfma_f32_16x16x32_bf16 a[124:127], a[148:151], v[160:163], a[124:127]
  v_exp_f32 v29, v109
  v_or3_b32 v1, v1, v46, v47
  v_mfma_f32_16x16x32_bf16 a[92:95], a[148:151], v[156:159], a[92:95]
  s_add_u32 m0, s29, 155648
  v_exp_f32 v30, v110
  v_cvt_pk_bf16_f32 v14, v28, v29
  v_mfma_f32_16x16x32_bf16 a[92:95], a[144:147], v[140:143], a[92:95]
  buffer_load_dwordx4 v248, s[8:11], s38 offen sc1 lds
  v_exp_f32 v31, v111
  v_mfma_f32_16x16x32_bf16 a[60:63], a[144:147], v[136:139], a[60:63]
  v_exp_f32 v32, v112
  v_mfma_f32_16x16x32_bf16 a[60:63], a[148:151], v[152:155], a[60:63]
  s_add_u32 m0, s29, 159744
  v_exp_f32 v33, v113
  v_cvt_pk_bf16_f32 v15, v30, v31
  v_mfma_f32_16x16x32_bf16 a[28:31], a[148:151], v[148:151], a[28:31]
  buffer_load_dwordx4 v249, s[8:11], s38 offen sc1 lds
  v_or3_b32 v3, v3, v14, v15
  v_mfma_f32_16x16x32_bf16 a[28:31], a[144:147], v[132:135], a[28:31]
  v_exp_f32 v34, v114
  v_cvt_pk_bf16_f32 v16, v32, v33
  v_mfma_f32_16x16x32_bf16 a[232:235], a[240:243], v[140:143], a[232:235]
  v_exp_f32 v35, v115
  v_mfma_f32_16x16x32_bf16 a[232:235], a[240:243], v[156:159], a[232:235]
  v_cvt_pk_bf16_f32 v17, v34, v35
  v_or3_b32 v1, v1, v16, v17
  v_bitop3_b32 v1, v1, v3, v6 bitop3:0xa8
  v_cmp_ne_u32 vcc, 0, v1
  v_mfma_f32_16x16x32_bf16 a[236:239], a[240:243], v[144:147], a[236:239]
  v_mfma_f32_16x16x32_bf16 a[236:239], a[240:243], v[160:163], a[236:239]
  s_cbranch_vccnz L_raret3a
L_rett3a:
  ds_read_b64_tr_b16 a[152:153], v10 offset:49152
  ds_read_b64_tr_b16 a[154:155], v10 offset:51200
  ds_read_b64_tr_b16 a[156:157], v10 offset:53248
  ds_read_b64_tr_b16 a[158:159], v10 offset:55296
  ds_read_b64_tr_b16 a[160:161], v11 offset:49152
  ds_read_b64_tr_b16 a[162:163], v11 offset:51200
  ds_read_b64_tr_b16 a[164:165], v11 offset:53248
  ds_read_b64_tr_b16 a[166:167], v11 offset:55296
  v_mfma_f32_16x16x32_bf16 a[224:227], a[240:243], v[164:167], a[224:227]
  ds_read_b64_tr_b16 a[168:169], v12 offset:49152
  v_mfma_f32_16x16x32_bf16 a[224:227], a[240:243], v[36:39], a[224:227]
  ds_read_b64_tr_b16 a[170:171], v12 offset:51200
  v_mfma_f32_16x16x32_bf16 a[228:231], a[240:243], v[168:171], a[228:231]
  v_mfma_f32_16x16x32_bf16 a[228:231], a[240:243], v[40:43], a[228:231]
  v_mfma_f32_16x16x32_bf16 a[232:235], a[240:243], v[172:175], a[232:235]
  ds_read_b64_tr_b16 a[172:173], v12 offset:53248
  v_mfma_f32_16x16x32_bf16 a[232:235], a[240:243], v[44:47], a[232:235]
  ds_read_b64_tr_b16 a[174:175], v12 offset:55296
  v_mfma_f32_16x16x32_bf16 a[236:239], a[240:243], v[176:179], a[236:239]
  v_mfma_f32_16x16x32_bf16 a[236:239], a[240:243], v[14:17], a[236:239]
  s_waitcnt lgkmcnt(4)
  v_mfma_f32_16x16x32_bf16 a[0:3], a[152:155], v[164:167], a[0:3]
  ds_read_b64_tr_b16 a[176:177], v13 offset:49152
  v_mfma_f32_16x16x32_bf16 a[0:3], a[156:159], v[36:39], a[0:3]
  ds_read_b64_tr_b16 a[178:179], v13 offset:51200
  v_mfma_f32_16x16x32_bf16 a[32:35], a[156:159], v[40:43], a[32:35]
  v_mfma_f32_16x16x32_bf16 a[32:35], a[152:155], v[168:171], a[32:35]
  s_lshr_b32 s33, s40, 2
  s_lshl_b32 s33, s33, 19
  s_and_b32 s35, s40, 3
  s_lshl_b32 s35, s35, 10
  s_add_u32 s33, s33, s35
  s_lshl_b32 s35, s30, 14
  s_add_u32 s33, s33, s35
  v_mfma_f32_16x16x32_bf16 a[64:67], a[152:155], v[172:175], a[64:67]
  ds_read_b64_tr_b16 a[180:181], v13 offset:53248
  v_accvgpr_read_b32 v28, a224
  v_mfma_f32_16x16x32_bf16 a[64:67], a[156:159], v[44:47], a[64:67]
  ds_read_b64_tr_b16 a[182:183], v13 offset:55296
  v_accvgpr_read_b32 v29, a228
  v_mfma_f32_16x16x32_bf16 a[96:99], a[156:159], v[14:17], a[96:99]
  v_accvgpr_read_b32 v30, a232
  v_accvgpr_read_b32 v31, a236
  v_mfma_f32_16x16x32_bf16 a[96:99], a[152:155], v[176:179], a[96:99]
  v_rcp_f32 v52, v28
  v_mfma_f32_16x16x32_bf16 a[100:103], a[160:163], v[176:179], a[100:103]
  ds_read_b64_tr_b16 a[184:185], v10 offset:57344
  v_mov_b32 v53, v52
  v_mfma_f32_16x16x32_bf16 a[100:103], a[164:167], v[14:17], a[100:103]
  ds_read_b64_tr_b16 a[186:187], v10 offset:59392
  v_mfma_f32_16x16x32_bf16 a[68:71], a[164:167], v[44:47], a[68:71]
  v_rcp_f32 v54, v29
  v_mfma_f32_16x16x32_bf16 a[68:71], a[160:163], v[172:175], a[68:71]
  v_rcp_f32 v56, v30
  v_mfma_f32_16x16x32_bf16 a[36:39], a[160:163], v[168:171], a[36:39]
  ds_read_b64_tr_b16 a[188:189], v10 offset:61440
  v_mov_b32 v55, v54
  v_mfma_f32_16x16x32_bf16 a[36:39], a[164:167], v[40:43], a[36:39]
  ds_read_b64_tr_b16 a[190:191], v10 offset:63488
  v_mov_b32 v57, v56
  v_mfma_f32_16x16x32_bf16 a[4:7], a[164:167], v[36:39], a[4:7]
  v_rcp_f32 v58, v31
  s_nop 0
  v_mov_b32 v59, v58
  v_mfma_f32_16x16x32_bf16 a[4:7], a[160:163], v[164:167], a[4:7]
  s_waitcnt lgkmcnt(4)
  v_mfma_f32_16x16x32_bf16 a[8:11], a[168:171], v[164:167], a[8:11]
  ds_read_b64_tr_b16 a[128:129], v11 offset:57344
  v_mfma_f32_16x16x32_bf16 a[8:11], a[172:175], v[36:39], a[8:11]
  ds_read_b64_tr_b16 a[130:131], v11 offset:59392
  v_mfma_f32_16x16x32_bf16 a[40:43], a[172:175], v[40:43], a[40:43]
  v_mfma_f32_16x16x32_bf16 a[40:43], a[168:171], v[168:171], a[40:43]
  s_add_u32 s35, s33, 0
  v_accvgpr_read_b32 v60, a0
  v_accvgpr_read_b32 v61, a1
  v_accvgpr_read_b32 v62, a2
  v_accvgpr_read_b32 v63, a3
  v_accvgpr_read_b32 v64, a4
  v_accvgpr_read_b32 v65, a5
  v_accvgpr_read_b32 v66, a6
  v_accvgpr_read_b32 v67, a7
  v_pk_mul_f32 v[60:61], v[60:61], v[52:53]
  v_pk_mul_f32 v[62:63], v[62:63], v[52:53]
  v_pk_mul_f32 v[64:65], v[64:65], v[52:53]
  v_pk_mul_f32 v[66:67], v[66:67], v[52:53]
  v_cvt_pk_bf16_f32 v180, v60, v61
  v_cvt_pk_bf16_f32 v181, v62, v63
  v_cvt_pk_bf16_f32 v182, v64, v65
  v_cvt_pk_bf16_f32 v183, v66, v67
  buffer_store_dwordx4 v[180:183], v25, s[24:27], s35 offen offset:0 sc1
  v_accvgpr_read_b32 v68, a32
  v_accvgpr_read_b32 v69, a33
  v_accvgpr_read_b32 v70, a34
  v_accvgpr_read_b32 v71, a35
  v_accvgpr_read_b32 v72, a36
  v_accvgpr_read_b32 v73, a37
  v_accvgpr_read_b32 v74, a38
  v_accvgpr_read_b32 v75, a39
  v_pk_mul_f32 v[68:69], v[68:69], v[54:55]
  v_pk_mul_f32 v[70:71], v[70:71], v[54:55]
  v_pk_mul_f32 v[72:73], v[72:73], v[54:55]
  v_pk_mul_f32 v[74:75], v[74:75], v[54:55]
  v_cvt_pk_bf16_f32 v184, v68, v69
  v_cvt_pk_bf16_f32 v185, v70, v71
  v_cvt_pk_bf16_f32 v186, v72, v73
  v_cvt_pk_bf16_f32 v187, v74, v75
  buffer_store_dwordx4 v[184:187], v25, s[24:27], s35 offen offset:1024 sc1
  v_accvgpr_read_b32 v76, a64
  v_accvgpr_read_b32 v77, a65
  v_accvgpr_read_b32 v78, a66
  v_accvgpr_read_b32 v79, a67
  v_accvgpr_read_b32 v80, a68
  v_accvgpr_read_b32 v81, a69
  v_accvgpr_read_b32 v82, a70
  v_accvgpr_read_b32 v83, a71
  v_pk_mul_f32 v[76:77], v[76:77], v[56:57]
  v_pk_mul_f32 v[78:79], v[78:79], v[56:57]
  v_pk_mul_f32 v[80:81], v[80:81], v[56:57]
  v_pk_mul_f32 v[82:83], v[82:83], v[56:57]
  v_cvt_pk_bf16_f32 v188, v76, v77
  v_cvt_pk_bf16_f32 v189, v78, v79
  v_cvt_pk_bf16_f32 v190, v80, v81
  v_cvt_pk_bf16_f32 v191, v82, v83
  buffer_store_dwordx4 v[188:191], v25, s[24:27], s35 offen offset:2048 sc1
  v_accvgpr_read_b32 v60, a96
  v_accvgpr_read_b32 v61, a97
  v_accvgpr_read_b32 v62, a98
  v_accvgpr_read_b32 v63, a99
  v_accvgpr_read_b32 v64, a100
  v_accvgpr_read_b32 v65, a101
  v_accvgpr_read_b32 v66, a102
  v_accvgpr_read_b32 v67, a103
  v_pk_mul_f32 v[60:61], v[60:61], v[58:59]
  v_pk_mul_f32 v[62:63], v[62:63], v[58:59]
  v_pk_mul_f32 v[64:65], v[64:65], v[58:59]
  v_pk_mul_f32 v[66:67], v[66:67], v[58:59]
  v_cvt_pk_bf16_f32 v192, v60, v61
  v_cvt_pk_bf16_f32 v193, v62, v63
  v_cvt_pk_bf16_f32 v194, v64, v65
  v_cvt_pk_bf16_f32 v195, v66, v67
  buffer_store_dwordx4 v[192:195], v25, s[24:27], s35 offen offset:3072 sc1
  v_mfma_f32_16x16x32_bf16 a[72:75], a[168:171], v[172:175], a[72:75]
  ds_read_b64_tr_b16 a[132:133], v11 offset:61440
  v_mfma_f32_16x16x32_bf16 a[72:75], a[172:175], v[44:47], a[72:75]
  ds_read_b64_tr_b16 a[134:135], v11 offset:63488
  v_mfma_f32_16x16x32_bf16 a[104:107], a[172:175], v[14:17], a[104:107]
  v_mfma_f32_16x16x32_bf16 a[104:107], a[168:171], v[176:179], a[104:107]
  v_mfma_f32_16x16x32_bf16 a[108:111], a[176:179], v[176:179], a[108:111]
  ds_read_b64_tr_b16 a[136:137], v12 offset:57344
  v_mfma_f32_16x16x32_bf16 a[108:111], a[180:183], v[14:17], a[108:111]
  ds_read_b64_tr_b16 a[138:139], v12 offset:59392
  v_mfma_f32_16x16x32_bf16 a[76:79], a[180:183], v[44:47], a[76:79]
  v_mfma_f32_16x16x32_bf16 a[76:79], a[176:179], v[172:175], a[76:79]
  v_mfma_f32_16x16x32_bf16 a[44:47], a[176:179], v[168:171], a[44:47]
  ds_read_b64_tr_b16 a[140:141], v12 offset:61440
  v_mfma_f32_16x16x32_bf16 a[44:47], a[180:183], v[40:43], a[44:47]
  ds_read_b64_tr_b16 a[142:143], v12 offset:63488
  v_mfma_f32_16x16x32_bf16 a[12:15], a[180:183], v[36:39], a[12:15]
  v_mfma_f32_16x16x32_bf16 a[12:15], a[176:179], v[164:167], a[12:15]
  s_waitcnt lgkmcnt(4)
  v_mfma_f32_16x16x32_bf16 a[16:19], a[184:187], v[164:167], a[16:19]
  ds_read_b64_tr_b16 a[144:145], v13 offset:57344
  v_mfma_f32_16x16x32_bf16 a[16:19], a[188:191], v[36:39], a[16:19]
  ds_read_b64_tr_b16 a[146:147], v13 offset:59392
  v_mfma_f32_16x16x32_bf16 a[48:51], a[188:191], v[40:43], a[48:51]
  v_mfma_f32_16x16x32_bf16 a[48:51], a[184:187], v[168:171], a[48:51]
  s_add_u32 s35, s33, 4096
  v_accvgpr_read_b32 v68, a8
  v_accvgpr_read_b32 v69, a9
  v_accvgpr_read_b32 v70, a10
  v_accvgpr_read_b32 v71, a11
  v_accvgpr_read_b32 v72, a12
  v_accvgpr_read_b32 v73, a13
  v_accvgpr_read_b32 v74, a14
  v_accvgpr_read_b32 v75, a15
  v_pk_mul_f32 v[68:69], v[68:69], v[52:53]
  v_pk_mul_f32 v[70:71], v[70:71], v[52:53]
  v_pk_mul_f32 v[72:73], v[72:73], v[52:53]
  v_pk_mul_f32 v[74:75], v[74:75], v[52:53]
  v_cvt_pk_bf16_f32 v196, v68, v69
  v_cvt_pk_bf16_f32 v197, v70, v71
  v_cvt_pk_bf16_f32 v198, v72, v73
  v_cvt_pk_bf16_f32 v199, v74, v75
  buffer_store_dwordx4 v[196:199], v25, s[24:27], s35 offen offset:0 sc1
  v_accvgpr_read_b32 v76, a40
  v_accvgpr_read_b32 v77, a41
  v_accvgpr_read_b32 v78, a42
  v_accvgpr_read_b32 v79, a43
  v_accvgpr_read_b32 v80, a44
  v_accvgpr_read_b32 v81, a45
  v_accvgpr_read_b32 v82, a46
  v_accvgpr_read_b32 v83, a47
  v_pk_mul_f32 v[76:77], v[76:77], v[54:55]
  v_pk_mul_f32 v[78:79], v[78:79], v[54:55]
  v_pk_mul_f32 v[80:81], v[80:81], v[54:55]
  v_pk_mul_f32 v[82:83], v[82:83], v[54:55]
  v_cvt_pk_bf16_f32 v200, v76, v77
  v_cvt_pk_bf16_f32 v201, v78, v79
  v_cvt_pk_bf16_f32 v202, v80, v81
  v_cvt_pk_bf16_f32 v203, v82, v83
  buffer_store_dwordx4 v[200:203], v25, s[24:27], s35 offen offset:1024 sc1
  v_accvgpr_read_b32 v60, a72
  v_accvgpr_read_b32 v61, a73
  v_accvgpr_read_b32 v62, a74
  v_accvgpr_read_b32 v63, a75
  v_accvgpr_read_b32 v64, a76
  v_accvgpr_read_b32 v65, a77
  v_accvgpr_read_b32 v66, a78
  v_accvgpr_read_b32 v67, a79
  v_pk_mul_f32 v[60:61], v[60:61], v[56:57]
  v_pk_mul_f32 v[62:63], v[62:63], v[56:57]
  v_pk_mul_f32 v[64:65], v[64:65], v[56:57]
  v_pk_mul_f32 v[66:67], v[66:67], v[56:57]
  v_cvt_pk_bf16_f32 v204, v60, v61
  v_cvt_pk_bf16_f32 v205, v62, v63
  v_cvt_pk_bf16_f32 v206, v64, v65
  v_cvt_pk_bf16_f32 v207, v66, v67
  buffer_store_dwordx4 v[204:207], v25, s[24:27], s35 offen offset:2048 sc1
  v_accvgpr_read_b32 v68, a104
  v_accvgpr_read_b32 v69, a105
  v_accvgpr_read_b32 v70, a106
  v_accvgpr_read_b32 v71, a107
  v_accvgpr_read_b32 v72, a108
  v_accvgpr_read_b32 v73, a109
  v_accvgpr_read_b32 v74, a110
  v_accvgpr_read_b32 v75, a111
  v_pk_mul_f32 v[68:69], v[68:69], v[58:59]
  v_pk_mul_f32 v[70:71], v[70:71], v[58:59]
  v_pk_mul_f32 v[72:73], v[72:73], v[58:59]
  v_pk_mul_f32 v[74:75], v[74:75], v[58:59]
  v_cvt_pk_bf16_f32 v208, v68, v69
  v_cvt_pk_bf16_f32 v209, v70, v71
  v_cvt_pk_bf16_f32 v210, v72, v73
  v_cvt_pk_bf16_f32 v211, v74, v75
  buffer_store_dwordx4 v[208:211], v25, s[24:27], s35 offen offset:3072 sc1
  v_mfma_f32_16x16x32_bf16 a[80:83], a[184:187], v[172:175], a[80:83]
  ds_read_b64_tr_b16 a[148:149], v13 offset:61440
  v_mfma_f32_16x16x32_bf16 a[80:83], a[188:191], v[44:47], a[80:83]
  ds_read_b64_tr_b16 a[150:151], v13 offset:63488
  v_mfma_f32_16x16x32_bf16 a[112:115], a[188:191], v[14:17], a[112:115]
  v_mfma_f32_16x16x32_bf16 a[112:115], a[184:187], v[176:179], a[112:115]
  v_mfma_f32_16x16x32_bf16 a[116:119], a[128:131], v[176:179], a[116:119]
  v_mfma_f32_16x16x32_bf16 a[116:119], a[132:135], v[14:17], a[116:119]
  v_mfma_f32_16x16x32_bf16 a[84:87], a[132:135], v[44:47], a[84:87]
  v_mfma_f32_16x16x32_bf16 a[84:87], a[128:131], v[172:175], a[84:87]
  v_mfma_f32_16x16x32_bf16 a[52:55], a[128:131], v[168:171], a[52:55]
  v_mfma_f32_16x16x32_bf16 a[52:55], a[132:135], v[40:43], a[52:55]
  v_mfma_f32_16x16x32_bf16 a[20:23], a[132:135], v[36:39], a[20:23]
  v_mfma_f32_16x16x32_bf16 a[20:23], a[128:131], v[164:167], a[20:23]
  s_waitcnt lgkmcnt(0)
  v_mfma_f32_16x16x32_bf16 a[24:27], a[136:139], v[164:167], a[24:27]
  v_mfma_f32_16x16x32_bf16 a[24:27], a[140:143], v[36:39], a[24:27]
  v_mfma_f32_16x16x32_bf16 a[56:59], a[140:143], v[40:43], a[56:59]
  v_mfma_f32_16x16x32_bf16 a[56:59], a[136:139], v[168:171], a[56:59]
  s_add_u32 s35, s33, 8192
  v_accvgpr_read_b32 v76, a16
  v_accvgpr_read_b32 v77, a17
  v_accvgpr_read_b32 v78, a18
  v_accvgpr_read_b32 v79, a19
  v_accvgpr_read_b32 v80, a20
  v_accvgpr_read_b32 v81, a21
  v_accvgpr_read_b32 v82, a22
  v_accvgpr_read_b32 v83, a23
  v_pk_mul_f32 v[76:77], v[76:77], v[52:53]
  v_pk_mul_f32 v[78:79], v[78:79], v[52:53]
  v_pk_mul_f32 v[80:81], v[80:81], v[52:53]
  v_pk_mul_f32 v[82:83], v[82:83], v[52:53]
  v_cvt_pk_bf16_f32 v180, v76, v77
  v_cvt_pk_bf16_f32 v181, v78, v79
  v_cvt_pk_bf16_f32 v182, v80, v81
  v_cvt_pk_bf16_f32 v183, v82, v83
  buffer_store_dwordx4 v[180:183], v25, s[24:27], s35 offen offset:0 sc1
  v_accvgpr_read_b32 v60, a48
  v_accvgpr_read_b32 v61, a49
  v_accvgpr_read_b32 v62, a50
  v_accvgpr_read_b32 v63, a51
  v_accvgpr_read_b32 v64, a52
  v_accvgpr_read_b32 v65, a53
  v_accvgpr_read_b32 v66, a54
  v_accvgpr_read_b32 v67, a55
  v_pk_mul_f32 v[60:61], v[60:61], v[54:55]
  v_pk_mul_f32 v[62:63], v[62:63], v[54:55]
  v_pk_mul_f32 v[64:65], v[64:65], v[54:55]
  v_pk_mul_f32 v[66:67], v[66:67], v[54:55]
  v_cvt_pk_bf16_f32 v184, v60, v61
  v_cvt_pk_bf16_f32 v185, v62, v63
  v_cvt_pk_bf16_f32 v186, v64, v65
  v_cvt_pk_bf16_f32 v187, v66, v67
  buffer_store_dwordx4 v[184:187], v25, s[24:27], s35 offen offset:1024 sc1
  v_accvgpr_read_b32 v68, a80
  v_accvgpr_read_b32 v69, a81
  v_accvgpr_read_b32 v70, a82
  v_accvgpr_read_b32 v71, a83
  v_accvgpr_read_b32 v72, a84
  v_accvgpr_read_b32 v73, a85
  v_accvgpr_read_b32 v74, a86
  v_accvgpr_read_b32 v75, a87
  v_pk_mul_f32 v[68:69], v[68:69], v[56:57]
  v_pk_mul_f32 v[70:71], v[70:71], v[56:57]
  v_pk_mul_f32 v[72:73], v[72:73], v[56:57]
  v_pk_mul_f32 v[74:75], v[74:75], v[56:57]
  v_cvt_pk_bf16_f32 v188, v68, v69
  v_cvt_pk_bf16_f32 v189, v70, v71
  v_cvt_pk_bf16_f32 v190, v72, v73
  v_cvt_pk_bf16_f32 v191, v74, v75
  buffer_store_dwordx4 v[188:191], v25, s[24:27], s35 offen offset:2048 sc1
  v_accvgpr_read_b32 v76, a112
  v_accvgpr_read_b32 v77, a113
  v_accvgpr_read_b32 v78, a114
  v_accvgpr_read_b32 v79, a115
  v_accvgpr_read_b32 v80, a116
  v_accvgpr_read_b32 v81, a117
  v_accvgpr_read_b32 v82, a118
  v_accvgpr_read_b32 v83, a119
  v_pk_mul_f32 v[76:77], v[76:77], v[58:59]
  v_pk_mul_f32 v[78:79], v[78:79], v[58:59]
  v_pk_mul_f32 v[80:81], v[80:81], v[58:59]
  v_pk_mul_f32 v[82:83], v[82:83], v[58:59]
  v_cvt_pk_bf16_f32 v192, v76, v77
  v_cvt_pk_bf16_f32 v193, v78, v79
  v_cvt_pk_bf16_f32 v194, v80, v81
  v_cvt_pk_bf16_f32 v195, v82, v83
  buffer_store_dwordx4 v[192:195], v25, s[24:27], s35 offen offset:3072 sc1
  v_mfma_f32_16x16x32_bf16 a[88:91], a[136:139], v[172:175], a[88:91]
  v_mfma_f32_16x16x32_bf16 a[88:91], a[140:143], v[44:47], a[88:91]
  v_mfma_f32_16x16x32_bf16 a[120:123], a[140:143], v[14:17], a[120:123]
  v_mfma_f32_16x16x32_bf16 a[120:123], a[136:139], v[176:179], a[120:123]
  v_mfma_f32_16x16x32_bf16 a[124:127], a[144:147], v[176:179], a[124:127]
  v_mfma_f32_16x16x32_bf16 a[124:127], a[148:151], v[14:17], a[124:127]
  v_mfma_f32_16x16x32_bf16 a[92:95], a[148:151], v[44:47], a[92:95]
  v_mfma_f32_16x16x32_bf16 a[92:95], a[144:147], v[172:175], a[92:95]
  v_mfma_f32_16x16x32_bf16 a[60:63], a[144:147], v[168:171], a[60:63]
  v_mfma_f32_16x16x32_bf16 a[60:63], a[148:151], v[40:43], a[60:63]
  v_mfma_f32_16x16x32_bf16 a[28:31], a[148:151], v[36:39], a[28:31]
  v_mfma_f32_16x16x32_bf16 a[28:31], a[144:147], v[164:167], a[28:31]
  s_add_u32 s35, s33, 12288
  v_accvgpr_read_b32 v60, a24
  v_accvgpr_read_b32 v61, a25
  v_accvgpr_read_b32 v62, a26
  v_accvgpr_read_b32 v63, a27
  s_nop 2
  v_accvgpr_read_b32 v64, a28
  v_accvgpr_read_b32 v65, a29
  v_accvgpr_read_b32 v66, a30
  v_accvgpr_read_b32 v67, a31
  v_pk_mul_f32 v[60:61], v[60:61], v[52:53]
  v_pk_mul_f32 v[62:63], v[62:63], v[52:53]
  v_pk_mul_f32 v[64:65], v[64:65], v[52:53]
  v_pk_mul_f32 v[66:67], v[66:67], v[52:53]
  v_cvt_pk_bf16_f32 v196, v60, v61
  v_cvt_pk_bf16_f32 v197, v62, v63
  v_cvt_pk_bf16_f32 v198, v64, v65
  v_cvt_pk_bf16_f32 v199, v66, v67
  buffer_store_dwordx4 v[196:199], v25, s[24:27], s35 offen offset:0 sc1
  v_accvgpr_read_b32 v68, a56
  v_accvgpr_read_b32 v69, a57
  v_accvgpr_read_b32 v70, a58
  v_accvgpr_read_b32 v71, a59
  v_accvgpr_read_b32 v72, a60
  v_accvgpr_read_b32 v73, a61
  v_accvgpr_read_b32 v74, a62
  v_accvgpr_read_b32 v75, a63
  v_pk_mul_f32 v[68:69], v[68:69], v[54:55]
  v_pk_mul_f32 v[70:71], v[70:71], v[54:55]
  v_pk_mul_f32 v[72:73], v[72:73], v[54:55]
  v_pk_mul_f32 v[74:75], v[74:75], v[54:55]
  v_cvt_pk_bf16_f32 v200, v68, v69
  v_cvt_pk_bf16_f32 v201, v70, v71
  v_cvt_pk_bf16_f32 v202, v72, v73
  v_cvt_pk_bf16_f32 v203, v74, v75
  buffer_store_dwordx4 v[200:203], v25, s[24:27], s35 offen offset:1024 sc1
  v_accvgpr_read_b32 v76, a88
  v_accvgpr_read_b32 v77, a89
  v_accvgpr_read_b32 v78, a90
  v_accvgpr_read_b32 v79, a91
  v_accvgpr_read_b32 v80, a92
  v_accvgpr_read_b32 v81, a93
  v_accvgpr_read_b32 v82, a94
  v_accvgpr_read_b32 v83, a95
  v_pk_mul_f32 v[76:77], v[76:77], v[56:57]
  v_pk_mul_f32 v[78:79], v[78:79], v[56:57]
  v_pk_mul_f32 v[80:81], v[80:81], v[56:57]
  v_pk_mul_f32 v[82:83], v[82:83], v[56:57]
  v_cvt_pk_bf16_f32 v204, v76, v77
  v_cvt_pk_bf16_f32 v205, v78, v79
  v_cvt_pk_bf16_f32 v206, v80, v81
  v_cvt_pk_bf16_f32 v207, v82, v83
  buffer_store_dwordx4 v[204:207], v25, s[24:27], s35 offen offset:2048 sc1
  v_accvgpr_read_b32 v60, a120
  v_accvgpr_read_b32 v61, a121
  v_accvgpr_read_b32 v62, a122
  v_accvgpr_read_b32 v63, a123
  v_accvgpr_read_b32 v64, a124
  v_accvgpr_read_b32 v65, a125
  v_accvgpr_read_b32 v66, a126
  v_accvgpr_read_b32 v67, a127
  v_pk_mul_f32 v[60:61], v[60:61], v[58:59]
  v_pk_mul_f32 v[62:63], v[62:63], v[58:59]
  v_pk_mul_f32 v[64:65], v[64:65], v[58:59]
  v_pk_mul_f32 v[66:67], v[66:67], v[58:59]
  v_cvt_pk_bf16_f32 v208, v60, v61
  v_cvt_pk_bf16_f32 v209, v62, v63
  v_cvt_pk_bf16_f32 v210, v64, v65
  v_cvt_pk_bf16_f32 v211, v66, v67
  buffer_store_dwordx4 v[208:211], v25, s[24:27], s35 offen offset:3072 sc1
L_t0:
  s_load_dwordx2 s[4:5], s[0:1], 104
  s_load_dwordx2 s[6:7], s[0:1], 0
  s_load_dwordx2 s[44:45], s[0:1], 88
  s_load_dwordx4 s[48:51], s[0:1], 48
  v_mov_b32 v1, s28
  v_lshlrev_b32 v2, 4, v0
  s_bfe_u32 s31, s2, 0x20001
  s_xor_b32 s31, s31, 0
  s_and_b32 s30, s2, 1
  s_lshl_b32 s30, s30, 2
  s_lshr_b32 s33, s2, 6
  s_add_u32 s30, s30, s33
  s_bfe_u32 s32, s2, 0x30003
  s_lshl_b32 s29, s28, 10
  s_lshr_b32 s35, s32, 1
  s_mul_i32 s33, s31, 1310720
  s_mul_i32 s34, s35, 10240
  s_add_u32 s33, s33, s34
  s_sub_u32 s36, 1310720, s34
  s_lshl_b32 s37, s30, 2
  s_and_b32 s38, s32, 1
  s_lshl_b32 s41, s38, 11
  s_add_u32 s41, s41, 4096
  s_bfe_u32 s46, s2, 0x30001
  s_lshl_b32 s46, s46, 8
  s_lshl_b32 s38, s38, 1
  s_add_u32 s37, s37, s38
  s_lshr_b32 s38, s28, 1
  s_add_u32 s37, s37, s38
  s_and_b32 s38, s28, 1
  s_lshl_b32 s38, s38, 11
  s_lshl_b32 s39, s37, 19
  s_lshl_b32 s40, s31, 17
  s_add_u32 s39, s39, s40
  s_add_u32 s39, s39, s38
  s_sub_u32 s40, 131072, s38
  s_waitcnt lgkmcnt(0)
  s_add_u32 s12, s4, s39
  s_addc_u32 s13, s5, 0
  s_add_u32 s12, s12, 2686976
  s_addc_u32 s13, s13, 0
  s_mov_b32 s14, s40
  s_mov_b32 s15, 0x20000
  v_add_u32 v10, 0, v2
  v_add_u32 v11, 61440, v2
  v_add_u32 v12, 122880, v2
  s_mul_i32 s39, s37, 81920
  s_mul_i32 s40, s31, 2621440
  s_add_u32 s39, s39, s40
  s_mul_i32 s40, s35, 20480
  s_add_u32 s39, s39, s40
  s_add_u32 s39, s39, s38
  s_sub_u32 s40, 20480, s38
  s_mul_i32 s42, s30, 16384
  s_add_u32 s16, s4, s39
  s_addc_u32 s17, s5, 0
  s_add_u32 s16, s16, 26918912
  s_addc_u32 s17, s17, 0
  s_mov_b32 s18, s40
  s_mov_b32 s19, 0x20000
  s_add_u32 s52, s4, s42
  s_addc_u32 s53, s5, 0
  s_add_u32 s52, s52, 52346880
  s_addc_u32 s53, s53, 0
  s_mov_b32 s54, 16384
  s_mov_b32 s55, 0x20000
  v_and_b32 v5, 7, v0
  v_bfe_u32 v6, v0, 3, 2
  v_lshrrev_b32 v7, 5, v0
  v_lshl_add_u32 v7, v1, 1, v7
  v_lshlrev_b32 v8, 2, v6
  v_lshl_add_u32 v8, v7, 5, v8
  v_mul_u32_u24 v212, 1280, v5
  v_lshl_add_u32 v212, v8, 1, v212
  v_lshlrev_b32 v213, 2, v8
  v_lshlrev_b32 v214, 4, v5
  v_lshl_add_u32 v214, v6, 8, v214
  v_lshl_add_u32 v214, v7, 12, v214
  v_lshrrev_b32 v217, 1, v1
  v_lshl_add_u32 v218, v217, 30, v212
  v_lshl_add_u32 v217, v217, 30, v214
  v_lshlrev_b32 v216, 3, v5
  v_add_u32 v216, 122880, v216
  v_lshl_add_u32 v215, v1, 6, v216
  s_lshl_b32 s36, s30, 5
  s_and_b32 s37, s32, 1
  s_lshl_b32 s37, s37, 4
  s_add_u32 s36, s36, s37
  s_lshl_b32 s37, s31, 2
  s_add_u32 s36, s36, s37
  s_add_u32 s36, s36, s35
  s_mul_i32 s37, s36, 10240
  s_lshr_b32 s38, s36, 3
  s_mul_i32 s38, s38, 81920
  s_bfe_u32 s39, s36, 0x20001
  s_lshl_b32 s39, s39, 10
  s_and_b32 s40, s36, 1
  s_lshl_b32 s40, s40, 7
  s_add_u32 s39, s39, s40
  s_add_u32 s38, s38, s39
  s_sub_u32 s39, 81920, s39
  s_add_u32 s40, s39, 7864320
  s_add_u32 s56, s6, s37
  s_addc_u32 s57, s7, 0
  s_mov_b32 s58, 10240
  s_mov_b32 s59, 0x20000
  s_add_u32 s60, s4, 0
  s_addc_u32 s61, s5, 0
  s_mov_b32 s62, 15360
  s_mov_b32 s63, 0x20000
  s_add_u32 s64, s4, s38
  s_addc_u32 s65, s5, 0
  s_add_u32 s64, s64, 26918912
  s_addc_u32 s65, s65, 0
  s_mov_b32 s66, s40
  s_mov_b32 s67, 0x20000
  s_add_u32 s68, s4, s38
  s_addc_u32 s69, s5, 0
  s_add_u32 s68, s68, 40026112
  s_addc_u32 s69, s69, 0
  s_mov_b32 s70, s39
  s_mov_b32 s71, 0x20000
  s_add_u32 s72, s4, s38
  s_addc_u32 s73, s5, 0
  s_add_u32 s72, s72, 37404672
  s_addc_u32 s73, s73, 0
  s_mov_b32 s74, s39
  s_mov_b32 s75, 0x20000
  s_mov_b32 s20, 5120
  s_mov_b32 s21, 7680
  s_mov_b32 s22, 10240
  s_mov_b32 s24, 0
  s_mov_b32 s25, 32768
  s_mov_b32 s26, 65536
  s_lshl_b32 s23, s32, 1
  s_lshl_b32 s27, s32, 14
  v_and_b32 v239, 3, v0
  v_lshlrev_b32 v239, 2, v239
  v_add_u32 v239, s41, v239
  v_bfe_u32 v5, v0, 1, 2
  v_lshrrev_b32 v6, 4, v0
  v_xor_b32 v5, v5, v6
  v_lshlrev_b32 v5, 5, v5
  v_and_b32 v6, 1, v0
  v_lshl_add_u32 v7, v6, 4, v5
  v_lshrrev_b32 v5, 3, v0
  v_lshl_add_u32 v5, v1, 3, v5
  v_mul_u32_u24 v5, 3456, v5
  v_add_u32 v254, v5, v7
  s_mul_i32 s43, s31, 7
  s_add_u32 s43, s43, s32
  s_cmp_eq_u32 s32, 7
  s_cselect_b32 s43, 27, s43
  s_lshl_b32 s36, s43, 7
  s_sub_u32 s37, 2211840, s36
  s_add_u32 s76, s48, s36
  s_addc_u32 s77, s49, 0
  s_mov_b32 s78, s37
  s_mov_b32 s79, 0x20000
  s_add_u32 s80, s50, s36
  s_addc_u32 s81, s51, 0
  s_mov_b32 s82, s37
  s_mov_b32 s83, 0x20000
  s_lshl_b32 s47, s31, 8
  s_add_u32 s47, s47, 1024
  s_waitcnt vmcnt(0)
  s_barrier
  s_cmp_lg_u32 s28, 0
  s_cbranch_scc1 L_osig
  s_mov_b64 exec, 1
  v_mov_b32 v251, s88
  v_mov_b32 v250, 1
  buffer_atomic_add v250, v251, s[84:87], 0 offen sc1
  s_mov_b64 exec, -1
L_osig:
  s_add_u32 m0, s29, 20480
  s_mov_b32 s33, 163840
  buffer_load_dwordx4 v245, s[8:11], s33 offen sc1 lds
  s_add_u32 m0, s29, 24576
  s_nop 0
  buffer_load_dwordx4 v246, s[8:11], s33 offen sc1 lds
  s_add_u32 m0, s29, 28672
  s_nop 0
  buffer_load_dwordx4 v247, s[8:11], s33 offen sc1 lds
  s_add_u32 m0, s29, 32768
  s_nop 0
  buffer_load_dwordx4 v248, s[8:11], s33 offen sc1 lds
  s_add_u32 m0, s29, 36864
  s_nop 0
  buffer_load_dwordx4 v249, s[8:11], s33 offen sc1 lds
  s_add_u32 m0, s29, 40960
  s_mov_b32 s33, 245760
  buffer_load_dwordx4 v245, s[8:11], s33 offen sc1 lds
  s_add_u32 m0, s29, 45056
  s_nop 0
  buffer_load_dwordx4 v246, s[8:11], s33 offen sc1 lds
  s_add_u32 m0, s29, 49152
  s_nop 0
  buffer_load_dwordx4 v247, s[8:11], s33 offen sc1 lds
  s_add_u32 m0, s29, 53248
  s_nop 0
  buffer_load_dwordx4 v248, s[8:11], s33 offen sc1 lds
  s_add_u32 m0, s29, 57344
  s_nop 0
  buffer_load_dwordx4 v249, s[8:11], s33 offen sc1 lds
  s_add_u32 m0, s29, 61440
  s_mov_b32 s33, 327680
  buffer_load_dwordx4 v245, s[8:11], s33 offen sc1 lds
  s_add_u32 m0, s29, 65536
  s_nop 0
  buffer_load_dwordx4 v246, s[8:11], s33 offen sc1 lds
  s_add_u32 m0, s29, 69632
  s_nop 0
  buffer_load_dwordx4 v247, s[8:11], s33 offen sc1 lds
  s_add_u32 m0, s29, 73728
  s_nop 0
  buffer_load_dwordx4 v248, s[8:11], s33 offen sc1 lds
  s_add_u32 m0, s29, 77824
  s_nop 0
  buffer_load_dwordx4 v249, s[8:11], s33 offen sc1 lds
  s_cmp_lg_u32 s28, 0
  s_cbranch_scc1 L_got0
  v_mov_b32 v3, s47
  s_mov_b32 s33, 131072
L_poll0:
  buffer_load_dword v4, v3, s[52:55], 0 offen sc1
  s_sub_u32 s33, s33, 1
  s_cmp_eq_u32 s33, 0
  s_cbranch_scc1 L_got0
  s_waitcnt vmcnt(0)
  v_readfirstlane_b32 s34, v4
  s_cmp_lt_u32 s34, 8
  s_cbranch_scc1 L_poll0
L_got0:
  s_barrier
  s_mov_b32 s34, 0
  s_nop 0
  buffer_load_dwordx4 a[0:3], v2, s[12:15], s34 offen offset:0 sc1
  buffer_load_dwordx4 a[4:7], v2, s[12:15], s34 offen offset:1024 sc1
  s_mov_b32 s34, 4096
  buffer_load_dwordx4 a[8:11], v2, s[12:15], s34 offen offset:0 sc1
  buffer_load_dwordx4 a[12:15], v2, s[12:15], s34 offen offset:1024 sc1
  s_mov_b32 s34, 8192
  buffer_load_dwordx4 a[16:19], v2, s[12:15], s34 offen offset:0 sc1
  buffer_load_dwordx4 a[20:23], v2, s[12:15], s34 offen offset:1024 sc1
  s_mov_b32 s34, 12288
  buffer_load_dwordx4 a[24:27], v2, s[12:15], s34 offen offset:0 sc1
  buffer_load_dwordx4 a[28:31], v2, s[12:15], s34 offen offset:1024 sc1
  s_mov_b32 s34, 16384
  buffer_load_dwordx4 a[32:35], v2, s[12:15], s34 offen offset:0 sc1
  buffer_load_dwordx4 a[36:39], v2, s[12:15], s34 offen offset:1024 sc1
  s_mov_b32 s34, 20480
  buffer_load_dwordx4 a[40:43], v2, s[12:15], s34 offen offset:0 sc1
  buffer_load_dwordx4 a[44:47], v2, s[12:15], s34 offen offset:1024 sc1
  s_mov_b32 s34, 24576
  buffer_load_dwordx4 a[48:51], v2, s[12:15], s34 offen offset:0 sc1
  buffer_load_dwordx4 a[52:55], v2, s[12:15], s34 offen offset:1024 sc1
  s_mov_b32 s34, 28672
  buffer_load_dwordx4 a[56:59], v2, s[12:15], s34 offen offset:0 sc1
  buffer_load_dwordx4 a[60:63], v2, s[12:15], s34 offen offset:1024 sc1
  s_waitcnt vmcnt(12)
  s_barrier
  ds_read_b128 a[80:83], v10 offset:0
  ds_read_b128 a[84:87], v10 offset:10240
  ds_read_b128 a[88:91], v10 offset:1024
  ds_read_b128 a[92:95], v10 offset:11264
  ds_read_b128 a[96:99], v10 offset:2048
  ds_read_b128 a[100:103], v10 offset:12288
  ds_read_b128 a[104:107], v10 offset:3072
  ds_read_b128 a[108:111], v10 offset:13312
  ds_read_b128 a[112:115], v10 offset:4096
  ds_read_b128 a[116:119], v10 offset:14336
  s_waitcnt lgkmcnt(6)
  v_mfma_f32_16x16x32_bf16 v[20:23], a[80:83], a[0:3], 0
  ds_read_b128 a[120:123], v10 offset:5120
  v_mfma_f32_16x16x32_bf16 v[20:23], a[84:87], a[8:11], v[20:23]
  v_mfma_f32_16x16x32_bf16 v[60:63], a[84:87], a[12:15], 0
  s_mov_b32 s34, 32768
  ds_read_b128 a[124:127], v10 offset:15360
  v_mfma_f32_16x16x32_bf16 v[60:63], a[80:83], a[4:7], v[60:63]
  buffer_load_dwordx4 a[64:67], v2, s[12:15], s34 offen offset:0 sc1
  v_mfma_f32_16x16x32_bf16 v[24:27], a[88:91], a[0:3], 0
  ds_read_b128 a[128:131], v10 offset:6144
  v_mfma_f32_16x16x32_bf16 v[24:27], a[92:95], a[8:11], v[24:27]
  buffer_load_dwordx4 a[68:71], v2, s[12:15], s34 offen offset:1024 sc1
  v_mfma_f32_16x16x32_bf16 v[64:67], a[92:95], a[12:15], 0
  ds_read_b128 a[132:135], v10 offset:16384
  v_mfma_f32_16x16x32_bf16 v[64:67], a[88:91], a[4:7], v[64:67]
  s_waitcnt lgkmcnt(6)
  v_mfma_f32_16x16x32_bf16 v[28:31], a[96:99], a[0:3], 0
  s_mov_b32 s34, 36864
  ds_read_b128 a[136:139], v10 offset:7168
  v_mfma_f32_16x16x32_bf16 v[28:31], a[100:103], a[8:11], v[28:31]
  buffer_load_dwordx4 a[72:75], v2, s[12:15], s34 offen offset:0 sc1
  v_mfma_f32_16x16x32_bf16 v[68:71], a[100:103], a[12:15], 0
  ds_read_b128 a[140:143], v10 offset:17408
  v_mfma_f32_16x16x32_bf16 v[68:71], a[96:99], a[4:7], v[68:71]
  v_mfma_f32_16x16x32_bf16 v[32:35], a[104:107], a[0:3], 0
  ds_read_b128 a[144:147], v10 offset:8192
  v_mfma_f32_16x16x32_bf16 v[32:35], a[108:111], a[8:11], v[32:35]
  v_mfma_f32_16x16x32_bf16 v[72:75], a[108:111], a[12:15], 0
  ds_read_b128 a[148:151], v10 offset:18432
  v_mfma_f32_16x16x32_bf16 v[72:75], a[104:107], a[4:7], v[72:75]
  s_waitcnt lgkmcnt(6)
  buffer_load_dwordx4 a[76:79], v2, s[12:15], s34 offen offset:1024 sc1
  v_mfma_f32_16x16x32_bf16 v[36:39], a[112:115], a[0:3], 0
  ds_read_b128 a[152:155], v10 offset:9216
  v_mfma_f32_16x16x32_bf16 v[36:39], a[116:119], a[8:11], v[36:39]
  s_mov_b32 s33, 409600
  v_mfma_f32_16x16x32_bf16 v[76:79], a[116:119], a[12:15], 0
  s_add_u32 m0, s29, 81920
  ds_read_b128 a[156:159], v10 offset:19456
  v_mfma_f32_16x16x32_bf16 v[76:79], a[112:115], a[4:7], v[76:79]
  s_waitcnt vmcnt(12)
  buffer_load_dwordx4 v245, s[8:11], s33 offen sc1 lds
  v_mfma_f32_16x16x32_bf16 v[40:43], a[120:123], a[0:3], 0
  s_barrier
  ds_read_b128 a[80:83], v12 offset:20480
  v_mfma_f32_16x16x32_bf16 v[40:43], a[124:127], a[8:11], v[40:43]
  v_mfma_f32_16x16x32_bf16 v[80:83], a[124:127], a[12:15], 0
  s_add_u32 m0, s29, 86016
  ds_read_b128 a[84:87], v12 offset:30720
  v_mfma_f32_16x16x32_bf16 v[80:83], a[120:123], a[4:7], v[80:83]
  s_waitcnt lgkmcnt(6)
  buffer_load_dwordx4 v246, s[8:11], s33 offen sc1 lds
  v_mfma_f32_16x16x32_bf16 v[44:47], a[128:131], a[0:3], 0
  ds_read_b128 a[88:91], v12 offset:21504
  v_mfma_f32_16x16x32_bf16 v[44:47], a[132:135], a[8:11], v[44:47]
  v_mfma_f32_16x16x32_bf16 v[84:87], a[132:135], a[12:15], 0
  s_add_u32 m0, s29, 90112
  ds_read_b128 a[92:95], v12 offset:31744
  v_mfma_f32_16x16x32_bf16 v[84:87], a[128:131], a[4:7], v[84:87]
  buffer_load_dwordx4 v247, s[8:11], s33 offen sc1 lds
  v_mfma_f32_16x16x32_bf16 v[48:51], a[136:139], a[0:3], 0
  ds_read_b128 a[96:99], v12 offset:22528
  v_mfma_f32_16x16x32_bf16 v[48:51], a[140:143], a[8:11], v[48:51]
  v_mfma_f32_16x16x32_bf16 v[88:91], a[140:143], a[12:15], 0
  s_add_u32 m0, s29, 94208
  ds_read_b128 a[100:103], v12 offset:32768
  v_mfma_f32_16x16x32_bf16 v[88:91], a[136:139], a[4:7], v[88:91]
  s_waitcnt lgkmcnt(6)
  buffer_load_dwordx4 v248, s[8:11], s33 offen sc1 lds
  v_mfma_f32_16x16x32_bf16 v[52:55], a[144:147], a[0:3], 0
  ds_read_b128 a[104:107], v12 offset:23552
  v_mfma_f32_16x16x32_bf16 v[52:55], a[148:151], a[8:11], v[52:55]
  v_mfma_f32_16x16x32_bf16 v[92:95], a[148:151], a[12:15], 0
  s_add_u32 m0, s29, 98304
  ds_read_b128 a[108:111], v12 offset:33792
  v_mfma_f32_16x16x32_bf16 v[92:95], a[144:147], a[4:7], v[92:95]
  buffer_load_dwordx4 v249, s[8:11], s33 offen sc1 lds
  v_mfma_f32_16x16x32_bf16 v[56:59], a[152:155], a[0:3], 0
  ds_read_b128 a[112:115], v12 offset:24576
  v_mfma_f32_16x16x32_bf16 v[56:59], a[156:159], a[8:11], v[56:59]
  v_mfma_f32_16x16x32_bf16 v[96:99], a[156:159], a[12:15], 0
  ds_read_b128 a[116:119], v12 offset:34816
  v_mfma_f32_16x16x32_bf16 v[96:99], a[152:155], a[4:7], v[96:99]
  s_waitcnt lgkmcnt(6)
  v_mfma_f32_16x16x32_bf16 v[20:23], a[80:83], a[16:19], v[20:23]
  ds_read_b128 a[120:123], v12 offset:25600
  v_mfma_f32_16x16x32_bf16 v[20:23], a[84:87], a[24:27], v[20:23]
  v_mfma_f32_16x16x32_bf16 v[60:63], a[84:87], a[28:31], v[60:63]
  s_mov_b32 s34, 40960
  ds_read_b128 a[124:127], v12 offset:35840
  v_mfma_f32_16x16x32_bf16 v[60:63], a[80:83], a[20:23], v[60:63]
  buffer_load_dwordx4 a[0:3], v2, s[12:15], s34 offen offset:0 sc1
  v_mfma_f32_16x16x32_bf16 v[24:27], a[88:91], a[16:19], v[24:27]
  ds_read_b128 a[128:131], v12 offset:26624
  v_mfma_f32_16x16x32_bf16 v[24:27], a[92:95], a[24:27], v[24:27]
  buffer_load_dwordx4 a[4:7], v2, s[12:15], s34 offen offset:1024 sc1
  v_mfma_f32_16x16x32_bf16 v[64:67], a[92:95], a[28:31], v[64:67]
  ds_read_b128 a[132:135], v12 offset:36864
  v_mfma_f32_16x16x32_bf16 v[64:67], a[88:91], a[20:23], v[64:67]
  s_waitcnt lgkmcnt(6)
  v_mfma_f32_16x16x32_bf16 v[28:31], a[96:99], a[16:19], v[28:31]
  s_mov_b32 s34, 45056
  ds_read_b128 a[136:139], v12 offset:27648
  v_mfma_f32_16x16x32_bf16 v[28:31], a[100:103], a[24:27], v[28:31]
  buffer_load_dwordx4 a[8:11], v2, s[12:15], s34 offen offset:0 sc1
  v_mfma_f32_16x16x32_bf16 v[68:71], a[100:103], a[28:31], v[68:71]
  ds_read_b128 a[140:143], v12 offset:37888
  v_mfma_f32_16x16x32_bf16 v[68:71], a[96:99], a[20:23], v[68:71]
  v_mfma_f32_16x16x32_bf16 v[32:35], a[104:107], a[16:19], v[32:35]
  ds_read_b128 a[144:147], v12 offset:28672
  v_mfma_f32_16x16x32_bf16 v[32:35], a[108:111], a[24:27], v[32:35]
  v_mfma_f32_16x16x32_bf16 v[72:75], a[108:111], a[28:31], v[72:75]
  ds_read_b128 a[148:151], v12 offset:38912
  v_mfma_f32_16x16x32_bf16 v[72:75], a[104:107], a[20:23], v[72:75]
  s_waitcnt lgkmcnt(6)
  buffer_load_dwordx4 a[12:15], v2, s[12:15], s34 offen offset:1024 sc1
  v_mfma_f32_16x16x32_bf16 v[36:39], a[112:115], a[16:19], v[36:39]
  ds_read_b128 a[152:155], v12 offset:29696
  v_mfma_f32_16x16x32_bf16 v[36:39], a[116:119], a[24:27], v[36:39]
  s_mov_b32 s33, 491520
  v_mfma_f32_16x16x32_bf16 v[76:79], a[116:119], a[28:31], v[76:79]
  s_add_u32 m0, s29, 102400
  ds_read_b128 a[156:159], v12 offset:39936
  v_mfma_f32_16x16x32_bf16 v[76:79], a[112:115], a[20:23], v[76:79]
  s_waitcnt vmcnt(17)
  buffer_load_dwordx4 v245, s[8:11], s33 offen sc1 lds
  v_mfma_f32_16x16x32_bf16 v[40:43], a[120:123], a[16:19], v[40:43]
  s_barrier
  ds_read_b128 a[80:83], v10 offset:20480
  v_mfma_f32_16x16x32_bf16 v[40:43], a[124:127], a[24:27], v[40:43]
  v_mfma_f32_16x16x32_bf16 v[80:83], a[124:127], a[28:31], v[80:83]
  s_add_u32 m0, s29, 106496
  ds_read_b128 a[84:87], v10 offset:30720
  v_mfma_f32_16x16x32_bf16 v[80:83], a[120:123], a[20:23], v[80:83]
  s_waitcnt lgkmcnt(6)
  buffer_load_dwordx4 v246, s[8:11], s33 offen sc1 lds
  v_mfma_f32_16x16x32_bf16 v[44:47], a[128:131], a[16:19], v[44:47]
  ds_read_b128 a[88:91], v10 offset:21504
  v_mfma_f32_16x16x32_bf16 v[44:47], a[132:135], a[24:27], v[44:47]
  v_mfma_f32_16x16x32_bf16 v[84:87], a[132:135], a[28:31], v[84:87]
  s_add_u32 m0, s29, 110592
  ds_read_b128 a[92:95], v10 offset:31744
  v_mfma_f32_16x16x32_bf16 v[84:87], a[128:131], a[20:23], v[84:87]
  buffer_load_dwordx4 v247, s[8:11], s33 offen sc1 lds
  v_mfma_f32_16x16x32_bf16 v[48:51], a[136:139], a[16:19], v[48:51]
  ds_read_b128 a[96:99], v10 offset:22528
  v_mfma_f32_16x16x32_bf16 v[48:51], a[140:143], a[24:27], v[48:51]
  v_mfma_f32_16x16x32_bf16 v[88:91], a[140:143], a[28:31], v[88:91]
  s_add_u32 m0, s29, 114688
  ds_read_b128 a[100:103], v10 offset:32768
  v_mfma_f32_16x16x32_bf16 v[88:91], a[136:139], a[20:23], v[88:91]
  s_waitcnt lgkmcnt(6)
  buffer_load_dwordx4 v248, s[8:11], s33 offen sc1 lds
  v_mfma_f32_16x16x32_bf16 v[52:55], a[144:147], a[16:19], v[52:55]
  ds_read_b128 a[104:107], v10 offset:23552
  v_mfma_f32_16x16x32_bf16 v[52:55], a[148:151], a[24:27], v[52:55]
  v_mfma_f32_16x16x32_bf16 v[92:95], a[148:151], a[28:31], v[92:95]
  s_add_u32 m0, s29, 118784
  ds_read_b128 a[108:111], v10 offset:33792
  v_mfma_f32_16x16x32_bf16 v[92:95], a[144:147], a[20:23], v[92:95]
  buffer_load_dwordx4 v249, s[8:11], s33 offen sc1 lds
  v_mfma_f32_16x16x32_bf16 v[56:59], a[152:155], a[16:19], v[56:59]
  ds_read_b128 a[112:115], v10 offset:24576
  v_mfma_f32_16x16x32_bf16 v[56:59], a[156:159], a[24:27], v[56:59]
  v_mfma_f32_16x16x32_bf16 v[96:99], a[156:159], a[28:31], v[96:99]
  ds_read_b128 a[116:119], v10 offset:34816
  v_mfma_f32_16x16x32_bf16 v[96:99], a[152:155], a[20:23], v[96:99]
  s_waitcnt lgkmcnt(6)
  v_mfma_f32_16x16x32_bf16 v[20:23], a[80:83], a[32:35], v[20:23]
  ds_read_b128 a[120:123], v10 offset:25600
  v_mfma_f32_16x16x32_bf16 v[20:23], a[84:87], a[40:43], v[20:23]
  v_mfma_f32_16x16x32_bf16 v[60:63], a[84:87], a[44:47], v[60:63]
  s_mov_b32 s34, 49152
  ds_read_b128 a[124:127], v10 offset:35840
  v_mfma_f32_16x16x32_bf16 v[60:63], a[80:83], a[36:39], v[60:63]
  buffer_load_dwordx4 a[16:19], v2, s[12:15], s34 offen offset:0 sc1
  v_mfma_f32_16x16x32_bf16 v[24:27], a[88:91], a[32:35], v[24:27]
  ds_read_b128 a[128:131], v10 offset:26624
  v_mfma_f32_16x16x32_bf16 v[24:27], a[92:95], a[40:43], v[24:27]
  buffer_load_dwordx4 a[20:23], v2, s[12:15], s34 offen offset:1024 sc1
  v_mfma_f32_16x16x32_bf16 v[64:67], a[92:95], a[44:47], v[64:67]
  ds_read_b128 a[132:135], v10 offset:36864
  v_mfma_f32_16x16x32_bf16 v[64:67], a[88:91], a[36:39], v[64:67]
  s_waitcnt lgkmcnt(6)
  v_mfma_f32_16x16x32_bf16 v[28:31], a[96:99], a[32:35], v[28:31]
  s_mov_b32 s34, 53248
  ds_read_b128 a[136:139], v10 offset:27648
  v_mfma_f32_16x16x32_bf16 v[28:31], a[100:103], a[40:43], v[28:31]
  buffer_load_dwordx4 a[24:27], v2, s[12:15], s34 offen offset:0 sc1
  v_mfma_f32_16x16x32_bf16 v[68:71], a[100:103], a[44:47], v[68:71]
  ds_read_b128 a[140:143], v10 offset:37888
  v_mfma_f32_16x16x32_bf16 v[68:71], a[96:99], a[36:39], v[68:71]
  v_mfma_f32_16x16x32_bf16 v[32:35], a[104:107], a[32:35], v[32:35]
  ds_read_b128 a[144:147], v10 offset:28672
  v_mfma_f32_16x16x32_bf16 v[32:35], a[108:111], a[40:43], v[32:35]
  v_mfma_f32_16x16x32_bf16 v[72:75], a[108:111], a[44:47], v[72:75]
  ds_read_b128 a[148:151], v10 offset:38912
  v_mfma_f32_16x16x32_bf16 v[72:75], a[104:107], a[36:39], v[72:75]
  s_waitcnt lgkmcnt(6)
  buffer_load_dwordx4 a[28:31], v2, s[12:15], s34 offen offset:1024 sc1
  v_mfma_f32_16x16x32_bf16 v[36:39], a[112:115], a[32:35], v[36:39]
  ds_read_b128 a[152:155], v10 offset:29696
  v_mfma_f32_16x16x32_bf16 v[36:39], a[116:119], a[40:43], v[36:39]
  s_mov_b32 s33, 573440
  v_mfma_f32_16x16x32_bf16 v[76:79], a[116:119], a[44:47], v[76:79]
  s_add_u32 m0, s29, 122880
  ds_read_b128 a[156:159], v10 offset:39936
  v_mfma_f32_16x16x32_bf16 v[76:79], a[112:115], a[36:39], v[76:79]
  s_waitcnt vmcnt(22)
  buffer_load_dwordx4 v245, s[8:11], s33 offen sc1 lds
  v_mfma_f32_16x16x32_bf16 v[40:43], a[120:123], a[32:35], v[40:43]
  s_barrier
  ds_read_b128 a[80:83], v10 offset:40960
  v_mfma_f32_16x16x32_bf16 v[40:43], a[124:127], a[40:43], v[40:43]
  v_mfma_f32_16x16x32_bf16 v[80:83], a[124:127], a[44:47], v[80:83]
  s_add_u32 m0, s29, 126976
  ds_read_b128 a[84:87], v10 offset:51200
  v_mfma_f32_16x16x32_bf16 v[80:83], a[120:123], a[36:39], v[80:83]
  s_waitcnt lgkmcnt(6)
  buffer_load_dwordx4 v246, s[8:11], s33 offen sc1 lds
  v_mfma_f32_16x16x32_bf16 v[44:47], a[128:131], a[32:35], v[44:47]
  ds_read_b128 a[88:91], v10 offset:41984
  v_mfma_f32_16x16x32_bf16 v[44:47], a[132:135], a[40:43], v[44:47]
  v_mfma_f32_16x16x32_bf16 v[84:87], a[132:135], a[44:47], v[84:87]
  s_add_u32 m0, s29, 131072
  ds_read_b128 a[92:95], v10 offset:52224
  v_mfma_f32_16x16x32_bf16 v[84:87], a[128:131], a[36:39], v[84:87]
  buffer_load_dwordx4 v247, s[8:11], s33 offen sc1 lds
  v_mfma_f32_16x16x32_bf16 v[48:51], a[136:139], a[32:35], v[48:51]
  ds_read_b128 a[96:99], v10 offset:43008
  v_mfma_f32_16x16x32_bf16 v[48:51], a[140:143], a[40:43], v[48:51]
  v_mfma_f32_16x16x32_bf16 v[88:91], a[140:143], a[44:47], v[88:91]
  s_add_u32 m0, s29, 135168
  ds_read_b128 a[100:103], v10 offset:53248
  v_mfma_f32_16x16x32_bf16 v[88:91], a[136:139], a[36:39], v[88:91]
  s_waitcnt lgkmcnt(6)
  buffer_load_dwordx4 v248, s[8:11], s33 offen sc1 lds
  v_mfma_f32_16x16x32_bf16 v[52:55], a[144:147], a[32:35], v[52:55]
  ds_read_b128 a[104:107], v10 offset:44032
  v_mfma_f32_16x16x32_bf16 v[52:55], a[148:151], a[40:43], v[52:55]
  v_mfma_f32_16x16x32_bf16 v[92:95], a[148:151], a[44:47], v[92:95]
  s_add_u32 m0, s29, 139264
  ds_read_b128 a[108:111], v10 offset:54272
  v_mfma_f32_16x16x32_bf16 v[92:95], a[144:147], a[36:39], v[92:95]
  buffer_load_dwordx4 v249, s[8:11], s33 offen sc1 lds
  v_mfma_f32_16x16x32_bf16 v[56:59], a[152:155], a[32:35], v[56:59]
  ds_read_b128 a[112:115], v10 offset:45056
  v_mfma_f32_16x16x32_bf16 v[56:59], a[156:159], a[40:43], v[56:59]
  v_mfma_f32_16x16x32_bf16 v[96:99], a[156:159], a[44:47], v[96:99]
  ds_read_b128 a[116:119], v10 offset:55296
  v_mfma_f32_16x16x32_bf16 v[96:99], a[152:155], a[36:39], v[96:99]
  s_waitcnt lgkmcnt(6)
  v_mfma_f32_16x16x32_bf16 v[20:23], a[80:83], a[48:51], v[20:23]
  ds_read_b128 a[120:123], v10 offset:46080
  v_mfma_f32_16x16x32_bf16 v[20:23], a[84:87], a[56:59], v[20:23]
  v_mfma_f32_16x16x32_bf16 v[60:63], a[84:87], a[60:63], v[60:63]
  s_mov_b32 s34, 57344
  ds_read_b128 a[124:127], v10 offset:56320
  v_mfma_f32_16x16x32_bf16 v[60:63], a[80:83], a[52:55], v[60:63]
  buffer_load_dwordx4 a[32:35], v2, s[12:15], s34 offen offset:0 sc1
  v_mfma_f32_16x16x32_bf16 v[24:27], a[88:91], a[48:51], v[24:27]
  ds_read_b128 a[128:131], v10 offset:47104
  v_mfma_f32_16x16x32_bf16 v[24:27], a[92:95], a[56:59], v[24:27]
  buffer_load_dwordx4 a[36:39], v2, s[12:15], s34 offen offset:1024 sc1
  v_mfma_f32_16x16x32_bf16 v[64:67], a[92:95], a[60:63], v[64:67]
  ds_read_b128 a[132:135], v10 offset:57344
  v_mfma_f32_16x16x32_bf16 v[64:67], a[88:91], a[52:55], v[64:67]
  s_waitcnt lgkmcnt(6)
  v_mfma_f32_16x16x32_bf16 v[28:31], a[96:99], a[48:51], v[28:31]
  s_mov_b32 s34, 61440
  ds_read_b128 a[136:139], v10 offset:48128
  v_mfma_f32_16x16x32_bf16 v[28:31], a[100:103], a[56:59], v[28:31]
  buffer_load_dwordx4 a[40:43], v2, s[12:15], s34 offen offset:0 sc1
  v_mfma_f32_16x16x32_bf16 v[68:71], a[100:103], a[60:63], v[68:71]
  ds_read_b128 a[140:143], v10 offset:58368
  v_mfma_f32_16x16x32_bf16 v[68:71], a[96:99], a[52:55], v[68:71]
  v_mfma_f32_16x16x32_bf16 v[32:35], a[104:107], a[48:51], v[32:35]
  ds_read_b128 a[144:147], v10 offset:49152
  v_mfma_f32_16x16x32_bf16 v[32:35], a[108:111], a[56:59], v[32:35]
  v_mfma_f32_16x16x32_bf16 v[72:75], a[108:111], a[60:63], v[72:75]
  ds_read_b128 a[148:151], v10 offset:59392
  v_mfma_f32_16x16x32_bf16 v[72:75], a[104:107], a[52:55], v[72:75]
  s_waitcnt lgkmcnt(6)
  buffer_load_dwordx4 a[44:47], v2, s[12:15], s34 offen offset:1024 sc1
  v_mfma_f32_16x16x32_bf16 v[36:39], a[112:115], a[48:51], v[36:39]
  ds_read_b128 a[152:155], v10 offset:50176
  v_mfma_f32_16x16x32_bf16 v[36:39], a[116:119], a[56:59], v[36:39]
  s_mov_b32 s33, 655360
  v_mfma_f32_16x16x32_bf16 v[76:79], a[116:119], a[60:63], v[76:79]
  s_add_u32 m0, s29, 0
  ds_read_b128 a[156:159], v10 offset:60416
  v_mfma_f32_16x16x32_bf16 v[76:79], a[112:115], a[52:55], v[76:79]
  s_waitcnt vmcnt(27)
  buffer_load_dwordx4 v245, s[8:11], s33 offen sc1 lds
  v_mfma_f32_16x16x32_bf16 v[40:43], a[120:123], a[48:51], v[40:43]
  s_barrier
  ds_read_b128 a[80:83], v11 offset:0
  v_mfma_f32_16x16x32_bf16 v[40:43], a[124:127], a[56:59], v[40:43]
  v_mfma_f32_16x16x32_bf16 v[80:83], a[124:127], a[60:63], v[80:83]
  s_add_u32 m0, s29, 4096
  ds_read_b128 a[84:87], v11 offset:10240
  v_mfma_f32_16x16x32_bf16 v[80:83], a[120:123], a[52:55], v[80:83]
  s_waitcnt lgkmcnt(6)
  buffer_load_dwordx4 v246, s[8:11], s33 offen sc1 lds
  v_mfma_f32_16x16x32_bf16 v[44:47], a[128:131], a[48:51], v[44:47]
  ds_read_b128 a[88:91], v11 offset:1024
  v_mfma_f32_16x16x32_bf16 v[44:47], a[132:135], a[56:59], v[44:47]
  v_mfma_f32_16x16x32_bf16 v[84:87], a[132:135], a[60:63], v[84:87]
  s_add_u32 m0, s29, 8192
  ds_read_b128 a[92:95], v11 offset:11264
  v_mfma_f32_16x16x32_bf16 v[84:87], a[128:131], a[52:55], v[84:87]
  buffer_load_dwordx4 v247, s[8:11], s33 offen sc1 lds
  v_mfma_f32_16x16x32_bf16 v[48:51], a[136:139], a[48:51], v[48:51]
  ds_read_b128 a[96:99], v11 offset:2048
  v_mfma_f32_16x16x32_bf16 v[48:51], a[140:143], a[56:59], v[48:51]
  v_mfma_f32_16x16x32_bf16 v[88:91], a[140:143], a[60:63], v[88:91]
  s_add_u32 m0, s29, 12288
  ds_read_b128 a[100:103], v11 offset:12288
  v_mfma_f32_16x16x32_bf16 v[88:91], a[136:139], a[52:55], v[88:91]
  s_waitcnt lgkmcnt(6)
  buffer_load_dwordx4 v248, s[8:11], s33 offen sc1 lds
  v_mfma_f32_16x16x32_bf16 v[52:55], a[144:147], a[48:51], v[52:55]
  ds_read_b128 a[104:107], v11 offset:3072
  v_mfma_f32_16x16x32_bf16 v[52:55], a[148:151], a[56:59], v[52:55]
  v_mfma_f32_16x16x32_bf16 v[92:95], a[148:151], a[60:63], v[92:95]
  s_add_u32 m0, s29, 16384
  ds_read_b128 a[108:111], v11 offset:13312
  v_mfma_f32_16x16x32_bf16 v[92:95], a[144:147], a[52:55], v[92:95]
  buffer_load_dwordx4 v249, s[8:11], s33 offen sc1 lds
  v_mfma_f32_16x16x32_bf16 v[56:59], a[152:155], a[48:51], v[56:59]
  ds_read_b128 a[112:115], v11 offset:4096
  v_mfma_f32_16x16x32_bf16 v[56:59], a[156:159], a[56:59], v[56:59]
  v_mfma_f32_16x16x32_bf16 v[96:99], a[156:159], a[60:63], v[96:99]
  ds_read_b128 a[116:119], v11 offset:14336
  v_mfma_f32_16x16x32_bf16 v[96:99], a[152:155], a[52:55], v[96:99]
  s_waitcnt lgkmcnt(6)
  v_mfma_f32_16x16x32_bf16 v[20:23], a[80:83], a[64:67], v[20:23]
  ds_read_b128 a[120:123], v11 offset:5120
  v_mfma_f32_16x16x32_bf16 v[20:23], a[84:87], a[72:75], v[20:23]
  v_mfma_f32_16x16x32_bf16 v[60:63], a[84:87], a[76:79], v[60:63]
  s_mov_b32 s34, 65536
  ds_read_b128 a[124:127], v11 offset:15360
  v_mfma_f32_16x16x32_bf16 v[60:63], a[80:83], a[68:71], v[60:63]
  buffer_load_dwordx4 a[48:51], v2, s[12:15], s34 offen offset:0 sc1
  v_mfma_f32_16x16x32_bf16 v[24:27], a[88:91], a[64:67], v[24:27]
  ds_read_b128 a[128:131], v11 offset:6144
  v_mfma_f32_16x16x32_bf16 v[24:27], a[92:95], a[72:75], v[24:27]
  buffer_load_dwordx4 a[52:55], v2, s[12:15], s34 offen offset:1024 sc1
  v_mfma_f32_16x16x32_bf16 v[64:67], a[92:95], a[76:79], v[64:67]
  ds_read_b128 a[132:135], v11 offset:16384
  v_mfma_f32_16x16x32_bf16 v[64:67], a[88:91], a[68:71], v[64:67]
  s_waitcnt lgkmcnt(6)
  v_mfma_f32_16x16x32_bf16 v[28:31], a[96:99], a[64:67], v[28:31]
  s_mov_b32 s34, 69632
  ds_read_b128 a[136:139], v11 offset:7168
  v_mfma_f32_16x16x32_bf16 v[28:31], a[100:103], a[72:75], v[28:31]
  buffer_load_dwordx4 a[56:59], v2, s[12:15], s34 offen offset:0 sc1
  v_mfma_f32_16x16x32_bf16 v[68:71], a[100:103], a[76:79], v[68:71]
  ds_read_b128 a[140:143], v11 offset:17408
  v_mfma_f32_16x16x32_bf16 v[68:71], a[96:99], a[68:71], v[68:71]
  v_mfma_f32_16x16x32_bf16 v[32:35], a[104:107], a[64:67], v[32:35]
  ds_read_b128 a[144:147], v11 offset:8192
  v_mfma_f32_16x16x32_bf16 v[32:35], a[108:111], a[72:75], v[32:35]
  v_mfma_f32_16x16x32_bf16 v[72:75], a[108:111], a[76:79], v[72:75]
  ds_read_b128 a[148:151], v11 offset:18432
  v_mfma_f32_16x16x32_bf16 v[72:75], a[104:107], a[68:71], v[72:75]
  s_waitcnt lgkmcnt(6)
  buffer_load_dwordx4 a[60:63], v2, s[12:15], s34 offen offset:1024 sc1
  v_mfma_f32_16x16x32_bf16 v[36:39], a[112:115], a[64:67], v[36:39]
  ds_read_b128 a[152:155], v11 offset:9216
  v_mfma_f32_16x16x32_bf16 v[36:39], a[116:119], a[72:75], v[36:39]
  s_mov_b32 s33, 737280
  v_mfma_f32_16x16x32_bf16 v[76:79], a[116:119], a[76:79], v[76:79]
  s_add_u32 m0, s29, 143360
  ds_read_b128 a[156:159], v11 offset:19456
  v_mfma_f32_16x16x32_bf16 v[76:79], a[112:115], a[68:71], v[76:79]
  s_waitcnt vmcnt(27)
  buffer_load_dwordx4 v245, s[8:11], s33 offen sc1 lds
  v_mfma_f32_16x16x32_bf16 v[40:43], a[120:123], a[64:67], v[40:43]
  s_barrier
  ds_read_b128 a[80:83], v11 offset:20480
  v_mfma_f32_16x16x32_bf16 v[40:43], a[124:127], a[72:75], v[40:43]
  v_mfma_f32_16x16x32_bf16 v[80:83], a[124:127], a[76:79], v[80:83]
  s_add_u32 m0, s29, 147456
  ds_read_b128 a[84:87], v11 offset:30720
  v_mfma_f32_16x16x32_bf16 v[80:83], a[120:123], a[68:71], v[80:83]
  s_waitcnt lgkmcnt(6)
  buffer_load_dwordx4 v246, s[8:11], s33 offen sc1 lds
  v_mfma_f32_16x16x32_bf16 v[44:47], a[128:131], a[64:67], v[44:47]
  ds_read_b128 a[88:91], v11 offset:21504
  v_mfma_f32_16x16x32_bf16 v[44:47], a[132:135], a[72:75], v[44:47]
  v_mfma_f32_16x16x32_bf16 v[84:87], a[132:135], a[76:79], v[84:87]
  s_add_u32 m0, s29, 151552
  ds_read_b128 a[92:95], v11 offset:31744
  v_mfma_f32_16x16x32_bf16 v[84:87], a[128:131], a[68:71], v[84:87]
  buffer_load_dwordx4 v247, s[8:11], s33 offen sc1 lds
  v_mfma_f32_16x16x32_bf16 v[48:51], a[136:139], a[64:67], v[48:51]
  ds_read_b128 a[96:99], v11 offset:22528
  v_mfma_f32_16x16x32_bf16 v[48:51], a[140:143], a[72:75], v[48:51]
  v_mfma_f32_16x16x32_bf16 v[88:91], a[140:143], a[76:79], v[88:91]
  s_add_u32 m0, s29, 155648
  ds_read_b128 a[100:103], v11 offset:32768
  v_mfma_f32_16x16x32_bf16 v[88:91], a[136:139], a[68:71], v[88:91]
  s_waitcnt lgkmcnt(6)
  buffer_load_dwordx4 v248, s[8:11], s33 offen sc1 lds
  v_mfma_f32_16x16x32_bf16 v[52:55], a[144:147], a[64:67], v[52:55]
  ds_read_b128 a[104:107], v11 offset:23552
  v_mfma_f32_16x16x32_bf16 v[52:55], a[148:151], a[72:75], v[52:55]
  v_mfma_f32_16x16x32_bf16 v[92:95], a[148:151], a[76:79], v[92:95]
  s_add_u32 m0, s29, 159744
  ds_read_b128 a[108:111], v11 offset:33792
  v_mfma_f32_16x16x32_bf16 v[92:95], a[144:147], a[68:71], v[92:95]
  buffer_load_dwordx4 v249, s[8:11], s33 offen sc1 lds
  v_mfma_f32_16x16x32_bf16 v[56:59], a[152:155], a[64:67], v[56:59]
  ds_read_b128 a[112:115], v11 offset:24576
  v_mfma_f32_16x16x32_bf16 v[56:59], a[156:159], a[72:75], v[56:59]
  v_mfma_f32_16x16x32_bf16 v[96:99], a[156:159], a[76:79], v[96:99]
  ds_read_b128 a[116:119], v11 offset:34816
  v_mfma_f32_16x16x32_bf16 v[96:99], a[152:155], a[68:71], v[96:99]
  s_waitcnt lgkmcnt(6)
  v_mfma_f32_16x16x32_bf16 v[20:23], a[80:83], a[0:3], v[20:23]
  ds_read_b128 a[120:123], v11 offset:25600
  v_mfma_f32_16x16x32_bf16 v[20:23], a[84:87], a[8:11], v[20:23]
  v_mfma_f32_16x16x32_bf16 v[60:63], a[84:87], a[12:15], v[60:63]
  s_mov_b32 s34, 73728
  ds_read_b128 a[124:127], v11 offset:35840
  v_mfma_f32_16x16x32_bf16 v[60:63], a[80:83], a[4:7], v[60:63]
  buffer_load_dwordx4 a[64:67], v2, s[12:15], s34 offen offset:0 sc1
  v_mfma_f32_16x16x32_bf16 v[24:27], a[88:91], a[0:3], v[24:27]
  ds_read_b128 a[128:131], v11 offset:26624
  v_mfma_f32_16x16x32_bf16 v[24:27], a[92:95], a[8:11], v[24:27]
  buffer_load_dwordx4 a[68:71], v2, s[12:15], s34 offen offset:1024 sc1
  v_mfma_f32_16x16x32_bf16 v[64:67], a[92:95], a[12:15], v[64:67]
  ds_read_b128 a[132:135], v11 offset:36864
  v_mfma_f32_16x16x32_bf16 v[64:67], a[88:91], a[4:7], v[64:67]
  s_waitcnt lgkmcnt(6)
  v_mfma_f32_16x16x32_bf16 v[28:31], a[96:99], a[0:3], v[28:31]
  s_mov_b32 s34, 77824
  ds_read_b128 a[136:139], v11 offset:27648
  v_mfma_f32_16x16x32_bf16 v[28:31], a[100:103], a[8:11], v[28:31]
  buffer_load_dwordx4 a[72:75], v2, s[12:15], s34 offen offset:0 sc1
  v_mfma_f32_16x16x32_bf16 v[68:71], a[100:103], a[12:15], v[68:71]
  ds_read_b128 a[140:143], v11 offset:37888
  v_mfma_f32_16x16x32_bf16 v[68:71], a[96:99], a[4:7], v[68:71]
  v_mfma_f32_16x16x32_bf16 v[32:35], a[104:107], a[0:3], v[32:35]
  ds_read_b128 a[144:147], v11 offset:28672
  v_mfma_f32_16x16x32_bf16 v[32:35], a[108:111], a[8:11], v[32:35]
  v_mfma_f32_16x16x32_bf16 v[72:75], a[108:111], a[12:15], v[72:75]
  ds_read_b128 a[148:151], v11 offset:38912
  v_mfma_f32_16x16x32_bf16 v[72:75], a[104:107], a[4:7], v[72:75]
  s_waitcnt lgkmcnt(6)
  buffer_load_dwordx4 a[76:79], v2, s[12:15], s34 offen offset:1024 sc1
  v_mfma_f32_16x16x32_bf16 v[36:39], a[112:115], a[0:3], v[36:39]
  ds_read_b128 a[152:155], v11 offset:29696
  v_mfma_f32_16x16x32_bf16 v[36:39], a[116:119], a[8:11], v[36:39]
  s_mov_b32 s33, 819200
  v_mfma_f32_16x16x32_bf16 v[76:79], a[116:119], a[12:15], v[76:79]
  s_add_u32 m0, s29, 20480
  ds_read_b128 a[156:159], v11 offset:39936
  v_mfma_f32_16x16x32_bf16 v[76:79], a[112:115], a[4:7], v[76:79]
  s_waitcnt vmcnt(27)
  buffer_load_dwordx4 v245, s[8:11], s33 offen sc1 lds
  v_mfma_f32_16x16x32_bf16 v[40:43], a[120:123], a[0:3], v[40:43]
  s_barrier
  ds_read_b128 a[80:83], v11 offset:40960
  v_mfma_f32_16x16x32_bf16 v[40:43], a[124:127], a[8:11], v[40:43]
  v_mfma_f32_16x16x32_bf16 v[80:83], a[124:127], a[12:15], v[80:83]
  s_add_u32 m0, s29, 24576
  ds_read_b128 a[84:87], v11 offset:51200
  v_mfma_f32_16x16x32_bf16 v[80:83], a[120:123], a[4:7], v[80:83]
  s_waitcnt lgkmcnt(6)
  buffer_load_dwordx4 v246, s[8:11], s33 offen sc1 lds
  v_mfma_f32_16x16x32_bf16 v[44:47], a[128:131], a[0:3], v[44:47]
  ds_read_b128 a[88:91], v11 offset:41984
  v_mfma_f32_16x16x32_bf16 v[44:47], a[132:135], a[8:11], v[44:47]
  v_mfma_f32_16x16x32_bf16 v[84:87], a[132:135], a[12:15], v[84:87]
  s_add_u32 m0, s29, 28672
  ds_read_b128 a[92:95], v11 offset:52224
  v_mfma_f32_16x16x32_bf16 v[84:87], a[128:131], a[4:7], v[84:87]
  buffer_load_dwordx4 v247, s[8:11], s33 offen sc1 lds
  v_mfma_f32_16x16x32_bf16 v[48:51], a[136:139], a[0:3], v[48:51]
  ds_read_b128 a[96:99], v11 offset:43008
  v_mfma_f32_16x16x32_bf16 v[48:51], a[140:143], a[8:11], v[48:51]
  v_mfma_f32_16x16x32_bf16 v[88:91], a[140:143], a[12:15], v[88:91]
  s_add_u32 m0, s29, 32768
  ds_read_b128 a[100:103], v11 offset:53248
  v_mfma_f32_16x16x32_bf16 v[88:91], a[136:139], a[4:7], v[88:91]
  s_waitcnt lgkmcnt(6)
  buffer_load_dwordx4 v248, s[8:11], s33 offen sc1 lds
  v_mfma_f32_16x16x32_bf16 v[52:55], a[144:147], a[0:3], v[52:55]
  ds_read_b128 a[104:107], v11 offset:44032
  v_mfma_f32_16x16x32_bf16 v[52:55], a[148:151], a[8:11], v[52:55]
  v_mfma_f32_16x16x32_bf16 v[92:95], a[148:151], a[12:15], v[92:95]
  s_add_u32 m0, s29, 36864
  ds_read_b128 a[108:111], v11 offset:54272
  v_mfma_f32_16x16x32_bf16 v[92:95], a[144:147], a[4:7], v[92:95]
  buffer_load_dwordx4 v249, s[8:11], s33 offen sc1 lds
  v_mfma_f32_16x16x32_bf16 v[56:59], a[152:155], a[0:3], v[56:59]
  ds_read_b128 a[112:115], v11 offset:45056
  v_mfma_f32_16x16x32_bf16 v[56:59], a[156:159], a[8:11], v[56:59]
  v_mfma_f32_16x16x32_bf16 v[96:99], a[156:159], a[12:15], v[96:99]
  ds_read_b128 a[116:119], v11 offset:55296
  v_mfma_f32_16x16x32_bf16 v[96:99], a[152:155], a[4:7], v[96:99]
  s_waitcnt lgkmcnt(6)
  v_mfma_f32_16x16x32_bf16 v[20:23], a[80:83], a[16:19], v[20:23]
  ds_read_b128 a[120:123], v11 offset:46080
  v_mfma_f32_16x16x32_bf16 v[20:23], a[84:87], a[24:27], v[20:23]
  v_mfma_f32_16x16x32_bf16 v[60:63], a[84:87], a[28:31], v[60:63]
  s_mov_b32 s34, 81920
  ds_read_b128 a[124:127], v11 offset:56320
  v_mfma_f32_16x16x32_bf16 v[60:63], a[80:83], a[20:23], v[60:63]
  buffer_load_dwordx4 a[0:3], v2, s[12:15], s34 offen offset:0 sc1
  v_mfma_f32_16x16x32_bf16 v[24:27], a[88:91], a[16:19], v[24:27]
  ds_read_b128 a[128:131], v11 offset:47104
  v_mfma_f32_16x16x32_bf16 v[24:27], a[92:95], a[24:27], v[24:27]
  buffer_load_dwordx4 a[4:7], v2, s[12:15], s34 offen offset:1024 sc1
  v_mfma_f32_16x16x32_bf16 v[64:67], a[92:95], a[28:31], v[64:67]
  ds_read_b128 a[132:135], v11 offset:57344
  v_mfma_f32_16x16x32_bf16 v[64:67], a[88:91], a[20:23], v[64:67]
  s_waitcnt lgkmcnt(6)
  v_mfma_f32_16x16x32_bf16 v[28:31], a[96:99], a[16:19], v[28:31]
  s_mov_b32 s34, 86016
  ds_read_b128 a[136:139], v11 offset:48128
  v_mfma_f32_16x16x32_bf16 v[28:31], a[100:103], a[24:27], v[28:31]
  buffer_load_dwordx4 a[8:11], v2, s[12:15], s34 offen offset:0 sc1
  v_mfma_f32_16x16x32_bf16 v[68:71], a[100:103], a[28:31], v[68:71]
  ds_read_b128 a[140:143], v11 offset:58368
  v_mfma_f32_16x16x32_bf16 v[68:71], a[96:99], a[20:23], v[68:71]
  v_mfma_f32_16x16x32_bf16 v[32:35], a[104:107], a[16:19], v[32:35]
  ds_read_b128 a[144:147], v11 offset:49152
  v_mfma_f32_16x16x32_bf16 v[32:35], a[108:111], a[24:27], v[32:35]
  v_mfma_f32_16x16x32_bf16 v[72:75], a[108:111], a[28:31], v[72:75]
  ds_read_b128 a[148:151], v11 offset:59392
  v_mfma_f32_16x16x32_bf16 v[72:75], a[104:107], a[20:23], v[72:75]
  s_waitcnt lgkmcnt(6)
  buffer_load_dwordx4 a[12:15], v2, s[12:15], s34 offen offset:1024 sc1
  v_mfma_f32_16x16x32_bf16 v[36:39], a[112:115], a[16:19], v[36:39]
  ds_read_b128 a[152:155], v11 offset:50176
  v_mfma_f32_16x16x32_bf16 v[36:39], a[116:119], a[24:27], v[36:39]
  s_mov_b32 s33, 901120
  v_mfma_f32_16x16x32_bf16 v[76:79], a[116:119], a[28:31], v[76:79]
  s_add_u32 m0, s29, 40960
  ds_read_b128 a[156:159], v11 offset:60416
  v_mfma_f32_16x16x32_bf16 v[76:79], a[112:115], a[20:23], v[76:79]
  s_waitcnt vmcnt(27)
  buffer_load_dwordx4 v245, s[8:11], s33 offen sc1 lds
  v_mfma_f32_16x16x32_bf16 v[40:43], a[120:123], a[16:19], v[40:43]
  s_barrier
  ds_read_b128 a[80:83], v12 offset:0
  v_mfma_f32_16x16x32_bf16 v[40:43], a[124:127], a[24:27], v[40:43]
  v_mfma_f32_16x16x32_bf16 v[80:83], a[124:127], a[28:31], v[80:83]
  s_add_u32 m0, s29, 45056
  ds_read_b128 a[84:87], v12 offset:10240
  v_mfma_f32_16x16x32_bf16 v[80:83], a[120:123], a[20:23], v[80:83]
  s_waitcnt lgkmcnt(6)
  buffer_load_dwordx4 v246, s[8:11], s33 offen sc1 lds
  v_mfma_f32_16x16x32_bf16 v[44:47], a[128:131], a[16:19], v[44:47]
  ds_read_b128 a[88:91], v12 offset:1024
  v_mfma_f32_16x16x32_bf16 v[44:47], a[132:135], a[24:27], v[44:47]
  v_mfma_f32_16x16x32_bf16 v[84:87], a[132:135], a[28:31], v[84:87]
  s_add_u32 m0, s29, 49152
  ds_read_b128 a[92:95], v12 offset:11264
  v_mfma_f32_16x16x32_bf16 v[84:87], a[128:131], a[20:23], v[84:87]
  buffer_load_dwordx4 v247, s[8:11], s33 offen sc1 lds
  v_mfma_f32_16x16x32_bf16 v[48:51], a[136:139], a[16:19], v[48:51]
  ds_read_b128 a[96:99], v12 offset:2048
  v_mfma_f32_16x16x32_bf16 v[48:51], a[140:143], a[24:27], v[48:51]
  v_mfma_f32_16x16x32_bf16 v[88:91], a[140:143], a[28:31], v[88:91]
  s_add_u32 m0, s29, 53248
  ds_read_b128 a[100:103], v12 offset:12288
  v_mfma_f32_16x16x32_bf16 v[88:91], a[136:139], a[20:23], v[88:91]
  s_waitcnt lgkmcnt(6)
  buffer_load_dwordx4 v248, s[8:11], s33 offen sc1 lds
  v_mfma_f32_16x16x32_bf16 v[52:55], a[144:147], a[16:19], v[52:55]
  ds_read_b128 a[104:107], v12 offset:3072
  v_mfma_f32_16x16x32_bf16 v[52:55], a[148:151], a[24:27], v[52:55]
  v_mfma_f32_16x16x32_bf16 v[92:95], a[148:151], a[28:31], v[92:95]
  s_add_u32 m0, s29, 57344
  ds_read_b128 a[108:111], v12 offset:13312
  v_mfma_f32_16x16x32_bf16 v[92:95], a[144:147], a[20:23], v[92:95]
  buffer_load_dwordx4 v249, s[8:11], s33 offen sc1 lds
  v_mfma_f32_16x16x32_bf16 v[56:59], a[152:155], a[16:19], v[56:59]
  ds_read_b128 a[112:115], v12 offset:4096
  v_mfma_f32_16x16x32_bf16 v[56:59], a[156:159], a[24:27], v[56:59]
  v_mfma_f32_16x16x32_bf16 v[96:99], a[156:159], a[28:31], v[96:99]
  ds_read_b128 a[116:119], v12 offset:14336
  v_mfma_f32_16x16x32_bf16 v[96:99], a[152:155], a[20:23], v[96:99]
  s_waitcnt lgkmcnt(6)
  v_mfma_f32_16x16x32_bf16 v[20:23], a[80:83], a[32:35], v[20:23]
  ds_read_b128 a[120:123], v12 offset:5120
  v_mfma_f32_16x16x32_bf16 v[20:23], a[84:87], a[40:43], v[20:23]
  v_mfma_f32_16x16x32_bf16 v[60:63], a[84:87], a[44:47], v[60:63]
  s_mov_b32 s34, 90112
  ds_read_b128 a[124:127], v12 offset:15360
  v_mfma_f32_16x16x32_bf16 v[60:63], a[80:83], a[36:39], v[60:63]
  buffer_load_dwordx4 a[16:19], v2, s[12:15], s34 offen offset:0 sc1
  v_mfma_f32_16x16x32_bf16 v[24:27], a[88:91], a[32:35], v[24:27]
  ds_read_b128 a[128:131], v12 offset:6144
  v_mfma_f32_16x16x32_bf16 v[24:27], a[92:95], a[40:43], v[24:27]
  buffer_load_dwordx4 a[20:23], v2, s[12:15], s34 offen offset:1024 sc1
  v_mfma_f32_16x16x32_bf16 v[64:67], a[92:95], a[44:47], v[64:67]
  ds_read_b128 a[132:135], v12 offset:16384
  v_mfma_f32_16x16x32_bf16 v[64:67], a[88:91], a[36:39], v[64:67]
  s_waitcnt lgkmcnt(6)
  v_mfma_f32_16x16x32_bf16 v[28:31], a[96:99], a[32:35], v[28:31]
  s_mov_b32 s34, 94208
  ds_read_b128 a[136:139], v12 offset:7168
  v_mfma_f32_16x16x32_bf16 v[28:31], a[100:103], a[40:43], v[28:31]
  buffer_load_dwordx4 a[24:27], v2, s[12:15], s34 offen offset:0 sc1
  v_mfma_f32_16x16x32_bf16 v[68:71], a[100:103], a[44:47], v[68:71]
  ds_read_b128 a[140:143], v12 offset:17408
  v_mfma_f32_16x16x32_bf16 v[68:71], a[96:99], a[36:39], v[68:71]
  v_mfma_f32_16x16x32_bf16 v[32:35], a[104:107], a[32:35], v[32:35]
  ds_read_b128 a[144:147], v12 offset:8192
  v_mfma_f32_16x16x32_bf16 v[32:35], a[108:111], a[40:43], v[32:35]
  v_mfma_f32_16x16x32_bf16 v[72:75], a[108:111], a[44:47], v[72:75]
  ds_read_b128 a[148:151], v12 offset:18432
  v_mfma_f32_16x16x32_bf16 v[72:75], a[104:107], a[36:39], v[72:75]
  s_waitcnt lgkmcnt(6)
  buffer_load_dwordx4 a[28:31], v2, s[12:15], s34 offen offset:1024 sc1
  v_mfma_f32_16x16x32_bf16 v[36:39], a[112:115], a[32:35], v[36:39]
  ds_read_b128 a[152:155], v12 offset:9216
  v_mfma_f32_16x16x32_bf16 v[36:39], a[116:119], a[40:43], v[36:39]
  s_mov_b32 s33, 983040
  v_mfma_f32_16x16x32_bf16 v[76:79], a[116:119], a[44:47], v[76:79]
  s_add_u32 m0, s29, 61440
  ds_read_b128 a[156:159], v12 offset:19456
  v_mfma_f32_16x16x32_bf16 v[76:79], a[112:115], a[36:39], v[76:79]
  s_waitcnt vmcnt(27)
  buffer_load_dwordx4 v245, s[8:11], s33 offen sc1 lds
  v_mfma_f32_16x16x32_bf16 v[40:43], a[120:123], a[32:35], v[40:43]
  s_barrier
  ds_read_b128 a[80:83], v10 offset:0
  v_mfma_f32_16x16x32_bf16 v[40:43], a[124:127], a[40:43], v[40:43]
  v_mfma_f32_16x16x32_bf16 v[80:83], a[124:127], a[44:47], v[80:83]
  s_add_u32 m0, s29, 65536
  ds_read_b128 a[84:87], v10 offset:10240
  v_mfma_f32_16x16x32_bf16 v[80:83], a[120:123], a[36:39], v[80:83]
  s_waitcnt lgkmcnt(6)
  buffer_load_dwordx4 v246, s[8:11], s33 offen sc1 lds
  v_mfma_f32_16x16x32_bf16 v[44:47], a[128:131], a[32:35], v[44:47]
  ds_read_b128 a[88:91], v10 offset:1024
  v_mfma_f32_16x16x32_bf16 v[44:47], a[132:135], a[40:43], v[44:47]
  v_mfma_f32_16x16x32_bf16 v[84:87], a[132:135], a[44:47], v[84:87]
  s_add_u32 m0, s29, 69632
  ds_read_b128 a[92:95], v10 offset:11264
  v_mfma_f32_16x16x32_bf16 v[84:87], a[128:131], a[36:39], v[84:87]
  buffer_load_dwordx4 v247, s[8:11], s33 offen sc1 lds
  v_mfma_f32_16x16x32_bf16 v[48:51], a[136:139], a[32:35], v[48:51]
  ds_read_b128 a[96:99], v10 offset:2048
  v_mfma_f32_16x16x32_bf16 v[48:51], a[140:143], a[40:43], v[48:51]
  v_mfma_f32_16x16x32_bf16 v[88:91], a[140:143], a[44:47], v[88:91]
  s_add_u32 m0, s29, 73728
  ds_read_b128 a[100:103], v10 offset:12288
  v_mfma_f32_16x16x32_bf16 v[88:91], a[136:139], a[36:39], v[88:91]
  s_waitcnt lgkmcnt(6)
  buffer_load_dwordx4 v248, s[8:11], s33 offen sc1 lds
  v_mfma_f32_16x16x32_bf16 v[52:55], a[144:147], a[32:35], v[52:55]
  ds_read_b128 a[104:107], v10 offset:3072
  v_mfma_f32_16x16x32_bf16 v[52:55], a[148:151], a[40:43], v[52:55]
  v_mfma_f32_16x16x32_bf16 v[92:95], a[148:151], a[44:47], v[92:95]
  s_add_u32 m0, s29, 77824
  ds_read_b128 a[108:111], v10 offset:13312
  v_mfma_f32_16x16x32_bf16 v[92:95], a[144:147], a[36:39], v[92:95]
  buffer_load_dwordx4 v249, s[8:11], s33 offen sc1 lds
  v_mfma_f32_16x16x32_bf16 v[56:59], a[152:155], a[32:35], v[56:59]
  ds_read_b128 a[112:115], v10 offset:4096
  v_mfma_f32_16x16x32_bf16 v[56:59], a[156:159], a[40:43], v[56:59]
  v_mfma_f32_16x16x32_bf16 v[96:99], a[156:159], a[44:47], v[96:99]
  ds_read_b128 a[116:119], v10 offset:14336
  v_mfma_f32_16x16x32_bf16 v[96:99], a[152:155], a[36:39], v[96:99]
  s_waitcnt lgkmcnt(6)
  v_mfma_f32_16x16x32_bf16 v[20:23], a[80:83], a[48:51], v[20:23]
  ds_read_b128 a[120:123], v10 offset:5120
  v_mfma_f32_16x16x32_bf16 v[20:23], a[84:87], a[56:59], v[20:23]
  v_mfma_f32_16x16x32_bf16 v[60:63], a[84:87], a[60:63], v[60:63]
  s_mov_b32 s34, 98304
  ds_read_b128 a[124:127], v10 offset:15360
  v_mfma_f32_16x16x32_bf16 v[60:63], a[80:83], a[52:55], v[60:63]
  buffer_load_dwordx4 a[32:35], v2, s[12:15], s34 offen offset:0 sc1
  v_mfma_f32_16x16x32_bf16 v[24:27], a[88:91], a[48:51], v[24:27]
  ds_read_b128 a[128:131], v10 offset:6144
  v_mfma_f32_16x16x32_bf16 v[24:27], a[92:95], a[56:59], v[24:27]
  buffer_load_dwordx4 a[36:39], v2, s[12:15], s34 offen offset:1024 sc1
  v_mfma_f32_16x16x32_bf16 v[64:67], a[92:95], a[60:63], v[64:67]
  ds_read_b128 a[132:135], v10 offset:16384
  v_mfma_f32_16x16x32_bf16 v[64:67], a[88:91], a[52:55], v[64:67]
  s_waitcnt lgkmcnt(6)
  v_mfma_f32_16x16x32_bf16 v[28:31], a[96:99], a[48:51], v[28:31]
  s_mov_b32 s34, 102400
  ds_read_b128 a[136:139], v10 offset:7168
  v_mfma_f32_16x16x32_bf16 v[28:31], a[100:103], a[56:59], v[28:31]
  buffer_load_dwordx4 a[40:43], v2, s[12:15], s34 offen offset:0 sc1
  v_mfma_f32_16x16x32_bf16 v[68:71], a[100:103], a[60:63], v[68:71]
  ds_read_b128 a[140:143], v10 offset:17408
  v_mfma_f32_16x16x32_bf16 v[68:71], a[96:99], a[52:55], v[68:71]
  v_mfma_f32_16x16x32_bf16 v[32:35], a[104:107], a[48:51], v[32:35]
  ds_read_b128 a[144:147], v10 offset:8192
  v_mfma_f32_16x16x32_bf16 v[32:35], a[108:111], a[56:59], v[32:35]
  v_mfma_f32_16x16x32_bf16 v[72:75], a[108:111], a[60:63], v[72:75]
  ds_read_b128 a[148:151], v10 offset:18432
  v_mfma_f32_16x16x32_bf16 v[72:75], a[104:107], a[52:55], v[72:75]
  s_waitcnt lgkmcnt(6)
  buffer_load_dwordx4 a[44:47], v2, s[12:15], s34 offen offset:1024 sc1
  v_mfma_f32_16x16x32_bf16 v[36:39], a[112:115], a[48:51], v[36:39]
  ds_read_b128 a[152:155], v10 offset:9216
  v_mfma_f32_16x16x32_bf16 v[36:39], a[116:119], a[56:59], v[36:39]
  s_mov_b32 s33, 1064960
  v_mfma_f32_16x16x32_bf16 v[76:79], a[116:119], a[60:63], v[76:79]
  s_add_u32 m0, s29, 81920
  ds_read_b128 a[156:159], v10 offset:19456
  v_mfma_f32_16x16x32_bf16 v[76:79], a[112:115], a[52:55], v[76:79]
  s_waitcnt vmcnt(27)
  buffer_load_dwordx4 v245, s[8:11], s33 offen sc1 lds
  v_mfma_f32_16x16x32_bf16 v[40:43], a[120:123], a[48:51], v[40:43]
  s_barrier
  ds_read_b128 a[80:83], v12 offset:20480
  v_mfma_f32_16x16x32_bf16 v[40:43], a[124:127], a[56:59], v[40:43]
  v_mfma_f32_16x16x32_bf16 v[80:83], a[124:127], a[60:63], v[80:83]
  s_add_u32 m0, s29, 86016
  ds_read_b128 a[84:87], v12 offset:30720
  v_mfma_f32_16x16x32_bf16 v[80:83], a[120:123], a[52:55], v[80:83]
  s_waitcnt lgkmcnt(6)
  buffer_load_dwordx4 v246, s[8:11], s33 offen sc1 lds
  v_mfma_f32_16x16x32_bf16 v[44:47], a[128:131], a[48:51], v[44:47]
  ds_read_b128 a[88:91], v12 offset:21504
  v_mfma_f32_16x16x32_bf16 v[44:47], a[132:135], a[56:59], v[44:47]
  v_mfma_f32_16x16x32_bf16 v[84:87], a[132:135], a[60:63], v[84:87]
  s_add_u32 m0, s29, 90112
  ds_read_b128 a[92:95], v12 offset:31744
  v_mfma_f32_16x16x32_bf16 v[84:87], a[128:131], a[52:55], v[84:87]
  buffer_load_dwordx4 v247, s[8:11], s33 offen sc1 lds
  v_mfma_f32_16x16x32_bf16 v[48:51], a[136:139], a[48:51], v[48:51]
  ds_read_b128 a[96:99], v12 offset:22528
  v_mfma_f32_16x16x32_bf16 v[48:51], a[140:143], a[56:59], v[48:51]
  v_mfma_f32_16x16x32_bf16 v[88:91], a[140:143], a[60:63], v[88:91]
  s_add_u32 m0, s29, 94208
  ds_read_b128 a[100:103], v12 offset:32768
  v_mfma_f32_16x16x32_bf16 v[88:91], a[136:139], a[52:55], v[88:91]
  s_waitcnt lgkmcnt(6)
  buffer_load_dwordx4 v248, s[8:11], s33 offen sc1 lds
  v_mfma_f32_16x16x32_bf16 v[52:55], a[144:147], a[48:51], v[52:55]
  ds_read_b128 a[104:107], v12 offset:23552
  v_mfma_f32_16x16x32_bf16 v[52:55], a[148:151], a[56:59], v[52:55]
  v_mfma_f32_16x16x32_bf16 v[92:95], a[148:151], a[60:63], v[92:95]
  s_add_u32 m0, s29, 98304
  ds_read_b128 a[108:111], v12 offset:33792
  v_mfma_f32_16x16x32_bf16 v[92:95], a[144:147], a[52:55], v[92:95]
  buffer_load_dwordx4 v249, s[8:11], s33 offen sc1 lds
  v_mfma_f32_16x16x32_bf16 v[56:59], a[152:155], a[48:51], v[56:59]
  ds_read_b128 a[112:115], v12 offset:24576
  v_mfma_f32_16x16x32_bf16 v[56:59], a[156:159], a[56:59], v[56:59]
  v_mfma_f32_16x16x32_bf16 v[96:99], a[156:159], a[60:63], v[96:99]
  ds_read_b128 a[116:119], v12 offset:34816
  v_mfma_f32_16x16x32_bf16 v[96:99], a[152:155], a[52:55], v[96:99]
  s_waitcnt lgkmcnt(6)
  v_mfma_f32_16x16x32_bf16 v[20:23], a[80:83], a[64:67], v[20:23]
  ds_read_b128 a[120:123], v12 offset:25600
  v_mfma_f32_16x16x32_bf16 v[20:23], a[84:87], a[72:75], v[20:23]
  v_mfma_f32_16x16x32_bf16 v[60:63], a[84:87], a[76:79], v[60:63]
  s_mov_b32 s34, 106496
  ds_read_b128 a[124:127], v12 offset:35840
  v_mfma_f32_16x16x32_bf16 v[60:63], a[80:83], a[68:71], v[60:63]
  buffer_load_dwordx4 a[48:51], v2, s[12:15], s34 offen offset:0 sc1
  v_mfma_f32_16x16x32_bf16 v[24:27], a[88:91], a[64:67], v[24:27]
  ds_read_b128 a[128:131], v12 offset:26624
  v_mfma_f32_16x16x32_bf16 v[24:27], a[92:95], a[72:75], v[24:27]
  buffer_load_dwordx4 a[52:55], v2, s[12:15], s34 offen offset:1024 sc1
  v_mfma_f32_16x16x32_bf16 v[64:67], a[92:95], a[76:79], v[64:67]
  ds_read_b128 a[132:135], v12 offset:36864
  v_mfma_f32_16x16x32_bf16 v[64:67], a[88:91], a[68:71], v[64:67]
  s_waitcnt lgkmcnt(6)
  v_mfma_f32_16x16x32_bf16 v[28:31], a[96:99], a[64:67], v[28:31]
  s_mov_b32 s34, 110592
  ds_read_b128 a[136:139], v12 offset:27648
  v_mfma_f32_16x16x32_bf16 v[28:31], a[100:103], a[72:75], v[28:31]
  buffer_load_dwordx4 a[56:59], v2, s[12:15], s34 offen offset:0 sc1
  v_mfma_f32_16x16x32_bf16 v[68:71], a[100:103], a[76:79], v[68:71]
  ds_read_b128 a[140:143], v12 offset:37888
  v_mfma_f32_16x16x32_bf16 v[68:71], a[96:99], a[68:71], v[68:71]
  v_mfma_f32_16x16x32_bf16 v[32:35], a[104:107], a[64:67], v[32:35]
  ds_read_b128 a[144:147], v12 offset:28672
  v_mfma_f32_16x16x32_bf16 v[32:35], a[108:111], a[72:75], v[32:35]
  v_mfma_f32_16x16x32_bf16 v[72:75], a[108:111], a[76:79], v[72:75]
  ds_read_b128 a[148:151], v12 offset:38912
  v_mfma_f32_16x16x32_bf16 v[72:75], a[104:107], a[68:71], v[72:75]
  s_waitcnt lgkmcnt(6)
  buffer_load_dwordx4 a[60:63], v2, s[12:15], s34 offen offset:1024 sc1
  v_mfma_f32_16x16x32_bf16 v[36:39], a[112:115], a[64:67], v[36:39]
  ds_read_b128 a[152:155], v12 offset:29696
  v_mfma_f32_16x16x32_bf16 v[36:39], a[116:119], a[72:75], v[36:39]
  s_mov_b32 s33, 1146880
  v_mfma_f32_16x16x32_bf16 v[76:79], a[116:119], a[76:79], v[76:79]
  s_add_u32 m0, s29, 102400
  ds_read_b128 a[156:159], v12 offset:39936
  v_mfma_f32_16x16x32_bf16 v[76:79], a[112:115], a[68:71], v[76:79]
  s_waitcnt vmcnt(27)
  buffer_load_dwordx4 v245, s[8:11], s33 offen sc1 lds
  v_mfma_f32_16x16x32_bf16 v[40:43], a[120:123], a[64:67], v[40:43]
  s_barrier
  ds_read_b128 a[80:83], v10 offset:20480
  v_mfma_f32_16x16x32_bf16 v[40:43], a[124:127], a[72:75], v[40:43]
  v_mfma_f32_16x16x32_bf16 v[80:83], a[124:127], a[76:79], v[80:83]
  s_add_u32 m0, s29, 106496
  ds_read_b128 a[84:87], v10 offset:30720
  v_mfma_f32_16x16x32_bf16 v[80:83], a[120:123], a[68:71], v[80:83]
  s_waitcnt lgkmcnt(6)
  buffer_load_dwordx4 v246, s[8:11], s33 offen sc1 lds
  v_mfma_f32_16x16x32_bf16 v[44:47], a[128:131], a[64:67], v[44:47]
  ds_read_b128 a[88:91], v10 offset:21504
  v_mfma_f32_16x16x32_bf16 v[44:47], a[132:135], a[72:75], v[44:47]
  v_mfma_f32_16x16x32_bf16 v[84:87], a[132:135], a[76:79], v[84:87]
  s_add_u32 m0, s29, 110592
  ds_read_b128 a[92:95], v10 offset:31744
  v_mfma_f32_16x16x32_bf16 v[84:87], a[128:131], a[68:71], v[84:87]
  buffer_load_dwordx4 v247, s[8:11], s33 offen sc1 lds
  v_mfma_f32_16x16x32_bf16 v[48:51], a[136:139], a[64:67], v[48:51]
  ds_read_b128 a[96:99], v10 offset:22528
  v_mfma_f32_16x16x32_bf16 v[48:51], a[140:143], a[72:75], v[48:51]
  v_mfma_f32_16x16x32_bf16 v[88:91], a[140:143], a[76:79], v[88:91]
  s_add_u32 m0, s29, 114688
  ds_read_b128 a[100:103], v10 offset:32768
  v_mfma_f32_16x16x32_bf16 v[88:91], a[136:139], a[68:71], v[88:91]
  s_waitcnt lgkmcnt(6)
  buffer_load_dwordx4 v248, s[8:11], s33 offen sc1 lds
  v_mfma_f32_16x16x32_bf16 v[52:55], a[144:147], a[64:67], v[52:55]
  ds_read_b128 a[104:107], v10 offset:23552
  v_mfma_f32_16x16x32_bf16 v[52:55], a[148:151], a[72:75], v[52:55]
  v_mfma_f32_16x16x32_bf16 v[92:95], a[148:151], a[76:79], v[92:95]
  s_add_u32 m0, s29, 118784
  ds_read_b128 a[108:111], v10 offset:33792
  v_mfma_f32_16x16x32_bf16 v[92:95], a[144:147], a[68:71], v[92:95]
  buffer_load_dwordx4 v249, s[8:11], s33 offen sc1 lds
  v_mfma_f32_16x16x32_bf16 v[56:59], a[152:155], a[64:67], v[56:59]
  ds_read_b128 a[112:115], v10 offset:24576
  v_mfma_f32_16x16x32_bf16 v[56:59], a[156:159], a[72:75], v[56:59]
  v_mfma_f32_16x16x32_bf16 v[96:99], a[156:159], a[76:79], v[96:99]
  ds_read_b128 a[116:119], v10 offset:34816
  v_mfma_f32_16x16x32_bf16 v[96:99], a[152:155], a[68:71], v[96:99]
  s_waitcnt lgkmcnt(6)
  v_mfma_f32_16x16x32_bf16 v[20:23], a[80:83], a[0:3], v[20:23]
  ds_read_b128 a[120:123], v10 offset:25600
  v_mfma_f32_16x16x32_bf16 v[20:23], a[84:87], a[8:11], v[20:23]
  v_mfma_f32_16x16x32_bf16 v[60:63], a[84:87], a[12:15], v[60:63]
  s_mov_b32 s34, 114688
  ds_read_b128 a[124:127], v10 offset:35840
  v_mfma_f32_16x16x32_bf16 v[60:63], a[80:83], a[4:7], v[60:63]
  buffer_load_dwordx4 a[64:67], v2, s[12:15], s34 offen offset:0 sc1
  v_mfma_f32_16x16x32_bf16 v[24:27], a[88:91], a[0:3], v[24:27]
  ds_read_b128 a[128:131], v10 offset:26624
  v_mfma_f32_16x16x32_bf16 v[24:27], a[92:95], a[8:11], v[24:27]
  buffer_load_dwordx4 a[68:71], v2, s[12:15], s34 offen offset:1024 sc1
  v_mfma_f32_16x16x32_bf16 v[64:67], a[92:95], a[12:15], v[64:67]
  ds_read_b128 a[132:135], v10 offset:36864
  v_mfma_f32_16x16x32_bf16 v[64:67], a[88:91], a[4:7], v[64:67]
  s_waitcnt lgkmcnt(6)
  v_mfma_f32_16x16x32_bf16 v[28:31], a[96:99], a[0:3], v[28:31]
  s_mov_b32 s34, 118784
  ds_read_b128 a[136:139], v10 offset:27648
  v_mfma_f32_16x16x32_bf16 v[28:31], a[100:103], a[8:11], v[28:31]
  buffer_load_dwordx4 a[72:75], v2, s[12:15], s34 offen offset:0 sc1
  v_mfma_f32_16x16x32_bf16 v[68:71], a[100:103], a[12:15], v[68:71]
  ds_read_b128 a[140:143], v10 offset:37888
  v_mfma_f32_16x16x32_bf16 v[68:71], a[96:99], a[4:7], v[68:71]
  v_mfma_f32_16x16x32_bf16 v[32:35], a[104:107], a[0:3], v[32:35]
  ds_read_b128 a[144:147], v10 offset:28672
  v_mfma_f32_16x16x32_bf16 v[32:35], a[108:111], a[8:11], v[32:35]
  v_mfma_f32_16x16x32_bf16 v[72:75], a[108:111], a[12:15], v[72:75]
  ds_read_b128 a[148:151], v10 offset:38912
  v_mfma_f32_16x16x32_bf16 v[72:75], a[104:107], a[4:7], v[72:75]
  s_waitcnt lgkmcnt(6)
  buffer_load_dwordx4 a[76:79], v2, s[12:15], s34 offen offset:1024 sc1
  v_mfma_f32_16x16x32_bf16 v[36:39], a[112:115], a[0:3], v[36:39]
  ds_read_b128 a[152:155], v10 offset:29696
  v_mfma_f32_16x16x32_bf16 v[36:39], a[116:119], a[8:11], v[36:39]
  s_mov_b32 s33, 1228800
  v_mfma_f32_16x16x32_bf16 v[76:79], a[116:119], a[12:15], v[76:79]
  s_add_u32 m0, s29, 122880
  ds_read_b128 a[156:159], v10 offset:39936
  v_mfma_f32_16x16x32_bf16 v[76:79], a[112:115], a[4:7], v[76:79]
  s_waitcnt vmcnt(27)
  buffer_load_dwordx4 v245, s[8:11], s33 offen sc1 lds
  v_mfma_f32_16x16x32_bf16 v[40:43], a[120:123], a[0:3], v[40:43]
  s_barrier
  ds_read_b128 a[80:83], v10 offset:40960
  v_mfma_f32_16x16x32_bf16 v[40:43], a[124:127], a[8:11], v[40:43]
  v_mfma_f32_16x16x32_bf16 v[80:83], a[124:127], a[12:15], v[80:83]
  s_add_u32 m0, s29, 126976
  ds_read_b128 a[84:87], v10 offset:51200
  v_mfma_f32_16x16x32_bf16 v[80:83], a[120:123], a[4:7], v[80:83]
  s_waitcnt lgkmcnt(6)
  buffer_load_dwordx4 v246, s[8:11], s33 offen sc1 lds
  v_mfma_f32_16x16x32_bf16 v[44:47], a[128:131], a[0:3], v[44:47]
  ds_read_b128 a[88:91], v10 offset:41984
  v_mfma_f32_16x16x32_bf16 v[44:47], a[132:135], a[8:11], v[44:47]
  v_mfma_f32_16x16x32_bf16 v[84:87], a[132:135], a[12:15], v[84:87]
  s_add_u32 m0, s29, 131072
  ds_read_b128 a[92:95], v10 offset:52224
  v_mfma_f32_16x16x32_bf16 v[84:87], a[128:131], a[4:7], v[84:87]
  buffer_load_dwordx4 v247, s[8:11], s33 offen sc1 lds
  v_mfma_f32_16x16x32_bf16 v[48:51], a[136:139], a[0:3], v[48:51]
  ds_read_b128 a[96:99], v10 offset:43008
  v_mfma_f32_16x16x32_bf16 v[48:51], a[140:143], a[8:11], v[48:51]
  v_mfma_f32_16x16x32_bf16 v[88:91], a[140:143], a[12:15], v[88:91]
  s_add_u32 m0, s29, 135168
  ds_read_b128 a[100:103], v10 offset:53248
  v_mfma_f32_16x16x32_bf16 v[88:91], a[136:139], a[4:7], v[88:91]
  s_waitcnt lgkmcnt(6)
  buffer_load_dwordx4 v248, s[8:11], s33 offen sc1 lds
  v_mfma_f32_16x16x32_bf16 v[52:55], a[144:147], a[0:3], v[52:55]
  ds_read_b128 a[104:107], v10 offset:44032
  v_mfma_f32_16x16x32_bf16 v[52:55], a[148:151], a[8:11], v[52:55]
  v_mfma_f32_16x16x32_bf16 v[92:95], a[148:151], a[12:15], v[92:95]
  s_add_u32 m0, s29, 139264
  ds_read_b128 a[108:111], v10 offset:54272
  v_mfma_f32_16x16x32_bf16 v[92:95], a[144:147], a[4:7], v[92:95]
  buffer_load_dwordx4 v249, s[8:11], s33 offen sc1 lds
  v_mfma_f32_16x16x32_bf16 v[56:59], a[152:155], a[0:3], v[56:59]
  ds_read_b128 a[112:115], v10 offset:45056
  v_mfma_f32_16x16x32_bf16 v[56:59], a[156:159], a[8:11], v[56:59]
  v_mfma_f32_16x16x32_bf16 v[96:99], a[156:159], a[12:15], v[96:99]
  ds_read_b128 a[116:119], v10 offset:55296
  v_mfma_f32_16x16x32_bf16 v[96:99], a[152:155], a[4:7], v[96:99]
  s_waitcnt lgkmcnt(6)
  v_mfma_f32_16x16x32_bf16 v[20:23], a[80:83], a[16:19], v[20:23]
  ds_read_b128 a[120:123], v10 offset:46080
  v_mfma_f32_16x16x32_bf16 v[20:23], a[84:87], a[24:27], v[20:23]
  v_mfma_f32_16x16x32_bf16 v[60:63], a[84:87], a[28:31], v[60:63]
  s_mov_b32 s34, 122880
  ds_read_b128 a[124:127], v10 offset:56320
  v_mfma_f32_16x16x32_bf16 v[60:63], a[80:83], a[20:23], v[60:63]
  buffer_load_dwordx4 a[0:3], v2, s[12:15], s34 offen offset:0 sc1
  v_mfma_f32_16x16x32_bf16 v[24:27], a[88:91], a[16:19], v[24:27]
  ds_read_b128 a[128:131], v10 offset:47104
  v_mfma_f32_16x16x32_bf16 v[24:27], a[92:95], a[24:27], v[24:27]
  v_mfma_f32_16x16x32_bf16 v[64:67], a[92:95], a[28:31], v[64:67]
  ds_read_b128 a[132:135], v10 offset:57344
  v_mfma_f32_16x16x32_bf16 v[64:67], a[88:91], a[20:23], v[64:67]
  s_waitcnt lgkmcnt(6)
  v_mfma_f32_16x16x32_bf16 v[28:31], a[96:99], a[16:19], v[28:31]
  ds_read_b128 a[136:139], v10 offset:48128
  v_mfma_f32_16x16x32_bf16 v[28:31], a[100:103], a[24:27], v[28:31]
  v_mfma_f32_16x16x32_bf16 v[68:71], a[100:103], a[28:31], v[68:71]
  ds_read_b128 a[140:143], v10 offset:58368
  v_mfma_f32_16x16x32_bf16 v[68:71], a[96:99], a[20:23], v[68:71]
  buffer_load_dwordx4 a[4:7], v2, s[12:15], s34 offen offset:1024 sc1
  v_mfma_f32_16x16x32_bf16 v[32:35], a[104:107], a[16:19], v[32:35]
  ds_read_b128 a[144:147], v10 offset:49152
  v_mfma_f32_16x16x32_bf16 v[32:35], a[108:111], a[24:27], v[32:35]
  v_mfma_f32_16x16x32_bf16 v[72:75], a[108:111], a[28:31], v[72:75]
  ds_read_b128 a[148:151], v10 offset:59392
  v_mfma_f32_16x16x32_bf16 v[72:75], a[104:107], a[20:23], v[72:75]
  s_waitcnt lgkmcnt(6)
  v_mfma_f32_16x16x32_bf16 v[36:39], a[112:115], a[16:19], v[36:39]
  ds_read_b128 a[152:155], v10 offset:50176
  v_mfma_f32_16x16x32_bf16 v[36:39], a[116:119], a[24:27], v[36:39]
  v_mfma_f32_16x16x32_bf16 v[76:79], a[116:119], a[28:31], v[76:79]
  s_mov_b32 s34, 126976
  ds_read_b128 a[156:159], v10 offset:60416
  v_mfma_f32_16x16x32_bf16 v[76:79], a[112:115], a[20:23], v[76:79]
  s_waitcnt vmcnt(25)
  v_mfma_f32_16x16x32_bf16 v[40:43], a[120:123], a[16:19], v[40:43]
  s_barrier
  ds_read_b128 a[80:83], v11 offset:0
  v_mfma_f32_16x16x32_bf16 v[40:43], a[124:127], a[24:27], v[40:43]
  buffer_load_dwordx4 a[8:11], v2, s[12:15], s34 offen offset:0 sc1
  v_mfma_f32_16x16x32_bf16 v[80:83], a[124:127], a[28:31], v[80:83]
  ds_read_b128 a[84:87], v11 offset:10240
  v_mfma_f32_16x16x32_bf16 v[80:83], a[120:123], a[20:23], v[80:83]
  s_waitcnt lgkmcnt(6)
  v_mfma_f32_16x16x32_bf16 v[44:47], a[128:131], a[16:19], v[44:47]
  ds_read_b128 a[88:91], v11 offset:1024
  v_mfma_f32_16x16x32_bf16 v[44:47], a[132:135], a[24:27], v[44:47]
  v_mfma_f32_16x16x32_bf16 v[84:87], a[132:135], a[28:31], v[84:87]
  ds_read_b128 a[92:95], v11 offset:11264
  v_mfma_f32_16x16x32_bf16 v[84:87], a[128:131], a[20:23], v[84:87]
  v_mfma_f32_16x16x32_bf16 v[48:51], a[136:139], a[16:19], v[48:51]
  ds_read_b128 a[96:99], v11 offset:2048
  v_mfma_f32_16x16x32_bf16 v[48:51], a[140:143], a[24:27], v[48:51]
  v_mfma_f32_16x16x32_bf16 v[88:91], a[140:143], a[28:31], v[88:91]
  ds_read_b128 a[100:103], v11 offset:12288
  v_mfma_f32_16x16x32_bf16 v[88:91], a[136:139], a[20:23], v[88:91]
  s_waitcnt lgkmcnt(6)
  buffer_load_dwordx4 a[12:15], v2, s[12:15], s34 offen offset:1024 sc1
  v_mfma_f32_16x16x32_bf16 v[52:55], a[144:147], a[16:19], v[52:55]
  ds_read_b128 a[104:107], v11 offset:3072
  v_mfma_f32_16x16x32_bf16 v[52:55], a[148:151], a[24:27], v[52:55]
  v_mfma_f32_16x16x32_bf16 v[92:95], a[148:151], a[28:31], v[92:95]
  ds_read_b128 a[108:111], v11 offset:13312
  v_mfma_f32_16x16x32_bf16 v[92:95], a[144:147], a[20:23], v[92:95]
  v_mfma_f32_16x16x32_bf16 v[56:59], a[152:155], a[16:19], v[56:59]
  ds_read_b128 a[112:115], v11 offset:4096
  v_mfma_f32_16x16x32_bf16 v[56:59], a[156:159], a[24:27], v[56:59]
  v_mfma_f32_16x16x32_bf16 v[96:99], a[156:159], a[28:31], v[96:99]
  ds_read_b128 a[116:119], v11 offset:14336
  v_mfma_f32_16x16x32_bf16 v[96:99], a[152:155], a[20:23], v[96:99]
  s_waitcnt lgkmcnt(6)
  v_mfma_f32_16x16x32_bf16 v[20:23], a[80:83], a[32:35], v[20:23]
  ds_read_b128 a[120:123], v11 offset:5120
  v_mfma_f32_16x16x32_bf16 v[20:23], a[84:87], a[40:43], v[20:23]
  buffer_load_dwordx2 v[128:129], v212, s[56:59], 0 offen offset:0
  v_mfma_f32_16x16x32_bf16 v[60:63], a[84:87], a[44:47], v[60:63]
  ds_read_b128 a[124:127], v11 offset:15360
  v_mfma_f32_16x16x32_bf16 v[60:63], a[80:83], a[36:39], v[60:63]
  buffer_load_dwordx2 v[130:131], v212, s[56:59], 0 offen offset:32
  v_mfma_f32_16x16x32_bf16 v[24:27], a[88:91], a[32:35], v[24:27]
  ds_read_b128 a[128:131], v11 offset:6144
  v_mfma_f32_16x16x32_bf16 v[24:27], a[92:95], a[40:43], v[24:27]
  buffer_load_dwordx4 v[140:143], v213, s[60:63], s20 offen offset:0 sc1
  v_mfma_f32_16x16x32_bf16 v[64:67], a[92:95], a[44:47], v[64:67]
  ds_read_b128 a[132:135], v11 offset:16384
  v_mfma_f32_16x16x32_bf16 v[64:67], a[88:91], a[36:39], v[64:67]
  s_waitcnt lgkmcnt(6)
  v_mfma_f32_16x16x32_bf16 v[28:31], a[96:99], a[32:35], v[28:31]
  ds_read_b128 a[136:139], v11 offset:7168
  v_mfma_f32_16x16x32_bf16 v[28:31], a[100:103], a[40:43], v[28:31]
  buffer_load_dwordx4 v[144:147], v213, s[60:63], s20 offen offset:64 sc1
  v_mfma_f32_16x16x32_bf16 v[68:71], a[100:103], a[44:47], v[68:71]
  ds_read_b128 a[140:143], v11 offset:17408
  v_mfma_f32_16x16x32_bf16 v[68:71], a[96:99], a[36:39], v[68:71]
  buffer_load_dwordx4 v[164:167], v213, s[60:63], s22 offen offset:0 sc1
  v_mfma_f32_16x16x32_bf16 v[32:35], a[104:107], a[32:35], v[32:35]
  ds_read_b128 a[144:147], v11 offset:8192
  v_mfma_f32_16x16x32_bf16 v[32:35], a[108:111], a[40:43], v[32:35]
  buffer_load_dwordx4 v[168:171], v213, s[60:63], s22 offen offset:64 sc1
  v_mfma_f32_16x16x32_bf16 v[72:75], a[108:111], a[44:47], v[72:75]
  ds_read_b128 a[148:151], v11 offset:18432
  v_mfma_f32_16x16x32_bf16 v[72:75], a[104:107], a[36:39], v[72:75]
  s_waitcnt lgkmcnt(6)
  buffer_load_dwordx4 v[188:191], v213, s[60:63], s21 offen offset:0 sc1
  v_mfma_f32_16x16x32_bf16 v[36:39], a[112:115], a[32:35], v[36:39]
  ds_read_b128 a[152:155], v11 offset:9216
  v_mfma_f32_16x16x32_bf16 v[36:39], a[116:119], a[40:43], v[36:39]
  v_mfma_f32_16x16x32_bf16 v[76:79], a[116:119], a[44:47], v[76:79]
  ds_read_b128 a[156:159], v11 offset:19456
  v_mfma_f32_16x16x32_bf16 v[76:79], a[112:115], a[36:39], v[76:79]
  s_waitcnt vmcnt(7)
  buffer_load_dwordx4 v[192:195], v213, s[60:63], s21 offen offset:64 sc1
  v_mfma_f32_16x16x32_bf16 v[40:43], a[120:123], a[32:35], v[40:43]
  s_barrier
  ds_read_b128 a[80:83], v11 offset:20480
  v_mfma_f32_16x16x32_bf16 v[40:43], a[124:127], a[40:43], v[40:43]
  buffer_load_dwordx2 v[132:133], v212, s[56:59], 0 offen offset:512
  v_mfma_f32_16x16x32_bf16 v[80:83], a[124:127], a[44:47], v[80:83]
  ds_read_b128 a[84:87], v11 offset:30720
  v_mfma_f32_16x16x32_bf16 v[80:83], a[120:123], a[36:39], v[80:83]
  s_waitcnt lgkmcnt(6)
  buffer_load_dwordx2 v[134:135], v212, s[56:59], 0 offen offset:544
  v_mfma_f32_16x16x32_bf16 v[44:47], a[128:131], a[32:35], v[44:47]
  ds_read_b128 a[88:91], v11 offset:40960
  v_mfma_f32_16x16x32_bf16 v[44:47], a[132:135], a[40:43], v[44:47]
  buffer_load_dwordx4 v[148:151], v213, s[60:63], s20 offen offset:1024 sc1
  v_mfma_f32_16x16x32_bf16 v[84:87], a[132:135], a[44:47], v[84:87]
  ds_read_b128 a[92:95], v11 offset:51200
  v_mfma_f32_16x16x32_bf16 v[84:87], a[128:131], a[36:39], v[84:87]
  buffer_load_dwordx4 v[152:155], v213, s[60:63], s20 offen offset:1088 sc1
  v_mfma_f32_16x16x32_bf16 v[48:51], a[136:139], a[32:35], v[48:51]
  ds_read_b128 a[96:99], v12 offset:0
  v_mfma_f32_16x16x32_bf16 v[48:51], a[140:143], a[40:43], v[48:51]
  v_mfma_f32_16x16x32_bf16 v[88:91], a[140:143], a[44:47], v[88:91]
  ds_read_b128 a[100:103], v12 offset:10240
  v_mfma_f32_16x16x32_bf16 v[88:91], a[136:139], a[36:39], v[88:91]
  s_waitcnt lgkmcnt(6)
  buffer_load_dwordx4 v[172:175], v213, s[60:63], s22 offen offset:1024 sc1
  v_mfma_f32_16x16x32_bf16 v[52:55], a[144:147], a[32:35], v[52:55]
  ds_read_b128 a[104:107], v11 offset:21504
  v_mfma_f32_16x16x32_bf16 v[52:55], a[148:151], a[40:43], v[52:55]
  buffer_load_dwordx4 v[176:179], v213, s[60:63], s22 offen offset:1088 sc1
  v_mfma_f32_16x16x32_bf16 v[92:95], a[148:151], a[44:47], v[92:95]
  ds_read_b128 a[108:111], v11 offset:31744
  v_mfma_f32_16x16x32_bf16 v[92:95], a[144:147], a[36:39], v[92:95]
  buffer_load_dwordx4 v[196:199], v213, s[60:63], s21 offen offset:1024 sc1
  v_mfma_f32_16x16x32_bf16 v[56:59], a[152:155], a[32:35], v[56:59]
  ds_read_b128 a[112:115], v11 offset:41984
  v_mfma_f32_16x16x32_bf16 v[56:59], a[156:159], a[40:43], v[56:59]
  buffer_load_dwordx4 v[200:203], v213, s[60:63], s21 offen offset:1088 sc1
  v_mfma_f32_16x16x32_bf16 v[96:99], a[156:159], a[44:47], v[96:99]
  ds_read_b128 a[116:119], v11 offset:52224
  v_mfma_f32_16x16x32_bf16 v[96:99], a[152:155], a[36:39], v[96:99]
  s_waitcnt lgkmcnt(6)
  v_mfma_f32_16x16x32_bf16 v[20:23], a[80:83], a[48:51], v[20:23]
  ds_read_b128 a[120:123], v12 offset:1024
  v_mfma_f32_16x16x32_bf16 v[20:23], a[84:87], a[56:59], v[20:23]
  buffer_load_dwordx2 v[136:137], v218, s[56:59], 0 offen offset:1024
  v_mfma_f32_16x16x32_bf16 v[20:23], a[88:91], a[64:67], v[20:23]
  ds_read_b128 a[124:127], v12 offset:11264
  v_mfma_f32_16x16x32_bf16 v[20:23], a[92:95], a[72:75], v[20:23]
  s_waitcnt lgkmcnt(4)
  v_mfma_f32_16x16x32_bf16 v[20:23], a[96:99], a[0:3], v[20:23]
  ds_read_b128 a[128:131], v11 offset:22528
  v_mfma_f32_16x16x32_bf16 v[20:23], a[100:103], a[8:11], v[20:23]
  v_mfma_f32_16x16x32_bf16 v[60:63], a[100:103], a[12:15], v[60:63]
  ds_read_b128 a[132:135], v11 offset:32768
  v_mfma_f32_16x16x32_bf16 v[60:63], a[96:99], a[4:7], v[60:63]
  v_mfma_f32_16x16x32_bf16 v[60:63], a[92:95], a[76:79], v[60:63]
  ds_read_b128 a[136:139], v11 offset:43008
  v_mfma_f32_16x16x32_bf16 v[60:63], a[88:91], a[68:71], v[60:63]
  v_mfma_f32_16x16x32_bf16 v[60:63], a[84:87], a[60:63], v[60:63]
  ds_read_b128 a[140:143], v11 offset:53248
  v_mfma_f32_16x16x32_bf16 v[60:63], a[80:83], a[52:55], v[60:63]
  v_mfma_f32_16x16x32_bf16 v[24:27], a[104:107], a[48:51], v[24:27]
  ds_read_b128 a[144:147], v12 offset:2048
  v_mfma_f32_16x16x32_bf16 v[24:27], a[108:111], a[56:59], v[24:27]
  s_waitcnt lgkmcnt(5)
  v_mfma_f32_16x16x32_bf16 v[24:27], a[112:115], a[64:67], v[24:27]
  ds_read_b128 a[148:151], v12 offset:12288
  v_mfma_f32_16x16x32_bf16 v[24:27], a[116:119], a[72:75], v[24:27]
  buffer_load_dwordx2 v[138:139], v218, s[56:59], 0 offen offset:1056
  v_mfma_f32_16x16x32_bf16 v[24:27], a[120:123], a[0:3], v[24:27]
  ds_read_b128 a[152:155], v11 offset:23552
  v_mfma_f32_16x16x32_bf16 v[24:27], a[124:127], a[8:11], v[24:27]
  v_mfma_f32_16x16x32_bf16 v[64:67], a[124:127], a[12:15], v[64:67]
  ds_read_b128 a[156:159], v11 offset:33792
  v_mfma_f32_16x16x32_bf16 v[64:67], a[120:123], a[4:7], v[64:67]
  v_mfma_f32_16x16x32_bf16 v[64:67], a[116:119], a[76:79], v[64:67]
  ds_read_b128 a[80:83], v11 offset:44032
  v_mfma_f32_16x16x32_bf16 v[64:67], a[112:115], a[68:71], v[64:67]
  v_mfma_f32_16x16x32_bf16 v[64:67], a[108:111], a[60:63], v[64:67]
  ds_read_b128 a[84:87], v11 offset:54272
  v_mfma_f32_16x16x32_bf16 v[64:67], a[104:107], a[52:55], v[64:67]
  s_waitcnt lgkmcnt(6)
  v_mfma_f32_16x16x32_bf16 v[28:31], a[128:131], a[48:51], v[28:31]
  ds_read_b128 a[88:91], v12 offset:3072
  v_mfma_f32_16x16x32_bf16 v[28:31], a[132:135], a[56:59], v[28:31]
  v_mfma_f32_16x16x32_bf16 v[28:31], a[136:139], a[64:67], v[28:31]
  ds_read_b128 a[92:95], v12 offset:13312
  v_mfma_f32_16x16x32_bf16 v[28:31], a[140:143], a[72:75], v[28:31]
  s_waitcnt lgkmcnt(4)
  v_mfma_f32_16x16x32_bf16 v[28:31], a[144:147], a[0:3], v[28:31]
  ds_read_b128 a[96:99], v11 offset:24576
  v_cvt_pk_bf16_f32 v100, v20, v21
  v_cvt_pk_bf16_f32 v101, v22, v23
  v_cvt_pk_bf16_f32 v102, v24, v25
  v_cvt_pk_bf16_f32 v103, v26, v27
  v_cvt_pk_bf16_f32 v104, v60, v61
  v_cvt_pk_bf16_f32 v105, v62, v63
  v_cvt_pk_bf16_f32 v106, v64, v65
  v_cvt_pk_bf16_f32 v107, v66, v67
  s_mov_b32 s36, 0
  buffer_store_dwordx4 v[100:103], v2, s[16:19], s36 offen offset:0 sc1
  buffer_store_dwordx4 v[104:107], v2, s[16:19], s36 offen offset:1024 sc1
  v_mfma_f32_16x16x32_bf16 v[28:31], a[148:151], a[8:11], v[28:31]
  v_mfma_f32_16x16x32_bf16 v[68:71], a[148:151], a[12:15], v[68:71]
  ds_read_b128 a[100:103], v11 offset:34816
  v_mfma_f32_16x16x32_bf16 v[68:71], a[144:147], a[4:7], v[68:71]
  buffer_load_dwordx4 v[156:159], v213, s[60:63], s20 offen offset:2048 sc1
  v_mfma_f32_16x16x32_bf16 v[68:71], a[140:143], a[76:79], v[68:71]
  ds_read_b128 a[104:107], v11 offset:45056
  v_mfma_f32_16x16x32_bf16 v[68:71], a[136:139], a[68:71], v[68:71]
  v_mfma_f32_16x16x32_bf16 v[68:71], a[132:135], a[60:63], v[68:71]
  ds_read_b128 a[108:111], v11 offset:55296
  v_mfma_f32_16x16x32_bf16 v[68:71], a[128:131], a[52:55], v[68:71]
  v_mfma_f32_16x16x32_bf16 v[32:35], a[152:155], a[48:51], v[32:35]
  ds_read_b128 a[112:115], v12 offset:4096
  v_mfma_f32_16x16x32_bf16 v[32:35], a[156:159], a[56:59], v[32:35]
  s_waitcnt lgkmcnt(5)
  v_mfma_f32_16x16x32_bf16 v[32:35], a[80:83], a[64:67], v[32:35]
  ds_read_b128 a[116:119], v12 offset:14336
  v_mfma_f32_16x16x32_bf16 v[32:35], a[84:87], a[72:75], v[32:35]
  v_mfma_f32_16x16x32_bf16 v[32:35], a[88:91], a[0:3], v[32:35]
  ds_read_b128 a[120:123], v11 offset:25600
  v_mfma_f32_16x16x32_bf16 v[32:35], a[92:95], a[8:11], v[32:35]
  v_mfma_f32_16x16x32_bf16 v[72:75], a[92:95], a[12:15], v[72:75]
  ds_read_b128 a[124:127], v11 offset:35840
  v_mfma_f32_16x16x32_bf16 v[72:75], a[88:91], a[4:7], v[72:75]
  v_mfma_f32_16x16x32_bf16 v[72:75], a[84:87], a[76:79], v[72:75]
  ds_read_b128 a[128:131], v11 offset:46080
  v_mfma_f32_16x16x32_bf16 v[72:75], a[80:83], a[68:71], v[72:75]
  buffer_load_dwordx4 v[160:163], v213, s[60:63], s20 offen offset:2112 sc1
  v_mfma_f32_16x16x32_bf16 v[72:75], a[156:159], a[60:63], v[72:75]
  ds_read_b128 a[132:135], v11 offset:56320
  v_mfma_f32_16x16x32_bf16 v[72:75], a[152:155], a[52:55], v[72:75]
  s_waitcnt lgkmcnt(6)
  v_mfma_f32_16x16x32_bf16 v[36:39], a[96:99], a[48:51], v[36:39]
  ds_read_b128 a[136:139], v12 offset:5120
  v_mfma_f32_16x16x32_bf16 v[36:39], a[100:103], a[56:59], v[36:39]
  v_mfma_f32_16x16x32_bf16 v[36:39], a[104:107], a[64:67], v[36:39]
  ds_read_b128 a[140:143], v12 offset:15360
  v_mfma_f32_16x16x32_bf16 v[36:39], a[108:111], a[72:75], v[36:39]
  s_waitcnt lgkmcnt(4)
  v_mfma_f32_16x16x32_bf16 v[36:39], a[112:115], a[0:3], v[36:39]
  ds_read_b128 a[144:147], v11 offset:26624
  v_cvt_pk_bf16_f32 v108, v28, v29
  v_cvt_pk_bf16_f32 v109, v30, v31
  v_cvt_pk_bf16_f32 v110, v32, v33
  v_cvt_pk_bf16_f32 v111, v34, v35
  v_cvt_pk_bf16_f32 v112, v68, v69
  v_cvt_pk_bf16_f32 v113, v70, v71
  v_cvt_pk_bf16_f32 v114, v72, v73
  v_cvt_pk_bf16_f32 v115, v74, v75
  s_mov_b32 s36, 4096
  buffer_store_dwordx4 v[108:111], v2, s[16:19], s36 offen offset:0 sc1
  buffer_store_dwordx4 v[112:115], v2, s[16:19], s36 offen offset:1024 sc1
  v_mfma_f32_16x16x32_bf16 v[36:39], a[116:119], a[8:11], v[36:39]
  v_mfma_f32_16x16x32_bf16 v[76:79], a[116:119], a[12:15], v[76:79]
  ds_read_b128 a[148:151], v11 offset:36864
  v_mfma_f32_16x16x32_bf16 v[76:79], a[112:115], a[4:7], v[76:79]
  v_mfma_f32_16x16x32_bf16 v[76:79], a[108:111], a[76:79], v[76:79]
  ds_read_b128 a[152:155], v11 offset:47104
  v_mfma_f32_16x16x32_bf16 v[76:79], a[104:107], a[68:71], v[76:79]
  v_mfma_f32_16x16x32_bf16 v[76:79], a[100:103], a[60:63], v[76:79]
  ds_read_b128 a[156:159], v11 offset:57344
  v_mfma_f32_16x16x32_bf16 v[76:79], a[96:99], a[52:55], v[76:79]
  v_mfma_f32_16x16x32_bf16 v[40:43], a[120:123], a[48:51], v[40:43]
  ds_read_b128 a[80:83], v12 offset:6144
  v_mfma_f32_16x16x32_bf16 v[40:43], a[124:127], a[56:59], v[40:43]
  s_waitcnt lgkmcnt(5)
  buffer_load_dwordx4 v[180:183], v213, s[60:63], s22 offen offset:2048 sc1
  v_mfma_f32_16x16x32_bf16 v[40:43], a[128:131], a[64:67], v[40:43]
  ds_read_b128 a[84:87], v12 offset:16384
  v_mfma_f32_16x16x32_bf16 v[40:43], a[132:135], a[72:75], v[40:43]
  v_mfma_f32_16x16x32_bf16 v[40:43], a[136:139], a[0:3], v[40:43]
  ds_read_b128 a[88:91], v11 offset:27648
  v_mfma_f32_16x16x32_bf16 v[40:43], a[140:143], a[8:11], v[40:43]
  v_mfma_f32_16x16x32_bf16 v[80:83], a[140:143], a[12:15], v[80:83]
  ds_read_b128 a[92:95], v11 offset:37888
  v_mfma_f32_16x16x32_bf16 v[80:83], a[136:139], a[4:7], v[80:83]
  v_mfma_f32_16x16x32_bf16 v[80:83], a[132:135], a[76:79], v[80:83]
  ds_read_b128 a[96:99], v11 offset:48128
  v_mfma_f32_16x16x32_bf16 v[80:83], a[128:131], a[68:71], v[80:83]
  v_mfma_f32_16x16x32_bf16 v[80:83], a[124:127], a[60:63], v[80:83]
  ds_read_b128 a[100:103], v11 offset:58368
  v_mfma_f32_16x16x32_bf16 v[80:83], a[120:123], a[52:55], v[80:83]
  s_waitcnt lgkmcnt(6)
  v_mfma_f32_16x16x32_bf16 v[44:47], a[144:147], a[48:51], v[44:47]
  ds_read_b128 a[104:107], v12 offset:7168
  v_mfma_f32_16x16x32_bf16 v[44:47], a[148:151], a[56:59], v[44:47]
  v_mfma_f32_16x16x32_bf16 v[44:47], a[152:155], a[64:67], v[44:47]
  ds_read_b128 a[108:111], v12 offset:17408
  v_mfma_f32_16x16x32_bf16 v[44:47], a[156:159], a[72:75], v[44:47]
  s_waitcnt lgkmcnt(4)
  buffer_load_dwordx4 v[184:187], v213, s[60:63], s22 offen offset:2112 sc1
  v_mfma_f32_16x16x32_bf16 v[44:47], a[80:83], a[0:3], v[44:47]
  ds_read_b128 a[112:115], v11 offset:28672
  v_cvt_pk_bf16_f32 v116, v36, v37
  v_cvt_pk_bf16_f32 v117, v38, v39
  v_cvt_pk_bf16_f32 v118, v40, v41
  v_cvt_pk_bf16_f32 v119, v42, v43
  v_cvt_pk_bf16_f32 v120, v76, v77
  v_cvt_pk_bf16_f32 v121, v78, v79
  v_cvt_pk_bf16_f32 v122, v80, v81
  v_cvt_pk_bf16_f32 v123, v82, v83
  s_mov_b32 s36, 8192
  buffer_store_dwordx4 v[116:119], v2, s[16:19], s36 offen offset:0 sc1
  buffer_store_dwordx4 v[120:123], v2, s[16:19], s36 offen offset:1024 sc1
  v_mfma_f32_16x16x32_bf16 v[44:47], a[84:87], a[8:11], v[44:47]
  v_mfma_f32_16x16x32_bf16 v[84:87], a[84:87], a[12:15], v[84:87]
  ds_read_b128 a[116:119], v11 offset:38912
  v_mfma_f32_16x16x32_bf16 v[84:87], a[80:83], a[4:7], v[84:87]
  v_mfma_f32_16x16x32_bf16 v[84:87], a[156:159], a[76:79], v[84:87]
  ds_read_b128 a[120:123], v11 offset:49152
  v_mfma_f32_16x16x32_bf16 v[84:87], a[152:155], a[68:71], v[84:87]
  v_mfma_f32_16x16x32_bf16 v[84:87], a[148:151], a[60:63], v[84:87]
  ds_read_b128 a[124:127], v11 offset:59392
  v_mfma_f32_16x16x32_bf16 v[84:87], a[144:147], a[52:55], v[84:87]
  v_mfma_f32_16x16x32_bf16 v[48:51], a[88:91], a[48:51], v[48:51]
  ds_read_b128 a[128:131], v12 offset:8192
  v_mfma_f32_16x16x32_bf16 v[48:51], a[92:95], a[56:59], v[48:51]
  s_waitcnt lgkmcnt(5)
  v_mfma_f32_16x16x32_bf16 v[48:51], a[96:99], a[64:67], v[48:51]
  ds_read_b128 a[132:135], v12 offset:18432
  v_mfma_f32_16x16x32_bf16 v[48:51], a[100:103], a[72:75], v[48:51]
  v_mfma_f32_16x16x32_bf16 v[48:51], a[104:107], a[0:3], v[48:51]
  ds_read_b128 a[136:139], v11 offset:29696
  v_mfma_f32_16x16x32_bf16 v[48:51], a[108:111], a[8:11], v[48:51]
  v_mfma_f32_16x16x32_bf16 v[88:91], a[108:111], a[12:15], v[88:91]
  ds_read_b128 a[140:143], v11 offset:39936
  v_mfma_f32_16x16x32_bf16 v[88:91], a[104:107], a[4:7], v[88:91]
  buffer_load_dwordx4 v[204:207], v213, s[60:63], s21 offen offset:2048 sc1
  v_mfma_f32_16x16x32_bf16 v[88:91], a[100:103], a[76:79], v[88:91]
  ds_read_b128 a[144:147], v11 offset:50176
  v_mfma_f32_16x16x32_bf16 v[88:91], a[96:99], a[68:71], v[88:91]
  v_mfma_f32_16x16x32_bf16 v[88:91], a[92:95], a[60:63], v[88:91]
  ds_read_b128 a[148:151], v11 offset:60416
  v_mfma_f32_16x16x32_bf16 v[88:91], a[88:91], a[52:55], v[88:91]
  s_waitcnt lgkmcnt(6)
  v_mfma_f32_16x16x32_bf16 v[52:55], a[112:115], a[48:51], v[52:55]
  ds_read_b128 a[152:155], v12 offset:9216
  v_mfma_f32_16x16x32_bf16 v[52:55], a[116:119], a[56:59], v[52:55]
  v_mfma_f32_16x16x32_bf16 v[52:55], a[120:123], a[64:67], v[52:55]
  ds_read_b128 a[156:159], v12 offset:19456
  v_mfma_f32_16x16x32_bf16 v[52:55], a[124:127], a[72:75], v[52:55]
  s_waitcnt lgkmcnt(4)
  v_mfma_f32_16x16x32_bf16 v[52:55], a[128:131], a[0:3], v[52:55]
  v_cvt_pk_bf16_f32 v124, v44, v45
  v_cvt_pk_bf16_f32 v125, v46, v47
  v_cvt_pk_bf16_f32 v126, v48, v49
  v_cvt_pk_bf16_f32 v127, v50, v51
  v_cvt_pk_bf16_f32 v100, v84, v85
  v_cvt_pk_bf16_f32 v101, v86, v87
  v_cvt_pk_bf16_f32 v102, v88, v89
  v_cvt_pk_bf16_f32 v103, v90, v91
  s_mov_b32 s36, 12288
  buffer_store_dwordx4 v[124:127], v2, s[16:19], s36 offen offset:0 sc1
  buffer_store_dwordx4 v[100:103], v2, s[16:19], s36 offen offset:1024 sc1
  v_mfma_f32_16x16x32_bf16 v[52:55], a[132:135], a[8:11], v[52:55]
  v_mfma_f32_16x16x32_bf16 v[92:95], a[132:135], a[12:15], v[92:95]
  v_mfma_f32_16x16x32_bf16 v[92:95], a[128:131], a[4:7], v[92:95]
  v_mfma_f32_16x16x32_bf16 v[92:95], a[124:127], a[76:79], v[92:95]
  v_mfma_f32_16x16x32_bf16 v[92:95], a[120:123], a[68:71], v[92:95]
  buffer_load_dwordx4 v[208:211], v213, s[60:63], s21 offen offset:2112 sc1
  v_mfma_f32_16x16x32_bf16 v[92:95], a[116:119], a[60:63], v[92:95]
  v_mfma_f32_16x16x32_bf16 v[92:95], a[112:115], a[52:55], v[92:95]
  v_mfma_f32_16x16x32_bf16 v[56:59], a[136:139], a[48:51], v[56:59]
  v_mfma_f32_16x16x32_bf16 v[56:59], a[140:143], a[56:59], v[56:59]
  s_waitcnt lgkmcnt(0)
  v_mfma_f32_16x16x32_bf16 v[56:59], a[144:147], a[64:67], v[56:59]
  v_mfma_f32_16x16x32_bf16 v[56:59], a[148:151], a[72:75], v[56:59]
  v_mfma_f32_16x16x32_bf16 v[56:59], a[152:155], a[0:3], v[56:59]
  v_mfma_f32_16x16x32_bf16 v[56:59], a[156:159], a[8:11], v[56:59]
  v_mfma_f32_16x16x32_bf16 v[96:99], a[156:159], a[12:15], v[96:99]
  v_mfma_f32_16x16x32_bf16 v[96:99], a[152:155], a[4:7], v[96:99]
  v_mfma_f32_16x16x32_bf16 v[96:99], a[148:151], a[76:79], v[96:99]
  v_mfma_f32_16x16x32_bf16 v[96:99], a[144:147], a[68:71], v[96:99]
  v_mfma_f32_16x16x32_bf16 v[96:99], a[140:143], a[60:63], v[96:99]
  v_mfma_f32_16x16x32_bf16 v[96:99], a[136:139], a[52:55], v[96:99]
  v_cvt_pk_bf16_f32 v104, v52, v53
  v_cvt_pk_bf16_f32 v105, v54, v55
  v_cvt_pk_bf16_f32 v106, v56, v57
  v_cvt_pk_bf16_f32 v107, v58, v59
  v_cvt_pk_bf16_f32 v108, v92, v93
  v_cvt_pk_bf16_f32 v109, v94, v95
  s_nop 1
  v_cvt_pk_bf16_f32 v110, v96, v97
  v_cvt_pk_bf16_f32 v111, v98, v99
  s_mov_b32 s36, 16384
  buffer_store_dwordx4 v[104:107], v2, s[16:19], s36 offen offset:0 sc1
  buffer_store_dwordx4 v[108:111], v2, s[16:19], s36 offen offset:1024 sc1
  s_lshl_b32 s38, s30, 2
  s_add_u32 s38, s38, s28
  s_mul_i32 s39, s38, 81920
  s_mul_i32 s38, s38, 221184
  s_lshl_b32 s40, s43, 13
  s_add_u32 s38, s38, s40
  s_add_u32 s16, s4, s39
  s_addc_u32 s17, s5, 0
  s_add_u32 s16, s16, 40026112
  s_addc_u32 s17, s17, 0
  s_mov_b32 s18, 81920
  s_mov_b32 s19, 0x20000
  s_add_u32 s20, s4, s38
  s_addc_u32 s21, s5, 0
  s_add_u32 s20, s20, 42647552
  s_addc_u32 s21, s21, 0
  s_mov_b32 s22, 8192
  s_mov_b32 s23, 0x20000
  v_lshrrev_b32 v5, 2, v0
  v_lshlrev_b32 v6, 7, v5
  v_and_b32 v7, 3, v0
  v_lshl_add_u32 v6, v7, 3, v6
  v_bfe_u32 v5, v0, 3, 2
  v_lshl_add_u32 v10, v5, 5, v6
  v_xor_b32 v11, 32, v10
  v_xor_b32 v12, 64, v10
  v_xor_b32 v13, 0x60, v10
  v_add_u32 v14, 0x10000, v10
  v_add_u32 v18, 0x20000, v10
  v_add_u32 v15, 0x10000, v11
  v_add_u32 v19, 0x20000, v11
  v_add_u32 v16, 0x10000, v12
  v_add_u32 v20, 0x20000, v12
  v_add_u32 v17, 0x10000, v13
  v_add_u32 v21, 0x20000, v13
  s_waitcnt vmcnt(0)
  s_barrier
  s_cmp_lg_u32 s28, 0
  s_cbranch_scc1 L_sig0
  s_mov_b64 exec, 255
  v_lshlrev_b32 v3, 8, v0
  v_add_u32 v3, s41, v3
  v_mov_b32 v4, 1
  buffer_atomic_add v4, v3, s[52:55], 0 offen sc1
  s_mov_b64 exec, -1
L_sig0:
  v_lshlrev_b32 v104, 16, v128
  v_and_b32 v105, 0xffff0000, v128
  v_lshlrev_b32 v106, 16, v129
  v_and_b32 v107, 0xffff0000, v129
  v_lshlrev_b32 v108, 16, v130
  v_and_b32 v109, 0xffff0000, v130
  v_lshlrev_b32 v110, 16, v131
  v_and_b32 v111, 0xffff0000, v131
  v_lshlrev_b32 v112, 16, v132
  v_and_b32 v113, 0xffff0000, v132
  v_lshlrev_b32 v114, 16, v133
  v_and_b32 v115, 0xffff0000, v133
  v_lshlrev_b32 v116, 16, v134
  v_and_b32 v117, 0xffff0000, v134
  v_lshlrev_b32 v118, 16, v135
  v_and_b32 v119, 0xffff0000, v135
  v_lshlrev_b32 v120, 16, v136
  v_and_b32 v121, 0xffff0000, v136
  v_lshlrev_b32 v122, 16, v137
  v_and_b32 v123, 0xffff0000, v137
  v_lshlrev_b32 v124, 16, v138
  v_and_b32 v125, 0xffff0000, v138
  v_lshlrev_b32 v126, 16, v139
  v_and_b32 v127, 0xffff0000, v139
  s_cmp_lt_u32 s28, 2
  s_cselect_b32 s38, 1.0, 0
  s_cselect_b32 s39, 1.0, 0
  s_mov_b32 s40, 0x3c000000
  s_cselect_b32 s40, 0x3baaaaab, s40
  s_add_u32 m0, s29, 0
  s_mov_b32 s33, 0
  buffer_load_dwordx4 v254, s[76:79], s33 offen lds
  s_add_u32 m0, s29, 8192
  s_mov_b32 s33, 0
  buffer_load_dwordx4 v254, s[80:83], s33 offen lds
  s_add_u32 m0, s29, 4096
  s_mov_b32 s33, 110592
  buffer_load_dwordx4 v254, s[76:79], s33 offen lds
  s_add_u32 m0, s29, 12288
  s_mov_b32 s33, 110592
  buffer_load_dwordx4 v254, s[80:83], s33 offen lds
  s_add_u32 m0, s29, 16384
  s_mov_b32 s33, 221184
  buffer_load_dwordx4 v254, s[76:79], s33 offen lds
  s_add_u32 m0, s29, 24576
  s_mov_b32 s33, 221184
  buffer_load_dwordx4 v254, s[80:83], s33 offen lds
  s_add_u32 m0, s29, 20480
  s_mov_b32 s33, 331776
  buffer_load_dwordx4 v254, s[76:79], s33 offen lds
  s_add_u32 m0, s29, 28672
  s_mov_b32 s33, 331776
  buffer_load_dwordx4 v254, s[80:83], s33 offen lds
  s_add_u32 m0, s29, 32768
  s_mov_b32 s33, 442368
  buffer_load_dwordx4 v254, s[76:79], s33 offen lds
  s_add_u32 m0, s29, 40960
  s_mov_b32 s33, 442368
  buffer_load_dwordx4 v254, s[80:83], s33 offen lds
  s_add_u32 m0, s29, 36864
  s_mov_b32 s33, 552960
  buffer_load_dwordx4 v254, s[76:79], s33 offen lds
  s_add_u32 m0, s29, 45056
  s_mov_b32 s33, 552960
  buffer_load_dwordx4 v254, s[80:83], s33 offen lds
  s_cmp_lg_u32 s28, 0
  s_cbranch_scc1 L_got1
  v_mov_b32 v3, s41
  s_mov_b32 s33, 131072
L_poll1:
  buffer_load_dword v4, v3, s[52:55], s46 offen sc1
  s_sub_u32 s33, s33, 1
  s_cmp_eq_u32 s33, 0
  s_cbranch_scc1 L_got1
  s_waitcnt vmcnt(0)
  v_readfirstlane_b32 s34, v4
  s_cmp_lt_u32 s34, 16
  s_cbranch_scc1 L_poll1
L_got1:
  s_barrier
  s_mov_b32 s33, 0
  buffer_load_dwordx4 v[32:35], v214, s[64:67], s33 offen sc1
  s_mov_b32 s33, 2621440
  buffer_load_dwordx4 v[36:39], v214, s[64:67], s33 offen sc1
  s_mov_b32 s33, 5242880
  buffer_load_dwordx4 v[40:43], v214, s[64:67], s33 offen sc1
  s_mov_b32 s33, 7864320
  buffer_load_dwordx4 v[44:47], v214, s[64:67], s33 offen sc1
  s_mov_b32 s33, 32768
  buffer_load_dwordx4 v[48:51], v214, s[64:67], s33 offen sc1
  s_mov_b32 s33, 2654208
  buffer_load_dwordx4 v[52:55], v214, s[64:67], s33 offen sc1
  s_mov_b32 s33, 5275648
  buffer_load_dwordx4 v[56:59], v214, s[64:67], s33 offen sc1
  s_mov_b32 s33, 7897088
  buffer_load_dwordx4 v[60:63], v214, s[64:67], s33 offen sc1
  s_mov_b32 s33, 65536
  buffer_load_dwordx4 v[64:67], v217, s[64:67], s33 offen sc1
  s_mov_b32 s33, 2686976
  buffer_load_dwordx4 v[68:71], v217, s[64:67], s33 offen sc1
  s_mov_b32 s33, 5308416
  buffer_load_dwordx4 v[72:75], v217, s[64:67], s33 offen sc1
  s_mov_b32 s33, 7929856
  buffer_load_dwordx4 v[76:79], v217, s[64:67], s33 offen sc1
  s_waitcnt vmcnt(0)
  v_lshlrev_b32 v80, 16, v32
  v_lshlrev_b32 v88, 16, v48
  v_lshlrev_b32 v96, 16, v64
  v_and_b32 v81, 0xffff0000, v32
  v_and_b32 v89, 0xffff0000, v48
  v_and_b32 v97, 0xffff0000, v64
  v_lshlrev_b32 v82, 16, v33
  v_lshlrev_b32 v90, 16, v49
  v_lshlrev_b32 v98, 16, v65
  v_and_b32 v83, 0xffff0000, v33
  v_and_b32 v91, 0xffff0000, v49
  v_and_b32 v99, 0xffff0000, v65
  v_lshlrev_b32 v84, 16, v34
  v_lshlrev_b32 v92, 16, v50
  v_lshlrev_b32 v100, 16, v66
  v_and_b32 v85, 0xffff0000, v34
  v_and_b32 v93, 0xffff0000, v50
  v_and_b32 v101, 0xffff0000, v66
  v_lshlrev_b32 v86, 16, v35
  v_lshlrev_b32 v94, 16, v51
  v_lshlrev_b32 v102, 16, v67
  v_and_b32 v87, 0xffff0000, v35
  v_and_b32 v95, 0xffff0000, v51
  v_and_b32 v103, 0xffff0000, v67
  v_lshlrev_b32 v226, 16, v36
  v_lshlrev_b32 v230, 16, v52
  v_lshlrev_b32 v234, 16, v68
  v_and_b32 v227, 0xffff0000, v36
  v_and_b32 v231, 0xffff0000, v52
  v_and_b32 v235, 0xffff0000, v68
  v_pk_add_f32 v[80:81], v[80:81], v[226:227]
  v_pk_add_f32 v[88:89], v[88:89], v[230:231]
  v_pk_add_f32 v[96:97], v[96:97], v[234:235]
  v_lshlrev_b32 v228, 16, v37
  v_lshlrev_b32 v232, 16, v53
  v_lshlrev_b32 v236, 16, v69
  v_and_b32 v229, 0xffff0000, v37
  v_and_b32 v233, 0xffff0000, v53
  v_and_b32 v237, 0xffff0000, v69
  v_pk_add_f32 v[82:83], v[82:83], v[228:229]
  v_pk_add_f32 v[90:91], v[90:91], v[232:233]
  v_pk_add_f32 v[98:99], v[98:99], v[236:237]
  v_lshlrev_b32 v226, 16, v38
  v_lshlrev_b32 v230, 16, v54
  v_lshlrev_b32 v234, 16, v70
  v_and_b32 v227, 0xffff0000, v38
  v_and_b32 v231, 0xffff0000, v54
  v_and_b32 v235, 0xffff0000, v70
  v_pk_add_f32 v[84:85], v[84:85], v[226:227]
  v_pk_add_f32 v[92:93], v[92:93], v[230:231]
  v_pk_add_f32 v[100:101], v[100:101], v[234:235]
  v_lshlrev_b32 v228, 16, v39
  v_lshlrev_b32 v232, 16, v55
  v_lshlrev_b32 v236, 16, v71
  v_and_b32 v229, 0xffff0000, v39
  v_and_b32 v233, 0xffff0000, v55
  v_and_b32 v237, 0xffff0000, v71
  v_pk_add_f32 v[86:87], v[86:87], v[228:229]
  v_pk_add_f32 v[94:95], v[94:95], v[232:233]
  v_pk_add_f32 v[102:103], v[102:103], v[236:237]
  v_lshlrev_b32 v226, 16, v40
  v_lshlrev_b32 v230, 16, v56
  v_lshlrev_b32 v234, 16, v72
  v_and_b32 v227, 0xffff0000, v40
  v_and_b32 v231, 0xffff0000, v56
  v_and_b32 v235, 0xffff0000, v72
  v_pk_add_f32 v[80:81], v[80:81], v[226:227]
  v_pk_add_f32 v[88:89], v[88:89], v[230:231]
  v_pk_add_f32 v[96:97], v[96:97], v[234:235]
  v_lshlrev_b32 v228, 16, v41
  v_lshlrev_b32 v232, 16, v57
  v_lshlrev_b32 v236, 16, v73
  v_and_b32 v229, 0xffff0000, v41
  v_and_b32 v233, 0xffff0000, v57
  v_and_b32 v237, 0xffff0000, v73
  v_pk_add_f32 v[82:83], v[82:83], v[228:229]
  v_pk_add_f32 v[90:91], v[90:91], v[232:233]
  v_pk_add_f32 v[98:99], v[98:99], v[236:237]
  v_lshlrev_b32 v226, 16, v42
  v_lshlrev_b32 v230, 16, v58
  v_lshlrev_b32 v234, 16, v74
  v_and_b32 v227, 0xffff0000, v42
  v_and_b32 v231, 0xffff0000, v58
  v_and_b32 v235, 0xffff0000, v74
  v_pk_add_f32 v[84:85], v[84:85], v[226:227]
  v_pk_add_f32 v[92:93], v[92:93], v[230:231]
  v_pk_add_f32 v[100:101], v[100:101], v[234:235]
  v_lshlrev_b32 v228, 16, v43
  v_lshlrev_b32 v232, 16, v59
  v_lshlrev_b32 v236, 16, v75
  v_and_b32 v229, 0xffff0000, v43
  v_and_b32 v233, 0xffff0000, v59
  v_and_b32 v237, 0xffff0000, v75
  v_pk_add_f32 v[86:87], v[86:87], v[228:229]
  v_pk_add_f32 v[94:95], v[94:95], v[232:233]
  v_pk_add_f32 v[102:103], v[102:103], v[236:237]
  v_lshlrev_b32 v226, 16, v44
  v_lshlrev_b32 v230, 16, v60
  v_lshlrev_b32 v234, 16, v76
  v_and_b32 v227, 0xffff0000, v44
  v_and_b32 v231, 0xffff0000, v60
  v_and_b32 v235, 0xffff0000, v76
  v_pk_add_f32 v[80:81], v[80:81], v[226:227]
  v_pk_add_f32 v[88:89], v[88:89], v[230:231]
  v_pk_add_f32 v[96:97], v[96:97], v[234:235]
  v_lshlrev_b32 v228, 16, v45
  v_lshlrev_b32 v232, 16, v61
  v_lshlrev_b32 v236, 16, v77
  v_and_b32 v229, 0xffff0000, v45
  v_and_b32 v233, 0xffff0000, v61
  v_and_b32 v237, 0xffff0000, v77
  v_pk_add_f32 v[82:83], v[82:83], v[228:229]
  v_pk_add_f32 v[90:91], v[90:91], v[232:233]
  v_pk_add_f32 v[98:99], v[98:99], v[236:237]
  v_lshlrev_b32 v226, 16, v46
  v_lshlrev_b32 v230, 16, v62
  v_lshlrev_b32 v234, 16, v78
  v_and_b32 v227, 0xffff0000, v46
  v_and_b32 v231, 0xffff0000, v62
  v_and_b32 v235, 0xffff0000, v78
  v_pk_add_f32 v[84:85], v[84:85], v[226:227]
  v_pk_add_f32 v[92:93], v[92:93], v[230:231]
  v_pk_add_f32 v[100:101], v[100:101], v[234:235]
  v_lshlrev_b32 v228, 16, v47
  v_lshlrev_b32 v232, 16, v63
  v_lshlrev_b32 v236, 16, v79
  v_and_b32 v229, 0xffff0000, v47
  v_and_b32 v233, 0xffff0000, v63
  v_and_b32 v237, 0xffff0000, v79
  v_pk_add_f32 v[86:87], v[86:87], v[228:229]
  v_pk_add_f32 v[94:95], v[94:95], v[232:233]
  v_pk_add_f32 v[102:103], v[102:103], v[236:237]
  v_pk_fma_f32 v[140:141], v[140:141], v[80:81], v[104:105]
  v_pk_fma_f32 v[148:149], v[148:149], v[88:89], v[112:113]
  v_pk_fma_f32 v[156:157], v[156:157], v[96:97], v[120:121]
  v_pk_fma_f32 v[142:143], v[142:143], v[82:83], v[106:107]
  v_pk_fma_f32 v[150:151], v[150:151], v[90:91], v[114:115]
  v_pk_fma_f32 v[158:159], v[158:159], v[98:99], v[122:123]
  v_pk_fma_f32 v[144:145], v[144:145], v[84:85], v[108:109]
  v_pk_fma_f32 v[152:153], v[152:153], v[92:93], v[116:117]
  v_pk_fma_f32 v[160:161], v[160:161], v[100:101], v[124:125]
  v_pk_fma_f32 v[146:147], v[146:147], v[86:87], v[110:111]
  v_pk_fma_f32 v[154:155], v[154:155], v[94:95], v[118:119]
  v_pk_fma_f32 v[162:163], v[162:163], v[102:103], v[126:127]
  v_cvt_pk_bf16_f32 v128, v140, v141
  v_cvt_pk_bf16_f32 v132, v148, v149
  v_cvt_pk_bf16_f32 v136, v156, v157
  v_cvt_pk_bf16_f32 v129, v142, v143
  v_cvt_pk_bf16_f32 v133, v150, v151
  v_cvt_pk_bf16_f32 v137, v158, v159
  v_cvt_pk_bf16_f32 v130, v144, v145
  v_cvt_pk_bf16_f32 v134, v152, v153
  v_cvt_pk_bf16_f32 v138, v160, v161
  v_cvt_pk_bf16_f32 v131, v146, v147
  v_cvt_pk_bf16_f32 v135, v154, v155
  v_cvt_pk_bf16_f32 v139, v162, v163
  buffer_store_dwordx4 v[128:131], v214, s[72:75], s24 offen sc1
  buffer_store_dwordx4 v[132:135], v214, s[72:75], s25 offen sc1
  buffer_store_dwordx4 v[136:139], v214, s[72:75], s26 offen sc1
  v_pk_add_f32 v[220:221], v[140:141], v[142:143]
  v_pk_add_f32 v[222:223], v[148:149], v[150:151]
  v_pk_add_f32 v[224:225], v[156:157], v[158:159]
  v_pk_add_f32 v[226:227], v[144:145], v[146:147]
  v_pk_add_f32 v[230:231], v[152:153], v[154:155]
  v_pk_add_f32 v[234:235], v[160:161], v[162:163]
  v_pk_add_f32 v[220:221], v[220:221], v[226:227]
  v_pk_add_f32 v[222:223], v[222:223], v[230:231]
  v_pk_add_f32 v[224:225], v[224:225], v[234:235]
  v_pk_add_f32 v[220:221], v[220:221], v[222:223]
  v_pk_fma_f32 v[220:221], v[224:225], s[38:39], v[220:221]
  v_add_f32 v220, v220, v221
  s_nop 1
  v_add_f32_dpp v220, v220, v220 row_ror:8 row_mask:0xf bank_mask:0xf
  v_mov_b32 v221, v220
  s_nop 1
  v_permlane16_swap_b32 v220, v221
  v_add_f32 v220, v220, v221
  v_mov_b32 v221, v220
  s_nop 1
  v_permlane32_swap_b32 v220, v221
  v_add_f32 v220, v220, v221
  v_mul_f32 v220, s40, v220
  v_pk_add_f32 v[226:227], v[140:141], v[220:221] op_sel_hi:[1,0] neg_lo:[0,1] neg_hi:[0,1]
  v_pk_add_f32 v[230:231], v[148:149], v[220:221] op_sel_hi:[1,0] neg_lo:[0,1] neg_hi:[0,1]
  v_pk_add_f32 v[234:235], v[156:157], v[220:221] op_sel_hi:[1,0] neg_lo:[0,1] neg_hi:[0,1]
  v_pk_mul_f32 v[80:81], v[226:227], v[226:227]
  v_pk_mul_f32 v[88:89], v[230:231], v[230:231]
  v_pk_mul_f32 v[96:97], v[234:235], v[234:235]
  v_pk_add_f32 v[228:229], v[142:143], v[220:221] op_sel_hi:[1,0] neg_lo:[0,1] neg_hi:[0,1]
  v_pk_add_f32 v[232:233], v[150:151], v[220:221] op_sel_hi:[1,0] neg_lo:[0,1] neg_hi:[0,1]
  v_pk_add_f32 v[236:237], v[158:159], v[220:221] op_sel_hi:[1,0] neg_lo:[0,1] neg_hi:[0,1]
  v_pk_fma_f32 v[80:81], v[228:229], v[228:229], v[80:81]
  v_pk_fma_f32 v[88:89], v[232:233], v[232:233], v[88:89]
  v_pk_fma_f32 v[96:97], v[236:237], v[236:237], v[96:97]
  v_pk_add_f32 v[226:227], v[144:145], v[220:221] op_sel_hi:[1,0] neg_lo:[0,1] neg_hi:[0,1]
  v_pk_add_f32 v[230:231], v[152:153], v[220:221] op_sel_hi:[1,0] neg_lo:[0,1] neg_hi:[0,1]
  v_pk_add_f32 v[234:235], v[160:161], v[220:221] op_sel_hi:[1,0] neg_lo:[0,1] neg_hi:[0,1]
  v_pk_fma_f32 v[80:81], v[226:227], v[226:227], v[80:81]
  v_pk_fma_f32 v[88:89], v[230:231], v[230:231], v[88:89]
  v_pk_fma_f32 v[96:97], v[234:235], v[234:235], v[96:97]
  v_pk_add_f32 v[228:229], v[146:147], v[220:221] op_sel_hi:[1,0] neg_lo:[0,1] neg_hi:[0,1]
  v_pk_add_f32 v[232:233], v[154:155], v[220:221] op_sel_hi:[1,0] neg_lo:[0,1] neg_hi:[0,1]
  v_pk_add_f32 v[236:237], v[162:163], v[220:221] op_sel_hi:[1,0] neg_lo:[0,1] neg_hi:[0,1]
  v_pk_fma_f32 v[80:81], v[228:229], v[228:229], v[80:81]
  v_pk_fma_f32 v[88:89], v[232:233], v[232:233], v[88:89]
  v_pk_fma_f32 v[96:97], v[236:237], v[236:237], v[96:97]
  v_pk_add_f32 v[80:81], v[80:81], v[88:89]
  v_pk_fma_f32 v[80:81], v[96:97], s[38:39], v[80:81]
  v_add_f32 v221, v80, v81
  s_nop 1
  v_add_f32_dpp v221, v221, v221 row_ror:8 row_mask:0xf bank_mask:0xf
  v_mov_b32 v226, v221
  s_nop 1
  v_permlane16_swap_b32 v221, v226
  v_add_f32 v221, v221, v226
  v_mov_b32 v226, v221
  s_nop 1
  v_permlane32_swap_b32 v221, v226
  v_add_f32 v221, v221, v226
  ds_write_b64 v215, v[220:221]
  s_waitcnt lgkmcnt(0)
  s_barrier
  ds_read_b64 v[72:73], v216 offset:0
  ds_read_b64 v[74:75], v216 offset:64
  ds_read_b64 v[76:77], v216 offset:128
  ds_read_b64 v[78:79], v216 offset:192
  s_waitcnt lgkmcnt(0)
  v_pk_add_f32 v[220:221], v[72:73], v[74:75]
  v_pk_add_f32 v[226:227], v[76:77], v[78:79]
  v_mul_f32 v220, 0x3e99999a, v220
  v_add_f32 v221, v221, v227
  v_fmac_f32 v220, 0x3e4ccccd, v226
  v_sub_f32 v72, v72, v220
  v_sub_f32 v74, v74, v220
  v_sub_f32 v76, v76, v220
  v_sub_f32 v78, v78, v220
  v_mul_f32 v226, v72, v72
  v_mul_f32 v227, v76, v76
  v_fmac_f32 v226, v74, v74
  v_fmac_f32 v227, v78, v78
  v_mov_b32 v228, 0x3727c5ac
  v_fmac_f32 v221, 0x43400000, v226
  v_fmac_f32 v221, 0x43000000, v227
  v_fmac_f32 v228, 0x3acccccd, v221
  v_rsq_f32 v228, v228
  v_pk_add_f32 v[140:141], v[140:141], v[220:221] op_sel_hi:[1,0] neg_lo:[0,1] neg_hi:[0,1]
  v_pk_add_f32 v[148:149], v[148:149], v[220:221] op_sel_hi:[1,0] neg_lo:[0,1] neg_hi:[0,1]
  v_pk_add_f32 v[156:157], v[156:157], v[220:221] op_sel_hi:[1,0] neg_lo:[0,1] neg_hi:[0,1]
  v_pk_add_f32 v[142:143], v[142:143], v[220:221] op_sel_hi:[1,0] neg_lo:[0,1] neg_hi:[0,1]
  v_pk_add_f32 v[150:151], v[150:151], v[220:221] op_sel_hi:[1,0] neg_lo:[0,1] neg_hi:[0,1]
  v_pk_add_f32 v[158:159], v[158:159], v[220:221] op_sel_hi:[1,0] neg_lo:[0,1] neg_hi:[0,1]
  v_pk_add_f32 v[144:145], v[144:145], v[220:221] op_sel_hi:[1,0] neg_lo:[0,1] neg_hi:[0,1]
  v_pk_add_f32 v[152:153], v[152:153], v[220:221] op_sel_hi:[1,0] neg_lo:[0,1] neg_hi:[0,1]
  v_pk_add_f32 v[160:161], v[160:161], v[220:221] op_sel_hi:[1,0] neg_lo:[0,1] neg_hi:[0,1]
  v_pk_add_f32 v[146:147], v[146:147], v[220:221] op_sel_hi:[1,0] neg_lo:[0,1] neg_hi:[0,1]
  v_pk_add_f32 v[154:155], v[154:155], v[220:221] op_sel_hi:[1,0] neg_lo:[0,1] neg_hi:[0,1]
  v_pk_add_f32 v[162:163], v[162:163], v[220:221] op_sel_hi:[1,0] neg_lo:[0,1] neg_hi:[0,1]
  v_pk_mul_f32 v[140:141], v[140:141], v[228:229] op_sel_hi:[1,0]
  v_pk_mul_f32 v[148:149], v[148:149], v[228:229] op_sel_hi:[1,0]
  v_pk_mul_f32 v[156:157], v[156:157], v[228:229] op_sel_hi:[1,0]
  v_pk_mul_f32 v[142:143], v[142:143], v[228:229] op_sel_hi:[1,0]
  v_pk_mul_f32 v[150:151], v[150:151], v[228:229] op_sel_hi:[1,0]
  v_pk_mul_f32 v[158:159], v[158:159], v[228:229] op_sel_hi:[1,0]
  v_pk_mul_f32 v[144:145], v[144:145], v[228:229] op_sel_hi:[1,0]
  v_pk_mul_f32 v[152:153], v[152:153], v[228:229] op_sel_hi:[1,0]
  v_pk_mul_f32 v[160:161], v[160:161], v[228:229] op_sel_hi:[1,0]
  v_pk_mul_f32 v[146:147], v[146:147], v[228:229] op_sel_hi:[1,0]
  v_pk_mul_f32 v[154:155], v[154:155], v[228:229] op_sel_hi:[1,0]
  v_pk_mul_f32 v[162:163], v[162:163], v[228:229] op_sel_hi:[1,0]
  v_pk_fma_f32 v[140:141], v[140:141], v[164:165], v[188:189]
  v_pk_fma_f32 v[148:149], v[148:149], v[172:173], v[196:197]
  v_pk_fma_f32 v[156:157], v[156:157], v[180:181], v[204:205]
  v_pk_fma_f32 v[142:143], v[142:143], v[166:167], v[190:191]
  v_pk_fma_f32 v[150:151], v[150:151], v[174:175], v[198:199]
  v_pk_fma_f32 v[158:159], v[158:159], v[182:183], v[206:207]
  v_pk_fma_f32 v[144:145], v[144:145], v[168:169], v[192:193]
  v_pk_fma_f32 v[152:153], v[152:153], v[176:177], v[200:201]
  v_pk_fma_f32 v[160:161], v[160:161], v[184:185], v[208:209]
  v_pk_fma_f32 v[146:147], v[146:147], v[170:171], v[194:195]
  v_pk_fma_f32 v[154:155], v[154:155], v[178:179], v[202:203]
  v_pk_fma_f32 v[162:163], v[162:163], v[186:187], v[210:211]
  v_cvt_pk_bf16_f32 v32, v140, v141
  v_cvt_pk_bf16_f32 v48, v148, v149
  v_cvt_pk_bf16_f32 v64, v156, v157
  v_cvt_pk_bf16_f32 v33, v142, v143
  v_cvt_pk_bf16_f32 v49, v150, v151
  v_cvt_pk_bf16_f32 v65, v158, v159
  v_cvt_pk_bf16_f32 v34, v144, v145
  v_cvt_pk_bf16_f32 v50, v152, v153
  v_cvt_pk_bf16_f32 v66, v160, v161
  v_cvt_pk_bf16_f32 v35, v146, v147
  v_cvt_pk_bf16_f32 v51, v154, v155
  v_cvt_pk_bf16_f32 v67, v162, v163
  buffer_store_dwordx4 v[32:35], v214, s[68:71], s24 offen sc1
  buffer_store_dwordx4 v[48:51], v214, s[68:71], s25 offen sc1
  buffer_store_dwordx4 v[64:67], v214, s[68:71], s26 offen sc1
  v_add_u32 v4, 0, v1
  v_mul_u32_u24 v5, 13108, v4
  v_lshrrev_b32 v5, 16, v5
  v_mul_u32_u24 v5, 35, v5
  v_add_u32 v4, v4, v5
  v_lshl_add_u32 v245, v4, 10, v2
  v_add_u32 v4, 4, v1
  v_mul_u32_u24 v5, 13108, v4
  v_lshrrev_b32 v5, 16, v5
  v_mul_u32_u24 v5, 35, v5
  v_add_u32 v4, v4, v5
  v_lshl_add_u32 v246, v4, 10, v2
  v_add_u32 v4, 8, v1
  v_mul_u32_u24 v5, 13108, v4
  v_lshrrev_b32 v5, 16, v5
  v_mul_u32_u24 v5, 35, v5
  v_add_u32 v4, v4, v5
  v_lshl_add_u32 v247, v4, 10, v2
  v_add_u32 v4, 12, v1
  v_mul_u32_u24 v5, 13108, v4
  v_lshrrev_b32 v5, 16, v5
  v_mul_u32_u24 v5, 35, v5
  v_add_u32 v4, v4, v5
  v_lshl_add_u32 v248, v4, 10, v2
  v_add_u32 v4, 16, v1
  v_mul_u32_u24 v5, 13108, v4
  v_lshrrev_b32 v5, 16, v5
  v_mul_u32_u24 v5, 35, v5
  v_add_u32 v4, v4, v5
  v_lshl_add_u32 v249, v4, 10, v2
  s_lshl_b32 s35, s30, 2
  s_and_b32 s36, s31, 1
  s_lshl_b32 s36, s36, 1
  s_add_u32 s35, s35, s36
  s_and_b32 s36, s32, 1
  s_add_u32 s35, s35, s36
  s_lshr_b32 s37, s31, 1
  s_lshl_b32 s37, s37, 2
  s_lshr_b32 s36, s32, 1
  s_add_u32 s37, s37, s36
  s_mul_i32 s38, s37, 5120
  s_sub_u32 s36, 2211840, s38
  s_add_u32 s56, s4, s38
  s_addc_u32 s57, s5, 0
  s_add_u32 s56, s56, 24707072
  s_addc_u32 s57, s57, 0
  s_mov_b32 s58, s36
  s_mov_b32 s59, 0x20000
  s_waitcnt vmcnt(0)
  s_barrier
  s_cmp_lg_u32 s28, 0
  s_cbranch_scc1 L_sig1
  s_mov_b64 exec, 255
  v_lshlrev_b32 v3, 8, v0
  v_add_u32 v3, 8192, v3
  v_mov_b32 v4, 1
  buffer_atomic_add v4, v3, s[52:55], 0 offen sc1
  s_mov_b64 exec, -1
L_sig1:
  s_cmp_lg_u32 s28, 0
  s_cbranch_scc1 L_got2
  v_mov_b32 v3, 8192
  s_mov_b32 s33, 131072
L_poll2:
  buffer_load_dword v4, v3, s[52:55], s46 offen sc1
  s_sub_u32 s33, s33, 1
  s_cmp_eq_u32 s33, 0
  s_cbranch_scc1 L_got2
  s_waitcnt vmcnt(0)
  v_readfirstlane_b32 s34, v4
  s_cmp_lt_u32 s34, 32
  s_cbranch_scc1 L_poll2
L_got2:
  s_barrier
  s_cmp_ge_u32 s43, 27
  s_cbranch_scc1 L_idle
  s_mov_b32 s34, 0
  buffer_load_dwordx4 a[0:3], v2, s[16:19], s34 offen offset:0 sc1
  buffer_load_dwordx4 a[4:7], v2, s[16:19], s34 offen offset:1024 sc1
  buffer_load_dwordx4 a[8:11], v2, s[16:19], s34 offen offset:2048 sc1
  buffer_load_dwordx4 a[12:15], v2, s[16:19], s34 offen offset:3072 sc1
  s_mov_b32 s34, 4096
  buffer_load_dwordx4 a[16:19], v2, s[16:19], s34 offen offset:0 sc1
  buffer_load_dwordx4 a[20:23], v2, s[16:19], s34 offen offset:1024 sc1
  buffer_load_dwordx4 a[24:27], v2, s[16:19], s34 offen offset:2048 sc1
  buffer_load_dwordx4 a[28:31], v2, s[16:19], s34 offen offset:3072 sc1
  s_mov_b32 s34, 8192
  buffer_load_dwordx4 a[32:35], v2, s[16:19], s34 offen offset:0 sc1
  buffer_load_dwordx4 a[36:39], v2, s[16:19], s34 offen offset:1024 sc1
  buffer_load_dwordx4 a[40:43], v2, s[16:19], s34 offen offset:2048 sc1
  buffer_load_dwordx4 a[44:47], v2, s[16:19], s34 offen offset:3072 sc1
  s_mov_b32 s34, 12288
  buffer_load_dwordx4 a[48:51], v2, s[16:19], s34 offen offset:0 sc1
  buffer_load_dwordx4 a[52:55], v2, s[16:19], s34 offen offset:1024 sc1
  buffer_load_dwordx4 a[56:59], v2, s[16:19], s34 offen offset:2048 sc1
  buffer_load_dwordx4 a[60:63], v2, s[16:19], s34 offen offset:3072 sc1
  s_waitcnt vmcnt(8)
  s_barrier
  ds_read_b64_tr_b16 a[128:129], v10 offset:0
  ds_read_b64_tr_b16 a[130:131], v10 offset:2048
  ds_read_b64_tr_b16 a[132:133], v10 offset:4096
  ds_read_b64_tr_b16 a[134:135], v10 offset:6144
  ds_read_b64_tr_b16 a[136:137], v10 offset:8192
  ds_read_b64_tr_b16 a[138:139], v10 offset:10240
  ds_read_b64_tr_b16 a[140:141], v10 offset:12288
  ds_read_b64_tr_b16 a[142:143], v10 offset:14336
  ds_read_b64_tr_b16 a[144:145], v11 offset:0
  ds_read_b64_tr_b16 a[146:147], v11 offset:2048
  ds_read_b64_tr_b16 a[148:149], v11 offset:4096
  ds_read_b64_tr_b16 a[150:151], v11 offset:6144
  ds_read_b64_tr_b16 a[152:153], v11 offset:8192
  ds_read_b64_tr_b16 a[154:155], v11 offset:10240
  s_waitcnt lgkmcnt(6)
  v_mfma_f32_16x16x32_bf16 v[32:35], a[128:131], a[0:3], 0
  ds_read_b64_tr_b16 a[156:157], v11 offset:12288
  v_mfma_f32_16x16x32_bf16 v[32:35], a[132:135], a[16:19], v[32:35]
  s_mov_b32 s34, 16384
  ds_read_b64_tr_b16 a[158:159], v11 offset:14336
  v_mfma_f32_16x16x32_bf16 v[64:67], a[132:135], a[20:23], 0
  buffer_load_dwordx4 a[64:67], v2, s[16:19], s34 offen offset:0 sc1
  v_mfma_f32_16x16x32_bf16 v[64:67], a[128:131], a[4:7], v[64:67]
  v_mfma_f32_16x16x32_bf16 v[96:99], a[128:131], a[8:11], 0
  ds_read_b64_tr_b16 a[160:161], v12 offset:0
  v_mfma_f32_16x16x32_bf16 v[96:99], a[132:135], a[24:27], v[96:99]
  ds_read_b64_tr_b16 a[162:163], v12 offset:2048
  v_mfma_f32_16x16x32_bf16 v[128:131], a[132:135], a[28:31], 0
  buffer_load_dwordx4 a[68:71], v2, s[16:19], s34 offen offset:1024 sc1
  v_mfma_f32_16x16x32_bf16 v[128:131], a[128:131], a[12:15], v[128:131]
  buffer_load_dwordx4 a[72:75], v2, s[16:19], s34 offen offset:2048 sc1
  v_mfma_f32_16x16x32_bf16 v[48:51], a[136:139], a[0:3], 0
  ds_read_b64_tr_b16 a[164:165], v12 offset:4096
  v_mfma_f32_16x16x32_bf16 v[48:51], a[140:143], a[16:19], v[48:51]
  ds_read_b64_tr_b16 a[166:167], v12 offset:6144
  v_mfma_f32_16x16x32_bf16 v[80:83], a[140:143], a[20:23], 0
  buffer_load_dwordx4 a[76:79], v2, s[16:19], s34 offen offset:3072 sc1
  v_mfma_f32_16x16x32_bf16 v[80:83], a[136:139], a[4:7], v[80:83]
  v_mfma_f32_16x16x32_bf16 v[112:115], a[136:139], a[8:11], 0
  ds_read_b64_tr_b16 a[168:169], v12 offset:8192
  v_mfma_f32_16x16x32_bf16 v[112:115], a[140:143], a[24:27], v[112:115]
  s_mov_b32 s34, 20480
  ds_read_b64_tr_b16 a[170:171], v12 offset:10240
  v_mfma_f32_16x16x32_bf16 v[144:147], a[140:143], a[28:31], 0
  buffer_load_dwordx4 a[80:83], v2, s[16:19], s34 offen offset:0 sc1
  v_mfma_f32_16x16x32_bf16 v[144:147], a[136:139], a[12:15], v[144:147]
  s_waitcnt lgkmcnt(6)
  v_mfma_f32_16x16x32_bf16 v[36:39], a[144:147], a[0:3], 0
  ds_read_b64_tr_b16 a[172:173], v12 offset:12288
  v_mfma_f32_16x16x32_bf16 v[36:39], a[148:151], a[16:19], v[36:39]
  ds_read_b64_tr_b16 a[174:175], v12 offset:14336
  v_mfma_f32_16x16x32_bf16 v[68:71], a[148:151], a[20:23], 0
  buffer_load_dwordx4 a[84:87], v2, s[16:19], s34 offen offset:1024 sc1
  v_mfma_f32_16x16x32_bf16 v[68:71], a[144:147], a[4:7], v[68:71]
  buffer_load_dwordx4 a[88:91], v2, s[16:19], s34 offen offset:2048 sc1
  v_mfma_f32_16x16x32_bf16 v[100:103], a[144:147], a[8:11], 0
  ds_read_b64_tr_b16 a[176:177], v13 offset:0
  v_mfma_f32_16x16x32_bf16 v[100:103], a[148:151], a[24:27], v[100:103]
  ds_read_b64_tr_b16 a[178:179], v13 offset:2048
  v_mfma_f32_16x16x32_bf16 v[132:135], a[148:151], a[28:31], 0
  v_mfma_f32_16x16x32_bf16 v[132:135], a[144:147], a[12:15], v[132:135]
  buffer_load_dwordx4 a[92:95], v2, s[16:19], s34 offen offset:3072 sc1
  v_mfma_f32_16x16x32_bf16 v[52:55], a[152:155], a[0:3], 0
  ds_read_b64_tr_b16 a[180:181], v13 offset:4096
  v_mfma_f32_16x16x32_bf16 v[52:55], a[156:159], a[16:19], v[52:55]
  s_mov_b32 s34, 24576
  ds_read_b64_tr_b16 a[182:183], v13 offset:6144
  v_mfma_f32_16x16x32_bf16 v[84:87], a[156:159], a[20:23], 0
  buffer_load_dwordx4 a[96:99], v2, s[16:19], s34 offen offset:0 sc1
  v_mfma_f32_16x16x32_bf16 v[84:87], a[152:155], a[4:7], v[84:87]
  v_mfma_f32_16x16x32_bf16 v[116:119], a[152:155], a[8:11], 0
  ds_read_b64_tr_b16 a[184:185], v13 offset:8192
  v_mfma_f32_16x16x32_bf16 v[116:119], a[156:159], a[24:27], v[116:119]
  ds_read_b64_tr_b16 a[186:187], v13 offset:10240
  v_mfma_f32_16x16x32_bf16 v[148:151], a[156:159], a[28:31], 0
  buffer_load_dwordx4 a[100:103], v2, s[16:19], s34 offen offset:1024 sc1
  v_mfma_f32_16x16x32_bf16 v[148:151], a[152:155], a[12:15], v[148:151]
  s_waitcnt lgkmcnt(6)
  v_mfma_f32_16x16x32_bf16 v[40:43], a[160:163], a[0:3], 0
  ds_read_b64_tr_b16 a[188:189], v13 offset:12288
  v_mfma_f32_16x16x32_bf16 v[40:43], a[164:167], a[16:19], v[40:43]
  ds_read_b64_tr_b16 a[190:191], v13 offset:14336
  v_mfma_f32_16x16x32_bf16 v[72:75], a[164:167], a[20:23], 0
  buffer_load_dwordx4 a[104:107], v2, s[16:19], s34 offen offset:2048 sc1
  v_mfma_f32_16x16x32_bf16 v[72:75], a[160:163], a[4:7], v[72:75]
  s_waitcnt vmcnt(11)
  buffer_load_dwordx4 a[108:111], v2, s[16:19], s34 offen offset:3072 sc1
  v_mfma_f32_16x16x32_bf16 v[104:107], a[160:163], a[8:11], 0
  s_barrier
  ds_read_b64_tr_b16 a[128:129], v10 offset:16384
  v_mfma_f32_16x16x32_bf16 v[104:107], a[164:167], a[24:27], v[104:107]
  s_mov_b32 s34, 28672
  ds_read_b64_tr_b16 a[130:131], v10 offset:18432
  v_mfma_f32_16x16x32_bf16 v[136:139], a[164:167], a[28:31], 0
  buffer_load_dwordx4 a[112:115], v2, s[16:19], s34 offen offset:0 sc1
  v_mfma_f32_16x16x32_bf16 v[136:139], a[160:163], a[12:15], v[136:139]
  v_mfma_f32_16x16x32_bf16 v[56:59], a[168:171], a[0:3], 0
  ds_read_b64_tr_b16 a[132:133], v10 offset:20480
  v_mfma_f32_16x16x32_bf16 v[56:59], a[172:175], a[16:19], v[56:59]
  ds_read_b64_tr_b16 a[134:135], v10 offset:22528
  v_mfma_f32_16x16x32_bf16 v[88:91], a[172:175], a[20:23], 0
  buffer_load_dwordx4 a[116:119], v2, s[16:19], s34 offen offset:1024 sc1
  v_mfma_f32_16x16x32_bf16 v[88:91], a[168:171], a[4:7], v[88:91]
  v_mfma_f32_16x16x32_bf16 v[120:123], a[168:171], a[8:11], 0
  ds_read_b64_tr_b16 a[136:137], v10 offset:24576
  v_mfma_f32_16x16x32_bf16 v[120:123], a[172:175], a[24:27], v[120:123]
  ds_read_b64_tr_b16 a[138:139], v10 offset:26624
  v_mfma_f32_16x16x32_bf16 v[152:155], a[172:175], a[28:31], 0
  buffer_load_dwordx4 a[120:123], v2, s[16:19], s34 offen offset:2048 sc1
  v_mfma_f32_16x16x32_bf16 v[152:155], a[168:171], a[12:15], v[152:155]
  s_waitcnt lgkmcnt(6)
  v_mfma_f32_16x16x32_bf16 v[44:47], a[176:179], a[0:3], 0
  ds_read_b64_tr_b16 a[140:141], v10 offset:28672
  v_mfma_f32_16x16x32_bf16 v[44:47], a[180:183], a[16:19], v[44:47]
  ds_read_b64_tr_b16 a[142:143], v10 offset:30720
  v_mfma_f32_16x16x32_bf16 v[76:79], a[180:183], a[20:23], 0
  buffer_load_dwordx4 a[124:127], v2, s[16:19], s34 offen offset:3072 sc1
  v_mfma_f32_16x16x32_bf16 v[76:79], a[176:179], a[4:7], v[76:79]
  v_mfma_f32_16x16x32_bf16 v[108:111], a[176:179], a[8:11], 0
  s_mov_b32 s33, 663552
  ds_read_b64_tr_b16 a[144:145], v11 offset:16384
  v_mfma_f32_16x16x32_bf16 v[108:111], a[180:183], a[24:27], v[108:111]
  s_add_u32 m0, s29, 49152
  ds_read_b64_tr_b16 a[146:147], v11 offset:18432
  v_mfma_f32_16x16x32_bf16 v[140:143], a[180:183], a[28:31], 0
  buffer_load_dwordx4 v254, s[76:79], s33 offen lds
  v_mfma_f32_16x16x32_bf16 v[140:143], a[176:179], a[12:15], v[140:143]
  v_mfma_f32_16x16x32_bf16 v[60:63], a[184:187], a[0:3], 0
  s_mov_b32 s33, 663552
  ds_read_b64_tr_b16 a[148:149], v11 offset:20480
  v_mfma_f32_16x16x32_bf16 v[60:63], a[188:191], a[16:19], v[60:63]
  s_add_u32 m0, s29, 57344
  ds_read_b64_tr_b16 a[150:151], v11 offset:22528
  v_mfma_f32_16x16x32_bf16 v[92:95], a[188:191], a[20:23], 0
  buffer_load_dwordx4 v254, s[80:83], s33 offen lds
  v_mfma_f32_16x16x32_bf16 v[92:95], a[184:187], a[4:7], v[92:95]
  v_mfma_f32_16x16x32_bf16 v[124:127], a[184:187], a[8:11], 0
  s_mov_b32 s33, 774144
  ds_read_b64_tr_b16 a[152:153], v11 offset:24576
  v_mfma_f32_16x16x32_bf16 v[124:127], a[188:191], a[24:27], v[124:127]
  s_add_u32 m0, s29, 53248
  ds_read_b64_tr_b16 a[154:155], v11 offset:26624
  v_mfma_f32_16x16x32_bf16 v[156:159], a[188:191], a[28:31], 0
  buffer_load_dwordx4 v254, s[76:79], s33 offen lds
  v_mfma_f32_16x16x32_bf16 v[156:159], a[184:187], a[12:15], v[156:159]
  s_waitcnt lgkmcnt(6)
  s_add_u32 m0, s29, 61440
  s_mov_b32 s33, 774144
  buffer_load_dwordx4 v254, s[80:83], s33 offen lds
  v_mfma_f32_16x16x32_bf16 v[32:35], a[128:131], a[32:35], v[32:35]
  ds_read_b64_tr_b16 a[156:157], v11 offset:28672
  v_mfma_f32_16x16x32_bf16 v[32:35], a[132:135], a[48:51], v[32:35]
  s_mov_b32 s34, 32768
  ds_read_b64_tr_b16 a[158:159], v11 offset:30720
  v_mfma_f32_16x16x32_bf16 v[64:67], a[132:135], a[52:55], v[64:67]
  buffer_load_dwordx4 a[0:3], v2, s[16:19], s34 offen offset:0 sc1
  v_mfma_f32_16x16x32_bf16 v[64:67], a[128:131], a[36:39], v[64:67]
  v_mfma_f32_16x16x32_bf16 v[96:99], a[128:131], a[40:43], v[96:99]
  ds_read_b64_tr_b16 a[160:161], v12 offset:16384
  v_mfma_f32_16x16x32_bf16 v[96:99], a[132:135], a[56:59], v[96:99]
  ds_read_b64_tr_b16 a[162:163], v12 offset:18432
  v_mfma_f32_16x16x32_bf16 v[128:131], a[132:135], a[60:63], v[128:131]
  buffer_load_dwordx4 a[4:7], v2, s[16:19], s34 offen offset:1024 sc1
  v_mfma_f32_16x16x32_bf16 v[128:131], a[128:131], a[44:47], v[128:131]
  v_mfma_f32_16x16x32_bf16 v[48:51], a[136:139], a[32:35], v[48:51]
  ds_read_b64_tr_b16 a[164:165], v12 offset:20480
  v_mfma_f32_16x16x32_bf16 v[48:51], a[140:143], a[48:51], v[48:51]
  ds_read_b64_tr_b16 a[166:167], v12 offset:22528
  v_mfma_f32_16x16x32_bf16 v[80:83], a[140:143], a[52:55], v[80:83]
  v_mfma_f32_16x16x32_bf16 v[80:83], a[136:139], a[36:39], v[80:83]
  buffer_load_dwordx4 a[8:11], v2, s[16:19], s34 offen offset:2048 sc1
  v_mfma_f32_16x16x32_bf16 v[112:115], a[136:139], a[40:43], v[112:115]
  ds_read_b64_tr_b16 a[168:169], v12 offset:24576
  v_mfma_f32_16x16x32_bf16 v[112:115], a[140:143], a[56:59], v[112:115]
  ds_read_b64_tr_b16 a[170:171], v12 offset:26624
  v_mfma_f32_16x16x32_bf16 v[144:147], a[140:143], a[60:63], v[144:147]
  v_mfma_f32_16x16x32_bf16 v[144:147], a[136:139], a[44:47], v[144:147]
  s_waitcnt lgkmcnt(6)
  v_mfma_f32_16x16x32_bf16 v[36:39], a[144:147], a[32:35], v[36:39]
  ds_read_b64_tr_b16 a[172:173], v12 offset:28672
  v_mfma_f32_16x16x32_bf16 v[36:39], a[148:151], a[48:51], v[36:39]
  ds_read_b64_tr_b16 a[174:175], v12 offset:30720
  v_mfma_f32_16x16x32_bf16 v[68:71], a[148:151], a[52:55], v[68:71]
  buffer_load_dwordx4 a[12:15], v2, s[16:19], s34 offen offset:3072 sc1
  v_mfma_f32_16x16x32_bf16 v[68:71], a[144:147], a[36:39], v[68:71]
  v_mfma_f32_16x16x32_bf16 v[100:103], a[144:147], a[40:43], v[100:103]
  ds_read_b64_tr_b16 a[176:177], v13 offset:16384
  v_mfma_f32_16x16x32_bf16 v[100:103], a[148:151], a[56:59], v[100:103]
  s_mov_b32 s34, 36864
  ds_read_b64_tr_b16 a[178:179], v13 offset:18432
  v_mfma_f32_16x16x32_bf16 v[132:135], a[148:151], a[60:63], v[132:135]
  buffer_load_dwordx4 a[16:19], v2, s[16:19], s34 offen offset:0 sc1
  v_mfma_f32_16x16x32_bf16 v[132:135], a[144:147], a[44:47], v[132:135]
  v_mfma_f32_16x16x32_bf16 v[52:55], a[152:155], a[32:35], v[52:55]
  ds_read_b64_tr_b16 a[180:181], v13 offset:20480
  v_mfma_f32_16x16x32_bf16 v[52:55], a[156:159], a[48:51], v[52:55]
  ds_read_b64_tr_b16 a[182:183], v13 offset:22528
  v_mfma_f32_16x16x32_bf16 v[84:87], a[156:159], a[52:55], v[84:87]
  v_mfma_f32_16x16x32_bf16 v[84:87], a[152:155], a[36:39], v[84:87]
  buffer_load_dwordx4 a[20:23], v2, s[16:19], s34 offen offset:1024 sc1
  v_mfma_f32_16x16x32_bf16 v[116:119], a[152:155], a[40:43], v[116:119]
  ds_read_b64_tr_b16 a[184:185], v13 offset:24576
  v_mfma_f32_16x16x32_bf16 v[116:119], a[156:159], a[56:59], v[116:119]
  ds_read_b64_tr_b16 a[186:187], v13 offset:26624
  v_mfma_f32_16x16x32_bf16 v[148:151], a[156:159], a[60:63], v[148:151]
  v_mfma_f32_16x16x32_bf16 v[148:151], a[152:155], a[44:47], v[148:151]
  s_waitcnt lgkmcnt(6)
  v_mfma_f32_16x16x32_bf16 v[40:43], a[160:163], a[32:35], v[40:43]
  ds_read_b64_tr_b16 a[188:189], v13 offset:28672
  v_mfma_f32_16x16x32_bf16 v[40:43], a[164:167], a[48:51], v[40:43]
  ds_read_b64_tr_b16 a[190:191], v13 offset:30720
  v_mfma_f32_16x16x32_bf16 v[72:75], a[164:167], a[52:55], v[72:75]
  buffer_load_dwordx4 a[24:27], v2, s[16:19], s34 offen offset:2048 sc1
  v_mfma_f32_16x16x32_bf16 v[72:75], a[160:163], a[36:39], v[72:75]
  s_waitcnt vmcnt(19)
  v_mfma_f32_16x16x32_bf16 v[104:107], a[160:163], a[40:43], v[104:107]
  s_barrier
  ds_read_b64_tr_b16 a[128:129], v10 offset:32768
  v_mfma_f32_16x16x32_bf16 v[104:107], a[164:167], a[56:59], v[104:107]
  ds_read_b64_tr_b16 a[130:131], v10 offset:34816
  v_mfma_f32_16x16x32_bf16 v[136:139], a[164:167], a[60:63], v[136:139]
  buffer_load_dwordx4 a[28:31], v2, s[16:19], s34 offen offset:3072 sc1
  v_mfma_f32_16x16x32_bf16 v[136:139], a[160:163], a[44:47], v[136:139]
  v_mfma_f32_16x16x32_bf16 v[56:59], a[168:171], a[32:35], v[56:59]
  ds_read_b64_tr_b16 a[132:133], v10 offset:36864
  v_mfma_f32_16x16x32_bf16 v[56:59], a[172:175], a[48:51], v[56:59]
  s_mov_b32 s33, 884736
  ds_read_b64_tr_b16 a[134:135], v10 offset:38912
  v_mfma_f32_16x16x32_bf16 v[88:91], a[172:175], a[52:55], v[88:91]
  s_add_u32 m0, s29, 65536
  v_mfma_f32_16x16x32_bf16 v[88:91], a[168:171], a[36:39], v[88:91]
  buffer_load_dwordx4 v254, s[76:79], s33 offen lds
  v_mfma_f32_16x16x32_bf16 v[120:123], a[168:171], a[40:43], v[120:123]
  ds_read_b64_tr_b16 a[136:137], v10 offset:40960
  v_mfma_f32_16x16x32_bf16 v[120:123], a[172:175], a[56:59], v[120:123]
  ds_read_b64_tr_b16 a[138:139], v10 offset:43008
  v_mfma_f32_16x16x32_bf16 v[152:155], a[172:175], a[60:63], v[152:155]
  v_mfma_f32_16x16x32_bf16 v[152:155], a[168:171], a[44:47], v[152:155]
  s_waitcnt lgkmcnt(6)
  v_mfma_f32_16x16x32_bf16 v[44:47], a[176:179], a[32:35], v[44:47]
  s_mov_b32 s33, 884736
  ds_read_b64_tr_b16 a[140:141], v10 offset:45056
  v_mfma_f32_16x16x32_bf16 v[44:47], a[180:183], a[48:51], v[44:47]
  s_add_u32 m0, s29, 73728
  ds_read_b64_tr_b16 a[142:143], v10 offset:47104
  v_mfma_f32_16x16x32_bf16 v[76:79], a[180:183], a[52:55], v[76:79]
  buffer_load_dwordx4 v254, s[80:83], s33 offen lds
  v_mfma_f32_16x16x32_bf16 v[76:79], a[176:179], a[36:39], v[76:79]
  v_mfma_f32_16x16x32_bf16 v[108:111], a[176:179], a[40:43], v[108:111]
  s_mov_b32 s33, 995328
  ds_read_b64_tr_b16 a[144:145], v11 offset:32768
  v_mfma_f32_16x16x32_bf16 v[108:111], a[180:183], a[56:59], v[108:111]
  s_add_u32 m0, s29, 69632
  ds_read_b64_tr_b16 a[146:147], v11 offset:34816
  v_mfma_f32_16x16x32_bf16 v[140:143], a[180:183], a[60:63], v[140:143]
  buffer_load_dwordx4 v254, s[76:79], s33 offen lds
  v_mfma_f32_16x16x32_bf16 v[140:143], a[176:179], a[44:47], v[140:143]
  v_mfma_f32_16x16x32_bf16 v[60:63], a[184:187], a[32:35], v[60:63]
  s_mov_b32 s33, 995328
  ds_read_b64_tr_b16 a[148:149], v11 offset:36864
  v_mfma_f32_16x16x32_bf16 v[60:63], a[188:191], a[48:51], v[60:63]
  s_add_u32 m0, s29, 77824
  ds_read_b64_tr_b16 a[150:151], v11 offset:38912
  v_mfma_f32_16x16x32_bf16 v[92:95], a[188:191], a[52:55], v[92:95]
  buffer_load_dwordx4 v254, s[80:83], s33 offen lds
  v_mfma_f32_16x16x32_bf16 v[92:95], a[184:187], a[36:39], v[92:95]
  v_mfma_f32_16x16x32_bf16 v[124:127], a[184:187], a[40:43], v[124:127]
  ds_read_b64_tr_b16 a[152:153], v11 offset:40960
  v_mfma_f32_16x16x32_bf16 v[124:127], a[188:191], a[56:59], v[124:127]
  ds_read_b64_tr_b16 a[154:155], v11 offset:43008
  v_mfma_f32_16x16x32_bf16 v[156:159], a[188:191], a[60:63], v[156:159]
  v_mfma_f32_16x16x32_bf16 v[156:159], a[184:187], a[44:47], v[156:159]
  s_waitcnt lgkmcnt(6)
  v_mfma_f32_16x16x32_bf16 v[32:35], a[128:131], a[64:67], v[32:35]
  ds_read_b64_tr_b16 a[156:157], v11 offset:45056
  v_mfma_f32_16x16x32_bf16 v[32:35], a[132:135], a[80:83], v[32:35]
  s_mov_b32 s34, 40960
  ds_read_b64_tr_b16 a[158:159], v11 offset:47104
  v_mfma_f32_16x16x32_bf16 v[64:67], a[132:135], a[84:87], v[64:67]
  buffer_load_dwordx4 a[32:35], v2, s[16:19], s34 offen offset:0 sc1
  v_mfma_f32_16x16x32_bf16 v[64:67], a[128:131], a[68:71], v[64:67]
  v_mfma_f32_16x16x32_bf16 v[96:99], a[128:131], a[72:75], v[96:99]
  ds_read_b64_tr_b16 a[160:161], v12 offset:32768
  v_mfma_f32_16x16x32_bf16 v[96:99], a[132:135], a[88:91], v[96:99]
  ds_read_b64_tr_b16 a[162:163], v12 offset:34816
  v_mfma_f32_16x16x32_bf16 v[128:131], a[132:135], a[92:95], v[128:131]
  buffer_load_dwordx4 a[36:39], v2, s[16:19], s34 offen offset:1024 sc1
  v_mfma_f32_16x16x32_bf16 v[128:131], a[128:131], a[76:79], v[128:131]
  v_mfma_f32_16x16x32_bf16 v[48:51], a[136:139], a[64:67], v[48:51]
  ds_read_b64_tr_b16 a[164:165], v12 offset:36864
  v_mfma_f32_16x16x32_bf16 v[48:51], a[140:143], a[80:83], v[48:51]
  ds_read_b64_tr_b16 a[166:167], v12 offset:38912
  v_mfma_f32_16x16x32_bf16 v[80:83], a[140:143], a[84:87], v[80:83]
  v_mfma_f32_16x16x32_bf16 v[80:83], a[136:139], a[68:71], v[80:83]
  buffer_load_dwordx4 a[40:43], v2, s[16:19], s34 offen offset:2048 sc1
  v_mfma_f32_16x16x32_bf16 v[112:115], a[136:139], a[72:75], v[112:115]
  ds_read_b64_tr_b16 a[168:169], v12 offset:40960
  v_mfma_f32_16x16x32_bf16 v[112:115], a[140:143], a[88:91], v[112:115]
  ds_read_b64_tr_b16 a[170:171], v12 offset:43008
  v_mfma_f32_16x16x32_bf16 v[144:147], a[140:143], a[92:95], v[144:147]
  v_mfma_f32_16x16x32_bf16 v[144:147], a[136:139], a[76:79], v[144:147]
  s_waitcnt lgkmcnt(6)
  v_mfma_f32_16x16x32_bf16 v[36:39], a[144:147], a[64:67], v[36:39]
  ds_read_b64_tr_b16 a[172:173], v12 offset:45056
  v_mfma_f32_16x16x32_bf16 v[36:39], a[148:151], a[80:83], v[36:39]
  ds_read_b64_tr_b16 a[174:175], v12 offset:47104
  v_mfma_f32_16x16x32_bf16 v[68:71], a[148:151], a[84:87], v[68:71]
  buffer_load_dwordx4 a[44:47], v2, s[16:19], s34 offen offset:3072 sc1
  v_mfma_f32_16x16x32_bf16 v[68:71], a[144:147], a[68:71], v[68:71]
  v_mfma_f32_16x16x32_bf16 v[100:103], a[144:147], a[72:75], v[100:103]
  ds_read_b64_tr_b16 a[176:177], v13 offset:32768
  v_mfma_f32_16x16x32_bf16 v[100:103], a[148:151], a[88:91], v[100:103]
  s_mov_b32 s34, 45056
  ds_read_b64_tr_b16 a[178:179], v13 offset:34816
  v_mfma_f32_16x16x32_bf16 v[132:135], a[148:151], a[92:95], v[132:135]
  buffer_load_dwordx4 a[48:51], v2, s[16:19], s34 offen offset:0 sc1
  v_mfma_f32_16x16x32_bf16 v[132:135], a[144:147], a[76:79], v[132:135]
  v_mfma_f32_16x16x32_bf16 v[52:55], a[152:155], a[64:67], v[52:55]
  ds_read_b64_tr_b16 a[180:181], v13 offset:36864
  v_mfma_f32_16x16x32_bf16 v[52:55], a[156:159], a[80:83], v[52:55]
  ds_read_b64_tr_b16 a[182:183], v13 offset:38912
  v_mfma_f32_16x16x32_bf16 v[84:87], a[156:159], a[84:87], v[84:87]
  v_mfma_f32_16x16x32_bf16 v[84:87], a[152:155], a[68:71], v[84:87]
  buffer_load_dwordx4 a[52:55], v2, s[16:19], s34 offen offset:1024 sc1
  v_mfma_f32_16x16x32_bf16 v[116:119], a[152:155], a[72:75], v[116:119]
  ds_read_b64_tr_b16 a[184:185], v13 offset:40960
  v_mfma_f32_16x16x32_bf16 v[116:119], a[156:159], a[88:91], v[116:119]
  ds_read_b64_tr_b16 a[186:187], v13 offset:43008
  v_mfma_f32_16x16x32_bf16 v[148:151], a[156:159], a[92:95], v[148:151]
  v_mfma_f32_16x16x32_bf16 v[148:151], a[152:155], a[76:79], v[148:151]
  s_waitcnt lgkmcnt(6)
  v_mfma_f32_16x16x32_bf16 v[40:43], a[160:163], a[64:67], v[40:43]
  ds_read_b64_tr_b16 a[188:189], v13 offset:45056
  v_mfma_f32_16x16x32_bf16 v[40:43], a[164:167], a[80:83], v[40:43]
  ds_read_b64_tr_b16 a[190:191], v13 offset:47104
  v_mfma_f32_16x16x32_bf16 v[72:75], a[164:167], a[84:87], v[72:75]
  buffer_load_dwordx4 a[56:59], v2, s[16:19], s34 offen offset:2048 sc1
  v_mfma_f32_16x16x32_bf16 v[72:75], a[160:163], a[68:71], v[72:75]
  s_waitcnt vmcnt(19)
  v_mfma_f32_16x16x32_bf16 v[104:107], a[160:163], a[72:75], v[104:107]
  s_barrier
  ds_read_b64_tr_b16 a[128:129], v10 offset:49152
  v_mfma_f32_16x16x32_bf16 v[104:107], a[164:167], a[88:91], v[104:107]
  ds_read_b64_tr_b16 a[130:131], v10 offset:51200
  v_mfma_f32_16x16x32_bf16 v[136:139], a[164:167], a[92:95], v[136:139]
  buffer_load_dwordx4 a[60:63], v2, s[16:19], s34 offen offset:3072 sc1
  v_mfma_f32_16x16x32_bf16 v[136:139], a[160:163], a[76:79], v[136:139]
  v_mfma_f32_16x16x32_bf16 v[56:59], a[168:171], a[64:67], v[56:59]
  ds_read_b64_tr_b16 a[132:133], v10 offset:53248
  v_mfma_f32_16x16x32_bf16 v[56:59], a[172:175], a[80:83], v[56:59]
  s_mov_b32 s33, 1105920
  ds_read_b64_tr_b16 a[134:135], v10 offset:55296
  v_mfma_f32_16x16x32_bf16 v[88:91], a[172:175], a[84:87], v[88:91]
  s_add_u32 m0, s29, 81920
  v_mfma_f32_16x16x32_bf16 v[88:91], a[168:171], a[68:71], v[88:91]
  buffer_load_dwordx4 v254, s[76:79], s33 offen lds
  v_mfma_f32_16x16x32_bf16 v[120:123], a[168:171], a[72:75], v[120:123]
  ds_read_b64_tr_b16 a[136:137], v10 offset:57344
  v_mfma_f32_16x16x32_bf16 v[120:123], a[172:175], a[88:91], v[120:123]
  ds_read_b64_tr_b16 a[138:139], v10 offset:59392
  v_mfma_f32_16x16x32_bf16 v[152:155], a[172:175], a[92:95], v[152:155]
  v_mfma_f32_16x16x32_bf16 v[152:155], a[168:171], a[76:79], v[152:155]
  s_waitcnt lgkmcnt(6)
  v_mfma_f32_16x16x32_bf16 v[44:47], a[176:179], a[64:67], v[44:47]
  s_mov_b32 s33, 1105920
  ds_read_b64_tr_b16 a[140:141], v10 offset:61440
  v_mfma_f32_16x16x32_bf16 v[44:47], a[180:183], a[80:83], v[44:47]
  s_add_u32 m0, s29, 90112
  ds_read_b64_tr_b16 a[142:143], v10 offset:63488
  v_mfma_f32_16x16x32_bf16 v[76:79], a[180:183], a[84:87], v[76:79]
  buffer_load_dwordx4 v254, s[80:83], s33 offen lds
  v_mfma_f32_16x16x32_bf16 v[76:79], a[176:179], a[68:71], v[76:79]
  v_mfma_f32_16x16x32_bf16 v[108:111], a[176:179], a[72:75], v[108:111]
  s_mov_b32 s33, 1216512
  ds_read_b64_tr_b16 a[144:145], v11 offset:49152
  v_mfma_f32_16x16x32_bf16 v[108:111], a[180:183], a[88:91], v[108:111]
  s_add_u32 m0, s29, 86016
  ds_read_b64_tr_b16 a[146:147], v11 offset:51200
  v_mfma_f32_16x16x32_bf16 v[140:143], a[180:183], a[92:95], v[140:143]
  buffer_load_dwordx4 v254, s[76:79], s33 offen lds
  v_mfma_f32_16x16x32_bf16 v[140:143], a[176:179], a[76:79], v[140:143]
  v_mfma_f32_16x16x32_bf16 v[60:63], a[184:187], a[64:67], v[60:63]
  s_mov_b32 s33, 1216512
  ds_read_b64_tr_b16 a[148:149], v11 offset:53248
  v_mfma_f32_16x16x32_bf16 v[60:63], a[188:191], a[80:83], v[60:63]
  s_add_u32 m0, s29, 94208
  ds_read_b64_tr_b16 a[150:151], v11 offset:55296
  v_mfma_f32_16x16x32_bf16 v[92:95], a[188:191], a[84:87], v[92:95]
  buffer_load_dwordx4 v254, s[80:83], s33 offen lds
  v_mfma_f32_16x16x32_bf16 v[92:95], a[184:187], a[68:71], v[92:95]
  v_mfma_f32_16x16x32_bf16 v[124:127], a[184:187], a[72:75], v[124:127]
  ds_read_b64_tr_b16 a[152:153], v11 offset:57344
  v_mfma_f32_16x16x32_bf16 v[124:127], a[188:191], a[88:91], v[124:127]
  ds_read_b64_tr_b16 a[154:155], v11 offset:59392
  v_mfma_f32_16x16x32_bf16 v[156:159], a[188:191], a[92:95], v[156:159]
  v_mfma_f32_16x16x32_bf16 v[156:159], a[184:187], a[76:79], v[156:159]
  s_waitcnt lgkmcnt(6)
  v_mfma_f32_16x16x32_bf16 v[32:35], a[128:131], a[96:99], v[32:35]
  ds_read_b64_tr_b16 a[156:157], v11 offset:61440
  v_mfma_f32_16x16x32_bf16 v[32:35], a[132:135], a[112:115], v[32:35]
  s_mov_b32 s34, 49152
  ds_read_b64_tr_b16 a[158:159], v11 offset:63488
  v_mfma_f32_16x16x32_bf16 v[64:67], a[132:135], a[116:119], v[64:67]
  buffer_load_dwordx4 a[64:67], v2, s[16:19], s34 offen offset:0 sc1
  v_mfma_f32_16x16x32_bf16 v[64:67], a[128:131], a[100:103], v[64:67]
  v_mfma_f32_16x16x32_bf16 v[96:99], a[128:131], a[104:107], v[96:99]
  ds_read_b64_tr_b16 a[160:161], v12 offset:49152
  v_mfma_f32_16x16x32_bf16 v[96:99], a[132:135], a[120:123], v[96:99]
  ds_read_b64_tr_b16 a[162:163], v12 offset:51200
  v_mfma_f32_16x16x32_bf16 v[128:131], a[132:135], a[124:127], v[128:131]
  buffer_load_dwordx4 a[68:71], v2, s[16:19], s34 offen offset:1024 sc1
  v_mfma_f32_16x16x32_bf16 v[128:131], a[128:131], a[108:111], v[128:131]
  v_mfma_f32_16x16x32_bf16 v[48:51], a[136:139], a[96:99], v[48:51]
  ds_read_b64_tr_b16 a[164:165], v12 offset:53248
  v_mfma_f32_16x16x32_bf16 v[48:51], a[140:143], a[112:115], v[48:51]
  ds_read_b64_tr_b16 a[166:167], v12 offset:55296
  v_mfma_f32_16x16x32_bf16 v[80:83], a[140:143], a[116:119], v[80:83]
  buffer_load_dwordx4 a[72:75], v2, s[16:19], s34 offen offset:2048 sc1
  v_mfma_f32_16x16x32_bf16 v[80:83], a[136:139], a[100:103], v[80:83]
  v_mfma_f32_16x16x32_bf16 v[112:115], a[136:139], a[104:107], v[112:115]
  ds_read_b64_tr_b16 a[168:169], v12 offset:57344
  v_mfma_f32_16x16x32_bf16 v[112:115], a[140:143], a[120:123], v[112:115]
  ds_read_b64_tr_b16 a[170:171], v12 offset:59392
  v_mfma_f32_16x16x32_bf16 v[144:147], a[140:143], a[124:127], v[144:147]
  buffer_load_dwordx4 a[76:79], v2, s[16:19], s34 offen offset:3072 sc1
  v_mfma_f32_16x16x32_bf16 v[144:147], a[136:139], a[108:111], v[144:147]
  s_waitcnt lgkmcnt(6)
  v_mfma_f32_16x16x32_bf16 v[36:39], a[144:147], a[96:99], v[36:39]
  ds_read_b64_tr_b16 a[172:173], v12 offset:61440
  v_mfma_f32_16x16x32_bf16 v[36:39], a[148:151], a[112:115], v[36:39]
  s_mov_b32 s34, 53248
  ds_read_b64_tr_b16 a[174:175], v12 offset:63488
  v_mfma_f32_16x16x32_bf16 v[68:71], a[148:151], a[116:119], v[68:71]
  buffer_load_dwordx4 a[80:83], v2, s[16:19], s34 offen offset:0 sc1
  v_mfma_f32_16x16x32_bf16 v[68:71], a[144:147], a[100:103], v[68:71]
  buffer_load_dwordx4 a[84:87], v2, s[16:19], s34 offen offset:1024 sc1
  v_mfma_f32_16x16x32_bf16 v[100:103], a[144:147], a[104:107], v[100:103]
  ds_read_b64_tr_b16 a[176:177], v13 offset:49152
  v_mfma_f32_16x16x32_bf16 v[100:103], a[148:151], a[120:123], v[100:103]
  ds_read_b64_tr_b16 a[178:179], v13 offset:51200
  v_mfma_f32_16x16x32_bf16 v[132:135], a[148:151], a[124:127], v[132:135]
  v_mfma_f32_16x16x32_bf16 v[132:135], a[144:147], a[108:111], v[132:135]
  buffer_load_dwordx4 a[88:91], v2, s[16:19], s34 offen offset:2048 sc1
  v_mfma_f32_16x16x32_bf16 v[52:55], a[152:155], a[96:99], v[52:55]
  ds_read_b64_tr_b16 a[180:181], v13 offset:53248
  v_mfma_f32_16x16x32_bf16 v[52:55], a[156:159], a[112:115], v[52:55]
  ds_read_b64_tr_b16 a[182:183], v13 offset:55296
  v_mfma_f32_16x16x32_bf16 v[84:87], a[156:159], a[116:119], v[84:87]
  buffer_load_dwordx4 a[92:95], v2, s[16:19], s34 offen offset:3072 sc1
  v_mfma_f32_16x16x32_bf16 v[84:87], a[152:155], a[100:103], v[84:87]
  v_mfma_f32_16x16x32_bf16 v[116:119], a[152:155], a[104:107], v[116:119]
  s_mov_b32 s33, 1327104
  ds_read_b64_tr_b16 a[184:185], v13 offset:57344
  v_mfma_f32_16x16x32_bf16 v[116:119], a[156:159], a[120:123], v[116:119]
  s_add_u32 m0, s29, 98304
  ds_read_b64_tr_b16 a[186:187], v13 offset:59392
  v_mfma_f32_16x16x32_bf16 v[148:151], a[156:159], a[124:127], v[148:151]
  buffer_load_dwordx4 v254, s[76:79], s33 offen lds
  v_mfma_f32_16x16x32_bf16 v[148:151], a[152:155], a[108:111], v[148:151]
  s_waitcnt lgkmcnt(6)
  v_mfma_f32_16x16x32_bf16 v[40:43], a[160:163], a[96:99], v[40:43]
  s_mov_b32 s33, 1327104
  ds_read_b64_tr_b16 a[188:189], v13 offset:61440
  v_mfma_f32_16x16x32_bf16 v[40:43], a[164:167], a[112:115], v[40:43]
  s_add_u32 m0, s29, 106496
  ds_read_b64_tr_b16 a[190:191], v13 offset:63488
  v_mfma_f32_16x16x32_bf16 v[72:75], a[164:167], a[116:119], v[72:75]
  buffer_load_dwordx4 v254, s[80:83], s33 offen lds
  v_mfma_f32_16x16x32_bf16 v[72:75], a[160:163], a[100:103], v[72:75]
  s_waitcnt vmcnt(22)
  v_mfma_f32_16x16x32_bf16 v[104:107], a[160:163], a[104:107], v[104:107]
  s_barrier
  ds_read_b64_tr_b16 a[128:129], v14 offset:0
  v_mfma_f32_16x16x32_bf16 v[104:107], a[164:167], a[120:123], v[104:107]
  s_add_u32 m0, s29, 102400
  s_mov_b32 s33, 1437696
  ds_read_b64_tr_b16 a[130:131], v14 offset:2048
  v_mfma_f32_16x16x32_bf16 v[136:139], a[164:167], a[124:127], v[136:139]
  buffer_load_dwordx4 v254, s[76:79], s33 offen lds
  v_mfma_f32_16x16x32_bf16 v[136:139], a[160:163], a[108:111], v[136:139]
  v_mfma_f32_16x16x32_bf16 v[56:59], a[168:171], a[96:99], v[56:59]
  s_mov_b32 s33, 1437696
  ds_read_b64_tr_b16 a[132:133], v14 offset:4096
  v_mfma_f32_16x16x32_bf16 v[56:59], a[172:175], a[112:115], v[56:59]
  s_add_u32 m0, s29, 110592
  ds_read_b64_tr_b16 a[134:135], v14 offset:6144
  v_mfma_f32_16x16x32_bf16 v[88:91], a[172:175], a[116:119], v[88:91]
  buffer_load_dwordx4 v254, s[80:83], s33 offen lds
  v_mfma_f32_16x16x32_bf16 v[88:91], a[168:171], a[100:103], v[88:91]
  v_mfma_f32_16x16x32_bf16 v[120:123], a[168:171], a[104:107], v[120:123]
  s_mov_b32 s33, 0
  ds_read_b64_tr_b16 a[136:137], v14 offset:8192
  v_mfma_f32_16x16x32_bf16 v[120:123], a[172:175], a[120:123], v[120:123]
  s_add_u32 m0, s29, 0
  ds_read_b64_tr_b16 a[138:139], v14 offset:10240
  v_mfma_f32_16x16x32_bf16 v[152:155], a[172:175], a[124:127], v[152:155]
  buffer_load_dwordx4 v245, s[56:59], s33 offen sc1 lds
  v_mfma_f32_16x16x32_bf16 v[152:155], a[168:171], a[108:111], v[152:155]
  s_waitcnt lgkmcnt(6)
  v_mfma_f32_16x16x32_bf16 v[44:47], a[176:179], a[96:99], v[44:47]
  ds_read_b64_tr_b16 a[140:141], v14 offset:12288
  v_mfma_f32_16x16x32_bf16 v[44:47], a[180:183], a[112:115], v[44:47]
  s_add_u32 m0, s29, 4096
  ds_read_b64_tr_b16 a[142:143], v14 offset:14336
  v_mfma_f32_16x16x32_bf16 v[76:79], a[180:183], a[116:119], v[76:79]
  buffer_load_dwordx4 v246, s[56:59], s33 offen sc1 lds
  v_mfma_f32_16x16x32_bf16 v[76:79], a[176:179], a[100:103], v[76:79]
  v_mfma_f32_16x16x32_bf16 v[108:111], a[176:179], a[104:107], v[108:111]
  ds_read_b64_tr_b16 a[144:145], v15 offset:0
  v_mfma_f32_16x16x32_bf16 v[108:111], a[180:183], a[120:123], v[108:111]
  s_add_u32 m0, s29, 8192
  ds_read_b64_tr_b16 a[146:147], v15 offset:2048
  v_mfma_f32_16x16x32_bf16 v[140:143], a[180:183], a[124:127], v[140:143]
  buffer_load_dwordx4 v247, s[56:59], s33 offen sc1 lds
  v_mfma_f32_16x16x32_bf16 v[140:143], a[176:179], a[108:111], v[140:143]
  v_mfma_f32_16x16x32_bf16 v[60:63], a[184:187], a[96:99], v[60:63]
  ds_read_b64_tr_b16 a[148:149], v15 offset:4096
  v_mfma_f32_16x16x32_bf16 v[60:63], a[188:191], a[112:115], v[60:63]
  s_add_u32 m0, s29, 12288
  ds_read_b64_tr_b16 a[150:151], v15 offset:6144
  v_mfma_f32_16x16x32_bf16 v[92:95], a[188:191], a[116:119], v[92:95]
  buffer_load_dwordx4 v248, s[56:59], s33 offen sc1 lds
  v_mfma_f32_16x16x32_bf16 v[92:95], a[184:187], a[100:103], v[92:95]
  v_mfma_f32_16x16x32_bf16 v[124:127], a[184:187], a[104:107], v[124:127]
  ds_read_b64_tr_b16 a[152:153], v15 offset:8192
  v_mfma_f32_16x16x32_bf16 v[124:127], a[188:191], a[120:123], v[124:127]
  s_add_u32 m0, s29, 16384
  ds_read_b64_tr_b16 a[154:155], v15 offset:10240
  v_mfma_f32_16x16x32_bf16 v[156:159], a[188:191], a[124:127], v[156:159]
  buffer_load_dwordx4 v249, s[56:59], s33 offen sc1 lds
  v_mfma_f32_16x16x32_bf16 v[156:159], a[184:187], a[108:111], v[156:159]
  s_waitcnt lgkmcnt(6)
  v_mfma_f32_16x16x32_bf16 v[32:35], a[128:131], a[0:3], v[32:35]
  ds_read_b64_tr_b16 a[156:157], v15 offset:12288
  v_mfma_f32_16x16x32_bf16 v[32:35], a[132:135], a[16:19], v[32:35]
  s_mov_b32 s34, 57344
  ds_read_b64_tr_b16 a[158:159], v15 offset:14336
  v_mfma_f32_16x16x32_bf16 v[64:67], a[132:135], a[20:23], v[64:67]
  buffer_load_dwordx4 a[96:99], v2, s[16:19], s34 offen offset:0 sc1
  v_mfma_f32_16x16x32_bf16 v[64:67], a[128:131], a[4:7], v[64:67]
  v_mfma_f32_16x16x32_bf16 v[96:99], a[128:131], a[8:11], v[96:99]
  ds_read_b64_tr_b16 a[160:161], v16 offset:0
  v_mfma_f32_16x16x32_bf16 v[96:99], a[132:135], a[24:27], v[96:99]
  ds_read_b64_tr_b16 a[162:163], v16 offset:2048
  v_mfma_f32_16x16x32_bf16 v[128:131], a[132:135], a[28:31], v[128:131]
  buffer_load_dwordx4 a[100:103], v2, s[16:19], s34 offen offset:1024 sc1
  v_mfma_f32_16x16x32_bf16 v[128:131], a[128:131], a[12:15], v[128:131]
  v_mfma_f32_16x16x32_bf16 v[48:51], a[136:139], a[0:3], v[48:51]
  ds_read_b64_tr_b16 a[164:165], v16 offset:4096
  v_mfma_f32_16x16x32_bf16 v[48:51], a[140:143], a[16:19], v[48:51]
  ds_read_b64_tr_b16 a[166:167], v16 offset:6144
  v_mfma_f32_16x16x32_bf16 v[80:83], a[140:143], a[20:23], v[80:83]
  buffer_load_dwordx4 a[104:107], v2, s[16:19], s34 offen offset:2048 sc1
  v_mfma_f32_16x16x32_bf16 v[80:83], a[136:139], a[4:7], v[80:83]
  v_mfma_f32_16x16x32_bf16 v[112:115], a[136:139], a[8:11], v[112:115]
  ds_read_b64_tr_b16 a[168:169], v16 offset:8192
  v_mfma_f32_16x16x32_bf16 v[112:115], a[140:143], a[24:27], v[112:115]
  ds_read_b64_tr_b16 a[170:171], v16 offset:10240
  v_mfma_f32_16x16x32_bf16 v[144:147], a[140:143], a[28:31], v[144:147]
  buffer_load_dwordx4 a[108:111], v2, s[16:19], s34 offen offset:3072 sc1
  v_mfma_f32_16x16x32_bf16 v[144:147], a[136:139], a[12:15], v[144:147]
  s_waitcnt lgkmcnt(6)
  v_mfma_f32_16x16x32_bf16 v[36:39], a[144:147], a[0:3], v[36:39]
  ds_read_b64_tr_b16 a[172:173], v16 offset:12288
  v_mfma_f32_16x16x32_bf16 v[36:39], a[148:151], a[16:19], v[36:39]
  s_mov_b32 s34, 61440
  ds_read_b64_tr_b16 a[174:175], v16 offset:14336
  v_mfma_f32_16x16x32_bf16 v[68:71], a[148:151], a[20:23], v[68:71]
  buffer_load_dwordx4 a[112:115], v2, s[16:19], s34 offen offset:0 sc1
  v_mfma_f32_16x16x32_bf16 v[68:71], a[144:147], a[4:7], v[68:71]
  buffer_load_dwordx4 a[116:119], v2, s[16:19], s34 offen offset:1024 sc1
  v_mfma_f32_16x16x32_bf16 v[100:103], a[144:147], a[8:11], v[100:103]
  ds_read_b64_tr_b16 a[176:177], v17 offset:0
  v_mfma_f32_16x16x32_bf16 v[100:103], a[148:151], a[24:27], v[100:103]
  ds_read_b64_tr_b16 a[178:179], v17 offset:2048
  v_mfma_f32_16x16x32_bf16 v[132:135], a[148:151], a[28:31], v[132:135]
  v_mfma_f32_16x16x32_bf16 v[132:135], a[144:147], a[12:15], v[132:135]
  buffer_load_dwordx4 a[120:123], v2, s[16:19], s34 offen offset:2048 sc1
  v_mfma_f32_16x16x32_bf16 v[52:55], a[152:155], a[0:3], v[52:55]
  ds_read_b64_tr_b16 a[180:181], v17 offset:4096
  v_mfma_f32_16x16x32_bf16 v[52:55], a[156:159], a[16:19], v[52:55]
  ds_read_b64_tr_b16 a[182:183], v17 offset:6144
  v_mfma_f32_16x16x32_bf16 v[84:87], a[156:159], a[20:23], v[84:87]
  buffer_load_dwordx4 a[124:127], v2, s[16:19], s34 offen offset:3072 sc1
  v_mfma_f32_16x16x32_bf16 v[84:87], a[152:155], a[4:7], v[84:87]
  v_mfma_f32_16x16x32_bf16 v[116:119], a[152:155], a[8:11], v[116:119]
  s_mov_b32 s33, 1548288
  ds_read_b64_tr_b16 a[184:185], v17 offset:8192
  v_mfma_f32_16x16x32_bf16 v[116:119], a[156:159], a[24:27], v[116:119]
  s_add_u32 m0, s29, 114688
  ds_read_b64_tr_b16 a[186:187], v17 offset:10240
  v_mfma_f32_16x16x32_bf16 v[148:151], a[156:159], a[28:31], v[148:151]
  buffer_load_dwordx4 v254, s[76:79], s33 offen lds
  v_mfma_f32_16x16x32_bf16 v[148:151], a[152:155], a[12:15], v[148:151]
  s_waitcnt lgkmcnt(6)
  v_mfma_f32_16x16x32_bf16 v[40:43], a[160:163], a[0:3], v[40:43]
  s_mov_b32 s33, 1548288
  ds_read_b64_tr_b16 a[188:189], v17 offset:12288
  v_mfma_f32_16x16x32_bf16 v[40:43], a[164:167], a[16:19], v[40:43]
  s_add_u32 m0, s29, 122880
  ds_read_b64_tr_b16 a[190:191], v17 offset:14336
  v_mfma_f32_16x16x32_bf16 v[72:75], a[164:167], a[20:23], v[72:75]
  buffer_load_dwordx4 v254, s[80:83], s33 offen lds
  v_mfma_f32_16x16x32_bf16 v[72:75], a[160:163], a[4:7], v[72:75]
  s_waitcnt vmcnt(27)
  v_mfma_f32_16x16x32_bf16 v[104:107], a[160:163], a[8:11], v[104:107]
  s_barrier
  ds_read_b64_tr_b16 a[128:129], v14 offset:16384
  v_mfma_f32_16x16x32_bf16 v[104:107], a[164:167], a[24:27], v[104:107]
  s_add_u32 m0, s29, 118784
  s_mov_b32 s33, 1658880
  ds_read_b64_tr_b16 a[130:131], v14 offset:18432
  v_mfma_f32_16x16x32_bf16 v[136:139], a[164:167], a[28:31], v[136:139]
  buffer_load_dwordx4 v254, s[76:79], s33 offen lds
  v_mfma_f32_16x16x32_bf16 v[136:139], a[160:163], a[12:15], v[136:139]
  v_mfma_f32_16x16x32_bf16 v[56:59], a[168:171], a[0:3], v[56:59]
  s_mov_b32 s33, 1658880
  ds_read_b64_tr_b16 a[132:133], v14 offset:20480
  v_mfma_f32_16x16x32_bf16 v[56:59], a[172:175], a[16:19], v[56:59]
  s_add_u32 m0, s29, 126976
  ds_read_b64_tr_b16 a[134:135], v14 offset:22528
  v_mfma_f32_16x16x32_bf16 v[88:91], a[172:175], a[20:23], v[88:91]
  buffer_load_dwordx4 v254, s[80:83], s33 offen lds
  v_mfma_f32_16x16x32_bf16 v[88:91], a[168:171], a[4:7], v[88:91]
  v_mfma_f32_16x16x32_bf16 v[120:123], a[168:171], a[8:11], v[120:123]
  s_mov_b32 s33, 163840
  ds_read_b64_tr_b16 a[136:137], v14 offset:24576
  v_mfma_f32_16x16x32_bf16 v[120:123], a[172:175], a[24:27], v[120:123]
  s_add_u32 m0, s29, 20480
  ds_read_b64_tr_b16 a[138:139], v14 offset:26624
  v_mfma_f32_16x16x32_bf16 v[152:155], a[172:175], a[28:31], v[152:155]
  buffer_load_dwordx4 v245, s[56:59], s33 offen sc1 lds
  v_mfma_f32_16x16x32_bf16 v[152:155], a[168:171], a[12:15], v[152:155]
  s_waitcnt lgkmcnt(6)
  v_mfma_f32_16x16x32_bf16 v[44:47], a[176:179], a[0:3], v[44:47]
  ds_read_b64_tr_b16 a[140:141], v14 offset:28672
  v_mfma_f32_16x16x32_bf16 v[44:47], a[180:183], a[16:19], v[44:47]
  s_add_u32 m0, s29, 24576
  ds_read_b64_tr_b16 a[142:143], v14 offset:30720
  v_mfma_f32_16x16x32_bf16 v[76:79], a[180:183], a[20:23], v[76:79]
  buffer_load_dwordx4 v246, s[56:59], s33 offen sc1 lds
  v_mfma_f32_16x16x32_bf16 v[76:79], a[176:179], a[4:7], v[76:79]
  v_mfma_f32_16x16x32_bf16 v[108:111], a[176:179], a[8:11], v[108:111]
  ds_read_b64_tr_b16 a[144:145], v15 offset:16384
  v_mfma_f32_16x16x32_bf16 v[108:111], a[180:183], a[24:27], v[108:111]
  s_add_u32 m0, s29, 28672
  ds_read_b64_tr_b16 a[146:147], v15 offset:18432
  v_mfma_f32_16x16x32_bf16 v[140:143], a[180:183], a[28:31], v[140:143]
  buffer_load_dwordx4 v247, s[56:59], s33 offen sc1 lds
  v_mfma_f32_16x16x32_bf16 v[140:143], a[176:179], a[12:15], v[140:143]
  v_mfma_f32_16x16x32_bf16 v[60:63], a[184:187], a[0:3], v[60:63]
  ds_read_b64_tr_b16 a[148:149], v15 offset:20480
  v_mfma_f32_16x16x32_bf16 v[60:63], a[188:191], a[16:19], v[60:63]
  s_add_u32 m0, s29, 32768
  ds_read_b64_tr_b16 a[150:151], v15 offset:22528
  v_mfma_f32_16x16x32_bf16 v[92:95], a[188:191], a[20:23], v[92:95]
  buffer_load_dwordx4 v248, s[56:59], s33 offen sc1 lds
  v_mfma_f32_16x16x32_bf16 v[92:95], a[184:187], a[4:7], v[92:95]
  v_mfma_f32_16x16x32_bf16 v[124:127], a[184:187], a[8:11], v[124:127]
  ds_read_b64_tr_b16 a[152:153], v15 offset:24576
  v_mfma_f32_16x16x32_bf16 v[124:127], a[188:191], a[24:27], v[124:127]
  s_add_u32 m0, s29, 36864
  ds_read_b64_tr_b16 a[154:155], v15 offset:26624
  v_mfma_f32_16x16x32_bf16 v[156:159], a[188:191], a[28:31], v[156:159]
  buffer_load_dwordx4 v249, s[56:59], s33 offen sc1 lds
  v_mfma_f32_16x16x32_bf16 v[156:159], a[184:187], a[12:15], v[156:159]
  s_waitcnt lgkmcnt(6)
  v_mfma_f32_16x16x32_bf16 v[32:35], a[128:131], a[32:35], v[32:35]
  ds_read_b64_tr_b16 a[156:157], v15 offset:28672
  v_mfma_f32_16x16x32_bf16 v[32:35], a[132:135], a[48:51], v[32:35]
  s_mov_b32 s34, 65536
  ds_read_b64_tr_b16 a[158:159], v15 offset:30720
  v_mfma_f32_16x16x32_bf16 v[64:67], a[132:135], a[52:55], v[64:67]
  buffer_load_dwordx4 a[0:3], v2, s[16:19], s34 offen offset:0 sc1
  v_mfma_f32_16x16x32_bf16 v[64:67], a[128:131], a[36:39], v[64:67]
  v_mfma_f32_16x16x32_bf16 v[96:99], a[128:131], a[40:43], v[96:99]
  ds_read_b64_tr_b16 a[160:161], v16 offset:16384
  v_mfma_f32_16x16x32_bf16 v[96:99], a[132:135], a[56:59], v[96:99]
  ds_read_b64_tr_b16 a[162:163], v16 offset:18432
  v_mfma_f32_16x16x32_bf16 v[128:131], a[132:135], a[60:63], v[128:131]
  buffer_load_dwordx4 a[4:7], v2, s[16:19], s34 offen offset:1024 sc1
  v_mfma_f32_16x16x32_bf16 v[128:131], a[128:131], a[44:47], v[128:131]
  v_mfma_f32_16x16x32_bf16 v[48:51], a[136:139], a[32:35], v[48:51]
  ds_read_b64_tr_b16 a[164:165], v16 offset:20480
  v_mfma_f32_16x16x32_bf16 v[48:51], a[140:143], a[48:51], v[48:51]
  ds_read_b64_tr_b16 a[166:167], v16 offset:22528
  v_mfma_f32_16x16x32_bf16 v[80:83], a[140:143], a[52:55], v[80:83]
  buffer_load_dwordx4 a[8:11], v2, s[16:19], s34 offen offset:2048 sc1
  v_mfma_f32_16x16x32_bf16 v[80:83], a[136:139], a[36:39], v[80:83]
  v_mfma_f32_16x16x32_bf16 v[112:115], a[136:139], a[40:43], v[112:115]
  ds_read_b64_tr_b16 a[168:169], v16 offset:24576
  v_mfma_f32_16x16x32_bf16 v[112:115], a[140:143], a[56:59], v[112:115]
  ds_read_b64_tr_b16 a[170:171], v16 offset:26624
  v_mfma_f32_16x16x32_bf16 v[144:147], a[140:143], a[60:63], v[144:147]
  buffer_load_dwordx4 a[12:15], v2, s[16:19], s34 offen offset:3072 sc1
  v_mfma_f32_16x16x32_bf16 v[144:147], a[136:139], a[44:47], v[144:147]
  s_waitcnt lgkmcnt(6)
  v_mfma_f32_16x16x32_bf16 v[36:39], a[144:147], a[32:35], v[36:39]
  ds_read_b64_tr_b16 a[172:173], v16 offset:28672
  v_mfma_f32_16x16x32_bf16 v[36:39], a[148:151], a[48:51], v[36:39]
  s_mov_b32 s34, 69632
  ds_read_b64_tr_b16 a[174:175], v16 offset:30720
  v_mfma_f32_16x16x32_bf16 v[68:71], a[148:151], a[52:55], v[68:71]
  buffer_load_dwordx4 a[16:19], v2, s[16:19], s34 offen offset:0 sc1
  v_mfma_f32_16x16x32_bf16 v[68:71], a[144:147], a[36:39], v[68:71]
  buffer_load_dwordx4 a[20:23], v2, s[16:19], s34 offen offset:1024 sc1
  v_mfma_f32_16x16x32_bf16 v[100:103], a[144:147], a[40:43], v[100:103]
  ds_read_b64_tr_b16 a[176:177], v17 offset:16384
  v_mfma_f32_16x16x32_bf16 v[100:103], a[148:151], a[56:59], v[100:103]
  ds_read_b64_tr_b16 a[178:179], v17 offset:18432
  v_mfma_f32_16x16x32_bf16 v[132:135], a[148:151], a[60:63], v[132:135]
  v_mfma_f32_16x16x32_bf16 v[132:135], a[144:147], a[44:47], v[132:135]
  buffer_load_dwordx4 a[24:27], v2, s[16:19], s34 offen offset:2048 sc1
  v_mfma_f32_16x16x32_bf16 v[52:55], a[152:155], a[32:35], v[52:55]
  ds_read_b64_tr_b16 a[180:181], v17 offset:20480
  v_mfma_f32_16x16x32_bf16 v[52:55], a[156:159], a[48:51], v[52:55]
  ds_read_b64_tr_b16 a[182:183], v17 offset:22528
  v_mfma_f32_16x16x32_bf16 v[84:87], a[156:159], a[52:55], v[84:87]
  buffer_load_dwordx4 a[28:31], v2, s[16:19], s34 offen offset:3072 sc1
  v_mfma_f32_16x16x32_bf16 v[84:87], a[152:155], a[36:39], v[84:87]
  v_mfma_f32_16x16x32_bf16 v[116:119], a[152:155], a[40:43], v[116:119]
  s_mov_b32 s33, 1769472
  ds_read_b64_tr_b16 a[184:185], v17 offset:24576
  v_mfma_f32_16x16x32_bf16 v[116:119], a[156:159], a[56:59], v[116:119]
  s_add_u32 m0, s29, 131072
  ds_read_b64_tr_b16 a[186:187], v17 offset:26624
  v_mfma_f32_16x16x32_bf16 v[148:151], a[156:159], a[60:63], v[148:151]
  buffer_load_dwordx4 v254, s[76:79], s33 offen lds
  v_mfma_f32_16x16x32_bf16 v[148:151], a[152:155], a[44:47], v[148:151]
  s_waitcnt lgkmcnt(6)
  v_mfma_f32_16x16x32_bf16 v[40:43], a[160:163], a[32:35], v[40:43]
  s_mov_b32 s33, 1769472
  ds_read_b64_tr_b16 a[188:189], v17 offset:28672
  v_mfma_f32_16x16x32_bf16 v[40:43], a[164:167], a[48:51], v[40:43]
  s_add_u32 m0, s29, 139264
  ds_read_b64_tr_b16 a[190:191], v17 offset:30720
  v_mfma_f32_16x16x32_bf16 v[72:75], a[164:167], a[52:55], v[72:75]
  buffer_load_dwordx4 v254, s[80:83], s33 offen lds
  v_mfma_f32_16x16x32_bf16 v[72:75], a[160:163], a[36:39], v[72:75]
  s_waitcnt vmcnt(32)
  v_mfma_f32_16x16x32_bf16 v[104:107], a[160:163], a[40:43], v[104:107]
  s_barrier
  ds_read_b64_tr_b16 a[128:129], v14 offset:32768
  v_mfma_f32_16x16x32_bf16 v[104:107], a[164:167], a[56:59], v[104:107]
  s_add_u32 m0, s29, 135168
  s_mov_b32 s33, 1880064
  ds_read_b64_tr_b16 a[130:131], v14 offset:34816
  v_mfma_f32_16x16x32_bf16 v[136:139], a[164:167], a[60:63], v[136:139]
  buffer_load_dwordx4 v254, s[76:79], s33 offen lds
  v_mfma_f32_16x16x32_bf16 v[136:139], a[160:163], a[44:47], v[136:139]
  v_mfma_f32_16x16x32_bf16 v[56:59], a[168:171], a[32:35], v[56:59]
  s_mov_b32 s33, 1880064
  ds_read_b64_tr_b16 a[132:133], v14 offset:36864
  v_mfma_f32_16x16x32_bf16 v[56:59], a[172:175], a[48:51], v[56:59]
  s_add_u32 m0, s29, 143360
  ds_read_b64_tr_b16 a[134:135], v14 offset:38912
  v_mfma_f32_16x16x32_bf16 v[88:91], a[172:175], a[52:55], v[88:91]
  buffer_load_dwordx4 v254, s[80:83], s33 offen lds
  v_mfma_f32_16x16x32_bf16 v[88:91], a[168:171], a[36:39], v[88:91]
  v_mfma_f32_16x16x32_bf16 v[120:123], a[168:171], a[40:43], v[120:123]
  s_mov_b32 s33, 327680
  ds_read_b64_tr_b16 a[136:137], v14 offset:40960
  v_mfma_f32_16x16x32_bf16 v[120:123], a[172:175], a[56:59], v[120:123]
  s_add_u32 m0, s29, 40960
  ds_read_b64_tr_b16 a[138:139], v14 offset:43008
  v_mfma_f32_16x16x32_bf16 v[152:155], a[172:175], a[60:63], v[152:155]
  buffer_load_dwordx4 v245, s[56:59], s33 offen sc1 lds
  v_mfma_f32_16x16x32_bf16 v[152:155], a[168:171], a[44:47], v[152:155]
  s_waitcnt lgkmcnt(6)
  v_mfma_f32_16x16x32_bf16 v[44:47], a[176:179], a[32:35], v[44:47]
  ds_read_b64_tr_b16 a[140:141], v14 offset:45056
  v_mfma_f32_16x16x32_bf16 v[44:47], a[180:183], a[48:51], v[44:47]
  s_add_u32 m0, s29, 45056
  ds_read_b64_tr_b16 a[142:143], v14 offset:47104
  v_mfma_f32_16x16x32_bf16 v[76:79], a[180:183], a[52:55], v[76:79]
  buffer_load_dwordx4 v246, s[56:59], s33 offen sc1 lds
  v_mfma_f32_16x16x32_bf16 v[76:79], a[176:179], a[36:39], v[76:79]
  v_mfma_f32_16x16x32_bf16 v[108:111], a[176:179], a[40:43], v[108:111]
  ds_read_b64_tr_b16 a[144:145], v15 offset:32768
  v_mfma_f32_16x16x32_bf16 v[108:111], a[180:183], a[56:59], v[108:111]
  s_add_u32 m0, s29, 49152
  ds_read_b64_tr_b16 a[146:147], v15 offset:34816
  v_mfma_f32_16x16x32_bf16 v[140:143], a[180:183], a[60:63], v[140:143]
  buffer_load_dwordx4 v247, s[56:59], s33 offen sc1 lds
  v_mfma_f32_16x16x32_bf16 v[140:143], a[176:179], a[44:47], v[140:143]
  v_mfma_f32_16x16x32_bf16 v[60:63], a[184:187], a[32:35], v[60:63]
  ds_read_b64_tr_b16 a[148:149], v15 offset:36864
  v_mfma_f32_16x16x32_bf16 v[60:63], a[188:191], a[48:51], v[60:63]
  s_add_u32 m0, s29, 53248
  ds_read_b64_tr_b16 a[150:151], v15 offset:38912
  v_mfma_f32_16x16x32_bf16 v[92:95], a[188:191], a[52:55], v[92:95]
  buffer_load_dwordx4 v248, s[56:59], s33 offen sc1 lds
  v_mfma_f32_16x16x32_bf16 v[92:95], a[184:187], a[36:39], v[92:95]
  v_mfma_f32_16x16x32_bf16 v[124:127], a[184:187], a[40:43], v[124:127]
  ds_read_b64_tr_b16 a[152:153], v15 offset:40960
  v_mfma_f32_16x16x32_bf16 v[124:127], a[188:191], a[56:59], v[124:127]
  s_add_u32 m0, s29, 57344
  ds_read_b64_tr_b16 a[154:155], v15 offset:43008
  v_mfma_f32_16x16x32_bf16 v[156:159], a[188:191], a[60:63], v[156:159]
  buffer_load_dwordx4 v249, s[56:59], s33 offen sc1 lds
  v_mfma_f32_16x16x32_bf16 v[156:159], a[184:187], a[44:47], v[156:159]
  s_waitcnt lgkmcnt(6)
  v_mfma_f32_16x16x32_bf16 v[32:35], a[128:131], a[64:67], v[32:35]
  ds_read_b64_tr_b16 a[156:157], v15 offset:45056
  v_mfma_f32_16x16x32_bf16 v[32:35], a[132:135], a[80:83], v[32:35]
  s_mov_b32 s34, 73728
  ds_read_b64_tr_b16 a[158:159], v15 offset:47104
  v_mfma_f32_16x16x32_bf16 v[64:67], a[132:135], a[84:87], v[64:67]
  buffer_load_dwordx4 a[32:35], v2, s[16:19], s34 offen offset:0 sc1
  v_mfma_f32_16x16x32_bf16 v[64:67], a[128:131], a[68:71], v[64:67]
  v_mfma_f32_16x16x32_bf16 v[96:99], a[128:131], a[72:75], v[96:99]
  ds_read_b64_tr_b16 a[160:161], v16 offset:32768
  v_mfma_f32_16x16x32_bf16 v[96:99], a[132:135], a[88:91], v[96:99]
  ds_read_b64_tr_b16 a[162:163], v16 offset:34816
  v_mfma_f32_16x16x32_bf16 v[128:131], a[132:135], a[92:95], v[128:131]
  buffer_load_dwordx4 a[36:39], v2, s[16:19], s34 offen offset:1024 sc1
  v_mfma_f32_16x16x32_bf16 v[128:131], a[128:131], a[76:79], v[128:131]
  v_mfma_f32_16x16x32_bf16 v[48:51], a[136:139], a[64:67], v[48:51]
  ds_read_b64_tr_b16 a[164:165], v16 offset:36864
  v_mfma_f32_16x16x32_bf16 v[48:51], a[140:143], a[80:83], v[48:51]
  ds_read_b64_tr_b16 a[166:167], v16 offset:38912
  v_mfma_f32_16x16x32_bf16 v[80:83], a[140:143], a[84:87], v[80:83]
  buffer_load_dwordx4 a[40:43], v2, s[16:19], s34 offen offset:2048 sc1
  v_mfma_f32_16x16x32_bf16 v[80:83], a[136:139], a[68:71], v[80:83]
  v_mfma_f32_16x16x32_bf16 v[112:115], a[136:139], a[72:75], v[112:115]
  ds_read_b64_tr_b16 a[168:169], v16 offset:40960
  v_mfma_f32_16x16x32_bf16 v[112:115], a[140:143], a[88:91], v[112:115]
  ds_read_b64_tr_b16 a[170:171], v16 offset:43008
  v_mfma_f32_16x16x32_bf16 v[144:147], a[140:143], a[92:95], v[144:147]
  buffer_load_dwordx4 a[44:47], v2, s[16:19], s34 offen offset:3072 sc1
  v_mfma_f32_16x16x32_bf16 v[144:147], a[136:139], a[76:79], v[144:147]
  s_waitcnt lgkmcnt(6)
  v_mfma_f32_16x16x32_bf16 v[36:39], a[144:147], a[64:67], v[36:39]
  ds_read_b64_tr_b16 a[172:173], v16 offset:45056
  v_mfma_f32_16x16x32_bf16 v[36:39], a[148:151], a[80:83], v[36:39]
  s_mov_b32 s34, 77824
  ds_read_b64_tr_b16 a[174:175], v16 offset:47104
  v_mfma_f32_16x16x32_bf16 v[68:71], a[148:151], a[84:87], v[68:71]
  buffer_load_dwordx4 a[48:51], v2, s[16:19], s34 offen offset:0 sc1
  v_mfma_f32_16x16x32_bf16 v[68:71], a[144:147], a[68:71], v[68:71]
  buffer_load_dwordx4 a[52:55], v2, s[16:19], s34 offen offset:1024 sc1
  v_mfma_f32_16x16x32_bf16 v[100:103], a[144:147], a[72:75], v[100:103]
  ds_read_b64_tr_b16 a[176:177], v17 offset:32768
  v_mfma_f32_16x16x32_bf16 v[100:103], a[148:151], a[88:91], v[100:103]
  ds_read_b64_tr_b16 a[178:179], v17 offset:34816
  v_mfma_f32_16x16x32_bf16 v[132:135], a[148:151], a[92:95], v[132:135]
  v_mfma_f32_16x16x32_bf16 v[132:135], a[144:147], a[76:79], v[132:135]
  buffer_load_dwordx4 a[56:59], v2, s[16:19], s34 offen offset:2048 sc1
  v_mfma_f32_16x16x32_bf16 v[52:55], a[152:155], a[64:67], v[52:55]
  ds_read_b64_tr_b16 a[180:181], v17 offset:36864
  v_mfma_f32_16x16x32_bf16 v[52:55], a[156:159], a[80:83], v[52:55]
  ds_read_b64_tr_b16 a[182:183], v17 offset:38912
  v_mfma_f32_16x16x32_bf16 v[84:87], a[156:159], a[84:87], v[84:87]
  buffer_load_dwordx4 a[60:63], v2, s[16:19], s34 offen offset:3072 sc1
  v_mfma_f32_16x16x32_bf16 v[84:87], a[152:155], a[68:71], v[84:87]
  v_mfma_f32_16x16x32_bf16 v[116:119], a[152:155], a[72:75], v[116:119]
  s_mov_b32 s33, 1990656
  ds_read_b64_tr_b16 a[184:185], v17 offset:40960
  v_mfma_f32_16x16x32_bf16 v[116:119], a[156:159], a[88:91], v[116:119]
  s_add_u32 m0, s29, 147456
  ds_read_b64_tr_b16 a[186:187], v17 offset:43008
  v_mfma_f32_16x16x32_bf16 v[148:151], a[156:159], a[92:95], v[148:151]
  buffer_load_dwordx4 v254, s[76:79], s33 offen lds
  v_mfma_f32_16x16x32_bf16 v[148:151], a[152:155], a[76:79], v[148:151]
  s_waitcnt lgkmcnt(6)
  v_mfma_f32_16x16x32_bf16 v[40:43], a[160:163], a[64:67], v[40:43]
  s_mov_b32 s33, 1990656
  ds_read_b64_tr_b16 a[188:189], v17 offset:45056
  v_mfma_f32_16x16x32_bf16 v[40:43], a[164:167], a[80:83], v[40:43]
  s_add_u32 m0, s29, 155648
  ds_read_b64_tr_b16 a[190:191], v17 offset:47104
  v_mfma_f32_16x16x32_bf16 v[72:75], a[164:167], a[84:87], v[72:75]
  buffer_load_dwordx4 v254, s[80:83], s33 offen lds
  v_mfma_f32_16x16x32_bf16 v[72:75], a[160:163], a[68:71], v[72:75]
  s_waitcnt vmcnt(32)
  v_mfma_f32_16x16x32_bf16 v[104:107], a[160:163], a[72:75], v[104:107]
  s_barrier
  ds_read_b64_tr_b16 a[128:129], v14 offset:49152
  v_mfma_f32_16x16x32_bf16 v[104:107], a[164:167], a[88:91], v[104:107]
  s_add_u32 m0, s29, 151552
  s_mov_b32 s33, 2101248
  ds_read_b64_tr_b16 a[130:131], v14 offset:51200
  v_mfma_f32_16x16x32_bf16 v[136:139], a[164:167], a[92:95], v[136:139]
  buffer_load_dwordx4 v254, s[76:79], s33 offen lds
  v_mfma_f32_16x16x32_bf16 v[136:139], a[160:163], a[76:79], v[136:139]
  v_mfma_f32_16x16x32_bf16 v[56:59], a[168:171], a[64:67], v[56:59]
  s_mov_b32 s33, 2101248
  ds_read_b64_tr_b16 a[132:133], v14 offset:53248
  v_mfma_f32_16x16x32_bf16 v[56:59], a[172:175], a[80:83], v[56:59]
  s_add_u32 m0, s29, 159744
  ds_read_b64_tr_b16 a[134:135], v14 offset:55296
  v_mfma_f32_16x16x32_bf16 v[88:91], a[172:175], a[84:87], v[88:91]
  buffer_load_dwordx4 v254, s[80:83], s33 offen lds
  v_mfma_f32_16x16x32_bf16 v[88:91], a[168:171], a[68:71], v[88:91]
  v_mfma_f32_16x16x32_bf16 v[120:123], a[168:171], a[72:75], v[120:123]
  s_mov_b32 s33, 491520
  ds_read_b64_tr_b16 a[136:137], v14 offset:57344
  v_mfma_f32_16x16x32_bf16 v[120:123], a[172:175], a[88:91], v[120:123]
  s_add_u32 m0, s29, 61440
  ds_read_b64_tr_b16 a[138:139], v14 offset:59392
  v_mfma_f32_16x16x32_bf16 v[152:155], a[172:175], a[92:95], v[152:155]
  buffer_load_dwordx4 v245, s[56:59], s33 offen sc1 lds
  v_mfma_f32_16x16x32_bf16 v[152:155], a[168:171], a[76:79], v[152:155]
  s_waitcnt lgkmcnt(6)
  v_mfma_f32_16x16x32_bf16 v[44:47], a[176:179], a[64:67], v[44:47]
  ds_read_b64_tr_b16 a[140:141], v14 offset:61440
  v_mfma_f32_16x16x32_bf16 v[44:47], a[180:183], a[80:83], v[44:47]
  s_add_u32 m0, s29, 65536
  ds_read_b64_tr_b16 a[142:143], v14 offset:63488
  v_mfma_f32_16x16x32_bf16 v[76:79], a[180:183], a[84:87], v[76:79]
  buffer_load_dwordx4 v246, s[56:59], s33 offen sc1 lds
  v_mfma_f32_16x16x32_bf16 v[76:79], a[176:179], a[68:71], v[76:79]
  v_mfma_f32_16x16x32_bf16 v[108:111], a[176:179], a[72:75], v[108:111]
  ds_read_b64_tr_b16 a[144:145], v15 offset:49152
  v_mfma_f32_16x16x32_bf16 v[108:111], a[180:183], a[88:91], v[108:111]
  s_add_u32 m0, s29, 69632
  ds_read_b64_tr_b16 a[146:147], v15 offset:51200
  v_mfma_f32_16x16x32_bf16 v[140:143], a[180:183], a[92:95], v[140:143]
  buffer_load_dwordx4 v247, s[56:59], s33 offen sc1 lds
  v_mfma_f32_16x16x32_bf16 v[140:143], a[176:179], a[76:79], v[140:143]
  v_mfma_f32_16x16x32_bf16 v[60:63], a[184:187], a[64:67], v[60:63]
  ds_read_b64_tr_b16 a[148:149], v15 offset:53248
  v_mfma_f32_16x16x32_bf16 v[60:63], a[188:191], a[80:83], v[60:63]
  s_add_u32 m0, s29, 73728
  ds_read_b64_tr_b16 a[150:151], v15 offset:55296
  v_mfma_f32_16x16x32_bf16 v[92:95], a[188:191], a[84:87], v[92:95]
  buffer_load_dwordx4 v248, s[56:59], s33 offen sc1 lds
  v_mfma_f32_16x16x32_bf16 v[92:95], a[184:187], a[68:71], v[92:95]
  v_mfma_f32_16x16x32_bf16 v[124:127], a[184:187], a[72:75], v[124:127]
  ds_read_b64_tr_b16 a[152:153], v15 offset:57344
  v_mfma_f32_16x16x32_bf16 v[124:127], a[188:191], a[88:91], v[124:127]
  s_add_u32 m0, s29, 77824
  ds_read_b64_tr_b16 a[154:155], v15 offset:59392
  v_mfma_f32_16x16x32_bf16 v[156:159], a[188:191], a[92:95], v[156:159]
  buffer_load_dwordx4 v249, s[56:59], s33 offen sc1 lds
  v_mfma_f32_16x16x32_bf16 v[156:159], a[184:187], a[76:79], v[156:159]
  s_waitcnt lgkmcnt(6)
  v_mfma_f32_16x16x32_bf16 v[32:35], a[128:131], a[96:99], v[32:35]
  ds_read_b64_tr_b16 a[156:157], v15 offset:61440
  v_mfma_f32_16x16x32_bf16 v[32:35], a[132:135], a[112:115], v[32:35]
  ds_read_b64_tr_b16 a[158:159], v15 offset:63488
  v_mfma_f32_16x16x32_bf16 v[64:67], a[132:135], a[116:119], v[64:67]
  v_mfma_f32_16x16x32_bf16 v[64:67], a[128:131], a[100:103], v[64:67]
  v_mfma_f32_16x16x32_bf16 v[96:99], a[128:131], a[104:107], v[96:99]
  ds_read_b64_tr_b16 a[160:161], v16 offset:49152
  v_mfma_f32_16x16x32_bf16 v[96:99], a[132:135], a[120:123], v[96:99]
  ds_read_b64_tr_b16 a[162:163], v16 offset:51200
  v_mfma_f32_16x16x32_bf16 v[128:131], a[132:135], a[124:127], v[128:131]
  v_mfma_f32_16x16x32_bf16 v[128:131], a[128:131], a[108:111], v[128:131]
  v_mfma_f32_16x16x32_bf16 v[48:51], a[136:139], a[96:99], v[48:51]
  ds_read_b64_tr_b16 a[164:165], v16 offset:53248
  v_mfma_f32_16x16x32_bf16 v[48:51], a[140:143], a[112:115], v[48:51]
  ds_read_b64_tr_b16 a[166:167], v16 offset:55296
  v_mfma_f32_16x16x32_bf16 v[80:83], a[140:143], a[116:119], v[80:83]
  v_mfma_f32_16x16x32_bf16 v[80:83], a[136:139], a[100:103], v[80:83]
  v_mfma_f32_16x16x32_bf16 v[112:115], a[136:139], a[104:107], v[112:115]
  ds_read_b64_tr_b16 a[168:169], v16 offset:57344
  v_mfma_f32_16x16x32_bf16 v[112:115], a[140:143], a[120:123], v[112:115]
  ds_read_b64_tr_b16 a[170:171], v16 offset:59392
  v_mfma_f32_16x16x32_bf16 v[144:147], a[140:143], a[124:127], v[144:147]
  v_mfma_f32_16x16x32_bf16 v[144:147], a[136:139], a[108:111], v[144:147]
  s_waitcnt lgkmcnt(6)
  v_mfma_f32_16x16x32_bf16 v[36:39], a[144:147], a[96:99], v[36:39]
  ds_read_b64_tr_b16 a[172:173], v16 offset:61440
  v_mfma_f32_16x16x32_bf16 v[36:39], a[148:151], a[112:115], v[36:39]
  ds_read_b64_tr_b16 a[174:175], v16 offset:63488
  v_mfma_f32_16x16x32_bf16 v[68:71], a[148:151], a[116:119], v[68:71]
  v_mfma_f32_16x16x32_bf16 v[68:71], a[144:147], a[100:103], v[68:71]
  v_mfma_f32_16x16x32_bf16 v[100:103], a[144:147], a[104:107], v[100:103]
  ds_read_b64_tr_b16 a[176:177], v17 offset:49152
  v_mfma_f32_16x16x32_bf16 v[100:103], a[148:151], a[120:123], v[100:103]
  ds_read_b64_tr_b16 a[178:179], v17 offset:51200
  v_mfma_f32_16x16x32_bf16 v[132:135], a[148:151], a[124:127], v[132:135]
  v_mfma_f32_16x16x32_bf16 v[132:135], a[144:147], a[108:111], v[132:135]
  v_mfma_f32_16x16x32_bf16 v[52:55], a[152:155], a[96:99], v[52:55]
  ds_read_b64_tr_b16 a[180:181], v17 offset:53248
  v_mfma_f32_16x16x32_bf16 v[52:55], a[156:159], a[112:115], v[52:55]
  ds_read_b64_tr_b16 a[182:183], v17 offset:55296
  v_mfma_f32_16x16x32_bf16 v[84:87], a[156:159], a[116:119], v[84:87]
  v_mfma_f32_16x16x32_bf16 v[84:87], a[152:155], a[100:103], v[84:87]
  v_mfma_f32_16x16x32_bf16 v[116:119], a[152:155], a[104:107], v[116:119]
  ds_read_b64_tr_b16 a[184:185], v17 offset:57344
  v_mfma_f32_16x16x32_bf16 v[116:119], a[156:159], a[120:123], v[116:119]
  ds_read_b64_tr_b16 a[186:187], v17 offset:59392
  v_mfma_f32_16x16x32_bf16 v[148:151], a[156:159], a[124:127], v[148:151]
  v_mfma_f32_16x16x32_bf16 v[148:151], a[152:155], a[108:111], v[148:151]
  s_waitcnt lgkmcnt(6)
  v_mfma_f32_16x16x32_bf16 v[40:43], a[160:163], a[96:99], v[40:43]
  ds_read_b64_tr_b16 a[188:189], v17 offset:61440
  v_mfma_f32_16x16x32_bf16 v[40:43], a[164:167], a[112:115], v[40:43]
  ds_read_b64_tr_b16 a[190:191], v17 offset:63488
  v_mfma_f32_16x16x32_bf16 v[72:75], a[164:167], a[116:119], v[72:75]
  v_mfma_f32_16x16x32_bf16 v[72:75], a[160:163], a[100:103], v[72:75]
  s_waitcnt vmcnt(5)
  v_mfma_f32_16x16x32_bf16 v[104:107], a[160:163], a[104:107], v[104:107]
  s_barrier
  ds_read_b64_tr_b16 a[128:129], v18 offset:0
  v_mfma_f32_16x16x32_bf16 v[104:107], a[164:167], a[120:123], v[104:107]
  ds_read_b64_tr_b16 a[130:131], v18 offset:2048
  v_mfma_f32_16x16x32_bf16 v[136:139], a[164:167], a[124:127], v[136:139]
  v_mfma_f32_16x16x32_bf16 v[136:139], a[160:163], a[108:111], v[136:139]
  v_mfma_f32_16x16x32_bf16 v[56:59], a[168:171], a[96:99], v[56:59]
  ds_read_b64_tr_b16 a[132:133], v18 offset:4096
  v_mfma_f32_16x16x32_bf16 v[56:59], a[172:175], a[112:115], v[56:59]
  ds_read_b64_tr_b16 a[134:135], v18 offset:6144
  v_mfma_f32_16x16x32_bf16 v[88:91], a[172:175], a[116:119], v[88:91]
  v_mfma_f32_16x16x32_bf16 v[88:91], a[168:171], a[100:103], v[88:91]
  v_mfma_f32_16x16x32_bf16 v[120:123], a[168:171], a[104:107], v[120:123]
  ds_read_b64_tr_b16 a[136:137], v18 offset:16384
  v_mfma_f32_16x16x32_bf16 v[120:123], a[172:175], a[120:123], v[120:123]
  ds_read_b64_tr_b16 a[138:139], v18 offset:18432
  v_mfma_f32_16x16x32_bf16 v[152:155], a[172:175], a[124:127], v[152:155]
  v_mfma_f32_16x16x32_bf16 v[152:155], a[168:171], a[108:111], v[152:155]
  s_waitcnt lgkmcnt(6)
  v_mfma_f32_16x16x32_bf16 v[44:47], a[176:179], a[96:99], v[44:47]
  ds_read_b64_tr_b16 a[140:141], v18 offset:20480
  v_mfma_f32_16x16x32_bf16 v[44:47], a[180:183], a[112:115], v[44:47]
  ds_read_b64_tr_b16 a[142:143], v18 offset:22528
  v_mfma_f32_16x16x32_bf16 v[76:79], a[180:183], a[116:119], v[76:79]
  v_mfma_f32_16x16x32_bf16 v[76:79], a[176:179], a[100:103], v[76:79]
  v_mfma_f32_16x16x32_bf16 v[108:111], a[176:179], a[104:107], v[108:111]
  ds_read_b64_tr_b16 a[144:145], v18 offset:8192
  v_mfma_f32_16x16x32_bf16 v[108:111], a[180:183], a[120:123], v[108:111]
  ds_read_b64_tr_b16 a[146:147], v18 offset:10240
  v_mfma_f32_16x16x32_bf16 v[140:143], a[180:183], a[124:127], v[140:143]
  v_mfma_f32_16x16x32_bf16 v[140:143], a[176:179], a[108:111], v[140:143]
  v_mfma_f32_16x16x32_bf16 v[60:63], a[184:187], a[96:99], v[60:63]
  ds_read_b64_tr_b16 a[148:149], v18 offset:12288
  v_mfma_f32_16x16x32_bf16 v[60:63], a[188:191], a[112:115], v[60:63]
  ds_read_b64_tr_b16 a[150:151], v18 offset:14336
  v_mfma_f32_16x16x32_bf16 v[92:95], a[188:191], a[116:119], v[92:95]
  v_mfma_f32_16x16x32_bf16 v[92:95], a[184:187], a[100:103], v[92:95]
  v_mfma_f32_16x16x32_bf16 v[124:127], a[184:187], a[104:107], v[124:127]
  ds_read_b64_tr_b16 a[152:153], v18 offset:24576
  v_mfma_f32_16x16x32_bf16 v[124:127], a[188:191], a[120:123], v[124:127]
  ds_read_b64_tr_b16 a[154:155], v18 offset:26624
  v_mfma_f32_16x16x32_bf16 v[156:159], a[188:191], a[124:127], v[156:159]
  v_mfma_f32_16x16x32_bf16 v[156:159], a[184:187], a[108:111], v[156:159]
  s_waitcnt lgkmcnt(6)
  v_mfma_f32_16x16x32_bf16 v[32:35], a[128:131], a[0:3], v[32:35]
  ds_read_b64_tr_b16 a[156:157], v18 offset:28672
  v_mfma_f32_16x16x32_bf16 v[32:35], a[132:135], a[16:19], v[32:35]
  s_mov_b32 s33, 655360
  ds_read_b64_tr_b16 a[158:159], v18 offset:30720
  v_mfma_f32_16x16x32_bf16 v[32:35], a[136:139], a[32:35], v[32:35]
  s_add_u32 m0, s29, 81920
  v_mfma_f32_16x16x32_bf16 v[32:35], a[140:143], a[48:51], v[32:35]
  buffer_load_dwordx4 v245, s[56:59], s33 offen sc1 lds
  v_mfma_f32_16x16x32_bf16 v[64:67], a[140:143], a[52:55], v[64:67]
  ds_read_b64_tr_b16 a[160:161], v19 offset:0
  v_mfma_f32_16x16x32_bf16 v[64:67], a[136:139], a[36:39], v[64:67]
  ds_read_b64_tr_b16 a[162:163], v19 offset:2048
  v_mfma_f32_16x16x32_bf16 v[64:67], a[132:135], a[20:23], v[64:67]
  v_mfma_f32_16x16x32_bf16 v[64:67], a[128:131], a[4:7], v[64:67]
  v_mfma_f32_16x16x32_bf16 v[96:99], a[128:131], a[8:11], v[96:99]
  ds_read_b64_tr_b16 a[164:165], v19 offset:4096
  v_mfma_f32_16x16x32_bf16 v[96:99], a[132:135], a[24:27], v[96:99]
  ds_read_b64_tr_b16 a[166:167], v19 offset:6144
  v_mfma_f32_16x16x32_bf16 v[96:99], a[136:139], a[40:43], v[96:99]
  v_mfma_f32_16x16x32_bf16 v[96:99], a[140:143], a[56:59], v[96:99]
  v_mfma_f32_16x16x32_bf16 v[128:131], a[140:143], a[60:63], v[128:131]
  ds_read_b64_tr_b16 a[168:169], v19 offset:16384
  v_mfma_f32_16x16x32_bf16 v[128:131], a[136:139], a[44:47], v[128:131]
  s_add_u32 m0, s29, 86016
  ds_read_b64_tr_b16 a[170:171], v19 offset:18432
  v_mfma_f32_16x16x32_bf16 v[128:131], a[132:135], a[28:31], v[128:131]
  buffer_load_dwordx4 v246, s[56:59], s33 offen sc1 lds
  v_mfma_f32_16x16x32_bf16 v[128:131], a[128:131], a[12:15], v[128:131]
  s_waitcnt lgkmcnt(6)
  v_mfma_f32_16x16x32_bf16 v[48:51], a[144:147], a[0:3], v[48:51]
  ds_read_b64_tr_b16 a[172:173], v19 offset:20480
  v_mfma_f32_16x16x32_bf16 v[48:51], a[148:151], a[16:19], v[48:51]
  ds_read_b64_tr_b16 a[174:175], v19 offset:22528
  v_mfma_f32_16x16x32_bf16 v[48:51], a[152:155], a[32:35], v[48:51]
  v_mfma_f32_16x16x32_bf16 v[48:51], a[156:159], a[48:51], v[48:51]
  v_mfma_f32_16x16x32_bf16 v[80:83], a[156:159], a[52:55], v[80:83]
  ds_read_b64_tr_b16 a[176:177], v19 offset:8192
  v_mfma_f32_16x16x32_bf16 v[80:83], a[152:155], a[36:39], v[80:83]
  ds_read_b64_tr_b16 a[178:179], v19 offset:10240
  v_mfma_f32_16x16x32_bf16 v[80:83], a[148:151], a[20:23], v[80:83]
  v_mfma_f32_16x16x32_bf16 v[80:83], a[144:147], a[4:7], v[80:83]
  v_mfma_f32_16x16x32_bf16 v[112:115], a[144:147], a[8:11], v[112:115]
  ds_read_b64_tr_b16 a[180:181], v19 offset:12288
  v_mfma_f32_16x16x32_bf16 v[112:115], a[148:151], a[24:27], v[112:115]
  s_add_u32 m0, s29, 90112
  ds_read_b64_tr_b16 a[182:183], v19 offset:14336
  v_mfma_f32_16x16x32_bf16 v[112:115], a[152:155], a[40:43], v[112:115]
  buffer_load_dwordx4 v247, s[56:59], s33 offen sc1 lds
  v_mfma_f32_16x16x32_bf16 v[112:115], a[156:159], a[56:59], v[112:115]
  v_mfma_f32_16x16x32_bf16 v[144:147], a[156:159], a[60:63], v[144:147]
  ds_read_b64_tr_b16 a[184:185], v19 offset:24576
  v_mfma_f32_16x16x32_bf16 v[144:147], a[152:155], a[44:47], v[144:147]
  ds_read_b64_tr_b16 a[186:187], v19 offset:26624
  v_mfma_f32_16x16x32_bf16 v[144:147], a[148:151], a[28:31], v[144:147]
  v_mfma_f32_16x16x32_bf16 v[144:147], a[144:147], a[12:15], v[144:147]
  s_waitcnt lgkmcnt(6)
  v_mfma_f32_16x16x32_bf16 v[36:39], a[160:163], a[0:3], v[36:39]
  ds_read_b64_tr_b16 a[188:189], v19 offset:28672
  v_mfma_f32_16x16x32_bf16 v[36:39], a[164:167], a[16:19], v[36:39]
  ds_read_b64_tr_b16 a[190:191], v19 offset:30720
  v_mfma_f32_16x16x32_bf16 v[36:39], a[168:171], a[32:35], v[36:39]
  v_mfma_f32_16x16x32_bf16 v[36:39], a[172:175], a[48:51], v[36:39]
  v_mfma_f32_16x16x32_bf16 v[68:71], a[172:175], a[52:55], v[68:71]
  ds_read_b64_tr_b16 a[128:129], v20 offset:0
  v_mfma_f32_16x16x32_bf16 v[68:71], a[168:171], a[36:39], v[68:71]
  s_add_u32 m0, s29, 94208
  ds_read_b64_tr_b16 a[130:131], v20 offset:2048
  v_max_f32 v32, 0, v32
  v_mfma_f32_16x16x32_bf16 v[68:71], a[164:167], a[20:23], v[68:71]
  buffer_load_dwordx4 v248, s[56:59], s33 offen sc1 lds
  v_mfma_f32_16x16x32_bf16 v[68:71], a[160:163], a[4:7], v[68:71]
  v_max_f32 v33, 0, v33
  v_max_f32 v34, 0, v34
  v_mfma_f32_16x16x32_bf16 v[100:103], a[160:163], a[8:11], v[100:103]
  ds_read_b64_tr_b16 a[132:133], v20 offset:4096
  v_max_f32 v35, 0, v35
  v_mfma_f32_16x16x32_bf16 v[100:103], a[164:167], a[24:27], v[100:103]
  ds_read_b64_tr_b16 a[134:135], v20 offset:6144
  v_mul_f32 v32, v32, v48
  v_mfma_f32_16x16x32_bf16 v[100:103], a[168:171], a[40:43], v[100:103]
  v_mul_f32 v33, v33, v49
  v_mul_f32 v34, v34, v50
  v_mfma_f32_16x16x32_bf16 v[100:103], a[172:175], a[56:59], v[100:103]
  v_mul_f32 v35, v35, v51
  v_cvt_pk_bf16_f32 v160, v32, v33
  v_mfma_f32_16x16x32_bf16 v[132:135], a[172:175], a[60:63], v[132:135]
  ds_read_b64_tr_b16 a[136:137], v20 offset:16384
  v_cvt_pk_bf16_f32 v161, v34, v35
  v_mfma_f32_16x16x32_bf16 v[132:135], a[168:171], a[44:47], v[132:135]
  ds_read_b64_tr_b16 a[138:139], v20 offset:18432
  v_max_f32 v64, 0, v64
  v_mfma_f32_16x16x32_bf16 v[132:135], a[164:167], a[28:31], v[132:135]
  v_max_f32 v65, 0, v65
  v_max_f32 v66, 0, v66
  v_mfma_f32_16x16x32_bf16 v[132:135], a[160:163], a[12:15], v[132:135]
  s_waitcnt lgkmcnt(6)
  v_max_f32 v67, 0, v67
  v_mul_f32 v64, v64, v80
  v_mfma_f32_16x16x32_bf16 v[52:55], a[176:179], a[0:3], v[52:55]
  ds_read_b64_tr_b16 a[140:141], v20 offset:20480
  v_mul_f32 v65, v65, v81
  v_mfma_f32_16x16x32_bf16 v[52:55], a[180:183], a[16:19], v[52:55]
  ds_read_b64_tr_b16 a[142:143], v20 offset:22528
  v_mul_f32 v66, v66, v82
  v_mfma_f32_16x16x32_bf16 v[52:55], a[184:187], a[32:35], v[52:55]
  s_add_u32 m0, s29, 98304
  v_mul_f32 v67, v67, v83
  v_cvt_pk_bf16_f32 v164, v64, v65
  v_mfma_f32_16x16x32_bf16 v[52:55], a[188:191], a[48:51], v[52:55]
  buffer_load_dwordx4 v249, s[56:59], s33 offen sc1 lds
  v_mfma_f32_16x16x32_bf16 v[84:87], a[188:191], a[52:55], v[84:87]
  ds_read_b64_tr_b16 a[144:145], v20 offset:8192
  v_cvt_pk_bf16_f32 v165, v66, v67
  v_mfma_f32_16x16x32_bf16 v[84:87], a[184:187], a[36:39], v[84:87]
  ds_read_b64_tr_b16 a[146:147], v20 offset:10240
  v_max_f32 v96, 0, v96
  v_mfma_f32_16x16x32_bf16 v[84:87], a[180:183], a[20:23], v[84:87]
  v_max_f32 v97, 0, v97
  v_max_f32 v98, 0, v98
  v_mfma_f32_16x16x32_bf16 v[84:87], a[176:179], a[4:7], v[84:87]
  v_max_f32 v99, 0, v99
  v_mul_f32 v96, v96, v112
  v_mfma_f32_16x16x32_bf16 v[116:119], a[176:179], a[8:11], v[116:119]
  ds_read_b64_tr_b16 a[148:149], v20 offset:12288
  v_mul_f32 v97, v97, v113
  v_mfma_f32_16x16x32_bf16 v[116:119], a[180:183], a[24:27], v[116:119]
  ds_read_b64_tr_b16 a[150:151], v20 offset:14336
  v_mul_f32 v98, v98, v114
  v_mfma_f32_16x16x32_bf16 v[116:119], a[184:187], a[40:43], v[116:119]
  v_mul_f32 v99, v99, v115
  v_cvt_pk_bf16_f32 v168, v96, v97
  v_mfma_f32_16x16x32_bf16 v[116:119], a[188:191], a[56:59], v[116:119]
  v_cvt_pk_bf16_f32 v169, v98, v99
  v_max_f32 v128, 0, v128
  v_mfma_f32_16x16x32_bf16 v[148:151], a[188:191], a[60:63], v[148:151]
  ds_read_b64_tr_b16 a[152:153], v20 offset:24576
  v_max_f32 v129, 0, v129
  v_mfma_f32_16x16x32_bf16 v[148:151], a[184:187], a[44:47], v[148:151]
  ds_read_b64_tr_b16 a[154:155], v20 offset:26624
  v_max_f32 v130, 0, v130
  v_mfma_f32_16x16x32_bf16 v[148:151], a[180:183], a[28:31], v[148:151]
  v_max_f32 v131, 0, v131
  v_mul_f32 v128, v128, v144
  v_mfma_f32_16x16x32_bf16 v[148:151], a[176:179], a[12:15], v[148:151]
  s_waitcnt lgkmcnt(6)
  v_mul_f32 v129, v129, v145
  v_mul_f32 v130, v130, v146
  v_mfma_f32_16x16x32_bf16 v[40:43], a[128:131], a[0:3], v[40:43]
  ds_read_b64_tr_b16 a[156:157], v20 offset:28672
  v_mul_f32 v131, v131, v147
  v_mfma_f32_16x16x32_bf16 v[40:43], a[132:135], a[16:19], v[40:43]
  ds_read_b64_tr_b16 a[158:159], v20 offset:30720
  v_cvt_pk_bf16_f32 v172, v128, v129
  v_mfma_f32_16x16x32_bf16 v[40:43], a[136:139], a[32:35], v[40:43]
  v_cvt_pk_bf16_f32 v173, v130, v131
  v_mfma_f32_16x16x32_bf16 v[40:43], a[140:143], a[48:51], v[40:43]
  v_mfma_f32_16x16x32_bf16 v[72:75], a[140:143], a[52:55], v[72:75]
  ds_read_b64_tr_b16 a[160:161], v21 offset:0
  v_mfma_f32_16x16x32_bf16 v[72:75], a[136:139], a[36:39], v[72:75]
  ds_read_b64_tr_b16 a[162:163], v21 offset:2048
  v_max_f32 v36, 0, v36
  v_max_f32 v37, 0, v37
  v_mfma_f32_16x16x32_bf16 v[72:75], a[132:135], a[20:23], v[72:75]
  v_max_f32 v38, 0, v38
  v_max_f32 v39, 0, v39
  v_mfma_f32_16x16x32_bf16 v[72:75], a[128:131], a[4:7], v[72:75]
  v_mul_f32 v36, v36, v52
  v_mul_f32 v37, v37, v53
  v_mul_f32 v38, v38, v54
  v_mfma_f32_16x16x32_bf16 v[104:107], a[128:131], a[8:11], v[104:107]
  ds_read_b64_tr_b16 a[164:165], v21 offset:4096
  v_mul_f32 v39, v39, v55
  v_mfma_f32_16x16x32_bf16 v[104:107], a[132:135], a[24:27], v[104:107]
  ds_read_b64_tr_b16 a[166:167], v21 offset:6144
  v_cvt_pk_bf16_f32 v162, v36, v37
  v_cvt_pk_bf16_f32 v163, v38, v39
  v_mfma_f32_16x16x32_bf16 v[104:107], a[136:139], a[40:43], v[104:107]
  v_max_f32 v68, 0, v68
  v_max_f32 v69, 0, v69
  v_mfma_f32_16x16x32_bf16 v[104:107], a[140:143], a[56:59], v[104:107]
  v_max_f32 v70, 0, v70
  v_max_f32 v71, 0, v71
  v_mul_f32 v68, v68, v84
  v_mfma_f32_16x16x32_bf16 v[136:139], a[140:143], a[60:63], v[136:139]
  ds_read_b64_tr_b16 a[168:169], v21 offset:16384
  v_mul_f32 v69, v69, v85
  v_mfma_f32_16x16x32_bf16 v[136:139], a[136:139], a[44:47], v[136:139]
  ds_read_b64_tr_b16 a[170:171], v21 offset:18432
  v_mul_f32 v70, v70, v86
  v_mul_f32 v71, v71, v87
  v_mfma_f32_16x16x32_bf16 v[136:139], a[132:135], a[28:31], v[136:139]
  v_cvt_pk_bf16_f32 v166, v68, v69
  v_cvt_pk_bf16_f32 v167, v70, v71
  v_mfma_f32_16x16x32_bf16 v[136:139], a[128:131], a[12:15], v[136:139]
  s_waitcnt lgkmcnt(6)
  v_max_f32 v100, 0, v100
  v_max_f32 v101, 0, v101
  v_max_f32 v102, 0, v102
  v_mfma_f32_16x16x32_bf16 v[56:59], a[144:147], a[0:3], v[56:59]
  ds_read_b64_tr_b16 a[172:173], v21 offset:20480
  v_max_f32 v103, 0, v103
  v_mfma_f32_16x16x32_bf16 v[56:59], a[148:151], a[16:19], v[56:59]
  ds_read_b64_tr_b16 a[174:175], v21 offset:22528
  v_mul_f32 v100, v100, v116
  v_mul_f32 v101, v101, v117
  v_mfma_f32_16x16x32_bf16 v[56:59], a[152:155], a[32:35], v[56:59]
  v_mul_f32 v102, v102, v118
  v_mul_f32 v103, v103, v119
  v_mfma_f32_16x16x32_bf16 v[56:59], a[156:159], a[48:51], v[56:59]
  v_cvt_pk_bf16_f32 v170, v100, v101
  v_cvt_pk_bf16_f32 v171, v102, v103
  v_max_f32 v132, 0, v132
  v_mfma_f32_16x16x32_bf16 v[88:91], a[156:159], a[52:55], v[88:91]
  ds_read_b64_tr_b16 a[176:177], v21 offset:8192
  v_max_f32 v133, 0, v133
  v_mfma_f32_16x16x32_bf16 v[88:91], a[152:155], a[36:39], v[88:91]
  ds_read_b64_tr_b16 a[178:179], v21 offset:10240
  v_max_f32 v134, 0, v134
  v_max_f32 v135, 0, v135
  v_mfma_f32_16x16x32_bf16 v[88:91], a[148:151], a[20:23], v[88:91]
  v_mul_f32 v132, v132, v148
  v_mul_f32 v133, v133, v149
  v_mfma_f32_16x16x32_bf16 v[88:91], a[144:147], a[4:7], v[88:91]
  v_mul_f32 v134, v134, v150
  v_mul_f32 v135, v135, v151
  v_cvt_pk_bf16_f32 v174, v132, v133
  v_mfma_f32_16x16x32_bf16 v[120:123], a[144:147], a[8:11], v[120:123]
  ds_read_b64_tr_b16 a[180:181], v21 offset:12288
  v_cvt_pk_bf16_f32 v175, v134, v135
  v_mfma_f32_16x16x32_bf16 v[120:123], a[148:151], a[24:27], v[120:123]
  ds_read_b64_tr_b16 a[182:183], v21 offset:14336
  s_mov_b32 s36, 0
  buffer_store_dwordx4 v[160:163], v2, s[20:23], s36 offen offset:0 sc1
  buffer_store_dwordx4 v[164:167], v2, s[20:23], s36 offen offset:1024 sc1
  buffer_store_dwordx4 v[168:171], v2, s[20:23], s36 offen offset:2048 sc1
  buffer_store_dwordx4 v[172:175], v2, s[20:23], s36 offen offset:3072 sc1
  v_mfma_f32_16x16x32_bf16 v[120:123], a[152:155], a[40:43], v[120:123]
  v_mfma_f32_16x16x32_bf16 v[120:123], a[156:159], a[56:59], v[120:123]
  v_mfma_f32_16x16x32_bf16 v[152:155], a[156:159], a[60:63], v[152:155]
  ds_read_b64_tr_b16 a[184:185], v21 offset:24576
  v_mfma_f32_16x16x32_bf16 v[152:155], a[152:155], a[44:47], v[152:155]
  ds_read_b64_tr_b16 a[186:187], v21 offset:26624
  v_mfma_f32_16x16x32_bf16 v[152:155], a[148:151], a[28:31], v[152:155]
  v_mfma_f32_16x16x32_bf16 v[152:155], a[144:147], a[12:15], v[152:155]
  s_waitcnt lgkmcnt(6)
  v_mfma_f32_16x16x32_bf16 v[44:47], a[160:163], a[0:3], v[44:47]
  ds_read_b64_tr_b16 a[188:189], v21 offset:28672
  v_mfma_f32_16x16x32_bf16 v[44:47], a[164:167], a[16:19], v[44:47]
  ds_read_b64_tr_b16 a[190:191], v21 offset:30720
  v_mfma_f32_16x16x32_bf16 v[44:47], a[168:171], a[32:35], v[44:47]
  v_mfma_f32_16x16x32_bf16 v[44:47], a[172:175], a[48:51], v[44:47]
  v_mfma_f32_16x16x32_bf16 v[76:79], a[172:175], a[52:55], v[76:79]
  v_mfma_f32_16x16x32_bf16 v[76:79], a[168:171], a[36:39], v[76:79]
  v_max_f32 v40, 0, v40
  v_max_f32 v41, 0, v41
  v_mfma_f32_16x16x32_bf16 v[76:79], a[164:167], a[20:23], v[76:79]
  v_max_f32 v42, 0, v42
  v_max_f32 v43, 0, v43
  v_mfma_f32_16x16x32_bf16 v[76:79], a[160:163], a[4:7], v[76:79]
  v_mul_f32 v40, v40, v56
  v_mul_f32 v41, v41, v57
  v_mfma_f32_16x16x32_bf16 v[108:111], a[160:163], a[8:11], v[108:111]
  v_mul_f32 v42, v42, v58
  v_mul_f32 v43, v43, v59
  v_mfma_f32_16x16x32_bf16 v[108:111], a[164:167], a[24:27], v[108:111]
  v_cvt_pk_bf16_f32 v176, v40, v41
  v_cvt_pk_bf16_f32 v177, v42, v43
  v_mfma_f32_16x16x32_bf16 v[108:111], a[168:171], a[40:43], v[108:111]
  v_max_f32 v72, 0, v72
  v_max_f32 v73, 0, v73
  v_mfma_f32_16x16x32_bf16 v[108:111], a[172:175], a[56:59], v[108:111]
  v_max_f32 v74, 0, v74
  v_max_f32 v75, 0, v75
  v_mfma_f32_16x16x32_bf16 v[140:143], a[172:175], a[60:63], v[140:143]
  v_mul_f32 v72, v72, v88
  v_mul_f32 v73, v73, v89
  v_mfma_f32_16x16x32_bf16 v[140:143], a[168:171], a[44:47], v[140:143]
  v_mul_f32 v74, v74, v90
  v_mul_f32 v75, v75, v91
  v_mfma_f32_16x16x32_bf16 v[140:143], a[164:167], a[28:31], v[140:143]
  v_cvt_pk_bf16_f32 v180, v72, v73
  v_cvt_pk_bf16_f32 v181, v74, v75
  v_mfma_f32_16x16x32_bf16 v[140:143], a[160:163], a[12:15], v[140:143]
  s_waitcnt lgkmcnt(0)
  v_max_f32 v104, 0, v104
  v_max_f32 v105, 0, v105
  v_mfma_f32_16x16x32_bf16 v[60:63], a[176:179], a[0:3], v[60:63]
  v_max_f32 v106, 0, v106
  v_max_f32 v107, 0, v107
  v_mfma_f32_16x16x32_bf16 v[60:63], a[180:183], a[16:19], v[60:63]
  v_mul_f32 v104, v104, v120
  v_mul_f32 v105, v105, v121
  v_mfma_f32_16x16x32_bf16 v[60:63], a[184:187], a[32:35], v[60:63]
  v_mul_f32 v106, v106, v122
  v_mul_f32 v107, v107, v123
  v_mfma_f32_16x16x32_bf16 v[60:63], a[188:191], a[48:51], v[60:63]
  v_cvt_pk_bf16_f32 v184, v104, v105
  v_cvt_pk_bf16_f32 v185, v106, v107
  v_mfma_f32_16x16x32_bf16 v[92:95], a[188:191], a[52:55], v[92:95]
  v_max_f32 v136, 0, v136
  v_max_f32 v137, 0, v137
  v_mfma_f32_16x16x32_bf16 v[92:95], a[184:187], a[36:39], v[92:95]
  v_max_f32 v138, 0, v138
  v_max_f32 v139, 0, v139
  v_mfma_f32_16x16x32_bf16 v[92:95], a[180:183], a[20:23], v[92:95]
  v_mul_f32 v136, v136, v152
  v_mul_f32 v137, v137, v153
  v_mfma_f32_16x16x32_bf16 v[92:95], a[176:179], a[4:7], v[92:95]
  v_mul_f32 v138, v138, v154
  v_mul_f32 v139, v139, v155
  v_mfma_f32_16x16x32_bf16 v[124:127], a[176:179], a[8:11], v[124:127]
  v_cvt_pk_bf16_f32 v188, v136, v137
  v_cvt_pk_bf16_f32 v189, v138, v139
  v_mfma_f32_16x16x32_bf16 v[124:127], a[180:183], a[24:27], v[124:127]
  v_mfma_f32_16x16x32_bf16 v[124:127], a[184:187], a[40:43], v[124:127]
  v_mfma_f32_16x16x32_bf16 v[124:127], a[188:191], a[56:59], v[124:127]
  v_mfma_f32_16x16x32_bf16 v[156:159], a[188:191], a[60:63], v[156:159]
  v_mfma_f32_16x16x32_bf16 v[156:159], a[184:187], a[44:47], v[156:159]
  v_mfma_f32_16x16x32_bf16 v[156:159], a[180:183], a[28:31], v[156:159]
  v_mfma_f32_16x16x32_bf16 v[156:159], a[176:179], a[12:15], v[156:159]
  v_max_f32 v44, 0, v44
  v_max_f32 v45, 0, v45
  v_max_f32 v46, 0, v46
  v_max_f32 v47, 0, v47
  v_mul_f32 v44, v44, v60
  v_mul_f32 v45, v45, v61
  v_mul_f32 v46, v46, v62
  v_mul_f32 v47, v47, v63
  v_cvt_pk_bf16_f32 v178, v44, v45
  v_cvt_pk_bf16_f32 v179, v46, v47
  v_max_f32 v76, 0, v76
  v_max_f32 v77, 0, v77
  v_max_f32 v78, 0, v78
  v_max_f32 v79, 0, v79
  v_mul_f32 v76, v76, v92
  v_mul_f32 v77, v77, v93
  v_mul_f32 v78, v78, v94
  v_mul_f32 v79, v79, v95
  v_cvt_pk_bf16_f32 v182, v76, v77
  v_cvt_pk_bf16_f32 v183, v78, v79
  v_max_f32 v108, 0, v108
  v_max_f32 v109, 0, v109
  v_max_f32 v110, 0, v110
  v_max_f32 v111, 0, v111
  v_mul_f32 v108, v108, v124
  v_mul_f32 v109, v109, v125
  v_mul_f32 v110, v110, v126
  v_mul_f32 v111, v111, v127
  v_cvt_pk_bf16_f32 v186, v108, v109
  v_cvt_pk_bf16_f32 v187, v110, v111
  v_max_f32 v140, 0, v140
  v_max_f32 v141, 0, v141
  v_max_f32 v142, 0, v142
  v_max_f32 v143, 0, v143
  v_mul_f32 v140, v140, v156
  v_mul_f32 v141, v141, v157
  v_mul_f32 v142, v142, v158
  v_mul_f32 v143, v143, v159
  v_cvt_pk_bf16_f32 v190, v140, v141
  v_cvt_pk_bf16_f32 v191, v142, v143
  s_mov_b32 s36, 4096
  buffer_store_dwordx4 v[176:179], v2, s[20:23], s36 offen offset:0 sc1
  buffer_store_dwordx4 v[180:183], v2, s[20:23], s36 offen offset:1024 sc1
  buffer_store_dwordx4 v[184:187], v2, s[20:23], s36 offen offset:2048 sc1
  buffer_store_dwordx4 v[188:191], v2, s[20:23], s36 offen offset:3072 sc1
  s_branch L_p4
L_idle:
  s_waitcnt vmcnt(0) lgkmcnt(0)
  s_barrier
  s_add_u32 m0, s29, 0
  s_mov_b32 s33, 0
  buffer_load_dwordx4 v245, s[56:59], s33 offen sc1 lds
  s_add_u32 m0, s29, 4096
  s_nop 0
  buffer_load_dwordx4 v246, s[56:59], s33 offen sc1 lds
  s_add_u32 m0, s29, 8192
  s_nop 0
  buffer_load_dwordx4 v247, s[56:59], s33 offen sc1 lds
  s_add_u32 m0, s29, 12288
  s_nop 0
  buffer_load_dwordx4 v248, s[56:59], s33 offen sc1 lds
  s_add_u32 m0, s29, 16384
  s_nop 0
  buffer_load_dwordx4 v249, s[56:59], s33 offen sc1 lds
  s_add_u32 m0, s29, 20480
  s_mov_b32 s33, 163840
  buffer_load_dwordx4 v245, s[56:59], s33 offen sc1 lds
  s_add_u32 m0, s29, 24576
  s_nop 0
  buffer_load_dwordx4 v246, s[56:59], s33 offen sc1 lds
  s_add_u32 m0, s29, 28672
  s_nop 0
  buffer_load_dwordx4 v247, s[56:59], s33 offen sc1 lds
  s_add_u32 m0, s29, 32768
  s_nop 0
  buffer_load_dwordx4 v248, s[56:59], s33 offen sc1 lds
  s_add_u32 m0, s29, 36864
  s_nop 0
  buffer_load_dwordx4 v249, s[56:59], s33 offen sc1 lds
  s_add_u32 m0, s29, 40960
  s_mov_b32 s33, 327680
  buffer_load_dwordx4 v245, s[56:59], s33 offen sc1 lds
  s_add_u32 m0, s29, 45056
  s_nop 0
  buffer_load_dwordx4 v246, s[56:59], s33 offen sc1 lds
  s_add_u32 m0, s29, 49152
  s_nop 0
  buffer_load_dwordx4 v247, s[56:59], s33 offen sc1 lds
  s_add_u32 m0, s29, 53248
  s_nop 0
  buffer_load_dwordx4 v248, s[56:59], s33 offen sc1 lds
  s_add_u32 m0, s29, 57344
  s_nop 0
  buffer_load_dwordx4 v249, s[56:59], s33 offen sc1 lds
  s_add_u32 m0, s29, 61440
  s_mov_b32 s33, 491520
  buffer_load_dwordx4 v245, s[56:59], s33 offen sc1 lds
  s_add_u32 m0, s29, 65536
  s_nop 0
  buffer_load_dwordx4 v246, s[56:59], s33 offen sc1 lds
  s_add_u32 m0, s29, 69632
  s_nop 0
  buffer_load_dwordx4 v247, s[56:59], s33 offen sc1 lds
  s_add_u32 m0, s29, 73728
  s_nop 0
  buffer_load_dwordx4 v248, s[56:59], s33 offen sc1 lds
  s_add_u32 m0, s29, 77824
  s_nop 0
  buffer_load_dwordx4 v249, s[56:59], s33 offen sc1 lds
  s_add_u32 m0, s29, 81920
  s_mov_b32 s33, 655360
  buffer_load_dwordx4 v245, s[56:59], s33 offen sc1 lds
  s_add_u32 m0, s29, 86016
  s_nop 0
  buffer_load_dwordx4 v246, s[56:59], s33 offen sc1 lds
  s_add_u32 m0, s29, 90112
  s_nop 0
  buffer_load_dwordx4 v247, s[56:59], s33 offen sc1 lds
  s_add_u32 m0, s29, 94208
  s_nop 0
  buffer_load_dwordx4 v248, s[56:59], s33 offen sc1 lds
  s_add_u32 m0, s29, 98304
  s_nop 0
  buffer_load_dwordx4 v249, s[56:59], s33 offen sc1 lds
L_p4:
  v_add_u32 v10, 0, v2
  v_add_u32 v11, 61440, v2
  v_add_u32 v12, 122880, v2
  s_mul_i32 s39, s35, 221184
  s_add_u32 s39, s39, s29
  s_sub_u32 s40, 221184, s29
  s_add_u32 s12, s4, s39
  s_addc_u32 s13, s5, 0
  s_add_u32 s12, s12, 42647552
  s_addc_u32 s13, s13, 0
  s_mov_b32 s14, s40
  s_mov_b32 s15, 0x20000
  v_and_b32 v5, 15, v0
  v_lshl_add_u32 v5, v1, 4, v5
  v_mul_u32_u24 v5, 1280, v5
  v_lshrrev_b32 v6, 4, v0
  v_lshl_add_u32 v18, v6, 3, v5
  v_lshlrev_b32 v19, 4, v6
  s_mul_i32 s39, s35, 81920
  s_mul_i32 s40, s37, 160
  s_add_u32 s39, s39, s40
  s_sub_u32 s38, 81920, s40
  s_add_u32 s16, s44, s39
  s_addc_u32 s17, s45, 0
  s_mov_b32 s18, s38
  s_mov_b32 s19, 0x20000
  s_mul_i32 s39, s35, 81920
  s_add_u32 s39, s39, s29
  s_sub_u32 s38, 81920, s29
  s_mul_i32 s41, s37, 5
  s_add_u32 s20, s4, s39
  s_addc_u32 s21, s5, 0
  s_add_u32 s20, s20, 37404672
  s_addc_u32 s21, s21, 0
  s_mov_b32 s22, s38
  s_mov_b32 s23, 0x20000
  s_add_u32 s42, s41, 0
  s_lshr_b32 s40, s42, 1
  s_lshl_b32 s40, s40, 12
  s_and_b32 s42, s42, 1
  s_lshl_b32 s42, s42, 3
  s_add_u32 s42, s42, s40
  s_mov_b32 s60, s42
  s_add_u32 s42, s41, 1
  s_lshr_b32 s40, s42, 1
  s_lshl_b32 s40, s40, 12
  s_and_b32 s42, s42, 1
  s_lshl_b32 s42, s42, 3
  s_add_u32 s42, s42, s40
  s_mov_b32 s61, s42
  s_add_u32 s42, s41, 2
  s_lshr_b32 s40, s42, 1
  s_lshl_b32 s40, s40, 12
  s_and_b32 s42, s42, 1
  s_lshl_b32 s42, s42, 3
  s_add_u32 s42, s42, s40
  s_mov_b32 s62, s42
  s_add_u32 s42, s41, 3
  s_lshr_b32 s40, s42, 1
  s_lshl_b32 s40, s40, 12
  s_and_b32 s42, s42, 1
  s_lshl_b32 s42, s42, 3
  s_add_u32 s42, s42, s40
  s_mov_b32 s63, s42
  s_add_u32 s42, s41, 4
  s_lshr_b32 s40, s42, 1
  s_lshl_b32 s40, s40, 12
  s_and_b32 s42, s42, 1
  s_lshl_b32 s42, s42, 3
  s_add_u32 s42, s42, s40
  s_mov_b32 s64, s42
  s_mul_i32 s40, s37, 320
  s_add_u32 s24, s4, s40
  s_addc_u32 s25, s5, 0
  s_add_u32 s24, s24, 12800
  s_addc_u32 s25, s25, 0
  s_mov_b32 s26, 320
  s_mov_b32 s27, 0x20000
  s_waitcnt vmcnt(0)
  s_barrier
  s_cmp_ge_u32 s43, 27
  s_cbranch_scc1 L_sig2
  s_cmp_lg_u32 s28, 0
  s_cbranch_scc1 L_sig2
  s_mov_b64 exec, 255
  v_lshlrev_b32 v3, 8, v0
  v_add_u32 v3, 10240, v3
  v_mov_b32 v4, 1
  buffer_atomic_add v4, v3, s[52:55], 0 offen sc1
  s_mov_b64 exec, -1
L_sig2:
  s_add_u32 m0, s29, 102400
  s_mov_b32 s33, 819200
  buffer_load_dwordx4 v245, s[56:59], s33 offen sc1 lds
  s_add_u32 m0, s29, 106496
  s_nop 0
  buffer_load_dwordx4 v246, s[56:59], s33 offen sc1 lds
  s_add_u32 m0, s29, 110592
  s_nop 0
  buffer_load_dwordx4 v247, s[56:59], s33 offen sc1 lds
  s_add_u32 m0, s29, 114688
  s_nop 0
  buffer_load_dwordx4 v248, s[56:59], s33 offen sc1 lds
  s_add_u32 m0, s29, 118784
  s_nop 0
  buffer_load_dwordx4 v249, s[56:59], s33 offen sc1 lds
  s_add_u32 m0, s29, 122880
  s_mov_b32 s33, 983040
  buffer_load_dwordx4 v245, s[56:59], s33 offen sc1 lds
  s_add_u32 m0, s29, 126976
  s_nop 0
  buffer_load_dwordx4 v246, s[56:59], s33 offen sc1 lds
  s_add_u32 m0, s29, 131072
  s_nop 0
  buffer_load_dwordx4 v247, s[56:59], s33 offen sc1 lds
  s_add_u32 m0, s29, 135168
  s_nop 0
  buffer_load_dwordx4 v248, s[56:59], s33 offen sc1 lds
  s_add_u32 m0, s29, 139264
  s_nop 0
  buffer_load_dwordx4 v249, s[56:59], s33 offen sc1 lds
  s_cmp_lg_u32 s28, 0
  s_cbranch_scc1 L_got3
  v_mov_b32 v3, 10240
  s_mov_b32 s33, 131072
L_poll3:
  buffer_load_dword v4, v3, s[52:55], s46 offen sc1
  s_sub_u32 s33, s33, 1
  s_cmp_eq_u32 s33, 0
  s_cbranch_scc1 L_got3
  s_waitcnt vmcnt(0)
  v_readfirstlane_b32 s34, v4
  s_cmp_lt_u32 s34, 27
  s_cbranch_scc1 L_poll3
L_got3:
  s_barrier
  s_mov_b32 s34, 0
  s_nop 0
  buffer_load_dwordx4 v[40:43], v2, s[12:15], s34 offen offset:0 sc1
  s_mov_b32 s34, 4096
  buffer_load_dwordx4 v[44:47], v2, s[12:15], s34 offen offset:0 sc1
  s_mov_b32 s34, 8192
  buffer_load_dwordx4 v[48:51], v2, s[12:15], s34 offen offset:0 sc1
  s_mov_b32 s34, 12288
  buffer_load_dwordx4 v[52:55], v2, s[12:15], s34 offen offset:0 sc1
  s_mov_b32 s34, 16384
  buffer_load_dwordx4 v[56:59], v2, s[12:15], s34 offen offset:0 sc1
  s_mov_b32 s34, 20480
  buffer_load_dwordx4 v[60:63], v2, s[12:15], s34 offen offset:0 sc1
  s_mov_b32 s34, 24576
  buffer_load_dwordx4 v[64:67], v2, s[12:15], s34 offen offset:0 sc1
  s_mov_b32 s34, 28672
  buffer_load_dwordx4 v[68:71], v2, s[12:15], s34 offen offset:0 sc1
  s_mov_b32 s34, 32768
  buffer_load_dwordx4 v[72:75], v2, s[12:15], s34 offen offset:0 sc1
  s_mov_b32 s34, 36864
  buffer_load_dwordx4 v[76:79], v2, s[12:15], s34 offen offset:0 sc1
  s_mov_b32 s34, 40960
  buffer_load_dwordx4 v[80:83], v2, s[12:15], s34 offen offset:0 sc1
  s_mov_b32 s34, 45056
  buffer_load_dwordx4 v[84:87], v2, s[12:15], s34 offen offset:0 sc1
  s_mov_b32 s34, 49152
  buffer_load_dwordx4 v[88:91], v2, s[12:15], s34 offen offset:0 sc1
  s_mov_b32 s34, 53248
  buffer_load_dwordx4 v[92:95], v2, s[12:15], s34 offen offset:0 sc1
  s_mov_b32 s34, 57344
  buffer_load_dwordx4 v[96:99], v2, s[12:15], s34 offen offset:0 sc1
  s_mov_b32 s34, 61440
  buffer_load_dwordx4 v[100:103], v2, s[12:15], s34 offen offset:0 sc1
  s_waitcnt vmcnt(12)
  s_barrier
  ds_read_b128 v[120:123], v10 offset:0
  ds_read_b128 v[124:127], v10 offset:5120
  ds_read_b128 v[128:131], v10 offset:10240
  ds_read_b128 v[132:135], v10 offset:15360
  ds_read_b128 v[136:139], v10 offset:1024
  ds_read_b128 v[140:143], v10 offset:6144
  ds_read_b128 v[144:147], v10 offset:11264
  ds_read_b128 v[148:151], v10 offset:16384
  ds_read_b128 v[152:155], v10 offset:2048
  ds_read_b128 v[156:159], v10 offset:7168
  s_waitcnt lgkmcnt(5)
  v_mfma_f32_16x16x32_bf16 v[20:23], v[120:123], v[40:43], 0
  ds_read_b128 v[160:163], v10 offset:12288
  v_mfma_f32_16x16x32_bf16 v[20:23], v[124:127], v[44:47], v[20:23]
  s_mov_b32 s34, 65536
  ds_read_b128 v[164:167], v10 offset:17408
  v_mfma_f32_16x16x32_bf16 v[20:23], v[128:131], v[48:51], v[20:23]
  buffer_load_dwordx4 v[104:107], v2, s[12:15], s34 offen offset:0 sc1
  ds_read_b128 v[168:171], v10 offset:3072
  v_mfma_f32_16x16x32_bf16 v[20:23], v[132:135], v[52:55], v[20:23]
  s_mov_b32 s34, 69632
  ds_read_b128 v[172:175], v10 offset:8192
  v_mfma_f32_16x16x32_bf16 v[24:27], v[136:139], v[40:43], 0
  s_waitcnt lgkmcnt(4)
  ds_read_b128 v[176:179], v10 offset:13312
  v_mfma_f32_16x16x32_bf16 v[24:27], v[140:143], v[44:47], v[24:27]
  buffer_load_dwordx4 v[108:111], v2, s[12:15], s34 offen offset:0 sc1
  ds_read_b128 v[120:123], v10 offset:18432
  v_mfma_f32_16x16x32_bf16 v[24:27], v[144:147], v[48:51], v[24:27]
  ds_read_b128 v[124:127], v10 offset:4096
  v_mfma_f32_16x16x32_bf16 v[24:27], v[148:151], v[52:55], v[24:27]
  s_mov_b32 s34, 73728
  ds_read_b128 v[128:131], v10 offset:9216
  v_mfma_f32_16x16x32_bf16 v[28:31], v[152:155], v[40:43], 0
  s_waitcnt lgkmcnt(3)
  ds_read_b128 v[132:135], v10 offset:14336
  v_mfma_f32_16x16x32_bf16 v[28:31], v[156:159], v[44:47], v[28:31]
  s_waitcnt vmcnt(10)
  ds_read_b128 v[136:139], v10 offset:19456
  v_mfma_f32_16x16x32_bf16 v[28:31], v[160:163], v[48:51], v[28:31]
  s_barrier
  buffer_load_dwordx4 v[112:115], v2, s[12:15], s34 offen offset:0 sc1
  ds_read_b128 v[140:143], v10 offset:20480
  v_mfma_f32_16x16x32_bf16 v[28:31], v[164:167], v[52:55], v[28:31]
  ds_read_b128 v[144:147], v10 offset:25600
  v_mfma_f32_16x16x32_bf16 v[32:35], v[168:171], v[40:43], 0
  ds_read_b128 v[148:151], v10 offset:30720
  v_mfma_f32_16x16x32_bf16 v[32:35], v[172:175], v[44:47], v[32:35]
  s_mov_b32 s34, 77824
  ds_read_b128 v[152:155], v10 offset:35840
  v_mfma_f32_16x16x32_bf16 v[32:35], v[176:179], v[48:51], v[32:35]
  s_waitcnt lgkmcnt(4)
  ds_read_b128 v[156:159], v10 offset:21504
  v_mfma_f32_16x16x32_bf16 v[32:35], v[120:123], v[52:55], v[32:35]
  buffer_load_dwordx4 v[116:119], v2, s[12:15], s34 offen offset:0 sc1
  ds_read_b128 v[160:163], v10 offset:26624
  v_mfma_f32_16x16x32_bf16 v[36:39], v[124:127], v[40:43], 0
  ds_read_b128 v[164:167], v10 offset:31744
  v_mfma_f32_16x16x32_bf16 v[36:39], v[128:131], v[44:47], v[36:39]
  ds_read_b128 v[168:171], v10 offset:36864
  v_mfma_f32_16x16x32_bf16 v[36:39], v[132:135], v[48:51], v[36:39]
  ds_read_b128 v[172:175], v10 offset:22528
  v_mfma_f32_16x16x32_bf16 v[36:39], v[136:139], v[52:55], v[36:39]
  s_waitcnt lgkmcnt(4)
  ds_read_b128 v[176:179], v10 offset:27648
  v_mfma_f32_16x16x32_bf16 v[20:23], v[140:143], v[56:59], v[20:23]
  ds_read_b128 v[120:123], v10 offset:32768
  v_mfma_f32_16x16x32_bf16 v[20:23], v[144:147], v[60:63], v[20:23]
  s_mov_b32 s34, 81920
  ds_read_b128 v[124:127], v10 offset:37888
  v_mfma_f32_16x16x32_bf16 v[20:23], v[148:151], v[64:67], v[20:23]
  buffer_load_dwordx4 v[40:43], v2, s[12:15], s34 offen offset:0 sc1
  ds_read_b128 v[128:131], v10 offset:23552
  v_mfma_f32_16x16x32_bf16 v[20:23], v[152:155], v[68:71], v[20:23]
  s_mov_b32 s34, 86016
  ds_read_b128 v[132:135], v10 offset:28672
  v_mfma_f32_16x16x32_bf16 v[24:27], v[156:159], v[56:59], v[24:27]
  s_waitcnt lgkmcnt(4)
  ds_read_b128 v[136:139], v10 offset:33792
  v_mfma_f32_16x16x32_bf16 v[24:27], v[160:163], v[60:63], v[24:27]
  buffer_load_dwordx4 v[44:47], v2, s[12:15], s34 offen offset:0 sc1
  ds_read_b128 v[140:143], v10 offset:38912
  v_mfma_f32_16x16x32_bf16 v[24:27], v[164:167], v[64:67], v[24:27]
  ds_read_b128 v[144:147], v10 offset:24576
  v_mfma_f32_16x16x32_bf16 v[24:27], v[168:171], v[68:71], v[24:27]
  s_mov_b32 s34, 90112
  ds_read_b128 v[148:151], v10 offset:29696
  v_mfma_f32_16x16x32_bf16 v[28:31], v[172:175], v[56:59], v[28:31]
  s_waitcnt lgkmcnt(3)
  ds_read_b128 v[152:155], v10 offset:34816
  v_mfma_f32_16x16x32_bf16 v[28:31], v[176:179], v[60:63], v[28:31]
  s_waitcnt vmcnt(10)
  ds_read_b128 v[156:159], v10 offset:39936
  v_mfma_f32_16x16x32_bf16 v[28:31], v[120:123], v[64:67], v[28:31]
  s_barrier
  buffer_load_dwordx4 v[48:51], v2, s[12:15], s34 offen offset:0 sc1
  ds_read_b128 v[160:163], v10 offset:40960
  v_mfma_f32_16x16x32_bf16 v[28:31], v[124:127], v[68:71], v[28:31]
  ds_read_b128 v[164:167], v10 offset:46080
  v_mfma_f32_16x16x32_bf16 v[32:35], v[128:131], v[56:59], v[32:35]
  ds_read_b128 v[168:171], v10 offset:51200
  v_mfma_f32_16x16x32_bf16 v[32:35], v[132:135], v[60:63], v[32:35]
  s_mov_b32 s34, 94208
  ds_read_b128 v[172:175], v10 offset:56320
  v_mfma_f32_16x16x32_bf16 v[32:35], v[136:139], v[64:67], v[32:35]
  s_waitcnt lgkmcnt(4)
  ds_read_b128 v[176:179], v10 offset:41984
  v_mfma_f32_16x16x32_bf16 v[32:35], v[140:143], v[68:71], v[32:35]
  buffer_load_dwordx4 v[52:55], v2, s[12:15], s34 offen offset:0 sc1
  ds_read_b128 v[120:123], v10 offset:47104
  v_mfma_f32_16x16x32_bf16 v[36:39], v[144:147], v[56:59], v[36:39]
  ds_read_b128 v[124:127], v10 offset:52224
  v_mfma_f32_16x16x32_bf16 v[36:39], v[148:151], v[60:63], v[36:39]
  ds_read_b128 v[128:131], v10 offset:57344
  v_mfma_f32_16x16x32_bf16 v[36:39], v[152:155], v[64:67], v[36:39]
  ds_read_b128 v[132:135], v10 offset:43008
  v_mfma_f32_16x16x32_bf16 v[36:39], v[156:159], v[68:71], v[36:39]
  s_waitcnt lgkmcnt(4)
  ds_read_b128 v[136:139], v10 offset:48128
  v_mfma_f32_16x16x32_bf16 v[20:23], v[160:163], v[72:75], v[20:23]
  ds_read_b128 v[140:143], v10 offset:53248
  v_mfma_f32_16x16x32_bf16 v[20:23], v[164:167], v[76:79], v[20:23]
  s_mov_b32 s34, 98304
  ds_read_b128 v[144:147], v10 offset:58368
  v_mfma_f32_16x16x32_bf16 v[20:23], v[168:171], v[80:83], v[20:23]
  buffer_load_dwordx4 v[56:59], v2, s[12:15], s34 offen offset:0 sc1
  ds_read_b128 v[148:151], v10 offset:44032
  v_mfma_f32_16x16x32_bf16 v[20:23], v[172:175], v[84:87], v[20:23]
  s_mov_b32 s34, 102400
  ds_read_b128 v[152:155], v10 offset:49152
  v_mfma_f32_16x16x32_bf16 v[24:27], v[176:179], v[72:75], v[24:27]
  s_waitcnt lgkmcnt(4)
  buffer_load_dwordx4 v[60:63], v2, s[12:15], s34 offen offset:0 sc1
  ds_read_b128 v[156:159], v10 offset:54272
  v_mfma_f32_16x16x32_bf16 v[24:27], v[120:123], v[76:79], v[24:27]
  s_mov_b32 s34, 106496
  ds_read_b128 v[160:163], v10 offset:59392
  v_mfma_f32_16x16x32_bf16 v[24:27], v[124:127], v[80:83], v[24:27]
  buffer_load_dwordx4 v[64:67], v2, s[12:15], s34 offen offset:0 sc1
  ds_read_b128 v[164:167], v10 offset:45056
  v_mfma_f32_16x16x32_bf16 v[24:27], v[128:131], v[84:87], v[24:27]
  s_mov_b32 s34, 110592
  ds_read_b128 v[168:171], v10 offset:50176
  v_mfma_f32_16x16x32_bf16 v[28:31], v[132:135], v[72:75], v[28:31]
  s_waitcnt lgkmcnt(3)
  buffer_load_dwordx4 v[68:71], v2, s[12:15], s34 offen offset:0 sc1
  ds_read_b128 v[172:175], v10 offset:55296
  v_mfma_f32_16x16x32_bf16 v[28:31], v[136:139], v[76:79], v[28:31]
  s_waitcnt vmcnt(12)
  ds_read_b128 v[176:179], v10 offset:60416
  v_mfma_f32_16x16x32_bf16 v[28:31], v[140:143], v[80:83], v[28:31]
  s_barrier
  s_add_u32 m0, s29, 0
  s_mov_b32 s33, 1146880
  ds_read_b128 v[120:123], v11 offset:0
  v_mfma_f32_16x16x32_bf16 v[28:31], v[144:147], v[84:87], v[28:31]
  buffer_load_dwordx4 v245, s[56:59], s33 offen sc1 lds
  ds_read_b128 v[124:127], v11 offset:5120
  v_mfma_f32_16x16x32_bf16 v[32:35], v[148:151], v[72:75], v[32:35]
  s_add_u32 m0, s29, 4096
  ds_read_b128 v[128:131], v11 offset:10240
  v_mfma_f32_16x16x32_bf16 v[32:35], v[152:155], v[76:79], v[32:35]
  buffer_load_dwordx4 v246, s[56:59], s33 offen sc1 lds
  ds_read_b128 v[132:135], v11 offset:15360
  v_mfma_f32_16x16x32_bf16 v[32:35], v[156:159], v[80:83], v[32:35]
  s_waitcnt lgkmcnt(4)
  s_add_u32 m0, s29, 8192
  ds_read_b128 v[136:139], v11 offset:1024
  v_mfma_f32_16x16x32_bf16 v[32:35], v[160:163], v[84:87], v[32:35]
  buffer_load_dwordx4 v247, s[56:59], s33 offen sc1 lds
  ds_read_b128 v[140:143], v11 offset:6144
  v_mfma_f32_16x16x32_bf16 v[36:39], v[164:167], v[72:75], v[36:39]
  s_add_u32 m0, s29, 12288
  ds_read_b128 v[144:147], v11 offset:11264
  v_mfma_f32_16x16x32_bf16 v[36:39], v[168:171], v[76:79], v[36:39]
  buffer_load_dwordx4 v248, s[56:59], s33 offen sc1 lds
  ds_read_b128 v[148:151], v11 offset:16384
  v_mfma_f32_16x16x32_bf16 v[36:39], v[172:175], v[80:83], v[36:39]
  s_add_u32 m0, s29, 16384
  ds_read_b128 v[152:155], v11 offset:2048
  v_mfma_f32_16x16x32_bf16 v[36:39], v[176:179], v[84:87], v[36:39]
  s_waitcnt lgkmcnt(4)
  buffer_load_dwordx4 v249, s[56:59], s33 offen sc1 lds
  ds_read_b128 v[156:159], v11 offset:7168
  v_mfma_f32_16x16x32_bf16 v[20:23], v[120:123], v[88:91], v[20:23]
  ds_read_b128 v[160:163], v11 offset:12288
  v_mfma_f32_16x16x32_bf16 v[20:23], v[124:127], v[92:95], v[20:23]
  s_mov_b32 s34, 114688
  ds_read_b128 v[164:167], v11 offset:17408
  v_mfma_f32_16x16x32_bf16 v[20:23], v[128:131], v[96:99], v[20:23]
  buffer_load_dwordx4 v[72:75], v2, s[12:15], s34 offen offset:0 sc1
  ds_read_b128 v[168:171], v11 offset:3072
  v_mfma_f32_16x16x32_bf16 v[20:23], v[132:135], v[100:103], v[20:23]
  s_mov_b32 s34, 118784
  ds_read_b128 v[172:175], v11 offset:8192
  v_mfma_f32_16x16x32_bf16 v[24:27], v[136:139], v[88:91], v[24:27]
  s_waitcnt lgkmcnt(4)
  buffer_load_dwordx4 v[76:79], v2, s[12:15], s34 offen offset:0 sc1
  ds_read_b128 v[176:179], v11 offset:13312
  v_mfma_f32_16x16x32_bf16 v[24:27], v[140:143], v[92:95], v[24:27]
  s_mov_b32 s34, 122880
  ds_read_b128 v[120:123], v11 offset:18432
  v_mfma_f32_16x16x32_bf16 v[24:27], v[144:147], v[96:99], v[24:27]
  buffer_load_dwordx4 v[80:83], v2, s[12:15], s34 offen offset:0 sc1
  ds_read_b128 v[124:127], v11 offset:4096
  v_mfma_f32_16x16x32_bf16 v[24:27], v[148:151], v[100:103], v[24:27]
  s_mov_b32 s34, 126976
  ds_read_b128 v[128:131], v11 offset:9216
  v_mfma_f32_16x16x32_bf16 v[28:31], v[152:155], v[88:91], v[28:31]
  s_waitcnt lgkmcnt(3)
  buffer_load_dwordx4 v[84:87], v2, s[12:15], s34 offen offset:0 sc1
  ds_read_b128 v[132:135], v11 offset:14336
  v_mfma_f32_16x16x32_bf16 v[28:31], v[156:159], v[92:95], v[28:31]
  s_waitcnt vmcnt(17)
  ds_read_b128 v[136:139], v11 offset:19456
  v_mfma_f32_16x16x32_bf16 v[28:31], v[160:163], v[96:99], v[28:31]
  s_barrier
  s_add_u32 m0, s29, 20480
  s_mov_b32 s33, 1310720
  ds_read_b128 v[140:143], v11 offset:20480
  v_mfma_f32_16x16x32_bf16 v[28:31], v[164:167], v[100:103], v[28:31]
  buffer_load_dwordx4 v245, s[56:59], s33 offen sc1 lds
  ds_read_b128 v[144:147], v11 offset:25600
  v_mfma_f32_16x16x32_bf16 v[32:35], v[168:171], v[88:91], v[32:35]
  s_add_u32 m0, s29, 24576
  ds_read_b128 v[148:151], v11 offset:30720
  v_mfma_f32_16x16x32_bf16 v[32:35], v[172:175], v[92:95], v[32:35]
  buffer_load_dwordx4 v246, s[56:59], s33 offen sc1 lds
  ds_read_b128 v[152:155], v11 offset:35840
  v_mfma_f32_16x16x32_bf16 v[32:35], v[176:179], v[96:99], v[32:35]
  s_waitcnt lgkmcnt(4)
  s_add_u32 m0, s29, 28672
  ds_read_b128 v[156:159], v11 offset:21504
  v_mfma_f32_16x16x32_bf16 v[32:35], v[120:123], v[100:103], v[32:35]
  buffer_load_dwordx4 v247, s[56:59], s33 offen sc1 lds
  ds_read_b128 v[160:163], v11 offset:26624
  v_mfma_f32_16x16x32_bf16 v[36:39], v[124:127], v[88:91], v[36:39]
  s_add_u32 m0, s29, 32768
  ds_read_b128 v[164:167], v11 offset:31744
  v_mfma_f32_16x16x32_bf16 v[36:39], v[128:131], v[92:95], v[36:39]
  buffer_load_dwordx4 v248, s[56:59], s33 offen sc1 lds
  ds_read_b128 v[168:171], v11 offset:36864
  v_mfma_f32_16x16x32_bf16 v[36:39], v[132:135], v[96:99], v[36:39]
  s_add_u32 m0, s29, 36864
  ds_read_b128 v[172:175], v11 offset:22528
  v_mfma_f32_16x16x32_bf16 v[36:39], v[136:139], v[100:103], v[36:39]
  s_waitcnt lgkmcnt(4)
  buffer_load_dwordx4 v249, s[56:59], s33 offen sc1 lds
  ds_read_b128 v[176:179], v11 offset:27648
  v_mfma_f32_16x16x32_bf16 v[20:23], v[140:143], v[104:107], v[20:23]
  ds_read_b128 v[120:123], v11 offset:32768
  v_mfma_f32_16x16x32_bf16 v[20:23], v[144:147], v[108:111], v[20:23]
  s_mov_b32 s34, 131072
  ds_read_b128 v[124:127], v11 offset:37888
  v_mfma_f32_16x16x32_bf16 v[20:23], v[148:151], v[112:115], v[20:23]
  buffer_load_dwordx4 v[88:91], v2, s[12:15], s34 offen offset:0 sc1
  ds_read_b128 v[128:131], v11 offset:23552
  v_mfma_f32_16x16x32_bf16 v[20:23], v[152:155], v[116:119], v[20:23]
  s_mov_b32 s34, 135168
  ds_read_b128 v[132:135], v11 offset:28672
  v_mfma_f32_16x16x32_bf16 v[24:27], v[156:159], v[104:107], v[24:27]
  s_waitcnt lgkmcnt(4)
  buffer_load_dwordx4 v[92:95], v2, s[12:15], s34 offen offset:0 sc1
  ds_read_b128 v[136:139], v11 offset:33792
  v_mfma_f32_16x16x32_bf16 v[24:27], v[160:163], v[108:111], v[24:27]
  s_mov_b32 s34, 139264
  ds_read_b128 v[140:143], v11 offset:38912
  v_mfma_f32_16x16x32_bf16 v[24:27], v[164:167], v[112:115], v[24:27]
  buffer_load_dwordx4 v[96:99], v2, s[12:15], s34 offen offset:0 sc1
  ds_read_b128 v[144:147], v11 offset:24576
  v_mfma_f32_16x16x32_bf16 v[24:27], v[168:171], v[116:119], v[24:27]
  s_mov_b32 s34, 143360
  ds_read_b128 v[148:151], v11 offset:29696
  v_mfma_f32_16x16x32_bf16 v[28:31], v[172:175], v[104:107], v[28:31]
  s_waitcnt lgkmcnt(3)
  buffer_load_dwordx4 v[100:103], v2, s[12:15], s34 offen offset:0 sc1
  ds_read_b128 v[152:155], v11 offset:34816
  v_mfma_f32_16x16x32_bf16 v[28:31], v[176:179], v[108:111], v[28:31]
  s_waitcnt vmcnt(22)
  ds_read_b128 v[156:159], v11 offset:39936
  v_mfma_f32_16x16x32_bf16 v[28:31], v[120:123], v[112:115], v[28:31]
  s_barrier
  s_add_u32 m0, s29, 40960
  s_mov_b32 s33, 1474560
  ds_read_b128 v[160:163], v11 offset:40960
  v_mfma_f32_16x16x32_bf16 v[28:31], v[124:127], v[116:119], v[28:31]
  buffer_load_dwordx4 v245, s[56:59], s33 offen sc1 lds
  ds_read_b128 v[164:167], v11 offset:46080
  v_mfma_f32_16x16x32_bf16 v[32:35], v[128:131], v[104:107], v[32:35]
  s_add_u32 m0, s29, 45056
  ds_read_b128 v[168:171], v11 offset:51200
  v_mfma_f32_16x16x32_bf16 v[32:35], v[132:135], v[108:111], v[32:35]
  buffer_load_dwordx4 v246, s[56:59], s33 offen sc1 lds
  ds_read_b128 v[172:175], v11 offset:56320
  v_mfma_f32_16x16x32_bf16 v[32:35], v[136:139], v[112:115], v[32:35]
  s_waitcnt lgkmcnt(4)
  s_add_u32 m0, s29, 49152
  ds_read_b128 v[176:179], v11 offset:41984
  v_mfma_f32_16x16x32_bf16 v[32:35], v[140:143], v[116:119], v[32:35]
  buffer_load_dwordx4 v247, s[56:59], s33 offen sc1 lds
  ds_read_b128 v[120:123], v11 offset:47104
  v_mfma_f32_16x16x32_bf16 v[36:39], v[144:147], v[104:107], v[36:39]
  s_add_u32 m0, s29, 53248
  ds_read_b128 v[124:127], v11 offset:52224
  v_mfma_f32_16x16x32_bf16 v[36:39], v[148:151], v[108:111], v[36:39]
  buffer_load_dwordx4 v248, s[56:59], s33 offen sc1 lds
  ds_read_b128 v[128:131], v11 offset:57344
  v_mfma_f32_16x16x32_bf16 v[36:39], v[152:155], v[112:115], v[36:39]
  s_add_u32 m0, s29, 57344
  ds_read_b128 v[132:135], v11 offset:43008
  v_mfma_f32_16x16x32_bf16 v[36:39], v[156:159], v[116:119], v[36:39]
  s_waitcnt lgkmcnt(4)
  buffer_load_dwordx4 v249, s[56:59], s33 offen sc1 lds
  ds_read_b128 v[136:139], v11 offset:48128
  v_mfma_f32_16x16x32_bf16 v[20:23], v[160:163], v[40:43], v[20:23]
  ds_read_b128 v[140:143], v11 offset:53248
  v_mfma_f32_16x16x32_bf16 v[20:23], v[164:167], v[44:47], v[20:23]
  s_mov_b32 s34, 147456
  ds_read_b128 v[144:147], v11 offset:58368
  v_mfma_f32_16x16x32_bf16 v[20:23], v[168:171], v[48:51], v[20:23]
  buffer_load_dwordx4 v[104:107], v2, s[12:15], s34 offen offset:0 sc1
  ds_read_b128 v[148:151], v11 offset:44032
  v_mfma_f32_16x16x32_bf16 v[20:23], v[172:175], v[52:55], v[20:23]
  s_mov_b32 s34, 151552
  ds_read_b128 v[152:155], v11 offset:49152
  v_mfma_f32_16x16x32_bf16 v[24:27], v[176:179], v[40:43], v[24:27]
  s_waitcnt lgkmcnt(4)
  buffer_load_dwordx4 v[108:111], v2, s[12:15], s34 offen offset:0 sc1
  ds_read_b128 v[156:159], v11 offset:54272
  v_mfma_f32_16x16x32_bf16 v[24:27], v[120:123], v[44:47], v[24:27]
  s_mov_b32 s34, 155648
  ds_read_b128 v[160:163], v11 offset:59392
  v_mfma_f32_16x16x32_bf16 v[24:27], v[124:127], v[48:51], v[24:27]
  buffer_load_dwordx4 v[112:115], v2, s[12:15], s34 offen offset:0 sc1
  ds_read_b128 v[164:167], v11 offset:45056
  v_mfma_f32_16x16x32_bf16 v[24:27], v[128:131], v[52:55], v[24:27]
  s_mov_b32 s34, 159744
  ds_read_b128 v[168:171], v11 offset:50176
  v_mfma_f32_16x16x32_bf16 v[28:31], v[132:135], v[40:43], v[28:31]
  s_waitcnt lgkmcnt(3)
  buffer_load_dwordx4 v[116:119], v2, s[12:15], s34 offen offset:0 sc1
  ds_read_b128 v[172:175], v11 offset:55296
  v_mfma_f32_16x16x32_bf16 v[28:31], v[136:139], v[44:47], v[28:31]
  s_waitcnt vmcnt(27)
  ds_read_b128 v[176:179], v11 offset:60416
  v_mfma_f32_16x16x32_bf16 v[28:31], v[140:143], v[48:51], v[28:31]
  s_barrier
  s_add_u32 m0, s29, 61440
  s_mov_b32 s33, 1638400
  ds_read_b128 v[120:123], v12 offset:0
  v_mfma_f32_16x16x32_bf16 v[28:31], v[144:147], v[52:55], v[28:31]
  buffer_load_dwordx4 v245, s[56:59], s33 offen sc1 lds
  ds_read_b128 v[124:127], v12 offset:5120
  v_mfma_f32_16x16x32_bf16 v[32:35], v[148:151], v[40:43], v[32:35]
  s_add_u32 m0, s29, 65536
  ds_read_b128 v[128:131], v12 offset:10240
  v_mfma_f32_16x16x32_bf16 v[32:35], v[152:155], v[44:47], v[32:35]
  buffer_load_dwordx4 v246, s[56:59], s33 offen sc1 lds
  ds_read_b128 v[132:135], v12 offset:15360
  v_mfma_f32_16x16x32_bf16 v[32:35], v[156:159], v[48:51], v[32:35]
  s_waitcnt lgkmcnt(4)
  s_add_u32 m0, s29, 69632
  ds_read_b128 v[136:139], v12 offset:1024
  v_mfma_f32_16x16x32_bf16 v[32:35], v[160:163], v[52:55], v[32:35]
  buffer_load_dwordx4 v247, s[56:59], s33 offen sc1 lds
  ds_read_b128 v[140:143], v12 offset:6144
  v_mfma_f32_16x16x32_bf16 v[36:39], v[164:167], v[40:43], v[36:39]
  s_add_u32 m0, s29, 73728
  ds_read_b128 v[144:147], v12 offset:11264
  v_mfma_f32_16x16x32_bf16 v[36:39], v[168:171], v[44:47], v[36:39]
  buffer_load_dwordx4 v248, s[56:59], s33 offen sc1 lds
  ds_read_b128 v[148:151], v12 offset:16384
  v_mfma_f32_16x16x32_bf16 v[36:39], v[172:175], v[48:51], v[36:39]
  s_add_u32 m0, s29, 77824
  ds_read_b128 v[152:155], v12 offset:2048
  v_mfma_f32_16x16x32_bf16 v[36:39], v[176:179], v[52:55], v[36:39]
  s_waitcnt lgkmcnt(4)
  buffer_load_dwordx4 v249, s[56:59], s33 offen sc1 lds
  ds_read_b128 v[156:159], v12 offset:7168
  v_mfma_f32_16x16x32_bf16 v[20:23], v[120:123], v[56:59], v[20:23]
  ds_read_b128 v[160:163], v12 offset:12288
  v_mfma_f32_16x16x32_bf16 v[20:23], v[124:127], v[60:63], v[20:23]
  s_mov_b32 s34, 163840
  ds_read_b128 v[164:167], v12 offset:17408
  v_mfma_f32_16x16x32_bf16 v[20:23], v[128:131], v[64:67], v[20:23]
  buffer_load_dwordx4 v[40:43], v2, s[12:15], s34 offen offset:0 sc1
  ds_read_b128 v[168:171], v12 offset:3072
  v_mfma_f32_16x16x32_bf16 v[20:23], v[132:135], v[68:71], v[20:23]
  s_mov_b32 s34, 167936
  ds_read_b128 v[172:175], v12 offset:8192
  v_mfma_f32_16x16x32_bf16 v[24:27], v[136:139], v[56:59], v[24:27]
  s_waitcnt lgkmcnt(4)
  buffer_load_dwordx4 v[44:47], v2, s[12:15], s34 offen offset:0 sc1
  ds_read_b128 v[176:179], v12 offset:13312
  v_mfma_f32_16x16x32_bf16 v[24:27], v[140:143], v[60:63], v[24:27]
  s_mov_b32 s34, 172032
  ds_read_b128 v[120:123], v12 offset:18432
  v_mfma_f32_16x16x32_bf16 v[24:27], v[144:147], v[64:67], v[24:27]
  buffer_load_dwordx4 v[48:51], v2, s[12:15], s34 offen offset:0 sc1
  ds_read_b128 v[124:127], v12 offset:4096
  v_mfma_f32_16x16x32_bf16 v[24:27], v[148:151], v[68:71], v[24:27]
  s_mov_b32 s34, 176128
  ds_read_b128 v[128:131], v12 offset:9216
  v_mfma_f32_16x16x32_bf16 v[28:31], v[152:155], v[56:59], v[28:31]
  s_waitcnt lgkmcnt(3)
  buffer_load_dwordx4 v[52:55], v2, s[12:15], s34 offen offset:0 sc1
  ds_read_b128 v[132:135], v12 offset:14336
  v_mfma_f32_16x16x32_bf16 v[28:31], v[156:159], v[60:63], v[28:31]
  s_waitcnt vmcnt(27)
  ds_read_b128 v[136:139], v12 offset:19456
  v_mfma_f32_16x16x32_bf16 v[28:31], v[160:163], v[64:67], v[28:31]
  s_barrier
  s_add_u32 m0, s29, 81920
  s_mov_b32 s33, 1802240
  ds_read_b128 v[140:143], v10 offset:0
  v_mfma_f32_16x16x32_bf16 v[28:31], v[164:167], v[68:71], v[28:31]
  buffer_load_dwordx4 v245, s[56:59], s33 offen sc1 lds
  ds_read_b128 v[144:147], v10 offset:5120
  v_mfma_f32_16x16x32_bf16 v[32:35], v[168:171], v[56:59], v[32:35]
  s_add_u32 m0, s29, 86016
  ds_read_b128 v[148:151], v10 offset:10240
  v_mfma_f32_16x16x32_bf16 v[32:35], v[172:175], v[60:63], v[32:35]
  buffer_load_dwordx4 v246, s[56:59], s33 offen sc1 lds
  ds_read_b128 v[152:155], v10 offset:15360
  v_mfma_f32_16x16x32_bf16 v[32:35], v[176:179], v[64:67], v[32:35]
  s_waitcnt lgkmcnt(4)
  s_add_u32 m0, s29, 90112
  ds_read_b128 v[156:159], v10 offset:1024
  v_mfma_f32_16x16x32_bf16 v[32:35], v[120:123], v[68:71], v[32:35]
  buffer_load_dwordx4 v247, s[56:59], s33 offen sc1 lds
  ds_read_b128 v[160:163], v10 offset:6144
  v_mfma_f32_16x16x32_bf16 v[36:39], v[124:127], v[56:59], v[36:39]
  s_add_u32 m0, s29, 94208
  ds_read_b128 v[164:167], v10 offset:11264
  v_mfma_f32_16x16x32_bf16 v[36:39], v[128:131], v[60:63], v[36:39]
  buffer_load_dwordx4 v248, s[56:59], s33 offen sc1 lds
  ds_read_b128 v[168:171], v10 offset:16384
  v_mfma_f32_16x16x32_bf16 v[36:39], v[132:135], v[64:67], v[36:39]
  s_add_u32 m0, s29, 98304
  ds_read_b128 v[172:175], v10 offset:2048
  v_mfma_f32_16x16x32_bf16 v[36:39], v[136:139], v[68:71], v[36:39]
  s_waitcnt lgkmcnt(4)
  buffer_load_dwordx4 v249, s[56:59], s33 offen sc1 lds
  ds_read_b128 v[176:179], v10 offset:7168
  v_mfma_f32_16x16x32_bf16 v[20:23], v[140:143], v[72:75], v[20:23]
  ds_read_b128 v[120:123], v10 offset:12288
  v_mfma_f32_16x16x32_bf16 v[20:23], v[144:147], v[76:79], v[20:23]
  s_mov_b32 s34, 180224
  ds_read_b128 v[124:127], v10 offset:17408
  v_mfma_f32_16x16x32_bf16 v[20:23], v[148:151], v[80:83], v[20:23]
  buffer_load_dwordx4 v[56:59], v2, s[12:15], s34 offen offset:0 sc1
  ds_read_b128 v[128:131], v10 offset:3072
  v_mfma_f32_16x16x32_bf16 v[20:23], v[152:155], v[84:87], v[20:23]
  s_mov_b32 s34, 184320
  ds_read_b128 v[132:135], v10 offset:8192
  v_mfma_f32_16x16x32_bf16 v[24:27], v[156:159], v[72:75], v[24:27]
  s_waitcnt lgkmcnt(4)
  buffer_load_dwordx4 v[60:63], v2, s[12:15], s34 offen offset:0 sc1
  ds_read_b128 v[136:139], v10 offset:13312
  v_mfma_f32_16x16x32_bf16 v[24:27], v[160:163], v[76:79], v[24:27]
  s_mov_b32 s34, 188416
  ds_read_b128 v[140:143], v10 offset:18432
  v_mfma_f32_16x16x32_bf16 v[24:27], v[164:167], v[80:83], v[24:27]
  buffer_load_dwordx4 v[64:67], v2, s[12:15], s34 offen offset:0 sc1
  ds_read_b128 v[144:147], v10 offset:4096
  v_mfma_f32_16x16x32_bf16 v[24:27], v[168:171], v[84:87], v[24:27]
  s_mov_b32 s34, 192512
  ds_read_b128 v[148:151], v10 offset:9216
  v_mfma_f32_16x16x32_bf16 v[28:31], v[172:175], v[72:75], v[28:31]
  s_waitcnt lgkmcnt(3)
  buffer_load_dwordx4 v[68:71], v2, s[12:15], s34 offen offset:0 sc1
  ds_read_b128 v[152:155], v10 offset:14336
  v_mfma_f32_16x16x32_bf16 v[28:31], v[176:179], v[76:79], v[28:31]
  s_waitcnt vmcnt(27)
  ds_read_b128 v[156:159], v10 offset:19456
  v_mfma_f32_16x16x32_bf16 v[28:31], v[120:123], v[80:83], v[28:31]
  s_barrier
  s_add_u32 m0, s29, 102400
  s_mov_b32 s33, 1966080
  ds_read_b128 v[160:163], v10 offset:20480
  v_mfma_f32_16x16x32_bf16 v[28:31], v[124:127], v[84:87], v[28:31]
  buffer_load_dwordx4 v245, s[56:59], s33 offen sc1 lds
  ds_read_b128 v[164:167], v10 offset:25600
  v_mfma_f32_16x16x32_bf16 v[32:35], v[128:131], v[72:75], v[32:35]
  s_add_u32 m0, s29, 106496
  ds_read_b128 v[168:171], v10 offset:30720
  v_mfma_f32_16x16x32_bf16 v[32:35], v[132:135], v[76:79], v[32:35]
  buffer_load_dwordx4 v246, s[56:59], s33 offen sc1 lds
  ds_read_b128 v[172:175], v10 offset:35840
  v_mfma_f32_16x16x32_bf16 v[32:35], v[136:139], v[80:83], v[32:35]
  s_waitcnt lgkmcnt(4)
  s_add_u32 m0, s29, 110592
  ds_read_b128 v[176:179], v10 offset:21504
  v_mfma_f32_16x16x32_bf16 v[32:35], v[140:143], v[84:87], v[32:35]
  buffer_load_dwordx4 v247, s[56:59], s33 offen sc1 lds
  ds_read_b128 v[120:123], v10 offset:26624
  v_mfma_f32_16x16x32_bf16 v[36:39], v[144:147], v[72:75], v[36:39]
  s_add_u32 m0, s29, 114688
  ds_read_b128 v[124:127], v10 offset:31744
  v_mfma_f32_16x16x32_bf16 v[36:39], v[148:151], v[76:79], v[36:39]
  buffer_load_dwordx4 v248, s[56:59], s33 offen sc1 lds
  ds_read_b128 v[128:131], v10 offset:36864
  v_mfma_f32_16x16x32_bf16 v[36:39], v[152:155], v[80:83], v[36:39]
  s_add_u32 m0, s29, 118784
  ds_read_b128 v[132:135], v10 offset:22528
  v_mfma_f32_16x16x32_bf16 v[36:39], v[156:159], v[84:87], v[36:39]
  s_waitcnt lgkmcnt(4)
  buffer_load_dwordx4 v249, s[56:59], s33 offen sc1 lds
  ds_read_b128 v[136:139], v10 offset:27648
  v_mfma_f32_16x16x32_bf16 v[20:23], v[160:163], v[88:91], v[20:23]
  ds_read_b128 v[140:143], v10 offset:32768
  v_mfma_f32_16x16x32_bf16 v[20:23], v[164:167], v[92:95], v[20:23]
  s_mov_b32 s34, 196608
  ds_read_b128 v[144:147], v10 offset:37888
  v_mfma_f32_16x16x32_bf16 v[20:23], v[168:171], v[96:99], v[20:23]
  buffer_load_dwordx4 v[72:75], v2, s[12:15], s34 offen offset:0 sc1
  ds_read_b128 v[148:151], v10 offset:23552
  v_mfma_f32_16x16x32_bf16 v[20:23], v[172:175], v[100:103], v[20:23]
  s_mov_b32 s34, 200704
  ds_read_b128 v[152:155], v10 offset:28672
  v_mfma_f32_16x16x32_bf16 v[24:27], v[176:179], v[88:91], v[24:27]
  s_waitcnt lgkmcnt(4)
  buffer_load_dwordx4 v[76:79], v2, s[12:15], s34 offen offset:0 sc1
  ds_read_b128 v[156:159], v10 offset:33792
  v_mfma_f32_16x16x32_bf16 v[24:27], v[120:123], v[92:95], v[24:27]
  s_mov_b32 s34, 204800
  ds_read_b128 v[160:163], v10 offset:38912
  v_mfma_f32_16x16x32_bf16 v[24:27], v[124:127], v[96:99], v[24:27]
  buffer_load_dwordx4 v[80:83], v2, s[12:15], s34 offen offset:0 sc1
  ds_read_b128 v[164:167], v10 offset:24576
  v_mfma_f32_16x16x32_bf16 v[24:27], v[128:131], v[100:103], v[24:27]
  s_mov_b32 s34, 208896
  ds_read_b128 v[168:171], v10 offset:29696
  v_mfma_f32_16x16x32_bf16 v[28:31], v[132:135], v[88:91], v[28:31]
  s_waitcnt lgkmcnt(3)
  buffer_load_dwordx4 v[84:87], v2, s[12:15], s34 offen offset:0 sc1
  ds_read_b128 v[172:175], v10 offset:34816
  v_mfma_f32_16x16x32_bf16 v[28:31], v[136:139], v[92:95], v[28:31]
  s_waitcnt vmcnt(27)
  ds_read_b128 v[176:179], v10 offset:39936
  v_mfma_f32_16x16x32_bf16 v[28:31], v[140:143], v[96:99], v[28:31]
  s_barrier
  s_add_u32 m0, s29, 122880
  s_mov_b32 s33, 2129920
  ds_read_b128 v[120:123], v10 offset:40960
  v_mfma_f32_16x16x32_bf16 v[28:31], v[144:147], v[100:103], v[28:31]
  buffer_load_dwordx4 v245, s[56:59], s33 offen sc1 lds
  ds_read_b128 v[124:127], v10 offset:46080
  v_mfma_f32_16x16x32_bf16 v[32:35], v[148:151], v[88:91], v[32:35]
  s_add_u32 m0, s29, 126976
  ds_read_b128 v[128:131], v10 offset:51200
  v_mfma_f32_16x16x32_bf16 v[32:35], v[152:155], v[92:95], v[32:35]
  buffer_load_dwordx4 v246, s[56:59], s33 offen sc1 lds
  ds_read_b128 v[132:135], v10 offset:56320
  v_mfma_f32_16x16x32_bf16 v[32:35], v[156:159], v[96:99], v[32:35]
  s_waitcnt lgkmcnt(4)
  s_add_u32 m0, s29, 131072
  ds_read_b128 v[136:139], v10 offset:41984
  v_mfma_f32_16x16x32_bf16 v[32:35], v[160:163], v[100:103], v[32:35]
  buffer_load_dwordx4 v247, s[56:59], s33 offen sc1 lds
  ds_read_b128 v[140:143], v10 offset:47104
  v_mfma_f32_16x16x32_bf16 v[36:39], v[164:167], v[88:91], v[36:39]
  s_add_u32 m0, s29, 135168
  ds_read_b128 v[144:147], v10 offset:52224
  v_mfma_f32_16x16x32_bf16 v[36:39], v[168:171], v[92:95], v[36:39]
  buffer_load_dwordx4 v248, s[56:59], s33 offen sc1 lds
  ds_read_b128 v[148:151], v10 offset:57344
  v_mfma_f32_16x16x32_bf16 v[36:39], v[172:175], v[96:99], v[36:39]
  s_add_u32 m0, s29, 139264
  ds_read_b128 v[152:155], v10 offset:43008
  v_mfma_f32_16x16x32_bf16 v[36:39], v[176:179], v[100:103], v[36:39]
  s_waitcnt lgkmcnt(4)
  buffer_load_dwordx4 v249, s[56:59], s33 offen sc1 lds
  ds_read_b128 v[156:159], v10 offset:48128
  v_mfma_f32_16x16x32_bf16 v[20:23], v[120:123], v[104:107], v[20:23]
  ds_read_b128 v[160:163], v10 offset:53248
  v_mfma_f32_16x16x32_bf16 v[20:23], v[124:127], v[108:111], v[20:23]
  s_mov_b32 s34, 212992
  ds_read_b128 v[164:167], v10 offset:58368
  v_mfma_f32_16x16x32_bf16 v[20:23], v[128:131], v[112:115], v[20:23]
  buffer_load_dwordx4 v[88:91], v2, s[12:15], s34 offen offset:0 sc1
  ds_read_b128 v[168:171], v10 offset:44032
  v_mfma_f32_16x16x32_bf16 v[20:23], v[132:135], v[116:119], v[20:23]
  s_mov_b32 s34, 217088
  ds_read_b128 v[172:175], v10 offset:49152
  v_mfma_f32_16x16x32_bf16 v[24:27], v[136:139], v[104:107], v[24:27]
  s_waitcnt lgkmcnt(4)
  buffer_load_dwordx4 v[92:95], v2, s[12:15], s34 offen offset:0 sc1
  ds_read_b128 v[176:179], v10 offset:54272
  v_mfma_f32_16x16x32_bf16 v[24:27], v[140:143], v[108:111], v[24:27]
  s_mov_b32 s34, 221184
  ds_read_b128 v[120:123], v10 offset:59392
  v_mfma_f32_16x16x32_bf16 v[24:27], v[144:147], v[112:115], v[24:27]
  buffer_load_dwordx4 v[96:99], v2, s[12:15], s34 offen offset:0 sc1
  ds_read_b128 v[124:127], v10 offset:45056
  v_mfma_f32_16x16x32_bf16 v[24:27], v[148:151], v[116:119], v[24:27]
  s_mov_b32 s34, 225280
  ds_read_b128 v[128:131], v10 offset:50176
  v_mfma_f32_16x16x32_bf16 v[28:31], v[152:155], v[104:107], v[28:31]
  s_waitcnt lgkmcnt(3)
  buffer_load_dwordx4 v[100:103], v2, s[12:15], s34 offen offset:0 sc1
  ds_read_b128 v[132:135], v10 offset:55296
  v_mfma_f32_16x16x32_bf16 v[28:31], v[156:159], v[108:111], v[28:31]
  s_waitcnt vmcnt(27)
  buffer_load_dwordx2 v[180:181], v2, s[20:23], s60 offen sc1
  ds_read_b128 v[136:139], v10 offset:60416
  v_mfma_f32_16x16x32_bf16 v[28:31], v[160:163], v[112:115], v[28:31]
  s_barrier
  ds_read_b128 v[140:143], v11 offset:0
  v_mfma_f32_16x16x32_bf16 v[28:31], v[164:167], v[116:119], v[28:31]
  buffer_load_dwordx2 v[182:183], v2, s[20:23], s61 offen sc1
  ds_read_b128 v[144:147], v11 offset:5120
  v_mfma_f32_16x16x32_bf16 v[32:35], v[168:171], v[104:107], v[32:35]
  ds_read_b128 v[148:151], v11 offset:10240
  v_mfma_f32_16x16x32_bf16 v[32:35], v[172:175], v[108:111], v[32:35]
  buffer_load_dwordx2 v[184:185], v2, s[20:23], s62 offen sc1
  ds_read_b128 v[152:155], v11 offset:15360
  v_mfma_f32_16x16x32_bf16 v[32:35], v[176:179], v[112:115], v[32:35]
  s_waitcnt lgkmcnt(4)
  ds_read_b128 v[156:159], v11 offset:1024
  v_mfma_f32_16x16x32_bf16 v[32:35], v[120:123], v[116:119], v[32:35]
  buffer_load_dwordx2 v[186:187], v2, s[20:23], s63 offen sc1
  ds_read_b128 v[160:163], v11 offset:6144
  v_mfma_f32_16x16x32_bf16 v[36:39], v[124:127], v[104:107], v[36:39]
  ds_read_b128 v[164:167], v11 offset:11264
  v_mfma_f32_16x16x32_bf16 v[36:39], v[128:131], v[108:111], v[36:39]
  buffer_load_dwordx2 v[188:189], v2, s[20:23], s64 offen sc1
  ds_read_b128 v[168:171], v11 offset:16384
  v_mfma_f32_16x16x32_bf16 v[36:39], v[132:135], v[112:115], v[36:39]
  ds_read_b128 v[172:175], v11 offset:2048
  v_mfma_f32_16x16x32_bf16 v[36:39], v[136:139], v[116:119], v[36:39]
  s_waitcnt lgkmcnt(4)
  ds_read_b128 v[176:179], v11 offset:7168
  v_mfma_f32_16x16x32_bf16 v[20:23], v[140:143], v[40:43], v[20:23]
  ds_read_b128 v[120:123], v11 offset:12288
  v_mfma_f32_16x16x32_bf16 v[20:23], v[144:147], v[44:47], v[20:23]
  buffer_load_dwordx4 v[192:195], v19, s[24:27], 0 offen offset:0 sc1
  ds_read_b128 v[124:127], v11 offset:17408
  v_mfma_f32_16x16x32_bf16 v[20:23], v[148:151], v[48:51], v[20:23]
  ds_read_b128 v[128:131], v11 offset:3072
  v_mfma_f32_16x16x32_bf16 v[20:23], v[152:155], v[52:55], v[20:23]
  ds_read_b128 v[132:135], v11 offset:8192
  v_mfma_f32_16x16x32_bf16 v[24:27], v[156:159], v[40:43], v[24:27]
  s_waitcnt lgkmcnt(4)
  buffer_load_dwordx4 v[196:199], v19, s[24:27], 0 offen offset:64 sc1
  ds_read_b128 v[136:139], v11 offset:13312
  v_mfma_f32_16x16x32_bf16 v[24:27], v[160:163], v[44:47], v[24:27]
  ds_read_b128 v[140:143], v11 offset:18432
  v_mfma_f32_16x16x32_bf16 v[24:27], v[164:167], v[48:51], v[24:27]
  ds_read_b128 v[144:147], v11 offset:4096
  v_mfma_f32_16x16x32_bf16 v[24:27], v[168:171], v[52:55], v[24:27]
  ds_read_b128 v[148:151], v11 offset:9216
  v_mfma_f32_16x16x32_bf16 v[28:31], v[172:175], v[40:43], v[28:31]
  s_waitcnt lgkmcnt(3)
  buffer_load_dwordx4 v[200:203], v19, s[24:27], 0 offen offset:128 sc1
  ds_read_b128 v[152:155], v11 offset:14336
  v_mfma_f32_16x16x32_bf16 v[28:31], v[176:179], v[44:47], v[28:31]
  s_waitcnt vmcnt(26)
  ds_read_b128 v[156:159], v11 offset:19456
  v_mfma_f32_16x16x32_bf16 v[28:31], v[120:123], v[48:51], v[28:31]
  s_barrier
  ds_read_b128 v[160:163], v11 offset:20480
  v_mfma_f32_16x16x32_bf16 v[28:31], v[124:127], v[52:55], v[28:31]
  ds_read_b128 v[164:167], v11 offset:25600
  v_mfma_f32_16x16x32_bf16 v[32:35], v[128:131], v[40:43], v[32:35]
  buffer_load_dwordx4 v[204:207], v19, s[24:27], 0 offen offset:192 sc1
  ds_read_b128 v[168:171], v11 offset:30720
  v_mfma_f32_16x16x32_bf16 v[32:35], v[132:135], v[44:47], v[32:35]
  ds_read_b128 v[172:175], v11 offset:35840
  v_mfma_f32_16x16x32_bf16 v[32:35], v[136:139], v[48:51], v[32:35]
  s_waitcnt lgkmcnt(4)
  ds_read_b128 v[176:179], v11 offset:21504
  v_mfma_f32_16x16x32_bf16 v[32:35], v[140:143], v[52:55], v[32:35]
  ds_read_b128 v[120:123], v11 offset:26624
  v_mfma_f32_16x16x32_bf16 v[36:39], v[144:147], v[40:43], v[36:39]
  buffer_load_dwordx4 v[208:211], v19, s[24:27], 0 offen offset:256 sc1
  ds_read_b128 v[124:127], v11 offset:31744
  v_mfma_f32_16x16x32_bf16 v[36:39], v[148:151], v[44:47], v[36:39]
  ds_read_b128 v[128:131], v11 offset:36864
  v_mfma_f32_16x16x32_bf16 v[36:39], v[152:155], v[48:51], v[36:39]
  ds_read_b128 v[132:135], v11 offset:22528
  v_mfma_f32_16x16x32_bf16 v[36:39], v[156:159], v[52:55], v[36:39]
  s_waitcnt lgkmcnt(4)
  ds_read_b128 v[136:139], v11 offset:27648
  v_mfma_f32_16x16x32_bf16 v[20:23], v[160:163], v[56:59], v[20:23]
  ds_read_b128 v[140:143], v11 offset:32768
  v_mfma_f32_16x16x32_bf16 v[20:23], v[164:167], v[60:63], v[20:23]
  ds_read_b128 v[144:147], v11 offset:37888
  v_mfma_f32_16x16x32_bf16 v[20:23], v[168:171], v[64:67], v[20:23]
  ds_read_b128 v[148:151], v11 offset:23552
  v_mfma_f32_16x16x32_bf16 v[20:23], v[172:175], v[68:71], v[20:23]
  ds_read_b128 v[152:155], v11 offset:28672
  v_mfma_f32_16x16x32_bf16 v[24:27], v[176:179], v[56:59], v[24:27]
  s_waitcnt lgkmcnt(4)
  ds_read_b128 v[156:159], v11 offset:33792
  v_mfma_f32_16x16x32_bf16 v[24:27], v[120:123], v[60:63], v[24:27]
  ds_read_b128 v[160:163], v11 offset:38912
  v_mfma_f32_16x16x32_bf16 v[24:27], v[124:127], v[64:67], v[24:27]
  ds_read_b128 v[164:167], v11 offset:24576
  v_mfma_f32_16x16x32_bf16 v[24:27], v[128:131], v[68:71], v[24:27]
  ds_read_b128 v[168:171], v11 offset:29696
  v_mfma_f32_16x16x32_bf16 v[28:31], v[132:135], v[56:59], v[28:31]
  s_waitcnt lgkmcnt(3)
  ds_read_b128 v[172:175], v11 offset:34816
  v_mfma_f32_16x16x32_bf16 v[28:31], v[136:139], v[60:63], v[28:31]
  s_waitcnt vmcnt(19)
  ds_read_b128 v[176:179], v11 offset:39936
  v_mfma_f32_16x16x32_bf16 v[28:31], v[140:143], v[64:67], v[28:31]
  s_barrier
  ds_read_b128 v[120:123], v11 offset:40960
  v_mfma_f32_16x16x32_bf16 v[28:31], v[144:147], v[68:71], v[28:31]
  ds_read_b128 v[124:127], v11 offset:46080
  v_mfma_f32_16x16x32_bf16 v[32:35], v[148:151], v[56:59], v[32:35]
  ds_read_b128 v[128:131], v11 offset:51200
  v_mfma_f32_16x16x32_bf16 v[32:35], v[152:155], v[60:63], v[32:35]
  ds_read_b128 v[132:135], v11 offset:56320
  v_mfma_f32_16x16x32_bf16 v[32:35], v[156:159], v[64:67], v[32:35]
  s_waitcnt lgkmcnt(4)
  ds_read_b128 v[136:139], v11 offset:41984
  v_mfma_f32_16x16x32_bf16 v[32:35], v[160:163], v[68:71], v[32:35]
  ds_read_b128 v[140:143], v11 offset:47104
  v_mfma_f32_16x16x32_bf16 v[36:39], v[164:167], v[56:59], v[36:39]
  ds_read_b128 v[144:147], v11 offset:52224
  v_mfma_f32_16x16x32_bf16 v[36:39], v[168:171], v[60:63], v[36:39]
  ds_read_b128 v[148:151], v11 offset:57344
  v_mfma_f32_16x16x32_bf16 v[36:39], v[172:175], v[64:67], v[36:39]
  ds_read_b128 v[152:155], v11 offset:43008
  v_mfma_f32_16x16x32_bf16 v[36:39], v[176:179], v[68:71], v[36:39]
  s_waitcnt lgkmcnt(4)
  ds_read_b128 v[156:159], v11 offset:48128
  v_mfma_f32_16x16x32_bf16 v[20:23], v[120:123], v[72:75], v[20:23]
  ds_read_b128 v[160:163], v11 offset:53248
  v_mfma_f32_16x16x32_bf16 v[20:23], v[124:127], v[76:79], v[20:23]
  ds_read_b128 v[164:167], v11 offset:58368
  v_mfma_f32_16x16x32_bf16 v[20:23], v[128:131], v[80:83], v[20:23]
  ds_read_b128 v[168:171], v11 offset:44032
  v_mfma_f32_16x16x32_bf16 v[20:23], v[132:135], v[84:87], v[20:23]
  ds_read_b128 v[172:175], v11 offset:49152
  v_mfma_f32_16x16x32_bf16 v[24:27], v[136:139], v[72:75], v[24:27]
  s_waitcnt lgkmcnt(4)
  ds_read_b128 v[176:179], v11 offset:54272
  v_mfma_f32_16x16x32_bf16 v[24:27], v[140:143], v[76:79], v[24:27]
  ds_read_b128 v[120:123], v11 offset:59392
  v_mfma_f32_16x16x32_bf16 v[24:27], v[144:147], v[80:83], v[24:27]
  ds_read_b128 v[124:127], v11 offset:45056
  v_mfma_f32_16x16x32_bf16 v[24:27], v[148:151], v[84:87], v[24:27]
  ds_read_b128 v[128:131], v11 offset:50176
  v_mfma_f32_16x16x32_bf16 v[28:31], v[152:155], v[72:75], v[28:31]
  s_waitcnt lgkmcnt(3)
  ds_read_b128 v[132:135], v11 offset:55296
  v_mfma_f32_16x16x32_bf16 v[28:31], v[156:159], v[76:79], v[28:31]
  s_waitcnt vmcnt(10)
  ds_read_b128 v[136:139], v11 offset:60416
  v_mfma_f32_16x16x32_bf16 v[28:31], v[160:163], v[80:83], v[28:31]
  s_barrier
  ds_read_b128 v[140:143], v12 offset:0
  v_mfma_f32_16x16x32_bf16 v[28:31], v[164:167], v[84:87], v[28:31]
  ds_read_b128 v[144:147], v12 offset:5120
  v_mfma_f32_16x16x32_bf16 v[32:35], v[168:171], v[72:75], v[32:35]
  ds_read_b128 v[148:151], v12 offset:1024
  v_mfma_f32_16x16x32_bf16 v[32:35], v[172:175], v[76:79], v[32:35]
  ds_read_b128 v[152:155], v12 offset:6144
  v_mfma_f32_16x16x32_bf16 v[32:35], v[176:179], v[80:83], v[32:35]
  s_waitcnt lgkmcnt(4)
  ds_read_b128 v[156:159], v12 offset:2048
  v_mfma_f32_16x16x32_bf16 v[32:35], v[120:123], v[84:87], v[32:35]
  ds_read_b128 v[160:163], v12 offset:7168
  v_mfma_f32_16x16x32_bf16 v[36:39], v[124:127], v[72:75], v[36:39]
  ds_read_b128 v[164:167], v12 offset:3072
  v_mfma_f32_16x16x32_bf16 v[36:39], v[128:131], v[76:79], v[36:39]
  ds_read_b128 v[168:171], v12 offset:8192
  v_mfma_f32_16x16x32_bf16 v[36:39], v[132:135], v[80:83], v[36:39]
  ds_read_b128 v[172:175], v12 offset:4096
  v_mfma_f32_16x16x32_bf16 v[36:39], v[136:139], v[84:87], v[36:39]
  s_waitcnt lgkmcnt(4)
  ds_read_b128 v[176:179], v12 offset:9216
  v_mfma_f32_16x16x32_bf16 v[20:23], v[140:143], v[88:91], v[20:23]
  v_mfma_f32_16x16x32_bf16 v[20:23], v[144:147], v[92:95], v[20:23]
  v_mfma_f32_16x16x32_bf16 v[24:27], v[148:151], v[88:91], v[24:27]
  v_mfma_f32_16x16x32_bf16 v[24:27], v[152:155], v[92:95], v[24:27]
  v_mfma_f32_16x16x32_bf16 v[28:31], v[156:159], v[88:91], v[28:31]
  s_waitcnt lgkmcnt(0)
  v_mfma_f32_16x16x32_bf16 v[28:31], v[160:163], v[92:95], v[28:31]
  v_mfma_f32_16x16x32_bf16 v[32:35], v[164:167], v[88:91], v[32:35]
  v_mfma_f32_16x16x32_bf16 v[32:35], v[168:171], v[92:95], v[32:35]
  v_mfma_f32_16x16x32_bf16 v[36:39], v[172:175], v[88:91], v[36:39]
  v_mfma_f32_16x16x32_bf16 v[36:39], v[176:179], v[92:95], v[36:39]
  s_waitcnt vmcnt(0)
  v_lshlrev_b32 v4, 16, v180
  v_and_b32 v5, 0xffff0000, v180
  v_fmac_f32 v4, v20, v192
  v_fmac_f32 v5, v21, v193
  v_cvt_pk_bf16_f32 v180, v4, v5
  v_lshlrev_b32 v6, 16, v181
  v_and_b32 v7, 0xffff0000, v181
  v_fmac_f32 v6, v22, v194
  v_fmac_f32 v7, v23, v195
  v_cvt_pk_bf16_f32 v181, v6, v7
  buffer_store_dwordx2 v[180:181], v18, s[16:19], 0 offen offset:0
  v_lshlrev_b32 v4, 16, v182
  v_and_b32 v5, 0xffff0000, v182
  v_fmac_f32 v4, v24, v196
  v_fmac_f32 v5, v25, v197
  v_cvt_pk_bf16_f32 v182, v4, v5
  v_lshlrev_b32 v6, 16, v183
  v_and_b32 v7, 0xffff0000, v183
  v_fmac_f32 v6, v26, v198
  v_fmac_f32 v7, v27, v199
  v_cvt_pk_bf16_f32 v183, v6, v7
  buffer_store_dwordx2 v[182:183], v18, s[16:19], 0 offen offset:32
  v_lshlrev_b32 v4, 16, v184
  v_and_b32 v5, 0xffff0000, v184
  v_fmac_f32 v4, v28, v200
  v_fmac_f32 v5, v29, v201
  v_cvt_pk_bf16_f32 v184, v4, v5
  v_lshlrev_b32 v6, 16, v185
  v_and_b32 v7, 0xffff0000, v185
  v_fmac_f32 v6, v30, v202
  v_fmac_f32 v7, v31, v203
  v_cvt_pk_bf16_f32 v185, v6, v7
  buffer_store_dwordx2 v[184:185], v18, s[16:19], 0 offen offset:64
  v_lshlrev_b32 v4, 16, v186
  v_and_b32 v5, 0xffff0000, v186
  v_fmac_f32 v4, v32, v204
  v_fmac_f32 v5, v33, v205
  v_cvt_pk_bf16_f32 v186, v4, v5
  v_lshlrev_b32 v6, 16, v187
  v_and_b32 v7, 0xffff0000, v187
  v_fmac_f32 v6, v34, v206
  v_fmac_f32 v7, v35, v207
  v_cvt_pk_bf16_f32 v187, v6, v7
  buffer_store_dwordx2 v[186:187], v18, s[16:19], 0 offen offset:96
  v_lshlrev_b32 v4, 16, v188
  v_and_b32 v5, 0xffff0000, v188
  v_fmac_f32 v4, v36, v208
  v_fmac_f32 v5, v37, v209
  v_cvt_pk_bf16_f32 v188, v4, v5
  v_lshlrev_b32 v6, 16, v189
  v_and_b32 v7, 0xffff0000, v189
  v_fmac_f32 v6, v38, v210
  v_fmac_f32 v7, v39, v211
  v_cvt_pk_bf16_f32 v189, v6, v7
  buffer_store_dwordx2 v[188:189], v18, s[16:19], 0 offen offset:128
L_end:
  s_endpgm
L_hotend:
L_rarez0a:
  s_nop 15
  v_max3_f32 v1, v84, v85, v86
  v_max3_f32 v1, v1, v87, v88
  v_max3_f32 v1, v1, v89, v90
  v_max_f32 v1, v1, v91
  v_mov_b32 v2, v1
  s_nop 1
  v_permlane16_swap_b32 v1, v2
  v_max_f32 v1, v1, v2
  v_mov_b32 v2, v1
  s_nop 1
  v_permlane32_swap_b32 v1, v2
  v_max_f32 v1, v1, v2
  v_add_f32 v1, v7, v1
  v_max_f32 v1, 0, v1
  v_ceil_f32 v1, v1
  v_exp_f32 v2, -v1
  s_nop 0
  v_lshlrev_b32 v3, 16, v132
  v_and_b32 v4, 0xffff0000, v132
  v_mul_f32 v3, v3, v2
  v_mul_f32 v4, v4, v2
  v_cvt_pk_bf16_f32 v132, v3, v4
  v_lshlrev_b32 v3, 16, v133
  v_and_b32 v4, 0xffff0000, v133
  v_mul_f32 v3, v3, v2
  v_mul_f32 v4, v4, v2
  v_cvt_pk_bf16_f32 v133, v3, v4
  v_lshlrev_b32 v3, 16, v134
  v_and_b32 v4, 0xffff0000, v134
  v_mul_f32 v3, v3, v2
  v_mul_f32 v4, v4, v2
  v_cvt_pk_bf16_f32 v134, v3, v4
  v_lshlrev_b32 v3, 16, v135
  v_and_b32 v4, 0xffff0000, v135
  v_mul_f32 v3, v3, v2
  v_mul_f32 v4, v4, v2
  v_cvt_pk_bf16_f32 v135, v3, v4
  v_accvgpr_read_b32 v3, a0
  v_mul_f32 v3, v3, v2
  v_accvgpr_write_b32 a0, v3
  v_accvgpr_read_b32 v4, a1
  v_mul_f32 v4, v4, v2
  v_accvgpr_write_b32 a1, v4
  v_accvgpr_read_b32 v5, a2
  v_mul_f32 v5, v5, v2
  v_accvgpr_write_b32 a2, v5
  v_accvgpr_read_b32 v3, a3
  v_mul_f32 v3, v3, v2
  v_accvgpr_write_b32 a3, v3
  v_accvgpr_read_b32 v4, a4
  v_mul_f32 v4, v4, v2
  v_accvgpr_write_b32 a4, v4
  v_accvgpr_read_b32 v5, a5
  v_mul_f32 v5, v5, v2
  v_accvgpr_write_b32 a5, v5
  v_accvgpr_read_b32 v3, a6
  v_mul_f32 v3, v3, v2
  v_accvgpr_write_b32 a6, v3
  v_accvgpr_read_b32 v4, a7
  v_mul_f32 v4, v4, v2
  v_accvgpr_write_b32 a7, v4
  v_accvgpr_read_b32 v5, a8
  v_mul_f32 v5, v5, v2
  v_accvgpr_write_b32 a8, v5
  v_accvgpr_read_b32 v3, a9
  v_mul_f32 v3, v3, v2
  v_accvgpr_write_b32 a9, v3
  v_accvgpr_read_b32 v4, a10
  v_mul_f32 v4, v4, v2
  v_accvgpr_write_b32 a10, v4
  v_accvgpr_read_b32 v5, a11
  v_mul_f32 v5, v5, v2
  v_accvgpr_write_b32 a11, v5
  v_accvgpr_read_b32 v3, a12
  v_mul_f32 v3, v3, v2
  v_accvgpr_write_b32 a12, v3
  v_accvgpr_read_b32 v4, a13
  v_mul_f32 v4, v4, v2
  v_accvgpr_write_b32 a13, v4
  v_accvgpr_read_b32 v5, a14
  v_mul_f32 v5, v5, v2
  v_accvgpr_write_b32 a14, v5
  v_accvgpr_read_b32 v3, a15
  v_mul_f32 v3, v3, v2
  v_accvgpr_write_b32 a15, v3
  v_accvgpr_read_b32 v4, a16
  v_mul_f32 v4, v4, v2
  v_accvgpr_write_b32 a16, v4
  v_accvgpr_read_b32 v5, a17
  v_mul_f32 v5, v5, v2
  v_accvgpr_write_b32 a17, v5
  v_accvgpr_read_b32 v3, a18
  v_mul_f32 v3, v3, v2
  v_accvgpr_write_b32 a18, v3
  v_accvgpr_read_b32 v4, a19
  v_mul_f32 v4, v4, v2
  v_accvgpr_write_b32 a19, v4
  v_accvgpr_read_b32 v5, a20
  v_mul_f32 v5, v5, v2
  v_accvgpr_write_b32 a20, v5
  v_accvgpr_read_b32 v3, a21
  v_mul_f32 v3, v3, v2
  v_accvgpr_write_b32 a21, v3
  v_accvgpr_read_b32 v4, a22
  v_mul_f32 v4, v4, v2
  v_accvgpr_write_b32 a22, v4
  v_accvgpr_read_b32 v5, a23
  v_mul_f32 v5, v5, v2
  v_accvgpr_write_b32 a23, v5
  v_accvgpr_read_b32 v3, a24
  v_mul_f32 v3, v3, v2
  v_accvgpr_write_b32 a24, v3
  v_accvgpr_read_b32 v4, a25
  v_mul_f32 v4, v4, v2
  v_accvgpr_write_b32 a25, v4
  v_accvgpr_read_b32 v5, a26
  v_mul_f32 v5, v5, v2
  v_accvgpr_write_b32 a26, v5
  v_accvgpr_read_b32 v3, a27
  v_mul_f32 v3, v3, v2
  v_accvgpr_write_b32 a27, v3
  v_accvgpr_read_b32 v4, a28
  v_mul_f32 v4, v4, v2
  v_accvgpr_write_b32 a28, v4
  v_accvgpr_read_b32 v5, a29
  v_mul_f32 v5, v5, v2
  v_accvgpr_write_b32 a29, v5
  v_accvgpr_read_b32 v3, a30
  v_mul_f32 v3, v3, v2
  v_accvgpr_write_b32 a30, v3
  v_accvgpr_read_b32 v4, a31
  v_mul_f32 v4, v4, v2
  v_accvgpr_write_b32 a31, v4
  v_accvgpr_read_b32 v5, a224
  v_mul_f32 v5, v5, v2
  v_accvgpr_write_b32 a224, v5
  v_accvgpr_read_b32 v3, a225
  v_mul_f32 v3, v3, v2
  v_accvgpr_write_b32 a225, v3
  v_accvgpr_read_b32 v4, a226
  v_mul_f32 v4, v4, v2
  v_accvgpr_write_b32 a226, v4
  v_accvgpr_read_b32 v5, a227
  v_mul_f32 v5, v5, v2
  v_accvgpr_write_b32 a227, v5
  v_sub_f32 v116, v116, v1
  v_sub_f32 v117, v117, v1
  v_sub_f32 v118, v118, v1
  v_sub_f32 v119, v119, v1
  v_sub_f32 v84, v84, v1
  v_sub_f32 v85, v85, v1
  v_sub_f32 v86, v86, v1
  v_sub_f32 v87, v87, v1
  v_sub_f32 v88, v88, v1
  v_sub_f32 v89, v89, v1
  v_sub_f32 v90, v90, v1
  v_sub_f32 v91, v91, v1
  v_sub_f32 v52, v52, v1
  v_sub_f32 v53, v53, v1
  v_sub_f32 v54, v54, v1
  v_sub_f32 v55, v55, v1
  v_sub_f32 v56, v56, v1
  v_sub_f32 v57, v57, v1
  v_sub_f32 v58, v58, v1
  v_sub_f32 v59, v59, v1
  v_max3_f32 v1, v92, v93, v94
  v_max3_f32 v1, v1, v95, v96
  v_max3_f32 v1, v1, v97, v98
  v_max_f32 v1, v1, v99
  v_mov_b32 v2, v1
  s_nop 1
  v_permlane16_swap_b32 v1, v2
  v_max_f32 v1, v1, v2
  v_mov_b32 v2, v1
  s_nop 1
  v_permlane32_swap_b32 v1, v2
  v_max_f32 v1, v1, v2
  v_add_f32 v1, v7, v1
  v_max_f32 v1, 0, v1
  v_ceil_f32 v1, v1
  v_exp_f32 v2, -v1
  s_nop 0
  v_lshlrev_b32 v3, 16, v136
  v_and_b32 v4, 0xffff0000, v136
  v_mul_f32 v3, v3, v2
  v_mul_f32 v4, v4, v2
  v_cvt_pk_bf16_f32 v136, v3, v4
  v_lshlrev_b32 v3, 16, v137
  v_and_b32 v4, 0xffff0000, v137
  v_mul_f32 v3, v3, v2
  v_mul_f32 v4, v4, v2
  v_cvt_pk_bf16_f32 v137, v3, v4
  v_lshlrev_b32 v3, 16, v138
  v_and_b32 v4, 0xffff0000, v138
  v_mul_f32 v3, v3, v2
  v_mul_f32 v4, v4, v2
  v_cvt_pk_bf16_f32 v138, v3, v4
  v_lshlrev_b32 v3, 16, v139
  v_and_b32 v4, 0xffff0000, v139
  v_mul_f32 v3, v3, v2
  v_mul_f32 v4, v4, v2
  v_cvt_pk_bf16_f32 v139, v3, v4
  v_accvgpr_read_b32 v3, a32
  v_mul_f32 v3, v3, v2
  v_accvgpr_write_b32 a32, v3
  v_accvgpr_read_b32 v4, a33
  v_mul_f32 v4, v4, v2
  v_accvgpr_write_b32 a33, v4
  v_accvgpr_read_b32 v5, a34
  v_mul_f32 v5, v5, v2
  v_accvgpr_write_b32 a34, v5
  v_accvgpr_read_b32 v3, a35
  v_mul_f32 v3, v3, v2
  v_accvgpr_write_b32 a35, v3
  v_accvgpr_read_b32 v4, a36
  v_mul_f32 v4, v4, v2
  v_accvgpr_write_b32 a36, v4
  v_accvgpr_read_b32 v5, a37
  v_mul_f32 v5, v5, v2
  v_accvgpr_write_b32 a37, v5
  v_accvgpr_read_b32 v3, a38
  v_mul_f32 v3, v3, v2
  v_accvgpr_write_b32 a38, v3
  v_accvgpr_read_b32 v4, a39
  v_mul_f32 v4, v4, v2
  v_accvgpr_write_b32 a39, v4
  v_accvgpr_read_b32 v5, a40
  v_mul_f32 v5, v5, v2
  v_accvgpr_write_b32 a40, v5
  v_accvgpr_read_b32 v3, a41
  v_mul_f32 v3, v3, v2
  v_accvgpr_write_b32 a41, v3
  v_accvgpr_read_b32 v4, a42
  v_mul_f32 v4, v4, v2
  v_accvgpr_write_b32 a42, v4
  v_accvgpr_read_b32 v5, a43
  v_mul_f32 v5, v5, v2
  v_accvgpr_write_b32 a43, v5
  v_accvgpr_read_b32 v3, a44
  v_mul_f32 v3, v3, v2
  v_accvgpr_write_b32 a44, v3
  v_accvgpr_read_b32 v4, a45
  v_mul_f32 v4, v4, v2
  v_accvgpr_write_b32 a45, v4
  v_accvgpr_read_b32 v5, a46
  v_mul_f32 v5, v5, v2
  v_accvgpr_write_b32 a46, v5
  v_accvgpr_read_b32 v3, a47
  v_mul_f32 v3, v3, v2
  v_accvgpr_write_b32 a47, v3
  v_accvgpr_read_b32 v4, a48
  v_mul_f32 v4, v4, v2
  v_accvgpr_write_b32 a48, v4
  v_accvgpr_read_b32 v5, a49
  v_mul_f32 v5, v5, v2
  v_accvgpr_write_b32 a49, v5
  v_accvgpr_read_b32 v3, a50
  v_mul_f32 v3, v3, v2
  v_accvgpr_write_b32 a50, v3
  v_accvgpr_read_b32 v4, a51
  v_mul_f32 v4, v4, v2
  v_accvgpr_write_b32 a51, v4
  v_accvgpr_read_b32 v5, a52
  v_mul_f32 v5, v5, v2
  v_accvgpr_write_b32 a52, v5
  v_accvgpr_read_b32 v3, a53
  v_mul_f32 v3, v3, v2
  v_accvgpr_write_b32 a53, v3
  v_accvgpr_read_b32 v4, a54
  v_mul_f32 v4, v4, v2
  v_accvgpr_write_b32 a54, v4
  v_accvgpr_read_b32 v5, a55
  v_mul_f32 v5, v5, v2
  v_accvgpr_write_b32 a55, v5
  v_accvgpr_read_b32 v3, a56
  v_mul_f32 v3, v3, v2
  v_accvgpr_write_b32 a56, v3
  v_accvgpr_read_b32 v4, a57
  v_mul_f32 v4, v4, v2
  v_accvgpr_write_b32 a57, v4
  v_accvgpr_read_b32 v5, a58
  v_mul_f32 v5, v5, v2
  v_accvgpr_write_b32 a58, v5
  v_accvgpr_read_b32 v3, a59
  v_mul_f32 v3, v3, v2
  v_accvgpr_write_b32 a59, v3
  v_accvgpr_read_b32 v4, a60
  v_mul_f32 v4, v4, v2
  v_accvgpr_write_b32 a60, v4
  v_accvgpr_read_b32 v5, a61
  v_mul_f32 v5, v5, v2
  v_accvgpr_write_b32 a61, v5
  v_accvgpr_read_b32 v3, a62
  v_mul_f32 v3, v3, v2
  v_accvgpr_write_b32 a62, v3
  v_accvgpr_read_b32 v4, a63
  v_mul_f32 v4, v4, v2
  v_accvgpr_write_b32 a63, v4
  v_accvgpr_read_b32 v5, a228
  v_mul_f32 v5, v5, v2
  v_accvgpr_write_b32 a228, v5
  v_accvgpr_read_b32 v3, a229
  v_mul_f32 v3, v3, v2
  v_accvgpr_write_b32 a229, v3
  v_accvgpr_read_b32 v4, a230
  v_mul_f32 v4, v4, v2
  v_accvgpr_write_b32 a230, v4
  v_accvgpr_read_b32 v5, a231
  v_mul_f32 v5, v5, v2
  v_accvgpr_write_b32 a231, v5
  v_sub_f32 v120, v120, v1
  v_sub_f32 v121, v121, v1
  v_sub_f32 v122, v122, v1
  v_sub_f32 v123, v123, v1
  v_sub_f32 v92, v92, v1
  v_sub_f32 v93, v93, v1
  v_sub_f32 v94, v94, v1
  v_sub_f32 v95, v95, v1
  v_sub_f32 v96, v96, v1
  v_sub_f32 v97, v97, v1
  v_sub_f32 v98, v98, v1
  v_sub_f32 v99, v99, v1
  v_sub_f32 v60, v60, v1
  v_sub_f32 v61, v61, v1
  v_sub_f32 v62, v62, v1
  v_sub_f32 v63, v63, v1
  v_sub_f32 v64, v64, v1
  v_sub_f32 v65, v65, v1
  v_sub_f32 v66, v66, v1
  v_sub_f32 v67, v67, v1
  v_max3_f32 v1, v100, v101, v102
  v_max3_f32 v1, v1, v103, v104
  v_max3_f32 v1, v1, v105, v106
  v_max_f32 v1, v1, v107
  v_mov_b32 v2, v1
  s_nop 1
  v_permlane16_swap_b32 v1, v2
  v_max_f32 v1, v1, v2
  v_mov_b32 v2, v1
  s_nop 1
  v_permlane32_swap_b32 v1, v2
  v_max_f32 v1, v1, v2
  v_add_f32 v1, v7, v1
  v_max_f32 v1, 0, v1
  v_ceil_f32 v1, v1
  v_exp_f32 v2, -v1
  s_nop 0
  v_lshlrev_b32 v3, 16, v140
  v_and_b32 v4, 0xffff0000, v140
  v_mul_f32 v3, v3, v2
  v_mul_f32 v4, v4, v2
  v_cvt_pk_bf16_f32 v140, v3, v4
  v_lshlrev_b32 v3, 16, v141
  v_and_b32 v4, 0xffff0000, v141
  v_mul_f32 v3, v3, v2
  v_mul_f32 v4, v4, v2
  v_cvt_pk_bf16_f32 v141, v3, v4
  v_lshlrev_b32 v3, 16, v142
  v_and_b32 v4, 0xffff0000, v142
  v_mul_f32 v3, v3, v2
  v_mul_f32 v4, v4, v2
  v_cvt_pk_bf16_f32 v142, v3, v4
  v_lshlrev_b32 v3, 16, v143
  v_and_b32 v4, 0xffff0000, v143
  v_mul_f32 v3, v3, v2
  v_mul_f32 v4, v4, v2
  v_cvt_pk_bf16_f32 v143, v3, v4
  v_accvgpr_read_b32 v3, a64
  v_mul_f32 v3, v3, v2
  v_accvgpr_write_b32 a64, v3
  v_accvgpr_read_b32 v4, a65
  v_mul_f32 v4, v4, v2
  v_accvgpr_write_b32 a65, v4
  v_accvgpr_read_b32 v5, a66
  v_mul_f32 v5, v5, v2
  v_accvgpr_write_b32 a66, v5
  v_accvgpr_read_b32 v3, a67
  v_mul_f32 v3, v3, v2
  v_accvgpr_write_b32 a67, v3
  v_accvgpr_read_b32 v4, a68
  v_mul_f32 v4, v4, v2
  v_accvgpr_write_b32 a68, v4
  v_accvgpr_read_b32 v5, a69
  v_mul_f32 v5, v5, v2
  v_accvgpr_write_b32 a69, v5
  v_accvgpr_read_b32 v3, a70
  v_mul_f32 v3, v3, v2
  v_accvgpr_write_b32 a70, v3
  v_accvgpr_read_b32 v4, a71
  v_mul_f32 v4, v4, v2
  v_accvgpr_write_b32 a71, v4
  v_accvgpr_read_b32 v5, a72
  v_mul_f32 v5, v5, v2
  v_accvgpr_write_b32 a72, v5
  v_accvgpr_read_b32 v3, a73
  v_mul_f32 v3, v3, v2
  v_accvgpr_write_b32 a73, v3
  v_accvgpr_read_b32 v4, a74
  v_mul_f32 v4, v4, v2
  v_accvgpr_write_b32 a74, v4
  v_accvgpr_read_b32 v5, a75
  v_mul_f32 v5, v5, v2
  v_accvgpr_write_b32 a75, v5
  v_accvgpr_read_b32 v3, a76
  v_mul_f32 v3, v3, v2
  v_accvgpr_write_b32 a76, v3
  v_accvgpr_read_b32 v4, a77
  v_mul_f32 v4, v4, v2
  v_accvgpr_write_b32 a77, v4
  v_accvgpr_read_b32 v5, a78
  v_mul_f32 v5, v5, v2
  v_accvgpr_write_b32 a78, v5
  v_accvgpr_read_b32 v3, a79
  v_mul_f32 v3, v3, v2
  v_accvgpr_write_b32 a79, v3
  v_accvgpr_read_b32 v4, a80
  v_mul_f32 v4, v4, v2
  v_accvgpr_write_b32 a80, v4
  v_accvgpr_read_b32 v5, a81
  v_mul_f32 v5, v5, v2
  v_accvgpr_write_b32 a81, v5
  v_accvgpr_read_b32 v3, a82
  v_mul_f32 v3, v3, v2
  v_accvgpr_write_b32 a82, v3
  v_accvgpr_read_b32 v4, a83
  v_mul_f32 v4, v4, v2
  v_accvgpr_write_b32 a83, v4
  v_accvgpr_read_b32 v5, a84
  v_mul_f32 v5, v5, v2
  v_accvgpr_write_b32 a84, v5
  v_accvgpr_read_b32 v3, a85
  v_mul_f32 v3, v3, v2
  v_accvgpr_write_b32 a85, v3
  v_accvgpr_read_b32 v4, a86
  v_mul_f32 v4, v4, v2
  v_accvgpr_write_b32 a86, v4
  v_accvgpr_read_b32 v5, a87
  v_mul_f32 v5, v5, v2
  v_accvgpr_write_b32 a87, v5
  v_accvgpr_read_b32 v3, a88
  v_mul_f32 v3, v3, v2
  v_accvgpr_write_b32 a88, v3
  v_accvgpr_read_b32 v4, a89
  v_mul_f32 v4, v4, v2
  v_accvgpr_write_b32 a89, v4
  v_accvgpr_read_b32 v5, a90
  v_mul_f32 v5, v5, v2
  v_accvgpr_write_b32 a90, v5
  v_accvgpr_read_b32 v3, a91
  v_mul_f32 v3, v3, v2
  v_accvgpr_write_b32 a91, v3
  v_accvgpr_read_b32 v4, a92
  v_mul_f32 v4, v4, v2
  v_accvgpr_write_b32 a92, v4
  v_accvgpr_read_b32 v5, a93
  v_mul_f32 v5, v5, v2
  v_accvgpr_write_b32 a93, v5
  v_accvgpr_read_b32 v3, a94
  v_mul_f32 v3, v3, v2
  v_accvgpr_write_b32 a94, v3
  v_accvgpr_read_b32 v4, a95
  v_mul_f32 v4, v4, v2
  v_accvgpr_write_b32 a95, v4
  v_accvgpr_read_b32 v5, a232
  v_mul_f32 v5, v5, v2
  v_accvgpr_write_b32 a232, v5
  v_accvgpr_read_b32 v3, a233
  v_mul_f32 v3, v3, v2
  v_accvgpr_write_b32 a233, v3
  v_accvgpr_read_b32 v4, a234
  v_mul_f32 v4, v4, v2
  v_accvgpr_write_b32 a234, v4
  v_accvgpr_read_b32 v5, a235
  v_mul_f32 v5, v5, v2
  v_accvgpr_write_b32 a235, v5
  v_sub_f32 v124, v124, v1
  v_sub_f32 v125, v125, v1
  v_sub_f32 v126, v126, v1
  v_sub_f32 v127, v127, v1
  v_sub_f32 v100, v100, v1
  v_sub_f32 v101, v101, v1
  v_sub_f32 v102, v102, v1
  v_sub_f32 v103, v103, v1
  v_sub_f32 v104, v104, v1
  v_sub_f32 v105, v105, v1
  v_sub_f32 v106, v106, v1
  v_sub_f32 v107, v107, v1
  v_sub_f32 v68, v68, v1
  v_sub_f32 v69, v69, v1
  v_sub_f32 v70, v70, v1
  v_sub_f32 v71, v71, v1
  v_sub_f32 v72, v72, v1
  v_sub_f32 v73, v73, v1
  v_sub_f32 v74, v74, v1
  v_sub_f32 v75, v75, v1
  v_max3_f32 v1, v108, v109, v110
  v_max3_f32 v1, v1, v111, v112
  v_max3_f32 v1, v1, v113, v114
  v_max_f32 v1, v1, v115
  v_mov_b32 v2, v1
  s_nop 1
  v_permlane16_swap_b32 v1, v2
  v_max_f32 v1, v1, v2
  v_mov_b32 v2, v1
  s_nop 1
  v_permlane32_swap_b32 v1, v2
  v_max_f32 v1, v1, v2
  v_add_f32 v1, v7, v1
  v_max_f32 v1, 0, v1
  v_ceil_f32 v1, v1
  v_exp_f32 v2, -v1
  s_nop 0
  v_lshlrev_b32 v3, 16, v144
  v_and_b32 v4, 0xffff0000, v144
  v_mul_f32 v3, v3, v2
  v_mul_f32 v4, v4, v2
  v_cvt_pk_bf16_f32 v144, v3, v4
  v_lshlrev_b32 v3, 16, v145
  v_and_b32 v4, 0xffff0000, v145
  v_mul_f32 v3, v3, v2
  v_mul_f32 v4, v4, v2
  v_cvt_pk_bf16_f32 v145, v3, v4
  v_lshlrev_b32 v3, 16, v146
  v_and_b32 v4, 0xffff0000, v146
  v_mul_f32 v3, v3, v2
  v_mul_f32 v4, v4, v2
  v_cvt_pk_bf16_f32 v146, v3, v4
  v_lshlrev_b32 v3, 16, v147
  v_and_b32 v4, 0xffff0000, v147
  v_mul_f32 v3, v3, v2
  v_mul_f32 v4, v4, v2
  v_cvt_pk_bf16_f32 v147, v3, v4
  v_accvgpr_read_b32 v3, a96
  v_mul_f32 v3, v3, v2
  v_accvgpr_write_b32 a96, v3
  v_accvgpr_read_b32 v4, a97
  v_mul_f32 v4, v4, v2
  v_accvgpr_write_b32 a97, v4
  v_accvgpr_read_b32 v5, a98
  v_mul_f32 v5, v5, v2
  v_accvgpr_write_b32 a98, v5
  v_accvgpr_read_b32 v3, a99
  v_mul_f32 v3, v3, v2
  v_accvgpr_write_b32 a99, v3
  v_accvgpr_read_b32 v4, a100
  v_mul_f32 v4, v4, v2
  v_accvgpr_write_b32 a100, v4
  v_accvgpr_read_b32 v5, a101
  v_mul_f32 v5, v5, v2
  v_accvgpr_write_b32 a101, v5
  v_accvgpr_read_b32 v3, a102
  v_mul_f32 v3, v3, v2
  v_accvgpr_write_b32 a102, v3
  v_accvgpr_read_b32 v4, a103
  v_mul_f32 v4, v4, v2
  v_accvgpr_write_b32 a103, v4
  v_accvgpr_read_b32 v5, a104
  v_mul_f32 v5, v5, v2
  v_accvgpr_write_b32 a104, v5
  v_accvgpr_read_b32 v3, a105
  v_mul_f32 v3, v3, v2
  v_accvgpr_write_b32 a105, v3
  v_accvgpr_read_b32 v4, a106
  v_mul_f32 v4, v4, v2
  v_accvgpr_write_b32 a106, v4
  v_accvgpr_read_b32 v5, a107
  v_mul_f32 v5, v5, v2
  v_accvgpr_write_b32 a107, v5
  v_accvgpr_read_b32 v3, a108
  v_mul_f32 v3, v3, v2
  v_accvgpr_write_b32 a108, v3
  v_accvgpr_read_b32 v4, a109
  v_mul_f32 v4, v4, v2
  v_accvgpr_write_b32 a109, v4
  v_accvgpr_read_b32 v5, a110
  v_mul_f32 v5, v5, v2
  v_accvgpr_write_b32 a110, v5
  v_accvgpr_read_b32 v3, a111
  v_mul_f32 v3, v3, v2
  v_accvgpr_write_b32 a111, v3
  v_accvgpr_read_b32 v4, a112
  v_mul_f32 v4, v4, v2
  v_accvgpr_write_b32 a112, v4
  v_accvgpr_read_b32 v5, a113
  v_mul_f32 v5, v5, v2
  v_accvgpr_write_b32 a113, v5
  v_accvgpr_read_b32 v3, a114
  v_mul_f32 v3, v3, v2
  v_accvgpr_write_b32 a114, v3
  v_accvgpr_read_b32 v4, a115
  v_mul_f32 v4, v4, v2
  v_accvgpr_write_b32 a115, v4
  v_accvgpr_read_b32 v5, a116
  v_mul_f32 v5, v5, v2
  v_accvgpr_write_b32 a116, v5
  v_accvgpr_read_b32 v3, a117
  v_mul_f32 v3, v3, v2
  v_accvgpr_write_b32 a117, v3
  v_accvgpr_read_b32 v4, a118
  v_mul_f32 v4, v4, v2
  v_accvgpr_write_b32 a118, v4
  v_accvgpr_read_b32 v5, a119
  v_mul_f32 v5, v5, v2
  v_accvgpr_write_b32 a119, v5
  v_accvgpr_read_b32 v3, a120
  v_mul_f32 v3, v3, v2
  v_accvgpr_write_b32 a120, v3
  v_accvgpr_read_b32 v4, a121
  v_mul_f32 v4, v4, v2
  v_accvgpr_write_b32 a121, v4
  v_accvgpr_read_b32 v5, a122
  v_mul_f32 v5, v5, v2
  v_accvgpr_write_b32 a122, v5
  v_accvgpr_read_b32 v3, a123
  v_mul_f32 v3, v3, v2
  v_accvgpr_write_b32 a123, v3
  v_accvgpr_read_b32 v4, a124
  v_mul_f32 v4, v4, v2
  v_accvgpr_write_b32 a124, v4
  v_accvgpr_read_b32 v5, a125
  v_mul_f32 v5, v5, v2
  v_accvgpr_write_b32 a125, v5
  v_accvgpr_read_b32 v3, a126
  v_mul_f32 v3, v3, v2
  v_accvgpr_write_b32 a126, v3
  v_accvgpr_read_b32 v4, a127
  v_mul_f32 v4, v4, v2
  v_accvgpr_write_b32 a127, v4
  v_accvgpr_read_b32 v5, a236
  v_mul_f32 v5, v5, v2
  v_accvgpr_write_b32 a236, v5
  v_accvgpr_read_b32 v3, a237
  v_mul_f32 v3, v3, v2
  v_accvgpr_write_b32 a237, v3
  v_accvgpr_read_b32 v4, a238
  v_mul_f32 v4, v4, v2
  v_accvgpr_write_b32 a238, v4
  v_accvgpr_read_b32 v5, a239
  v_mul_f32 v5, v5, v2
  v_accvgpr_write_b32 a239, v5
  v_sub_f32 v128, v128, v1
  v_sub_f32 v129, v129, v1
  v_sub_f32 v130, v130, v1
  v_sub_f32 v131, v131, v1
  v_sub_f32 v108, v108, v1
  v_sub_f32 v109, v109, v1
  v_sub_f32 v110, v110, v1
  v_sub_f32 v111, v111, v1
  v_sub_f32 v112, v112, v1
  v_sub_f32 v113, v113, v1
  v_sub_f32 v114, v114, v1
  v_sub_f32 v115, v115, v1
  v_sub_f32 v76, v76, v1
  v_sub_f32 v77, v77, v1
  v_sub_f32 v78, v78, v1
  v_sub_f32 v79, v79, v1
  v_sub_f32 v80, v80, v1
  v_sub_f32 v81, v81, v1
  v_sub_f32 v82, v82, v1
  v_sub_f32 v83, v83, v1
  v_exp_f32 v28, v84
  v_exp_f32 v29, v85
  v_exp_f32 v30, v86
  v_exp_f32 v31, v87
  v_cvt_pk_bf16_f32 v148, v28, v29
  v_exp_f32 v32, v88
  v_exp_f32 v33, v89
  v_cvt_pk_bf16_f32 v149, v30, v31
  v_exp_f32 v34, v90
  v_exp_f32 v35, v91
  v_cvt_pk_bf16_f32 v150, v32, v33
  v_exp_f32 v28, v92
  v_exp_f32 v29, v93
  v_cvt_pk_bf16_f32 v151, v34, v35
  v_exp_f32 v30, v94
  v_exp_f32 v31, v95
  v_cvt_pk_bf16_f32 v152, v28, v29
  v_exp_f32 v32, v96
  v_exp_f32 v33, v97
  v_cvt_pk_bf16_f32 v153, v30, v31
  v_exp_f32 v34, v98
  v_exp_f32 v35, v99
  v_cvt_pk_bf16_f32 v154, v32, v33
  v_exp_f32 v28, v100
  v_exp_f32 v29, v101
  v_cvt_pk_bf16_f32 v155, v34, v35
  v_exp_f32 v30, v102
  v_exp_f32 v31, v103
  v_cvt_pk_bf16_f32 v156, v28, v29
  v_exp_f32 v32, v104
  v_exp_f32 v33, v105
  v_cvt_pk_bf16_f32 v157, v30, v31
  v_exp_f32 v34, v106
  v_exp_f32 v35, v107
  v_cvt_pk_bf16_f32 v158, v32, v33
  v_exp_f32 v28, v108
  v_exp_f32 v29, v109
  v_cvt_pk_bf16_f32 v159, v34, v35
  v_exp_f32 v30, v110
  v_exp_f32 v31, v111
  v_cvt_pk_bf16_f32 v160, v28, v29
  v_exp_f32 v32, v112
  v_exp_f32 v33, v113
  v_cvt_pk_bf16_f32 v161, v30, v31
  v_exp_f32 v34, v114
  v_exp_f32 v35, v115
  v_cvt_pk_bf16_f32 v162, v32, v33
  v_cvt_pk_bf16_f32 v163, v34, v35
  s_nop 1
  s_branch L_retz0a
L_rarez0b:
  s_nop 15
  v_max3_f32 v1, v52, v53, v54
  v_max3_f32 v1, v1, v55, v56
  v_max3_f32 v1, v1, v57, v58
  v_max_f32 v1, v1, v59
  v_mov_b32 v2, v1
  s_nop 1
  v_permlane16_swap_b32 v1, v2
  v_max_f32 v1, v1, v2
  v_mov_b32 v2, v1
  s_nop 1
  v_permlane32_swap_b32 v1, v2
  v_max_f32 v1, v1, v2
  v_add_f32 v1, v7, v1
  v_max_f32 v1, 0, v1
  v_ceil_f32 v1, v1
  v_exp_f32 v2, -v1
  s_nop 0
  v_lshlrev_b32 v3, 16, v132
  v_and_b32 v4, 0xffff0000, v132
  v_mul_f32 v3, v3, v2
  v_mul_f32 v4, v4, v2
  v_cvt_pk_bf16_f32 v132, v3, v4
  v_lshlrev_b32 v3, 16, v133
  v_and_b32 v4, 0xffff0000, v133
  v_mul_f32 v3, v3, v2
  v_mul_f32 v4, v4, v2
  v_cvt_pk_bf16_f32 v133, v3, v4
  v_lshlrev_b32 v3, 16, v134
  v_and_b32 v4, 0xffff0000, v134
  v_mul_f32 v3, v3, v2
  v_mul_f32 v4, v4, v2
  v_cvt_pk_bf16_f32 v134, v3, v4
  v_lshlrev_b32 v3, 16, v135
  v_and_b32 v4, 0xffff0000, v135
  v_mul_f32 v3, v3, v2
  v_mul_f32 v4, v4, v2
  v_cvt_pk_bf16_f32 v135, v3, v4
  v_lshlrev_b32 v3, 16, v148
  v_and_b32 v4, 0xffff0000, v148
  v_mul_f32 v3, v3, v2
  v_mul_f32 v4, v4, v2
  v_cvt_pk_bf16_f32 v148, v3, v4
  v_lshlrev_b32 v3, 16, v149
  v_and_b32 v4, 0xffff0000, v149
  v_mul_f32 v3, v3, v2
  v_mul_f32 v4, v4, v2
  v_cvt_pk_bf16_f32 v149, v3, v4
  v_lshlrev_b32 v3, 16, v150
  v_and_b32 v4, 0xffff0000, v150
  v_mul_f32 v3, v3, v2
  v_mul_f32 v4, v4, v2
  v_cvt_pk_bf16_f32 v150, v3, v4
  v_lshlrev_b32 v3, 16, v151
  v_and_b32 v4, 0xffff0000, v151
  v_mul_f32 v3, v3, v2
  v_mul_f32 v4, v4, v2
  v_cvt_pk_bf16_f32 v151, v3, v4
  v_accvgpr_read_b32 v3, a0
  v_mul_f32 v3, v3, v2
  v_accvgpr_write_b32 a0, v3
  v_accvgpr_read_b32 v4, a1
  v_mul_f32 v4, v4, v2
  v_accvgpr_write_b32 a1, v4
  v_accvgpr_read_b32 v5, a2
  v_mul_f32 v5, v5, v2
  v_accvgpr_write_b32 a2, v5
  v_accvgpr_read_b32 v3, a3
  v_mul_f32 v3, v3, v2
  v_accvgpr_write_b32 a3, v3
  v_accvgpr_read_b32 v4, a4
  v_mul_f32 v4, v4, v2
  v_accvgpr_write_b32 a4, v4
  v_accvgpr_read_b32 v5, a5
  v_mul_f32 v5, v5, v2
  v_accvgpr_write_b32 a5, v5
  v_accvgpr_read_b32 v3, a6
  v_mul_f32 v3, v3, v2
  v_accvgpr_write_b32 a6, v3
  v_accvgpr_read_b32 v4, a7
  v_mul_f32 v4, v4, v2
  v_accvgpr_write_b32 a7, v4
  v_accvgpr_read_b32 v5, a8
  v_mul_f32 v5, v5, v2
  v_accvgpr_write_b32 a8, v5
  v_accvgpr_read_b32 v3, a9
  v_mul_f32 v3, v3, v2
  v_accvgpr_write_b32 a9, v3
  v_accvgpr_read_b32 v4, a10
  v_mul_f32 v4, v4, v2
  v_accvgpr_write_b32 a10, v4
  v_accvgpr_read_b32 v5, a11
  v_mul_f32 v5, v5, v2
  v_accvgpr_write_b32 a11, v5
  v_accvgpr_read_b32 v3, a12
  v_mul_f32 v3, v3, v2
  v_accvgpr_write_b32 a12, v3
  v_accvgpr_read_b32 v4, a13
  v_mul_f32 v4, v4, v2
  v_accvgpr_write_b32 a13, v4
  v_accvgpr_read_b32 v5, a14
  v_mul_f32 v5, v5, v2
  v_accvgpr_write_b32 a14, v5
  v_accvgpr_read_b32 v3, a15
  v_mul_f32 v3, v3, v2
  v_accvgpr_write_b32 a15, v3
  v_accvgpr_read_b32 v4, a16
  v_mul_f32 v4, v4, v2
  v_accvgpr_write_b32 a16, v4
  v_accvgpr_read_b32 v5, a17
  v_mul_f32 v5, v5, v2
  v_accvgpr_write_b32 a17, v5
  v_accvgpr_read_b32 v3, a18
  v_mul_f32 v3, v3, v2
  v_accvgpr_write_b32 a18, v3
  v_accvgpr_read_b32 v4, a19
  v_mul_f32 v4, v4, v2
  v_accvgpr_write_b32 a19, v4
  v_accvgpr_read_b32 v5, a20
  v_mul_f32 v5, v5, v2
  v_accvgpr_write_b32 a20, v5
  v_accvgpr_read_b32 v3, a21
  v_mul_f32 v3, v3, v2
  v_accvgpr_write_b32 a21, v3
  v_accvgpr_read_b32 v4, a22
  v_mul_f32 v4, v4, v2
  v_accvgpr_write_b32 a22, v4
  v_accvgpr_read_b32 v5, a23
  v_mul_f32 v5, v5, v2
  v_accvgpr_write_b32 a23, v5
  v_accvgpr_read_b32 v3, a24
  v_mul_f32 v3, v3, v2
  v_accvgpr_write_b32 a24, v3
  v_accvgpr_read_b32 v4, a25
  v_mul_f32 v4, v4, v2
  v_accvgpr_write_b32 a25, v4
  v_accvgpr_read_b32 v5, a26
  v_mul_f32 v5, v5, v2
  v_accvgpr_write_b32 a26, v5
  v_accvgpr_read_b32 v3, a27
  v_mul_f32 v3, v3, v2
  v_accvgpr_write_b32 a27, v3
  v_accvgpr_read_b32 v4, a28
  v_mul_f32 v4, v4, v2
  v_accvgpr_write_b32 a28, v4
  v_accvgpr_read_b32 v5, a29
  v_mul_f32 v5, v5, v2
  v_accvgpr_write_b32 a29, v5
  v_accvgpr_read_b32 v3, a30
  v_mul_f32 v3, v3, v2
  v_accvgpr_write_b32 a30, v3
  v_accvgpr_read_b32 v4, a31
  v_mul_f32 v4, v4, v2
  v_accvgpr_write_b32 a31, v4
  v_accvgpr_read_b32 v5, a224
  v_mul_f32 v5, v5, v2
  v_accvgpr_write_b32 a224, v5
  v_accvgpr_read_b32 v3, a225
  v_mul_f32 v3, v3, v2
  v_accvgpr_write_b32 a225, v3
  v_accvgpr_read_b32 v4, a226
  v_mul_f32 v4, v4, v2
  v_accvgpr_write_b32 a226, v4
  v_accvgpr_read_b32 v5, a227
  v_mul_f32 v5, v5, v2
  v_accvgpr_write_b32 a227, v5
  v_sub_f32 v116, v116, v1
  v_sub_f32 v117, v117, v1
  v_sub_f32 v118, v118, v1
  v_sub_f32 v119, v119, v1
  v_sub_f32 v52, v52, v1
  v_sub_f32 v53, v53, v1
  v_sub_f32 v54, v54, v1
  v_sub_f32 v55, v55, v1
  v_sub_f32 v56, v56, v1
  v_sub_f32 v57, v57, v1
  v_sub_f32 v58, v58, v1
  v_sub_f32 v59, v59, v1
  v_sub_f32 v84, v84, v1
  v_sub_f32 v85, v85, v1
  v_sub_f32 v86, v86, v1
  v_sub_f32 v87, v87, v1
  v_sub_f32 v88, v88, v1
  v_sub_f32 v89, v89, v1
  v_sub_f32 v90, v90, v1
  v_sub_f32 v91, v91, v1
  v_max3_f32 v1, v60, v61, v62
  v_max3_f32 v1, v1, v63, v64
  v_max3_f32 v1, v1, v65, v66
  v_max_f32 v1, v1, v67
  v_mov_b32 v2, v1
  s_nop 1
  v_permlane16_swap_b32 v1, v2
  v_max_f32 v1, v1, v2
  v_mov_b32 v2, v1
  s_nop 1
  v_permlane32_swap_b32 v1, v2
  v_max_f32 v1, v1, v2
  v_add_f32 v1, v7, v1
  v_max_f32 v1, 0, v1
  v_ceil_f32 v1, v1
  v_exp_f32 v2, -v1
  s_nop 0
  v_lshlrev_b32 v3, 16, v136
  v_and_b32 v4, 0xffff0000, v136
  v_mul_f32 v3, v3, v2
  v_mul_f32 v4, v4, v2
  v_cvt_pk_bf16_f32 v136, v3, v4
  v_lshlrev_b32 v3, 16, v137
  v_and_b32 v4, 0xffff0000, v137
  v_mul_f32 v3, v3, v2
  v_mul_f32 v4, v4, v2
  v_cvt_pk_bf16_f32 v137, v3, v4
  v_lshlrev_b32 v3, 16, v138
  v_and_b32 v4, 0xffff0000, v138
  v_mul_f32 v3, v3, v2
  v_mul_f32 v4, v4, v2
  v_cvt_pk_bf16_f32 v138, v3, v4
  v_lshlrev_b32 v3, 16, v139
  v_and_b32 v4, 0xffff0000, v139
  v_mul_f32 v3, v3, v2
  v_mul_f32 v4, v4, v2
  v_cvt_pk_bf16_f32 v139, v3, v4
  v_lshlrev_b32 v3, 16, v152
  v_and_b32 v4, 0xffff0000, v152
  v_mul_f32 v3, v3, v2
  v_mul_f32 v4, v4, v2
  v_cvt_pk_bf16_f32 v152, v3, v4
  v_lshlrev_b32 v3, 16, v153
  v_and_b32 v4, 0xffff0000, v153
  v_mul_f32 v3, v3, v2
  v_mul_f32 v4, v4, v2
  v_cvt_pk_bf16_f32 v153, v3, v4
  v_lshlrev_b32 v3, 16, v154
  v_and_b32 v4, 0xffff0000, v154
  v_mul_f32 v3, v3, v2
  v_mul_f32 v4, v4, v2
  v_cvt_pk_bf16_f32 v154, v3, v4
  v_lshlrev_b32 v3, 16, v155
  v_and_b32 v4, 0xffff0000, v155
  v_mul_f32 v3, v3, v2
  v_mul_f32 v4, v4, v2
  v_cvt_pk_bf16_f32 v155, v3, v4
  v_accvgpr_read_b32 v3, a32
  v_mul_f32 v3, v3, v2
  v_accvgpr_write_b32 a32, v3
  v_accvgpr_read_b32 v4, a33
  v_mul_f32 v4, v4, v2
  v_accvgpr_write_b32 a33, v4
  v_accvgpr_read_b32 v5, a34
  v_mul_f32 v5, v5, v2
  v_accvgpr_write_b32 a34, v5
  v_accvgpr_read_b32 v3, a35
  v_mul_f32 v3, v3, v2
  v_accvgpr_write_b32 a35, v3
  v_accvgpr_read_b32 v4, a36
  v_mul_f32 v4, v4, v2
  v_accvgpr_write_b32 a36, v4
  v_accvgpr_read_b32 v5, a37
  v_mul_f32 v5, v5, v2
  v_accvgpr_write_b32 a37, v5
  v_accvgpr_read_b32 v3, a38
  v_mul_f32 v3, v3, v2
  v_accvgpr_write_b32 a38, v3
  v_accvgpr_read_b32 v4, a39
  v_mul_f32 v4, v4, v2
  v_accvgpr_write_b32 a39, v4
  v_accvgpr_read_b32 v5, a40
  v_mul_f32 v5, v5, v2
  v_accvgpr_write_b32 a40, v5
  v_accvgpr_read_b32 v3, a41
  v_mul_f32 v3, v3, v2
  v_accvgpr_write_b32 a41, v3
  v_accvgpr_read_b32 v4, a42
  v_mul_f32 v4, v4, v2
  v_accvgpr_write_b32 a42, v4
  v_accvgpr_read_b32 v5, a43
  v_mul_f32 v5, v5, v2
  v_accvgpr_write_b32 a43, v5
  v_accvgpr_read_b32 v3, a44
  v_mul_f32 v3, v3, v2
  v_accvgpr_write_b32 a44, v3
  v_accvgpr_read_b32 v4, a45
  v_mul_f32 v4, v4, v2
  v_accvgpr_write_b32 a45, v4
  v_accvgpr_read_b32 v5, a46
  v_mul_f32 v5, v5, v2
  v_accvgpr_write_b32 a46, v5
  v_accvgpr_read_b32 v3, a47
  v_mul_f32 v3, v3, v2
  v_accvgpr_write_b32 a47, v3
  v_accvgpr_read_b32 v4, a48
  v_mul_f32 v4, v4, v2
  v_accvgpr_write_b32 a48, v4
  v_accvgpr_read_b32 v5, a49
  v_mul_f32 v5, v5, v2
  v_accvgpr_write_b32 a49, v5
  v_accvgpr_read_b32 v3, a50
  v_mul_f32 v3, v3, v2
  v_accvgpr_write_b32 a50, v3
  v_accvgpr_read_b32 v4, a51
  v_mul_f32 v4, v4, v2
  v_accvgpr_write_b32 a51, v4
  v_accvgpr_read_b32 v5, a52
  v_mul_f32 v5, v5, v2
  v_accvgpr_write_b32 a52, v5
  v_accvgpr_read_b32 v3, a53
  v_mul_f32 v3, v3, v2
  v_accvgpr_write_b32 a53, v3
  v_accvgpr_read_b32 v4, a54
  v_mul_f32 v4, v4, v2
  v_accvgpr_write_b32 a54, v4
  v_accvgpr_read_b32 v5, a55
  v_mul_f32 v5, v5, v2
  v_accvgpr_write_b32 a55, v5
  v_accvgpr_read_b32 v3, a56
  v_mul_f32 v3, v3, v2
  v_accvgpr_write_b32 a56, v3
  v_accvgpr_read_b32 v4, a57
  v_mul_f32 v4, v4, v2
  v_accvgpr_write_b32 a57, v4
  v_accvgpr_read_b32 v5, a58
  v_mul_f32 v5, v5, v2
  v_accvgpr_write_b32 a58, v5
  v_accvgpr_read_b32 v3, a59
  v_mul_f32 v3, v3, v2
  v_accvgpr_write_b32 a59, v3
  v_accvgpr_read_b32 v4, a60
  v_mul_f32 v4, v4, v2
  v_accvgpr_write_b32 a60, v4
  v_accvgpr_read_b32 v5, a61
  v_mul_f32 v5, v5, v2
  v_accvgpr_write_b32 a61, v5
  v_accvgpr_read_b32 v3, a62
  v_mul_f32 v3, v3, v2
  v_accvgpr_write_b32 a62, v3
  v_accvgpr_read_b32 v4, a63
  v_mul_f32 v4, v4, v2
  v_accvgpr_write_b32 a63, v4
  v_accvgpr_read_b32 v5, a228
  v_mul_f32 v5, v5, v2
  v_accvgpr_write_b32 a228, v5
  v_accvgpr_read_b32 v3, a229
  v_mul_f32 v3, v3, v2
  v_accvgpr_write_b32 a229, v3
  v_accvgpr_read_b32 v4, a230
  v_mul_f32 v4, v4, v2
  v_accvgpr_write_b32 a230, v4
  v_accvgpr_read_b32 v5, a231
  v_mul_f32 v5, v5, v2
  v_accvgpr_write_b32 a231, v5
  v_sub_f32 v120, v120, v1
  v_sub_f32 v121, v121, v1
  v_sub_f32 v122, v122, v1
  v_sub_f32 v123, v123, v1
  v_sub_f32 v60, v60, v1
  v_sub_f32 v61, v61, v1
  v_sub_f32 v62, v62, v1
  v_sub_f32 v63, v63, v1
  v_sub_f32 v64, v64, v1
  v_sub_f32 v65, v65, v1
  v_sub_f32 v66, v66, v1
  v_sub_f32 v67, v67, v1
  v_sub_f32 v92, v92, v1
  v_sub_f32 v93, v93, v1
  v_sub_f32 v94, v94, v1
  v_sub_f32 v95, v95, v1
  v_sub_f32 v96, v96, v1
  v_sub_f32 v97, v97, v1
  v_sub_f32 v98, v98, v1
  v_sub_f32 v99, v99, v1
  v_max3_f32 v1, v68, v69, v70
  v_max3_f32 v1, v1, v71, v72
  v_max3_f32 v1, v1, v73, v74
  v_max_f32 v1, v1, v75
  v_mov_b32 v2, v1
  s_nop 1
  v_permlane16_swap_b32 v1, v2
  v_max_f32 v1, v1, v2
  v_mov_b32 v2, v1
  s_nop 1
  v_permlane32_swap_b32 v1, v2
  v_max_f32 v1, v1, v2
  v_add_f32 v1, v7, v1
  v_max_f32 v1, 0, v1
  v_ceil_f32 v1, v1
  v_exp_f32 v2, -v1
  s_nop 0
  v_lshlrev_b32 v3, 16, v140
  v_and_b32 v4, 0xffff0000, v140
  v_mul_f32 v3, v3, v2
  v_mul_f32 v4, v4, v2
  v_cvt_pk_bf16_f32 v140, v3, v4
  v_lshlrev_b32 v3, 16, v141
  v_and_b32 v4, 0xffff0000, v141
  v_mul_f32 v3, v3, v2
  v_mul_f32 v4, v4, v2
  v_cvt_pk_bf16_f32 v141, v3, v4
  v_lshlrev_b32 v3, 16, v142
  v_and_b32 v4, 0xffff0000, v142
  v_mul_f32 v3, v3, v2
  v_mul_f32 v4, v4, v2
  v_cvt_pk_bf16_f32 v142, v3, v4
  v_lshlrev_b32 v3, 16, v143
  v_and_b32 v4, 0xffff0000, v143
  v_mul_f32 v3, v3, v2
  v_mul_f32 v4, v4, v2
  v_cvt_pk_bf16_f32 v143, v3, v4
  v_lshlrev_b32 v3, 16, v156
  v_and_b32 v4, 0xffff0000, v156
  v_mul_f32 v3, v3, v2
  v_mul_f32 v4, v4, v2
  v_cvt_pk_bf16_f32 v156, v3, v4
  v_lshlrev_b32 v3, 16, v157
  v_and_b32 v4, 0xffff0000, v157
  v_mul_f32 v3, v3, v2
  v_mul_f32 v4, v4, v2
  v_cvt_pk_bf16_f32 v157, v3, v4
  v_lshlrev_b32 v3, 16, v158
  v_and_b32 v4, 0xffff0000, v158
  v_mul_f32 v3, v3, v2
  v_mul_f32 v4, v4, v2
  v_cvt_pk_bf16_f32 v158, v3, v4
  v_lshlrev_b32 v3, 16, v159
  v_and_b32 v4, 0xffff0000, v159
  v_mul_f32 v3, v3, v2
  v_mul_f32 v4, v4, v2
  v_cvt_pk_bf16_f32 v159, v3, v4
  v_accvgpr_read_b32 v3, a64
  v_mul_f32 v3, v3, v2
  v_accvgpr_write_b32 a64, v3
  v_accvgpr_read_b32 v4, a65
  v_mul_f32 v4, v4, v2
  v_accvgpr_write_b32 a65, v4
  v_accvgpr_read_b32 v5, a66
  v_mul_f32 v5, v5, v2
  v_accvgpr_write_b32 a66, v5
  v_accvgpr_read_b32 v3, a67
  v_mul_f32 v3, v3, v2
  v_accvgpr_write_b32 a67, v3
  v_accvgpr_read_b32 v4, a68
  v_mul_f32 v4, v4, v2
  v_accvgpr_write_b32 a68, v4
  v_accvgpr_read_b32 v5, a69
  v_mul_f32 v5, v5, v2
  v_accvgpr_write_b32 a69, v5
  v_accvgpr_read_b32 v3, a70
  v_mul_f32 v3, v3, v2
  v_accvgpr_write_b32 a70, v3
  v_accvgpr_read_b32 v4, a71
  v_mul_f32 v4, v4, v2
  v_accvgpr_write_b32 a71, v4
  v_accvgpr_read_b32 v5, a72
  v_mul_f32 v5, v5, v2
  v_accvgpr_write_b32 a72, v5
  v_accvgpr_read_b32 v3, a73
  v_mul_f32 v3, v3, v2
  v_accvgpr_write_b32 a73, v3
  v_accvgpr_read_b32 v4, a74
  v_mul_f32 v4, v4, v2
  v_accvgpr_write_b32 a74, v4
  v_accvgpr_read_b32 v5, a75
  v_mul_f32 v5, v5, v2
  v_accvgpr_write_b32 a75, v5
  v_accvgpr_read_b32 v3, a76
  v_mul_f32 v3, v3, v2
  v_accvgpr_write_b32 a76, v3
  v_accvgpr_read_b32 v4, a77
  v_mul_f32 v4, v4, v2
  v_accvgpr_write_b32 a77, v4
  v_accvgpr_read_b32 v5, a78
  v_mul_f32 v5, v5, v2
  v_accvgpr_write_b32 a78, v5
  v_accvgpr_read_b32 v3, a79
  v_mul_f32 v3, v3, v2
  v_accvgpr_write_b32 a79, v3
  v_accvgpr_read_b32 v4, a80
  v_mul_f32 v4, v4, v2
  v_accvgpr_write_b32 a80, v4
  v_accvgpr_read_b32 v5, a81
  v_mul_f32 v5, v5, v2
  v_accvgpr_write_b32 a81, v5
  v_accvgpr_read_b32 v3, a82
  v_mul_f32 v3, v3, v2
  v_accvgpr_write_b32 a82, v3
  v_accvgpr_read_b32 v4, a83
  v_mul_f32 v4, v4, v2
  v_accvgpr_write_b32 a83, v4
  v_accvgpr_read_b32 v5, a84
  v_mul_f32 v5, v5, v2
  v_accvgpr_write_b32 a84, v5
  v_accvgpr_read_b32 v3, a85
  v_mul_f32 v3, v3, v2
  v_accvgpr_write_b32 a85, v3
  v_accvgpr_read_b32 v4, a86
  v_mul_f32 v4, v4, v2
  v_accvgpr_write_b32 a86, v4
  v_accvgpr_read_b32 v5, a87
  v_mul_f32 v5, v5, v2
  v_accvgpr_write_b32 a87, v5
  v_accvgpr_read_b32 v3, a88
  v_mul_f32 v3, v3, v2
  v_accvgpr_write_b32 a88, v3
  v_accvgpr_read_b32 v4, a89
  v_mul_f32 v4, v4, v2
  v_accvgpr_write_b32 a89, v4
  v_accvgpr_read_b32 v5, a90
  v_mul_f32 v5, v5, v2
  v_accvgpr_write_b32 a90, v5
  v_accvgpr_read_b32 v3, a91
  v_mul_f32 v3, v3, v2
  v_accvgpr_write_b32 a91, v3
  v_accvgpr_read_b32 v4, a92
  v_mul_f32 v4, v4, v2
  v_accvgpr_write_b32 a92, v4
  v_accvgpr_read_b32 v5, a93
  v_mul_f32 v5, v5, v2
  v_accvgpr_write_b32 a93, v5
  v_accvgpr_read_b32 v3, a94
  v_mul_f32 v3, v3, v2
  v_accvgpr_write_b32 a94, v3
  v_accvgpr_read_b32 v4, a95
  v_mul_f32 v4, v4, v2
  v_accvgpr_write_b32 a95, v4
  v_accvgpr_read_b32 v5, a232
  v_mul_f32 v5, v5, v2
  v_accvgpr_write_b32 a232, v5
  v_accvgpr_read_b32 v3, a233
  v_mul_f32 v3, v3, v2
  v_accvgpr_write_b32 a233, v3
  v_accvgpr_read_b32 v4, a234
  v_mul_f32 v4, v4, v2
  v_accvgpr_write_b32 a234, v4
  v_accvgpr_read_b32 v5, a235
  v_mul_f32 v5, v5, v2
  v_accvgpr_write_b32 a235, v5
  v_sub_f32 v124, v124, v1
  v_sub_f32 v125, v125, v1
  v_sub_f32 v126, v126, v1
  v_sub_f32 v127, v127, v1
  v_sub_f32 v68, v68, v1
  v_sub_f32 v69, v69, v1
  v_sub_f32 v70, v70, v1
  v_sub_f32 v71, v71, v1
  v_sub_f32 v72, v72, v1
  v_sub_f32 v73, v73, v1
  v_sub_f32 v74, v74, v1
  v_sub_f32 v75, v75, v1
  v_sub_f32 v100, v100, v1
  v_sub_f32 v101, v101, v1
  v_sub_f32 v102, v102, v1
  v_sub_f32 v103, v103, v1
  v_sub_f32 v104, v104, v1
  v_sub_f32 v105, v105, v1
  v_sub_f32 v106, v106, v1
  v_sub_f32 v107, v107, v1
  v_max3_f32 v1, v76, v77, v78
  v_max3_f32 v1, v1, v79, v80
  v_max3_f32 v1, v1, v81, v82
  v_max_f32 v1, v1, v83
  v_mov_b32 v2, v1
  s_nop 1
  v_permlane16_swap_b32 v1, v2
  v_max_f32 v1, v1, v2
  v_mov_b32 v2, v1
  s_nop 1
  v_permlane32_swap_b32 v1, v2
  v_max_f32 v1, v1, v2
  v_add_f32 v1, v7, v1
  v_max_f32 v1, 0, v1
  v_ceil_f32 v1, v1
  v_exp_f32 v2, -v1
  s_nop 0
  v_lshlrev_b32 v3, 16, v144
  v_and_b32 v4, 0xffff0000, v144
  v_mul_f32 v3, v3, v2
  v_mul_f32 v4, v4, v2
  v_cvt_pk_bf16_f32 v144, v3, v4
  v_lshlrev_b32 v3, 16, v145
  v_and_b32 v4, 0xffff0000, v145
  v_mul_f32 v3, v3, v2
  v_mul_f32 v4, v4, v2
  v_cvt_pk_bf16_f32 v145, v3, v4
  v_lshlrev_b32 v3, 16, v146
  v_and_b32 v4, 0xffff0000, v146
  v_mul_f32 v3, v3, v2
  v_mul_f32 v4, v4, v2
  v_cvt_pk_bf16_f32 v146, v3, v4
  v_lshlrev_b32 v3, 16, v147
  v_and_b32 v4, 0xffff0000, v147
  v_mul_f32 v3, v3, v2
  v_mul_f32 v4, v4, v2
  v_cvt_pk_bf16_f32 v147, v3, v4
  v_lshlrev_b32 v3, 16, v160
  v_and_b32 v4, 0xffff0000, v160
  v_mul_f32 v3, v3, v2
  v_mul_f32 v4, v4, v2
  v_cvt_pk_bf16_f32 v160, v3, v4
  v_lshlrev_b32 v3, 16, v161
  v_and_b32 v4, 0xffff0000, v161
  v_mul_f32 v3, v3, v2
  v_mul_f32 v4, v4, v2
  v_cvt_pk_bf16_f32 v161, v3, v4
  v_lshlrev_b32 v3, 16, v162
  v_and_b32 v4, 0xffff0000, v162
  v_mul_f32 v3, v3, v2
  v_mul_f32 v4, v4, v2
  v_cvt_pk_bf16_f32 v162, v3, v4
  v_lshlrev_b32 v3, 16, v163
  v_and_b32 v4, 0xffff0000, v163
  v_mul_f32 v3, v3, v2
  v_mul_f32 v4, v4, v2
  v_cvt_pk_bf16_f32 v163, v3, v4
  v_accvgpr_read_b32 v3, a96
  v_mul_f32 v3, v3, v2
  v_accvgpr_write_b32 a96, v3
  v_accvgpr_read_b32 v4, a97
  v_mul_f32 v4, v4, v2
  v_accvgpr_write_b32 a97, v4
  v_accvgpr_read_b32 v5, a98
  v_mul_f32 v5, v5, v2
  v_accvgpr_write_b32 a98, v5
  v_accvgpr_read_b32 v3, a99
  v_mul_f32 v3, v3, v2
  v_accvgpr_write_b32 a99, v3
  v_accvgpr_read_b32 v4, a100
  v_mul_f32 v4, v4, v2
  v_accvgpr_write_b32 a100, v4
  v_accvgpr_read_b32 v5, a101
  v_mul_f32 v5, v5, v2
  v_accvgpr_write_b32 a101, v5
  v_accvgpr_read_b32 v3, a102
  v_mul_f32 v3, v3, v2
  v_accvgpr_write_b32 a102, v3
  v_accvgpr_read_b32 v4, a103
  v_mul_f32 v4, v4, v2
  v_accvgpr_write_b32 a103, v4
  v_accvgpr_read_b32 v5, a104
  v_mul_f32 v5, v5, v2
  v_accvgpr_write_b32 a104, v5
  v_accvgpr_read_b32 v3, a105
  v_mul_f32 v3, v3, v2
  v_accvgpr_write_b32 a105, v3
  v_accvgpr_read_b32 v4, a106
  v_mul_f32 v4, v4, v2
  v_accvgpr_write_b32 a106, v4
  v_accvgpr_read_b32 v5, a107
  v_mul_f32 v5, v5, v2
  v_accvgpr_write_b32 a107, v5
  v_accvgpr_read_b32 v3, a108
  v_mul_f32 v3, v3, v2
  v_accvgpr_write_b32 a108, v3
  v_accvgpr_read_b32 v4, a109
  v_mul_f32 v4, v4, v2
  v_accvgpr_write_b32 a109, v4
  v_accvgpr_read_b32 v5, a110
  v_mul_f32 v5, v5, v2
  v_accvgpr_write_b32 a110, v5
  v_accvgpr_read_b32 v3, a111
  v_mul_f32 v3, v3, v2
  v_accvgpr_write_b32 a111, v3
  v_accvgpr_read_b32 v4, a112
  v_mul_f32 v4, v4, v2
  v_accvgpr_write_b32 a112, v4
  v_accvgpr_read_b32 v5, a113
  v_mul_f32 v5, v5, v2
  v_accvgpr_write_b32 a113, v5
  v_accvgpr_read_b32 v3, a114
  v_mul_f32 v3, v3, v2
  v_accvgpr_write_b32 a114, v3
  v_accvgpr_read_b32 v4, a115
  v_mul_f32 v4, v4, v2
  v_accvgpr_write_b32 a115, v4
  v_accvgpr_read_b32 v5, a116
  v_mul_f32 v5, v5, v2
  v_accvgpr_write_b32 a116, v5
  v_accvgpr_read_b32 v3, a117
  v_mul_f32 v3, v3, v2
  v_accvgpr_write_b32 a117, v3
  v_accvgpr_read_b32 v4, a118
  v_mul_f32 v4, v4, v2
  v_accvgpr_write_b32 a118, v4
  v_accvgpr_read_b32 v5, a119
  v_mul_f32 v5, v5, v2
  v_accvgpr_write_b32 a119, v5
  v_accvgpr_read_b32 v3, a120
  v_mul_f32 v3, v3, v2
  v_accvgpr_write_b32 a120, v3
  v_accvgpr_read_b32 v4, a121
  v_mul_f32 v4, v4, v2
  v_accvgpr_write_b32 a121, v4
  v_accvgpr_read_b32 v5, a122
  v_mul_f32 v5, v5, v2
  v_accvgpr_write_b32 a122, v5
  v_accvgpr_read_b32 v3, a123
  v_mul_f32 v3, v3, v2
  v_accvgpr_write_b32 a123, v3
  v_accvgpr_read_b32 v4, a124
  v_mul_f32 v4, v4, v2
  v_accvgpr_write_b32 a124, v4
  v_accvgpr_read_b32 v5, a125
  v_mul_f32 v5, v5, v2
  v_accvgpr_write_b32 a125, v5
  v_accvgpr_read_b32 v3, a126
  v_mul_f32 v3, v3, v2
  v_accvgpr_write_b32 a126, v3
  v_accvgpr_read_b32 v4, a127
  v_mul_f32 v4, v4, v2
  v_accvgpr_write_b32 a127, v4
  v_accvgpr_read_b32 v5, a236
  v_mul_f32 v5, v5, v2
  v_accvgpr_write_b32 a236, v5
  v_accvgpr_read_b32 v3, a237
  v_mul_f32 v3, v3, v2
  v_accvgpr_write_b32 a237, v3
  v_accvgpr_read_b32 v4, a238
  v_mul_f32 v4, v4, v2
  v_accvgpr_write_b32 a238, v4
  v_accvgpr_read_b32 v5, a239
  v_mul_f32 v5, v5, v2
  v_accvgpr_write_b32 a239, v5
  v_sub_f32 v128, v128, v1
  v_sub_f32 v129, v129, v1
  v_sub_f32 v130, v130, v1
  v_sub_f32 v131, v131, v1
  v_sub_f32 v76, v76, v1
  v_sub_f32 v77, v77, v1
  v_sub_f32 v78, v78, v1
  v_sub_f32 v79, v79, v1
  v_sub_f32 v80, v80, v1
  v_sub_f32 v81, v81, v1
  v_sub_f32 v82, v82, v1
  v_sub_f32 v83, v83, v1
  v_sub_f32 v108, v108, v1
  v_sub_f32 v109, v109, v1
  v_sub_f32 v110, v110, v1
  v_sub_f32 v111, v111, v1
  v_sub_f32 v112, v112, v1
  v_sub_f32 v113, v113, v1
  v_sub_f32 v114, v114, v1
  v_sub_f32 v115, v115, v1
  v_exp_f32 v28, v52
  v_exp_f32 v29, v53
  v_exp_f32 v30, v54
  v_exp_f32 v31, v55
  v_cvt_pk_bf16_f32 v164, v28, v29
  v_exp_f32 v32, v56
  v_exp_f32 v33, v57
  v_cvt_pk_bf16_f32 v165, v30, v31
  v_exp_f32 v34, v58
  v_exp_f32 v35, v59
  v_cvt_pk_bf16_f32 v166, v32, v33
  v_exp_f32 v28, v60
  v_exp_f32 v29, v61
  v_cvt_pk_bf16_f32 v167, v34, v35
  v_exp_f32 v30, v62
  v_exp_f32 v31, v63
  v_cvt_pk_bf16_f32 v168, v28, v29
  v_exp_f32 v32, v64
  v_exp_f32 v33, v65
  v_cvt_pk_bf16_f32 v169, v30, v31
  v_exp_f32 v34, v66
  v_exp_f32 v35, v67
  v_cvt_pk_bf16_f32 v170, v32, v33
  v_exp_f32 v28, v68
  v_exp_f32 v29, v69
  v_cvt_pk_bf16_f32 v171, v34, v35
  v_exp_f32 v30, v70
  v_exp_f32 v31, v71
  v_cvt_pk_bf16_f32 v172, v28, v29
  v_exp_f32 v32, v72
  v_exp_f32 v33, v73
  v_cvt_pk_bf16_f32 v173, v30, v31
  v_exp_f32 v34, v74
  v_exp_f32 v35, v75
  v_cvt_pk_bf16_f32 v174, v32, v33
  v_exp_f32 v28, v76
  v_exp_f32 v29, v77
  v_cvt_pk_bf16_f32 v175, v34, v35
  v_exp_f32 v30, v78
  v_exp_f32 v31, v79
  v_cvt_pk_bf16_f32 v176, v28, v29
  v_exp_f32 v32, v80
  v_exp_f32 v33, v81
  v_cvt_pk_bf16_f32 v177, v30, v31
  v_exp_f32 v34, v82
  v_exp_f32 v35, v83
  v_cvt_pk_bf16_f32 v178, v32, v33
  v_cvt_pk_bf16_f32 v179, v34, v35
  s_nop 1
  s_branch L_retz0b
L_rareb1a:
  s_nop 15
  v_max3_f32 v1, v84, v85, v86
  v_max3_f32 v1, v1, v87, v88
  v_max3_f32 v1, v1, v89, v90
  v_max_f32 v1, v1, v91
  v_mov_b32 v2, v1
  s_nop 1
  v_permlane16_swap_b32 v1, v2
  v_max_f32 v1, v1, v2
  v_mov_b32 v2, v1
  s_nop 1
  v_permlane32_swap_b32 v1, v2
  v_max_f32 v1, v1, v2
  v_add_f32 v1, v7, v1
  v_max_f32 v1, 0, v1
  v_ceil_f32 v1, v1
  v_exp_f32 v2, -v1
  s_nop 0
  v_lshlrev_b32 v3, 16, v164
  v_and_b32 v4, 0xffff0000, v164
  v_mul_f32 v3, v3, v2
  v_mul_f32 v4, v4, v2
  v_cvt_pk_bf16_f32 v164, v3, v4
  v_lshlrev_b32 v3, 16, v165
  v_and_b32 v4, 0xffff0000, v165
  v_mul_f32 v3, v3, v2
  v_mul_f32 v4, v4, v2
  v_cvt_pk_bf16_f32 v165, v3, v4
  v_lshlrev_b32 v3, 16, v166
  v_and_b32 v4, 0xffff0000, v166
  v_mul_f32 v3, v3, v2
  v_mul_f32 v4, v4, v2
  v_cvt_pk_bf16_f32 v166, v3, v4
  v_lshlrev_b32 v3, 16, v167
  v_and_b32 v4, 0xffff0000, v167
  v_mul_f32 v3, v3, v2
  v_mul_f32 v4, v4, v2
  v_cvt_pk_bf16_f32 v167, v3, v4
  v_accvgpr_read_b32 v3, a0
  v_mul_f32 v3, v3, v2
  v_accvgpr_write_b32 a0, v3
  v_accvgpr_read_b32 v4, a1
  v_mul_f32 v4, v4, v2
  v_accvgpr_write_b32 a1, v4
  v_accvgpr_read_b32 v5, a2
  v_mul_f32 v5, v5, v2
  v_accvgpr_write_b32 a2, v5
  v_accvgpr_read_b32 v3, a3
  v_mul_f32 v3, v3, v2
  v_accvgpr_write_b32 a3, v3
  v_accvgpr_read_b32 v4, a4
  v_mul_f32 v4, v4, v2
  v_accvgpr_write_b32 a4, v4
  v_accvgpr_read_b32 v5, a5
  v_mul_f32 v5, v5, v2
  v_accvgpr_write_b32 a5, v5
  v_accvgpr_read_b32 v3, a6
  v_mul_f32 v3, v3, v2
  v_accvgpr_write_b32 a6, v3
  v_accvgpr_read_b32 v4, a7
  v_mul_f32 v4, v4, v2
  v_accvgpr_write_b32 a7, v4
  v_accvgpr_read_b32 v5, a8
  v_mul_f32 v5, v5, v2
  v_accvgpr_write_b32 a8, v5
  v_accvgpr_read_b32 v3, a9
  v_mul_f32 v3, v3, v2
  v_accvgpr_write_b32 a9, v3
  v_accvgpr_read_b32 v4, a10
  v_mul_f32 v4, v4, v2
  v_accvgpr_write_b32 a10, v4
  v_accvgpr_read_b32 v5, a11
  v_mul_f32 v5, v5, v2
  v_accvgpr_write_b32 a11, v5
  v_accvgpr_read_b32 v3, a12
  v_mul_f32 v3, v3, v2
  v_accvgpr_write_b32 a12, v3
  v_accvgpr_read_b32 v4, a13
  v_mul_f32 v4, v4, v2
  v_accvgpr_write_b32 a13, v4
  v_accvgpr_read_b32 v5, a14
  v_mul_f32 v5, v5, v2
  v_accvgpr_write_b32 a14, v5
  v_accvgpr_read_b32 v3, a15
  v_mul_f32 v3, v3, v2
  v_accvgpr_write_b32 a15, v3
  v_accvgpr_read_b32 v4, a16
  v_mul_f32 v4, v4, v2
  v_accvgpr_write_b32 a16, v4
  v_accvgpr_read_b32 v5, a17
  v_mul_f32 v5, v5, v2
  v_accvgpr_write_b32 a17, v5
  v_accvgpr_read_b32 v3, a18
  v_mul_f32 v3, v3, v2
  v_accvgpr_write_b32 a18, v3
  v_accvgpr_read_b32 v4, a19
  v_mul_f32 v4, v4, v2
  v_accvgpr_write_b32 a19, v4
  v_accvgpr_read_b32 v5, a20
  v_mul_f32 v5, v5, v2
  v_accvgpr_write_b32 a20, v5
  v_accvgpr_read_b32 v3, a21
  v_mul_f32 v3, v3, v2
  v_accvgpr_write_b32 a21, v3
  v_accvgpr_read_b32 v4, a22
  v_mul_f32 v4, v4, v2
  v_accvgpr_write_b32 a22, v4
  v_accvgpr_read_b32 v5, a23
  v_mul_f32 v5, v5, v2
  v_accvgpr_write_b32 a23, v5
  v_accvgpr_read_b32 v3, a24
  v_mul_f32 v3, v3, v2
  v_accvgpr_write_b32 a24, v3
  v_accvgpr_read_b32 v4, a25
  v_mul_f32 v4, v4, v2
  v_accvgpr_write_b32 a25, v4
  v_accvgpr_read_b32 v5, a26
  v_mul_f32 v5, v5, v2
  v_accvgpr_write_b32 a26, v5
  v_accvgpr_read_b32 v3, a27
  v_mul_f32 v3, v3, v2
  v_accvgpr_write_b32 a27, v3
  v_accvgpr_read_b32 v4, a28
  v_mul_f32 v4, v4, v2
  v_accvgpr_write_b32 a28, v4
  v_accvgpr_read_b32 v5, a29
  v_mul_f32 v5, v5, v2
  v_accvgpr_write_b32 a29, v5
  v_accvgpr_read_b32 v3, a30
  v_mul_f32 v3, v3, v2
  v_accvgpr_write_b32 a30, v3
  v_accvgpr_read_b32 v4, a31
  v_mul_f32 v4, v4, v2
  v_accvgpr_write_b32 a31, v4
  v_accvgpr_read_b32 v5, a224
  v_mul_f32 v5, v5, v2
  v_accvgpr_write_b32 a224, v5
  v_accvgpr_read_b32 v3, a225
  v_mul_f32 v3, v3, v2
  v_accvgpr_write_b32 a225, v3
  v_accvgpr_read_b32 v4, a226
  v_mul_f32 v4, v4, v2
  v_accvgpr_write_b32 a226, v4
  v_accvgpr_read_b32 v5, a227
  v_mul_f32 v5, v5, v2
  v_accvgpr_write_b32 a227, v5
  v_sub_f32 v116, v116, v1
  v_sub_f32 v117, v117, v1
  v_sub_f32 v118, v118, v1
  v_sub_f32 v119, v119, v1
  v_sub_f32 v84, v84, v1
  v_sub_f32 v85, v85, v1
  v_sub_f32 v86, v86, v1
  v_sub_f32 v87, v87, v1
  v_sub_f32 v88, v88, v1
  v_sub_f32 v89, v89, v1
  v_sub_f32 v90, v90, v1
  v_sub_f32 v91, v91, v1
  v_sub_f32 v52, v52, v1
  v_sub_f32 v53, v53, v1
  v_sub_f32 v54, v54, v1
  v_sub_f32 v55, v55, v1
  v_sub_f32 v56, v56, v1
  v_sub_f32 v57, v57, v1
  v_sub_f32 v58, v58, v1
  v_sub_f32 v59, v59, v1
  v_max3_f32 v1, v92, v93, v94
  v_max3_f32 v1, v1, v95, v96
  v_max3_f32 v1, v1, v97, v98
  v_max_f32 v1, v1, v99
  v_mov_b32 v2, v1
  s_nop 1
  v_permlane16_swap_b32 v1, v2
  v_max_f32 v1, v1, v2
  v_mov_b32 v2, v1
  s_nop 1
  v_permlane32_swap_b32 v1, v2
  v_max_f32 v1, v1, v2
  v_add_f32 v1, v7, v1
  v_max_f32 v1, 0, v1
  v_ceil_f32 v1, v1
  v_exp_f32 v2, -v1
  s_nop 0
  v_lshlrev_b32 v3, 16, v168
  v_and_b32 v4, 0xffff0000, v168
  v_mul_f32 v3, v3, v2
  v_mul_f32 v4, v4, v2
  v_cvt_pk_bf16_f32 v168, v3, v4
  v_lshlrev_b32 v3, 16, v169
  v_and_b32 v4, 0xffff0000, v169
  v_mul_f32 v3, v3, v2
  v_mul_f32 v4, v4, v2
  v_cvt_pk_bf16_f32 v169, v3, v4
  v_lshlrev_b32 v3, 16, v170
  v_and_b32 v4, 0xffff0000, v170
  v_mul_f32 v3, v3, v2
  v_mul_f32 v4, v4, v2
  v_cvt_pk_bf16_f32 v170, v3, v4
  v_lshlrev_b32 v3, 16, v171
  v_and_b32 v4, 0xffff0000, v171
  v_mul_f32 v3, v3, v2
  v_mul_f32 v4, v4, v2
  v_cvt_pk_bf16_f32 v171, v3, v4
  v_accvgpr_read_b32 v3, a32
  v_mul_f32 v3, v3, v2
  v_accvgpr_write_b32 a32, v3
  v_accvgpr_read_b32 v4, a33
  v_mul_f32 v4, v4, v2
  v_accvgpr_write_b32 a33, v4
  v_accvgpr_read_b32 v5, a34
  v_mul_f32 v5, v5, v2
  v_accvgpr_write_b32 a34, v5
  v_accvgpr_read_b32 v3, a35
  v_mul_f32 v3, v3, v2
  v_accvgpr_write_b32 a35, v3
  v_accvgpr_read_b32 v4, a36
  v_mul_f32 v4, v4, v2
  v_accvgpr_write_b32 a36, v4
  v_accvgpr_read_b32 v5, a37
  v_mul_f32 v5, v5, v2
  v_accvgpr_write_b32 a37, v5
  v_accvgpr_read_b32 v3, a38
  v_mul_f32 v3, v3, v2
  v_accvgpr_write_b32 a38, v3
  v_accvgpr_read_b32 v4, a39
  v_mul_f32 v4, v4, v2
  v_accvgpr_write_b32 a39, v4
  v_accvgpr_read_b32 v5, a40
  v_mul_f32 v5, v5, v2
  v_accvgpr_write_b32 a40, v5
  v_accvgpr_read_b32 v3, a41
  v_mul_f32 v3, v3, v2
  v_accvgpr_write_b32 a41, v3
  v_accvgpr_read_b32 v4, a42
  v_mul_f32 v4, v4, v2
  v_accvgpr_write_b32 a42, v4
  v_accvgpr_read_b32 v5, a43
  v_mul_f32 v5, v5, v2
  v_accvgpr_write_b32 a43, v5
  v_accvgpr_read_b32 v3, a44
  v_mul_f32 v3, v3, v2
  v_accvgpr_write_b32 a44, v3
  v_accvgpr_read_b32 v4, a45
  v_mul_f32 v4, v4, v2
  v_accvgpr_write_b32 a45, v4
  v_accvgpr_read_b32 v5, a46
  v_mul_f32 v5, v5, v2
  v_accvgpr_write_b32 a46, v5
  v_accvgpr_read_b32 v3, a47
  v_mul_f32 v3, v3, v2
  v_accvgpr_write_b32 a47, v3
  v_accvgpr_read_b32 v4, a48
  v_mul_f32 v4, v4, v2
  v_accvgpr_write_b32 a48, v4
  v_accvgpr_read_b32 v5, a49
  v_mul_f32 v5, v5, v2
  v_accvgpr_write_b32 a49, v5
  v_accvgpr_read_b32 v3, a50
  v_mul_f32 v3, v3, v2
  v_accvgpr_write_b32 a50, v3
  v_accvgpr_read_b32 v4, a51
  v_mul_f32 v4, v4, v2
  v_accvgpr_write_b32 a51, v4
  v_accvgpr_read_b32 v5, a52
  v_mul_f32 v5, v5, v2
  v_accvgpr_write_b32 a52, v5
  v_accvgpr_read_b32 v3, a53
  v_mul_f32 v3, v3, v2
  v_accvgpr_write_b32 a53, v3
  v_accvgpr_read_b32 v4, a54
  v_mul_f32 v4, v4, v2
  v_accvgpr_write_b32 a54, v4
  v_accvgpr_read_b32 v5, a55
  v_mul_f32 v5, v5, v2
  v_accvgpr_write_b32 a55, v5
  v_accvgpr_read_b32 v3, a56
  v_mul_f32 v3, v3, v2
  v_accvgpr_write_b32 a56, v3
  v_accvgpr_read_b32 v4, a57
  v_mul_f32 v4, v4, v2
  v_accvgpr_write_b32 a57, v4
  v_accvgpr_read_b32 v5, a58
  v_mul_f32 v5, v5, v2
  v_accvgpr_write_b32 a58, v5
  v_accvgpr_read_b32 v3, a59
  v_mul_f32 v3, v3, v2
  v_accvgpr_write_b32 a59, v3
  v_accvgpr_read_b32 v4, a60
  v_mul_f32 v4, v4, v2
  v_accvgpr_write_b32 a60, v4
  v_accvgpr_read_b32 v5, a61
  v_mul_f32 v5, v5, v2
  v_accvgpr_write_b32 a61, v5
  v_accvgpr_read_b32 v3, a62
  v_mul_f32 v3, v3, v2
  v_accvgpr_write_b32 a62, v3
  v_accvgpr_read_b32 v4, a63
  v_mul_f32 v4, v4, v2
  v_accvgpr_write_b32 a63, v4
  v_accvgpr_read_b32 v5, a228
  v_mul_f32 v5, v5, v2
  v_accvgpr_write_b32 a228, v5
  v_accvgpr_read_b32 v3, a229
  v_mul_f32 v3, v3, v2
  v_accvgpr_write_b32 a229, v3
  v_accvgpr_read_b32 v4, a230
  v_mul_f32 v4, v4, v2
  v_accvgpr_write_b32 a230, v4
  v_accvgpr_read_b32 v5, a231
  v_mul_f32 v5, v5, v2
  v_accvgpr_write_b32 a231, v5
  v_sub_f32 v120, v120, v1
  v_sub_f32 v121, v121, v1
  v_sub_f32 v122, v122, v1
  v_sub_f32 v123, v123, v1
  v_sub_f32 v92, v92, v1
  v_sub_f32 v93, v93, v1
  v_sub_f32 v94, v94, v1
  v_sub_f32 v95, v95, v1
  v_sub_f32 v96, v96, v1
  v_sub_f32 v97, v97, v1
  v_sub_f32 v98, v98, v1
  v_sub_f32 v99, v99, v1
  v_sub_f32 v60, v60, v1
  v_sub_f32 v61, v61, v1
  v_sub_f32 v62, v62, v1
  v_sub_f32 v63, v63, v1
  v_sub_f32 v64, v64, v1
  v_sub_f32 v65, v65, v1
  v_sub_f32 v66, v66, v1
  v_sub_f32 v67, v67, v1
  v_max3_f32 v1, v100, v101, v102
  v_max3_f32 v1, v1, v103, v104
  v_max3_f32 v1, v1, v105, v106
  v_max_f32 v1, v1, v107
  v_mov_b32 v2, v1
  s_nop 1
  v_permlane16_swap_b32 v1, v2
  v_max_f32 v1, v1, v2
  v_mov_b32 v2, v1
  s_nop 1
  v_permlane32_swap_b32 v1, v2
  v_max_f32 v1, v1, v2
  v_add_f32 v1, v7, v1
  v_max_f32 v1, 0, v1
  v_ceil_f32 v1, v1
  v_exp_f32 v2, -v1
  s_nop 0
  v_lshlrev_b32 v3, 16, v172
  v_and_b32 v4, 0xffff0000, v172
  v_mul_f32 v3, v3, v2
  v_mul_f32 v4, v4, v2
  v_cvt_pk_bf16_f32 v172, v3, v4
  v_lshlrev_b32 v3, 16, v173
  v_and_b32 v4, 0xffff0000, v173
  v_mul_f32 v3, v3, v2
  v_mul_f32 v4, v4, v2
  v_cvt_pk_bf16_f32 v173, v3, v4
  v_lshlrev_b32 v3, 16, v174
  v_and_b32 v4, 0xffff0000, v174
  v_mul_f32 v3, v3, v2
  v_mul_f32 v4, v4, v2
  v_cvt_pk_bf16_f32 v174, v3, v4
  v_lshlrev_b32 v3, 16, v175
  v_and_b32 v4, 0xffff0000, v175
  v_mul_f32 v3, v3, v2
  v_mul_f32 v4, v4, v2
  v_cvt_pk_bf16_f32 v175, v3, v4
  v_accvgpr_read_b32 v3, a64
  v_mul_f32 v3, v3, v2
  v_accvgpr_write_b32 a64, v3
  v_accvgpr_read_b32 v4, a65
  v_mul_f32 v4, v4, v2
  v_accvgpr_write_b32 a65, v4
  v_accvgpr_read_b32 v5, a66
  v_mul_f32 v5, v5, v2
  v_accvgpr_write_b32 a66, v5
  v_accvgpr_read_b32 v3, a67
  v_mul_f32 v3, v3, v2
  v_accvgpr_write_b32 a67, v3
  v_accvgpr_read_b32 v4, a68
  v_mul_f32 v4, v4, v2
  v_accvgpr_write_b32 a68, v4
  v_accvgpr_read_b32 v5, a69
  v_mul_f32 v5, v5, v2
  v_accvgpr_write_b32 a69, v5
  v_accvgpr_read_b32 v3, a70
  v_mul_f32 v3, v3, v2
  v_accvgpr_write_b32 a70, v3
  v_accvgpr_read_b32 v4, a71
  v_mul_f32 v4, v4, v2
  v_accvgpr_write_b32 a71, v4
  v_accvgpr_read_b32 v5, a72
  v_mul_f32 v5, v5, v2
  v_accvgpr_write_b32 a72, v5
  v_accvgpr_read_b32 v3, a73
  v_mul_f32 v3, v3, v2
  v_accvgpr_write_b32 a73, v3
  v_accvgpr_read_b32 v4, a74
  v_mul_f32 v4, v4, v2
  v_accvgpr_write_b32 a74, v4
  v_accvgpr_read_b32 v5, a75
  v_mul_f32 v5, v5, v2
  v_accvgpr_write_b32 a75, v5
  v_accvgpr_read_b32 v3, a76
  v_mul_f32 v3, v3, v2
  v_accvgpr_write_b32 a76, v3
  v_accvgpr_read_b32 v4, a77
  v_mul_f32 v4, v4, v2
  v_accvgpr_write_b32 a77, v4
  v_accvgpr_read_b32 v5, a78
  v_mul_f32 v5, v5, v2
  v_accvgpr_write_b32 a78, v5
  v_accvgpr_read_b32 v3, a79
  v_mul_f32 v3, v3, v2
  v_accvgpr_write_b32 a79, v3
  v_accvgpr_read_b32 v4, a80
  v_mul_f32 v4, v4, v2
  v_accvgpr_write_b32 a80, v4
  v_accvgpr_read_b32 v5, a81
  v_mul_f32 v5, v5, v2
  v_accvgpr_write_b32 a81, v5
  v_accvgpr_read_b32 v3, a82
  v_mul_f32 v3, v3, v2
  v_accvgpr_write_b32 a82, v3
  v_accvgpr_read_b32 v4, a83
  v_mul_f32 v4, v4, v2
  v_accvgpr_write_b32 a83, v4
  v_accvgpr_read_b32 v5, a84
  v_mul_f32 v5, v5, v2
  v_accvgpr_write_b32 a84, v5
  v_accvgpr_read_b32 v3, a85
  v_mul_f32 v3, v3, v2
  v_accvgpr_write_b32 a85, v3
  v_accvgpr_read_b32 v4, a86
  v_mul_f32 v4, v4, v2
  v_accvgpr_write_b32 a86, v4
  v_accvgpr_read_b32 v5, a87
  v_mul_f32 v5, v5, v2
  v_accvgpr_write_b32 a87, v5
  v_accvgpr_read_b32 v3, a88
  v_mul_f32 v3, v3, v2
  v_accvgpr_write_b32 a88, v3
  v_accvgpr_read_b32 v4, a89
  v_mul_f32 v4, v4, v2
  v_accvgpr_write_b32 a89, v4
  v_accvgpr_read_b32 v5, a90
  v_mul_f32 v5, v5, v2
  v_accvgpr_write_b32 a90, v5
  v_accvgpr_read_b32 v3, a91
  v_mul_f32 v3, v3, v2
  v_accvgpr_write_b32 a91, v3
  v_accvgpr_read_b32 v4, a92
  v_mul_f32 v4, v4, v2
  v_accvgpr_write_b32 a92, v4
  v_accvgpr_read_b32 v5, a93
  v_mul_f32 v5, v5, v2
  v_accvgpr_write_b32 a93, v5
  v_accvgpr_read_b32 v3, a94
  v_mul_f32 v3, v3, v2
  v_accvgpr_write_b32 a94, v3
  v_accvgpr_read_b32 v4, a95
  v_mul_f32 v4, v4, v2
  v_accvgpr_write_b32 a95, v4
  v_accvgpr_read_b32 v5, a232
  v_mul_f32 v5, v5, v2
  v_accvgpr_write_b32 a232, v5
  v_accvgpr_read_b32 v3, a233
  v_mul_f32 v3, v3, v2
  v_accvgpr_write_b32 a233, v3
  v_accvgpr_read_b32 v4, a234
  v_mul_f32 v4, v4, v2
  v_accvgpr_write_b32 a234, v4
  v_accvgpr_read_b32 v5, a235
  v_mul_f32 v5, v5, v2
  v_accvgpr_write_b32 a235, v5
  v_sub_f32 v124, v124, v1
  v_sub_f32 v125, v125, v1
  v_sub_f32 v126, v126, v1
  v_sub_f32 v127, v127, v1
  v_sub_f32 v100, v100, v1
  v_sub_f32 v101, v101, v1
  v_sub_f32 v102, v102, v1
  v_sub_f32 v103, v103, v1
  v_sub_f32 v104, v104, v1
  v_sub_f32 v105, v105, v1
  v_sub_f32 v106, v106, v1
  v_sub_f32 v107, v107, v1
  v_sub_f32 v68, v68, v1
  v_sub_f32 v69, v69, v1
  v_sub_f32 v70, v70, v1
  v_sub_f32 v71, v71, v1
  v_sub_f32 v72, v72, v1
  v_sub_f32 v73, v73, v1
  v_sub_f32 v74, v74, v1
  v_sub_f32 v75, v75, v1
  v_max3_f32 v1, v108, v109, v110
  v_max3_f32 v1, v1, v111, v112
  v_max3_f32 v1, v1, v113, v114
  v_max_f32 v1, v1, v115
  v_mov_b32 v2, v1
  s_nop 1
  v_permlane16_swap_b32 v1, v2
  v_max_f32 v1, v1, v2
  v_mov_b32 v2, v1
  s_nop 1
  v_permlane32_swap_b32 v1, v2
  v_max_f32 v1, v1, v2
  v_add_f32 v1, v7, v1
  v_max_f32 v1, 0, v1
  v_ceil_f32 v1, v1
  v_exp_f32 v2, -v1
  s_nop 0
  v_lshlrev_b32 v3, 16, v176
  v_and_b32 v4, 0xffff0000, v176
  v_mul_f32 v3, v3, v2
  v_mul_f32 v4, v4, v2
  v_cvt_pk_bf16_f32 v176, v3, v4
  v_lshlrev_b32 v3, 16, v177
  v_and_b32 v4, 0xffff0000, v177
  v_mul_f32 v3, v3, v2
  v_mul_f32 v4, v4, v2
  v_cvt_pk_bf16_f32 v177, v3, v4
  v_lshlrev_b32 v3, 16, v178
  v_and_b32 v4, 0xffff0000, v178
  v_mul_f32 v3, v3, v2
  v_mul_f32 v4, v4, v2
  v_cvt_pk_bf16_f32 v178, v3, v4
  v_lshlrev_b32 v3, 16, v179
  v_and_b32 v4, 0xffff0000, v179
  v_mul_f32 v3, v3, v2
  v_mul_f32 v4, v4, v2
  v_cvt_pk_bf16_f32 v179, v3, v4
  v_accvgpr_read_b32 v3, a96
  v_mul_f32 v3, v3, v2
  v_accvgpr_write_b32 a96, v3
  v_accvgpr_read_b32 v4, a97
  v_mul_f32 v4, v4, v2
  v_accvgpr_write_b32 a97, v4
  v_accvgpr_read_b32 v5, a98
  v_mul_f32 v5, v5, v2
  v_accvgpr_write_b32 a98, v5
  v_accvgpr_read_b32 v3, a99
  v_mul_f32 v3, v3, v2
  v_accvgpr_write_b32 a99, v3
  v_accvgpr_read_b32 v4, a100
  v_mul_f32 v4, v4, v2
  v_accvgpr_write_b32 a100, v4
  v_accvgpr_read_b32 v5, a101
  v_mul_f32 v5, v5, v2
  v_accvgpr_write_b32 a101, v5
  v_accvgpr_read_b32 v3, a102
  v_mul_f32 v3, v3, v2
  v_accvgpr_write_b32 a102, v3
  v_accvgpr_read_b32 v4, a103
  v_mul_f32 v4, v4, v2
  v_accvgpr_write_b32 a103, v4
  v_accvgpr_read_b32 v5, a104
  v_mul_f32 v5, v5, v2
  v_accvgpr_write_b32 a104, v5
  v_accvgpr_read_b32 v3, a105
  v_mul_f32 v3, v3, v2
  v_accvgpr_write_b32 a105, v3
  v_accvgpr_read_b32 v4, a106
  v_mul_f32 v4, v4, v2
  v_accvgpr_write_b32 a106, v4
  v_accvgpr_read_b32 v5, a107
  v_mul_f32 v5, v5, v2
  v_accvgpr_write_b32 a107, v5
  v_accvgpr_read_b32 v3, a108
  v_mul_f32 v3, v3, v2
  v_accvgpr_write_b32 a108, v3
  v_accvgpr_read_b32 v4, a109
  v_mul_f32 v4, v4, v2
  v_accvgpr_write_b32 a109, v4
  v_accvgpr_read_b32 v5, a110
  v_mul_f32 v5, v5, v2
  v_accvgpr_write_b32 a110, v5
  v_accvgpr_read_b32 v3, a111
  v_mul_f32 v3, v3, v2
  v_accvgpr_write_b32 a111, v3
  v_accvgpr_read_b32 v4, a112
  v_mul_f32 v4, v4, v2
  v_accvgpr_write_b32 a112, v4
  v_accvgpr_read_b32 v5, a113
  v_mul_f32 v5, v5, v2
  v_accvgpr_write_b32 a113, v5
  v_accvgpr_read_b32 v3, a114
  v_mul_f32 v3, v3, v2
  v_accvgpr_write_b32 a114, v3
  v_accvgpr_read_b32 v4, a115
  v_mul_f32 v4, v4, v2
  v_accvgpr_write_b32 a115, v4
  v_accvgpr_read_b32 v5, a116
  v_mul_f32 v5, v5, v2
  v_accvgpr_write_b32 a116, v5
  v_accvgpr_read_b32 v3, a117
  v_mul_f32 v3, v3, v2
  v_accvgpr_write_b32 a117, v3
  v_accvgpr_read_b32 v4, a118
  v_mul_f32 v4, v4, v2
  v_accvgpr_write_b32 a118, v4
  v_accvgpr_read_b32 v5, a119
  v_mul_f32 v5, v5, v2
  v_accvgpr_write_b32 a119, v5
  v_accvgpr_read_b32 v3, a120
  v_mul_f32 v3, v3, v2
  v_accvgpr_write_b32 a120, v3
  v_accvgpr_read_b32 v4, a121
  v_mul_f32 v4, v4, v2
  v_accvgpr_write_b32 a121, v4
  v_accvgpr_read_b32 v5, a122
  v_mul_f32 v5, v5, v2
  v_accvgpr_write_b32 a122, v5
  v_accvgpr_read_b32 v3, a123
  v_mul_f32 v3, v3, v2
  v_accvgpr_write_b32 a123, v3
  v_accvgpr_read_b32 v4, a124
  v_mul_f32 v4, v4, v2
  v_accvgpr_write_b32 a124, v4
  v_accvgpr_read_b32 v5, a125
  v_mul_f32 v5, v5, v2
  v_accvgpr_write_b32 a125, v5
  v_accvgpr_read_b32 v3, a126
  v_mul_f32 v3, v3, v2
  v_accvgpr_write_b32 a126, v3
  v_accvgpr_read_b32 v4, a127
  v_mul_f32 v4, v4, v2
  v_accvgpr_write_b32 a127, v4
  v_accvgpr_read_b32 v5, a236
  v_mul_f32 v5, v5, v2
  v_accvgpr_write_b32 a236, v5
  v_accvgpr_read_b32 v3, a237
  v_mul_f32 v3, v3, v2
  v_accvgpr_write_b32 a237, v3
  v_accvgpr_read_b32 v4, a238
  v_mul_f32 v4, v4, v2
  v_accvgpr_write_b32 a238, v4
  v_accvgpr_read_b32 v5, a239
  v_mul_f32 v5, v5, v2
  v_accvgpr_write_b32 a239, v5
  v_sub_f32 v128, v128, v1
  v_sub_f32 v129, v129, v1
  v_sub_f32 v130, v130, v1
  v_sub_f32 v131, v131, v1
  v_sub_f32 v108, v108, v1
  v_sub_f32 v109, v109, v1
  v_sub_f32 v110, v110, v1
  v_sub_f32 v111, v111, v1
  v_sub_f32 v112, v112, v1
  v_sub_f32 v113, v113, v1
  v_sub_f32 v114, v114, v1
  v_sub_f32 v115, v115, v1
  v_sub_f32 v76, v76, v1
  v_sub_f32 v77, v77, v1
  v_sub_f32 v78, v78, v1
  v_sub_f32 v79, v79, v1
  v_sub_f32 v80, v80, v1
  v_sub_f32 v81, v81, v1
  v_sub_f32 v82, v82, v1
  v_sub_f32 v83, v83, v1
  v_exp_f32 v28, v84
  v_exp_f32 v29, v85
  v_exp_f32 v30, v86
  v_exp_f32 v31, v87
  v_cvt_pk_bf16_f32 v36, v28, v29
  v_exp_f32 v32, v88
  v_exp_f32 v33, v89
  v_cvt_pk_bf16_f32 v37, v30, v31
  v_exp_f32 v34, v90
  v_exp_f32 v35, v91
  v_cvt_pk_bf16_f32 v38, v32, v33
  v_exp_f32 v28, v92
  v_exp_f32 v29, v93
  v_cvt_pk_bf16_f32 v39, v34, v35
  v_exp_f32 v30, v94
  v_exp_f32 v31, v95
  v_cvt_pk_bf16_f32 v40, v28, v29
  v_exp_f32 v32, v96
  v_exp_f32 v33, v97
  v_cvt_pk_bf16_f32 v41, v30, v31
  v_exp_f32 v34, v98
  v_exp_f32 v35, v99
  v_cvt_pk_bf16_f32 v42, v32, v33
  v_exp_f32 v28, v100
  v_exp_f32 v29, v101
  v_cvt_pk_bf16_f32 v43, v34, v35
  v_exp_f32 v30, v102
  v_exp_f32 v31, v103
  v_cvt_pk_bf16_f32 v44, v28, v29
  v_exp_f32 v32, v104
  v_exp_f32 v33, v105
  v_cvt_pk_bf16_f32 v45, v30, v31
  v_exp_f32 v34, v106
  v_exp_f32 v35, v107
  v_cvt_pk_bf16_f32 v46, v32, v33
  v_exp_f32 v28, v108
  v_exp_f32 v29, v109
  v_cvt_pk_bf16_f32 v47, v34, v35
  v_exp_f32 v30, v110
  v_exp_f32 v31, v111
  v_cvt_pk_bf16_f32 v14, v28, v29
  v_exp_f32 v32, v112
  v_exp_f32 v33, v113
  v_cvt_pk_bf16_f32 v15, v30, v31
  v_exp_f32 v34, v114
  v_exp_f32 v35, v115
  v_cvt_pk_bf16_f32 v16, v32, v33
  v_cvt_pk_bf16_f32 v17, v34, v35
  s_nop 1
  s_branch L_retb1a
L_rareb1b:
  s_nop 15
  v_max3_f32 v1, v52, v53, v54
  v_max3_f32 v1, v1, v55, v56
  v_max3_f32 v1, v1, v57, v58
  v_max_f32 v1, v1, v59
  v_mov_b32 v2, v1
  s_nop 1
  v_permlane16_swap_b32 v1, v2
  v_max_f32 v1, v1, v2
  v_mov_b32 v2, v1
  s_nop 1
  v_permlane32_swap_b32 v1, v2
  v_max_f32 v1, v1, v2
  v_add_f32 v1, v7, v1
  v_max_f32 v1, 0, v1
  v_ceil_f32 v1, v1
  v_exp_f32 v2, -v1
  s_nop 0
  v_lshlrev_b32 v3, 16, v164
  v_and_b32 v4, 0xffff0000, v164
  v_mul_f32 v3, v3, v2
  v_mul_f32 v4, v4, v2
  v_cvt_pk_bf16_f32 v164, v3, v4
  v_lshlrev_b32 v3, 16, v165
  v_and_b32 v4, 0xffff0000, v165
  v_mul_f32 v3, v3, v2
  v_mul_f32 v4, v4, v2
  v_cvt_pk_bf16_f32 v165, v3, v4
  v_lshlrev_b32 v3, 16, v166
  v_and_b32 v4, 0xffff0000, v166
  v_mul_f32 v3, v3, v2
  v_mul_f32 v4, v4, v2
  v_cvt_pk_bf16_f32 v166, v3, v4
  v_lshlrev_b32 v3, 16, v167
  v_and_b32 v4, 0xffff0000, v167
  v_mul_f32 v3, v3, v2
  v_mul_f32 v4, v4, v2
  v_cvt_pk_bf16_f32 v167, v3, v4
  v_lshlrev_b32 v3, 16, v36
  v_and_b32 v4, 0xffff0000, v36
  v_mul_f32 v3, v3, v2
  v_mul_f32 v4, v4, v2
  v_cvt_pk_bf16_f32 v36, v3, v4
  v_lshlrev_b32 v3, 16, v37
  v_and_b32 v4, 0xffff0000, v37
  v_mul_f32 v3, v3, v2
  v_mul_f32 v4, v4, v2
  v_cvt_pk_bf16_f32 v37, v3, v4
  v_lshlrev_b32 v3, 16, v38
  v_and_b32 v4, 0xffff0000, v38
  v_mul_f32 v3, v3, v2
  v_mul_f32 v4, v4, v2
  v_cvt_pk_bf16_f32 v38, v3, v4
  v_lshlrev_b32 v3, 16, v39
  v_and_b32 v4, 0xffff0000, v39
  v_mul_f32 v3, v3, v2
  v_mul_f32 v4, v4, v2
  v_cvt_pk_bf16_f32 v39, v3, v4
  v_accvgpr_read_b32 v3, a0
  v_mul_f32 v3, v3, v2
  v_accvgpr_write_b32 a0, v3
  v_accvgpr_read_b32 v4, a1
  v_mul_f32 v4, v4, v2
  v_accvgpr_write_b32 a1, v4
  v_accvgpr_read_b32 v5, a2
  v_mul_f32 v5, v5, v2
  v_accvgpr_write_b32 a2, v5
  v_accvgpr_read_b32 v3, a3
  v_mul_f32 v3, v3, v2
  v_accvgpr_write_b32 a3, v3
  v_accvgpr_read_b32 v4, a4
  v_mul_f32 v4, v4, v2
  v_accvgpr_write_b32 a4, v4
  v_accvgpr_read_b32 v5, a5
  v_mul_f32 v5, v5, v2
  v_accvgpr_write_b32 a5, v5
  v_accvgpr_read_b32 v3, a6
  v_mul_f32 v3, v3, v2
  v_accvgpr_write_b32 a6, v3
  v_accvgpr_read_b32 v4, a7
  v_mul_f32 v4, v4, v2
  v_accvgpr_write_b32 a7, v4
  v_accvgpr_read_b32 v5, a8
  v_mul_f32 v5, v5, v2
  v_accvgpr_write_b32 a8, v5
  v_accvgpr_read_b32 v3, a9
  v_mul_f32 v3, v3, v2
  v_accvgpr_write_b32 a9, v3
  v_accvgpr_read_b32 v4, a10
  v_mul_f32 v4, v4, v2
  v_accvgpr_write_b32 a10, v4
  v_accvgpr_read_b32 v5, a11
  v_mul_f32 v5, v5, v2
  v_accvgpr_write_b32 a11, v5
  v_accvgpr_read_b32 v3, a12
  v_mul_f32 v3, v3, v2
  v_accvgpr_write_b32 a12, v3
  v_accvgpr_read_b32 v4, a13
  v_mul_f32 v4, v4, v2
  v_accvgpr_write_b32 a13, v4
  v_accvgpr_read_b32 v5, a14
  v_mul_f32 v5, v5, v2
  v_accvgpr_write_b32 a14, v5
  v_accvgpr_read_b32 v3, a15
  v_mul_f32 v3, v3, v2
  v_accvgpr_write_b32 a15, v3
  v_accvgpr_read_b32 v4, a16
  v_mul_f32 v4, v4, v2
  v_accvgpr_write_b32 a16, v4
  v_accvgpr_read_b32 v5, a17
  v_mul_f32 v5, v5, v2
  v_accvgpr_write_b32 a17, v5
  v_accvgpr_read_b32 v3, a18
  v_mul_f32 v3, v3, v2
  v_accvgpr_write_b32 a18, v3
  v_accvgpr_read_b32 v4, a19
  v_mul_f32 v4, v4, v2
  v_accvgpr_write_b32 a19, v4
  v_accvgpr_read_b32 v5, a20
  v_mul_f32 v5, v5, v2
  v_accvgpr_write_b32 a20, v5
  v_accvgpr_read_b32 v3, a21
  v_mul_f32 v3, v3, v2
  v_accvgpr_write_b32 a21, v3
  v_accvgpr_read_b32 v4, a22
  v_mul_f32 v4, v4, v2
  v_accvgpr_write_b32 a22, v4
  v_accvgpr_read_b32 v5, a23
  v_mul_f32 v5, v5, v2
  v_accvgpr_write_b32 a23, v5
  v_accvgpr_read_b32 v3, a24
  v_mul_f32 v3, v3, v2
  v_accvgpr_write_b32 a24, v3
  v_accvgpr_read_b32 v4, a25
  v_mul_f32 v4, v4, v2
  v_accvgpr_write_b32 a25, v4
  v_accvgpr_read_b32 v5, a26
  v_mul_f32 v5, v5, v2
  v_accvgpr_write_b32 a26, v5
  v_accvgpr_read_b32 v3, a27
  v_mul_f32 v3, v3, v2
  v_accvgpr_write_b32 a27, v3
  v_accvgpr_read_b32 v4, a28
  v_mul_f32 v4, v4, v2
  v_accvgpr_write_b32 a28, v4
  v_accvgpr_read_b32 v5, a29
  v_mul_f32 v5, v5, v2
  v_accvgpr_write_b32 a29, v5
  v_accvgpr_read_b32 v3, a30
  v_mul_f32 v3, v3, v2
  v_accvgpr_write_b32 a30, v3
  v_accvgpr_read_b32 v4, a31
  v_mul_f32 v4, v4, v2
  v_accvgpr_write_b32 a31, v4
  v_accvgpr_read_b32 v5, a224
  v_mul_f32 v5, v5, v2
  v_accvgpr_write_b32 a224, v5
  v_accvgpr_read_b32 v3, a225
  v_mul_f32 v3, v3, v2
  v_accvgpr_write_b32 a225, v3
  v_accvgpr_read_b32 v4, a226
  v_mul_f32 v4, v4, v2
  v_accvgpr_write_b32 a226, v4
  v_accvgpr_read_b32 v5, a227
  v_mul_f32 v5, v5, v2
  v_accvgpr_write_b32 a227, v5
  v_sub_f32 v116, v116, v1
  v_sub_f32 v117, v117, v1
  v_sub_f32 v118, v118, v1
  v_sub_f32 v119, v119, v1
  v_sub_f32 v52, v52, v1
  v_sub_f32 v53, v53, v1
  v_sub_f32 v54, v54, v1
  v_sub_f32 v55, v55, v1
  v_sub_f32 v56, v56, v1
  v_sub_f32 v57, v57, v1
  v_sub_f32 v58, v58, v1
  v_sub_f32 v59, v59, v1
  v_sub_f32 v84, v84, v1
  v_sub_f32 v85, v85, v1
  v_sub_f32 v86, v86, v1
  v_sub_f32 v87, v87, v1
  v_sub_f32 v88, v88, v1
  v_sub_f32 v89, v89, v1
  v_sub_f32 v90, v90, v1
  v_sub_f32 v91, v91, v1
  v_max3_f32 v1, v60, v61, v62
  v_max3_f32 v1, v1, v63, v64
  v_max3_f32 v1, v1, v65, v66
  v_max_f32 v1, v1, v67
  v_mov_b32 v2, v1
  s_nop 1
  v_permlane16_swap_b32 v1, v2
  v_max_f32 v1, v1, v2
  v_mov_b32 v2, v1
  s_nop 1
  v_permlane32_swap_b32 v1, v2
  v_max_f32 v1, v1, v2
  v_add_f32 v1, v7, v1
  v_max_f32 v1, 0, v1
  v_ceil_f32 v1, v1
  v_exp_f32 v2, -v1
  s_nop 0
  v_lshlrev_b32 v3, 16, v168
  v_and_b32 v4, 0xffff0000, v168
  v_mul_f32 v3, v3, v2
  v_mul_f32 v4, v4, v2
  v_cvt_pk_bf16_f32 v168, v3, v4
  v_lshlrev_b32 v3, 16, v169
  v_and_b32 v4, 0xffff0000, v169
  v_mul_f32 v3, v3, v2
  v_mul_f32 v4, v4, v2
  v_cvt_pk_bf16_f32 v169, v3, v4
  v_lshlrev_b32 v3, 16, v170
  v_and_b32 v4, 0xffff0000, v170
  v_mul_f32 v3, v3, v2
  v_mul_f32 v4, v4, v2
  v_cvt_pk_bf16_f32 v170, v3, v4
  v_lshlrev_b32 v3, 16, v171
  v_and_b32 v4, 0xffff0000, v171
  v_mul_f32 v3, v3, v2
  v_mul_f32 v4, v4, v2
  v_cvt_pk_bf16_f32 v171, v3, v4
  v_lshlrev_b32 v3, 16, v40
  v_and_b32 v4, 0xffff0000, v40
  v_mul_f32 v3, v3, v2
  v_mul_f32 v4, v4, v2
  v_cvt_pk_bf16_f32 v40, v3, v4
  v_lshlrev_b32 v3, 16, v41
  v_and_b32 v4, 0xffff0000, v41
  v_mul_f32 v3, v3, v2
  v_mul_f32 v4, v4, v2
  v_cvt_pk_bf16_f32 v41, v3, v4
  v_lshlrev_b32 v3, 16, v42
  v_and_b32 v4, 0xffff0000, v42
  v_mul_f32 v3, v3, v2
  v_mul_f32 v4, v4, v2
  v_cvt_pk_bf16_f32 v42, v3, v4
  v_lshlrev_b32 v3, 16, v43
  v_and_b32 v4, 0xffff0000, v43
  v_mul_f32 v3, v3, v2
  v_mul_f32 v4, v4, v2
  v_cvt_pk_bf16_f32 v43, v3, v4
  v_accvgpr_read_b32 v3, a32
  v_mul_f32 v3, v3, v2
  v_accvgpr_write_b32 a32, v3
  v_accvgpr_read_b32 v4, a33
  v_mul_f32 v4, v4, v2
  v_accvgpr_write_b32 a33, v4
  v_accvgpr_read_b32 v5, a34
  v_mul_f32 v5, v5, v2
  v_accvgpr_write_b32 a34, v5
  v_accvgpr_read_b32 v3, a35
  v_mul_f32 v3, v3, v2
  v_accvgpr_write_b32 a35, v3
  v_accvgpr_read_b32 v4, a36
  v_mul_f32 v4, v4, v2
  v_accvgpr_write_b32 a36, v4
  v_accvgpr_read_b32 v5, a37
  v_mul_f32 v5, v5, v2
  v_accvgpr_write_b32 a37, v5
  v_accvgpr_read_b32 v3, a38
  v_mul_f32 v3, v3, v2
  v_accvgpr_write_b32 a38, v3
  v_accvgpr_read_b32 v4, a39
  v_mul_f32 v4, v4, v2
  v_accvgpr_write_b32 a39, v4
  v_accvgpr_read_b32 v5, a40
  v_mul_f32 v5, v5, v2
  v_accvgpr_write_b32 a40, v5
  v_accvgpr_read_b32 v3, a41
  v_mul_f32 v3, v3, v2
  v_accvgpr_write_b32 a41, v3
  v_accvgpr_read_b32 v4, a42
  v_mul_f32 v4, v4, v2
  v_accvgpr_write_b32 a42, v4
  v_accvgpr_read_b32 v5, a43
  v_mul_f32 v5, v5, v2
  v_accvgpr_write_b32 a43, v5
  v_accvgpr_read_b32 v3, a44
  v_mul_f32 v3, v3, v2
  v_accvgpr_write_b32 a44, v3
  v_accvgpr_read_b32 v4, a45
  v_mul_f32 v4, v4, v2
  v_accvgpr_write_b32 a45, v4
  v_accvgpr_read_b32 v5, a46
  v_mul_f32 v5, v5, v2
  v_accvgpr_write_b32 a46, v5
  v_accvgpr_read_b32 v3, a47
  v_mul_f32 v3, v3, v2
  v_accvgpr_write_b32 a47, v3
  v_accvgpr_read_b32 v4, a48
  v_mul_f32 v4, v4, v2
  v_accvgpr_write_b32 a48, v4
  v_accvgpr_read_b32 v5, a49
  v_mul_f32 v5, v5, v2
  v_accvgpr_write_b32 a49, v5
  v_accvgpr_read_b32 v3, a50
  v_mul_f32 v3, v3, v2
  v_accvgpr_write_b32 a50, v3
  v_accvgpr_read_b32 v4, a51
  v_mul_f32 v4, v4, v2
  v_accvgpr_write_b32 a51, v4
  v_accvgpr_read_b32 v5, a52
  v_mul_f32 v5, v5, v2
  v_accvgpr_write_b32 a52, v5
  v_accvgpr_read_b32 v3, a53
  v_mul_f32 v3, v3, v2
  v_accvgpr_write_b32 a53, v3
  v_accvgpr_read_b32 v4, a54
  v_mul_f32 v4, v4, v2
  v_accvgpr_write_b32 a54, v4
  v_accvgpr_read_b32 v5, a55
  v_mul_f32 v5, v5, v2
  v_accvgpr_write_b32 a55, v5
  v_accvgpr_read_b32 v3, a56
  v_mul_f32 v3, v3, v2
  v_accvgpr_write_b32 a56, v3
  v_accvgpr_read_b32 v4, a57
  v_mul_f32 v4, v4, v2
  v_accvgpr_write_b32 a57, v4
  v_accvgpr_read_b32 v5, a58
  v_mul_f32 v5, v5, v2
  v_accvgpr_write_b32 a58, v5
  v_accvgpr_read_b32 v3, a59
  v_mul_f32 v3, v3, v2
  v_accvgpr_write_b32 a59, v3
  v_accvgpr_read_b32 v4, a60
  v_mul_f32 v4, v4, v2
  v_accvgpr_write_b32 a60, v4
  v_accvgpr_read_b32 v5, a61
  v_mul_f32 v5, v5, v2
  v_accvgpr_write_b32 a61, v5
  v_accvgpr_read_b32 v3, a62
  v_mul_f32 v3, v3, v2
  v_accvgpr_write_b32 a62, v3
  v_accvgpr_read_b32 v4, a63
  v_mul_f32 v4, v4, v2
  v_accvgpr_write_b32 a63, v4
  v_accvgpr_read_b32 v5, a228
  v_mul_f32 v5, v5, v2
  v_accvgpr_write_b32 a228, v5
  v_accvgpr_read_b32 v3, a229
  v_mul_f32 v3, v3, v2
  v_accvgpr_write_b32 a229, v3
  v_accvgpr_read_b32 v4, a230
  v_mul_f32 v4, v4, v2
  v_accvgpr_write_b32 a230, v4
  v_accvgpr_read_b32 v5, a231
  v_mul_f32 v5, v5, v2
  v_accvgpr_write_b32 a231, v5
  v_sub_f32 v120, v120, v1
  v_sub_f32 v121, v121, v1
  v_sub_f32 v122, v122, v1
  v_sub_f32 v123, v123, v1
  v_sub_f32 v60, v60, v1
  v_sub_f32 v61, v61, v1
  v_sub_f32 v62, v62, v1
  v_sub_f32 v63, v63, v1
  v_sub_f32 v64, v64, v1
  v_sub_f32 v65, v65, v1
  v_sub_f32 v66, v66, v1
  v_sub_f32 v67, v67, v1
  v_sub_f32 v92, v92, v1
  v_sub_f32 v93, v93, v1
  v_sub_f32 v94, v94, v1
  v_sub_f32 v95, v95, v1
  v_sub_f32 v96, v96, v1
  v_sub_f32 v97, v97, v1
  v_sub_f32 v98, v98, v1
  v_sub_f32 v99, v99, v1
  v_max3_f32 v1, v68, v69, v70
  v_max3_f32 v1, v1, v71, v72
  v_max3_f32 v1, v1, v73, v74
  v_max_f32 v1, v1, v75
  v_mov_b32 v2, v1
  s_nop 1
  v_permlane16_swap_b32 v1, v2
  v_max_f32 v1, v1, v2
  v_mov_b32 v2, v1
  s_nop 1
  v_permlane32_swap_b32 v1, v2
  v_max_f32 v1, v1, v2
  v_add_f32 v1, v7, v1
  v_max_f32 v1, 0, v1
  v_ceil_f32 v1, v1
  v_exp_f32 v2, -v1
  s_nop 0
  v_lshlrev_b32 v3, 16, v172
  v_and_b32 v4, 0xffff0000, v172
  v_mul_f32 v3, v3, v2
  v_mul_f32 v4, v4, v2
  v_cvt_pk_bf16_f32 v172, v3, v4
  v_lshlrev_b32 v3, 16, v173
  v_and_b32 v4, 0xffff0000, v173
  v_mul_f32 v3, v3, v2
  v_mul_f32 v4, v4, v2
  v_cvt_pk_bf16_f32 v173, v3, v4
  v_lshlrev_b32 v3, 16, v174
  v_and_b32 v4, 0xffff0000, v174
  v_mul_f32 v3, v3, v2
  v_mul_f32 v4, v4, v2
  v_cvt_pk_bf16_f32 v174, v3, v4
  v_lshlrev_b32 v3, 16, v175
  v_and_b32 v4, 0xffff0000, v175
  v_mul_f32 v3, v3, v2
  v_mul_f32 v4, v4, v2
  v_cvt_pk_bf16_f32 v175, v3, v4
  v_lshlrev_b32 v3, 16, v44
  v_and_b32 v4, 0xffff0000, v44
  v_mul_f32 v3, v3, v2
  v_mul_f32 v4, v4, v2
  v_cvt_pk_bf16_f32 v44, v3, v4
  v_lshlrev_b32 v3, 16, v45
  v_and_b32 v4, 0xffff0000, v45
  v_mul_f32 v3, v3, v2
  v_mul_f32 v4, v4, v2
  v_cvt_pk_bf16_f32 v45, v3, v4
  v_lshlrev_b32 v3, 16, v46
  v_and_b32 v4, 0xffff0000, v46
  v_mul_f32 v3, v3, v2
  v_mul_f32 v4, v4, v2
  v_cvt_pk_bf16_f32 v46, v3, v4
  v_lshlrev_b32 v3, 16, v47
  v_and_b32 v4, 0xffff0000, v47
  v_mul_f32 v3, v3, v2
  v_mul_f32 v4, v4, v2
  v_cvt_pk_bf16_f32 v47, v3, v4
  v_accvgpr_read_b32 v3, a64
  v_mul_f32 v3, v3, v2
  v_accvgpr_write_b32 a64, v3
  v_accvgpr_read_b32 v4, a65
  v_mul_f32 v4, v4, v2
  v_accvgpr_write_b32 a65, v4
  v_accvgpr_read_b32 v5, a66
  v_mul_f32 v5, v5, v2
  v_accvgpr_write_b32 a66, v5
  v_accvgpr_read_b32 v3, a67
  v_mul_f32 v3, v3, v2
  v_accvgpr_write_b32 a67, v3
  v_accvgpr_read_b32 v4, a68
  v_mul_f32 v4, v4, v2
  v_accvgpr_write_b32 a68, v4
  v_accvgpr_read_b32 v5, a69
  v_mul_f32 v5, v5, v2
  v_accvgpr_write_b32 a69, v5
  v_accvgpr_read_b32 v3, a70
  v_mul_f32 v3, v3, v2
  v_accvgpr_write_b32 a70, v3
  v_accvgpr_read_b32 v4, a71
  v_mul_f32 v4, v4, v2
  v_accvgpr_write_b32 a71, v4
  v_accvgpr_read_b32 v5, a72
  v_mul_f32 v5, v5, v2
  v_accvgpr_write_b32 a72, v5
  v_accvgpr_read_b32 v3, a73
  v_mul_f32 v3, v3, v2
  v_accvgpr_write_b32 a73, v3
  v_accvgpr_read_b32 v4, a74
  v_mul_f32 v4, v4, v2
  v_accvgpr_write_b32 a74, v4
  v_accvgpr_read_b32 v5, a75
  v_mul_f32 v5, v5, v2
  v_accvgpr_write_b32 a75, v5
  v_accvgpr_read_b32 v3, a76
  v_mul_f32 v3, v3, v2
  v_accvgpr_write_b32 a76, v3
  v_accvgpr_read_b32 v4, a77
  v_mul_f32 v4, v4, v2
  v_accvgpr_write_b32 a77, v4
  v_accvgpr_read_b32 v5, a78
  v_mul_f32 v5, v5, v2
  v_accvgpr_write_b32 a78, v5
  v_accvgpr_read_b32 v3, a79
  v_mul_f32 v3, v3, v2
  v_accvgpr_write_b32 a79, v3
  v_accvgpr_read_b32 v4, a80
  v_mul_f32 v4, v4, v2
  v_accvgpr_write_b32 a80, v4
  v_accvgpr_read_b32 v5, a81
  v_mul_f32 v5, v5, v2
  v_accvgpr_write_b32 a81, v5
  v_accvgpr_read_b32 v3, a82
  v_mul_f32 v3, v3, v2
  v_accvgpr_write_b32 a82, v3
  v_accvgpr_read_b32 v4, a83
  v_mul_f32 v4, v4, v2
  v_accvgpr_write_b32 a83, v4
  v_accvgpr_read_b32 v5, a84
  v_mul_f32 v5, v5, v2
  v_accvgpr_write_b32 a84, v5
  v_accvgpr_read_b32 v3, a85
  v_mul_f32 v3, v3, v2
  v_accvgpr_write_b32 a85, v3
  v_accvgpr_read_b32 v4, a86
  v_mul_f32 v4, v4, v2
  v_accvgpr_write_b32 a86, v4
  v_accvgpr_read_b32 v5, a87
  v_mul_f32 v5, v5, v2
  v_accvgpr_write_b32 a87, v5
  v_accvgpr_read_b32 v3, a88
  v_mul_f32 v3, v3, v2
  v_accvgpr_write_b32 a88, v3
  v_accvgpr_read_b32 v4, a89
  v_mul_f32 v4, v4, v2
  v_accvgpr_write_b32 a89, v4
  v_accvgpr_read_b32 v5, a90
  v_mul_f32 v5, v5, v2
  v_accvgpr_write_b32 a90, v5
  v_accvgpr_read_b32 v3, a91
  v_mul_f32 v3, v3, v2
  v_accvgpr_write_b32 a91, v3
  v_accvgpr_read_b32 v4, a92
  v_mul_f32 v4, v4, v2
  v_accvgpr_write_b32 a92, v4
  v_accvgpr_read_b32 v5, a93
  v_mul_f32 v5, v5, v2
  v_accvgpr_write_b32 a93, v5
  v_accvgpr_read_b32 v3, a94
  v_mul_f32 v3, v3, v2
  v_accvgpr_write_b32 a94, v3
  v_accvgpr_read_b32 v4, a95
  v_mul_f32 v4, v4, v2
  v_accvgpr_write_b32 a95, v4
  v_accvgpr_read_b32 v5, a232
  v_mul_f32 v5, v5, v2
  v_accvgpr_write_b32 a232, v5
  v_accvgpr_read_b32 v3, a233
  v_mul_f32 v3, v3, v2
  v_accvgpr_write_b32 a233, v3
  v_accvgpr_read_b32 v4, a234
  v_mul_f32 v4, v4, v2
  v_accvgpr_write_b32 a234, v4
  v_accvgpr_read_b32 v5, a235
  v_mul_f32 v5, v5, v2
  v_accvgpr_write_b32 a235, v5
  v_sub_f32 v124, v124, v1
  v_sub_f32 v125, v125, v1
  v_sub_f32 v126, v126, v1
  v_sub_f32 v127, v127, v1
  v_sub_f32 v68, v68, v1
  v_sub_f32 v69, v69, v1
  v_sub_f32 v70, v70, v1
  v_sub_f32 v71, v71, v1
  v_sub_f32 v72, v72, v1
  v_sub_f32 v73, v73, v1
  v_sub_f32 v74, v74, v1
  v_sub_f32 v75, v75, v1
  v_sub_f32 v100, v100, v1
  v_sub_f32 v101, v101, v1
  v_sub_f32 v102, v102, v1
  v_sub_f32 v103, v103, v1
  v_sub_f32 v104, v104, v1
  v_sub_f32 v105, v105, v1
  v_sub_f32 v106, v106, v1
  v_sub_f32 v107, v107, v1
  v_max3_f32 v1, v76, v77, v78
  v_max3_f32 v1, v1, v79, v80
  v_max3_f32 v1, v1, v81, v82
  v_max_f32 v1, v1, v83
  v_mov_b32 v2, v1
  s_nop 1
  v_permlane16_swap_b32 v1, v2
  v_max_f32 v1, v1, v2
  v_mov_b32 v2, v1
  s_nop 1
  v_permlane32_swap_b32 v1, v2
  v_max_f32 v1, v1, v2
  v_add_f32 v1, v7, v1
  v_max_f32 v1, 0, v1
  v_ceil_f32 v1, v1
  v_exp_f32 v2, -v1
  s_nop 0
  v_lshlrev_b32 v3, 16, v176
  v_and_b32 v4, 0xffff0000, v176
  v_mul_f32 v3, v3, v2
  v_mul_f32 v4, v4, v2
  v_cvt_pk_bf16_f32 v176, v3, v4
  v_lshlrev_b32 v3, 16, v177
  v_and_b32 v4, 0xffff0000, v177
  v_mul_f32 v3, v3, v2
  v_mul_f32 v4, v4, v2
  v_cvt_pk_bf16_f32 v177, v3, v4
  v_lshlrev_b32 v3, 16, v178
  v_and_b32 v4, 0xffff0000, v178
  v_mul_f32 v3, v3, v2
  v_mul_f32 v4, v4, v2
  v_cvt_pk_bf16_f32 v178, v3, v4
  v_lshlrev_b32 v3, 16, v179
  v_and_b32 v4, 0xffff0000, v179
  v_mul_f32 v3, v3, v2
  v_mul_f32 v4, v4, v2
  v_cvt_pk_bf16_f32 v179, v3, v4
  v_lshlrev_b32 v3, 16, v14
  v_and_b32 v4, 0xffff0000, v14
  v_mul_f32 v3, v3, v2
  v_mul_f32 v4, v4, v2
  v_cvt_pk_bf16_f32 v14, v3, v4
  v_lshlrev_b32 v3, 16, v15
  v_and_b32 v4, 0xffff0000, v15
  v_mul_f32 v3, v3, v2
  v_mul_f32 v4, v4, v2
  v_cvt_pk_bf16_f32 v15, v3, v4
  v_lshlrev_b32 v3, 16, v16
  v_and_b32 v4, 0xffff0000, v16
  v_mul_f32 v3, v3, v2
  v_mul_f32 v4, v4, v2
  v_cvt_pk_bf16_f32 v16, v3, v4
  v_lshlrev_b32 v3, 16, v17
  v_and_b32 v4, 0xffff0000, v17
  v_mul_f32 v3, v3, v2
  v_mul_f32 v4, v4, v2
  v_cvt_pk_bf16_f32 v17, v3, v4
  v_accvgpr_read_b32 v3, a96
  v_mul_f32 v3, v3, v2
  v_accvgpr_write_b32 a96, v3
  v_accvgpr_read_b32 v4, a97
  v_mul_f32 v4, v4, v2
  v_accvgpr_write_b32 a97, v4
  v_accvgpr_read_b32 v5, a98
  v_mul_f32 v5, v5, v2
  v_accvgpr_write_b32 a98, v5
  v_accvgpr_read_b32 v3, a99
  v_mul_f32 v3, v3, v2
  v_accvgpr_write_b32 a99, v3
  v_accvgpr_read_b32 v4, a100
  v_mul_f32 v4, v4, v2
  v_accvgpr_write_b32 a100, v4
  v_accvgpr_read_b32 v5, a101
  v_mul_f32 v5, v5, v2
  v_accvgpr_write_b32 a101, v5
  v_accvgpr_read_b32 v3, a102
  v_mul_f32 v3, v3, v2
  v_accvgpr_write_b32 a102, v3
  v_accvgpr_read_b32 v4, a103
  v_mul_f32 v4, v4, v2
  v_accvgpr_write_b32 a103, v4
  v_accvgpr_read_b32 v5, a104
  v_mul_f32 v5, v5, v2
  v_accvgpr_write_b32 a104, v5
  v_accvgpr_read_b32 v3, a105
  v_mul_f32 v3, v3, v2
  v_accvgpr_write_b32 a105, v3
  v_accvgpr_read_b32 v4, a106
  v_mul_f32 v4, v4, v2
  v_accvgpr_write_b32 a106, v4
  v_accvgpr_read_b32 v5, a107
  v_mul_f32 v5, v5, v2
  v_accvgpr_write_b32 a107, v5
  v_accvgpr_read_b32 v3, a108
  v_mul_f32 v3, v3, v2
  v_accvgpr_write_b32 a108, v3
  v_accvgpr_read_b32 v4, a109
  v_mul_f32 v4, v4, v2
  v_accvgpr_write_b32 a109, v4
  v_accvgpr_read_b32 v5, a110
  v_mul_f32 v5, v5, v2
  v_accvgpr_write_b32 a110, v5
  v_accvgpr_read_b32 v3, a111
  v_mul_f32 v3, v3, v2
  v_accvgpr_write_b32 a111, v3
  v_accvgpr_read_b32 v4, a112
  v_mul_f32 v4, v4, v2
  v_accvgpr_write_b32 a112, v4
  v_accvgpr_read_b32 v5, a113
  v_mul_f32 v5, v5, v2
  v_accvgpr_write_b32 a113, v5
  v_accvgpr_read_b32 v3, a114
  v_mul_f32 v3, v3, v2
  v_accvgpr_write_b32 a114, v3
  v_accvgpr_read_b32 v4, a115
  v_mul_f32 v4, v4, v2
  v_accvgpr_write_b32 a115, v4
  v_accvgpr_read_b32 v5, a116
  v_mul_f32 v5, v5, v2
  v_accvgpr_write_b32 a116, v5
  v_accvgpr_read_b32 v3, a117
  v_mul_f32 v3, v3, v2
  v_accvgpr_write_b32 a117, v3
  v_accvgpr_read_b32 v4, a118
  v_mul_f32 v4, v4, v2
  v_accvgpr_write_b32 a118, v4
  v_accvgpr_read_b32 v5, a119
  v_mul_f32 v5, v5, v2
  v_accvgpr_write_b32 a119, v5
  v_accvgpr_read_b32 v3, a120
  v_mul_f32 v3, v3, v2
  v_accvgpr_write_b32 a120, v3
  v_accvgpr_read_b32 v4, a121
  v_mul_f32 v4, v4, v2
  v_accvgpr_write_b32 a121, v4
  v_accvgpr_read_b32 v5, a122
  v_mul_f32 v5, v5, v2
  v_accvgpr_write_b32 a122, v5
  v_accvgpr_read_b32 v3, a123
  v_mul_f32 v3, v3, v2
  v_accvgpr_write_b32 a123, v3
  v_accvgpr_read_b32 v4, a124
  v_mul_f32 v4, v4, v2
  v_accvgpr_write_b32 a124, v4
  v_accvgpr_read_b32 v5, a125
  v_mul_f32 v5, v5, v2
  v_accvgpr_write_b32 a125, v5
  v_accvgpr_read_b32 v3, a126
  v_mul_f32 v3, v3, v2
  v_accvgpr_write_b32 a126, v3
  v_accvgpr_read_b32 v4, a127
  v_mul_f32 v4, v4, v2
  v_accvgpr_write_b32 a127, v4
  v_accvgpr_read_b32 v5, a236
  v_mul_f32 v5, v5, v2
  v_accvgpr_write_b32 a236, v5
  v_accvgpr_read_b32 v3, a237
  v_mul_f32 v3, v3, v2
  v_accvgpr_write_b32 a237, v3
  v_accvgpr_read_b32 v4, a238
  v_mul_f32 v4, v4, v2
  v_accvgpr_write_b32 a238, v4
  v_accvgpr_read_b32 v5, a239
  v_mul_f32 v5, v5, v2
  v_accvgpr_write_b32 a239, v5
  v_sub_f32 v128, v128, v1
  v_sub_f32 v129, v129, v1
  v_sub_f32 v130, v130, v1
  v_sub_f32 v131, v131, v1
  v_sub_f32 v76, v76, v1
  v_sub_f32 v77, v77, v1
  v_sub_f32 v78, v78, v1
  v_sub_f32 v79, v79, v1
  v_sub_f32 v80, v80, v1
  v_sub_f32 v81, v81, v1
  v_sub_f32 v82, v82, v1
  v_sub_f32 v83, v83, v1
  v_sub_f32 v108, v108, v1
  v_sub_f32 v109, v109, v1
  v_sub_f32 v110, v110, v1
  v_sub_f32 v111, v111, v1
  v_sub_f32 v112, v112, v1
  v_sub_f32 v113, v113, v1
  v_sub_f32 v114, v114, v1
  v_sub_f32 v115, v115, v1
  v_exp_f32 v28, v52
  v_exp_f32 v29, v53
  v_exp_f32 v30, v54
  v_exp_f32 v31, v55
  v_cvt_pk_bf16_f32 v132, v28, v29
  v_exp_f32 v32, v56
  v_exp_f32 v33, v57
  v_cvt_pk_bf16_f32 v133, v30, v31
  v_exp_f32 v34, v58
  v_exp_f32 v35, v59
  v_cvt_pk_bf16_f32 v134, v32, v33
  v_exp_f32 v28, v60
  v_exp_f32 v29, v61
  v_cvt_pk_bf16_f32 v135, v34, v35
  v_exp_f32 v30, v62
  v_exp_f32 v31, v63
  v_cvt_pk_bf16_f32 v136, v28, v29
  v_exp_f32 v32, v64
  v_exp_f32 v33, v65
  v_cvt_pk_bf16_f32 v137, v30, v31
  v_exp_f32 v34, v66
  v_exp_f32 v35, v67
  v_cvt_pk_bf16_f32 v138, v32, v33
  v_exp_f32 v28, v68
  v_exp_f32 v29, v69
  v_cvt_pk_bf16_f32 v139, v34, v35
  v_exp_f32 v30, v70
  v_exp_f32 v31, v71
  v_cvt_pk_bf16_f32 v140, v28, v29
  v_exp_f32 v32, v72
  v_exp_f32 v33, v73
  v_cvt_pk_bf16_f32 v141, v30, v31
  v_exp_f32 v34, v74
  v_exp_f32 v35, v75
  v_cvt_pk_bf16_f32 v142, v32, v33
  v_exp_f32 v28, v76
  v_exp_f32 v29, v77
  v_cvt_pk_bf16_f32 v143, v34, v35
  v_exp_f32 v30, v78
  v_exp_f32 v31, v79
  v_cvt_pk_bf16_f32 v144, v28, v29
  v_exp_f32 v32, v80
  v_exp_f32 v33, v81
  v_cvt_pk_bf16_f32 v145, v30, v31
  v_exp_f32 v34, v82
  v_exp_f32 v35, v83
  v_cvt_pk_bf16_f32 v146, v32, v33
  v_cvt_pk_bf16_f32 v147, v34, v35
  s_nop 1
  s_branch L_retb1b
L_rareb2a:
  s_nop 15
  v_max3_f32 v1, v84, v85, v86
  v_max3_f32 v1, v1, v87, v88
  v_max3_f32 v1, v1, v89, v90
  v_max_f32 v1, v1, v91
  v_mov_b32 v2, v1
  s_nop 1
  v_permlane16_swap_b32 v1, v2
  v_max_f32 v1, v1, v2
  v_mov_b32 v2, v1
  s_nop 1
  v_permlane32_swap_b32 v1, v2
  v_max_f32 v1, v1, v2
  v_add_f32 v1, v7, v1
  v_max_f32 v1, 0, v1
  v_ceil_f32 v1, v1
  v_exp_f32 v2, -v1
  s_nop 0
  v_lshlrev_b32 v3, 16, v132
  v_and_b32 v4, 0xffff0000, v132
  v_mul_f32 v3, v3, v2
  v_mul_f32 v4, v4, v2
  v_cvt_pk_bf16_f32 v132, v3, v4
  v_lshlrev_b32 v3, 16, v133
  v_and_b32 v4, 0xffff0000, v133
  v_mul_f32 v3, v3, v2
  v_mul_f32 v4, v4, v2
  v_cvt_pk_bf16_f32 v133, v3, v4
  v_lshlrev_b32 v3, 16, v134
  v_and_b32 v4, 0xffff0000, v134
  v_mul_f32 v3, v3, v2
  v_mul_f32 v4, v4, v2
  v_cvt_pk_bf16_f32 v134, v3, v4
  v_lshlrev_b32 v3, 16, v135
  v_and_b32 v4, 0xffff0000, v135
  v_mul_f32 v3, v3, v2
  v_mul_f32 v4, v4, v2
  v_cvt_pk_bf16_f32 v135, v3, v4
  v_accvgpr_read_b32 v3, a0
  v_mul_f32 v3, v3, v2
  v_accvgpr_write_b32 a0, v3
  v_accvgpr_read_b32 v4, a1
  v_mul_f32 v4, v4, v2
  v_accvgpr_write_b32 a1, v4
  v_accvgpr_read_b32 v5, a2
  v_mul_f32 v5, v5, v2
  v_accvgpr_write_b32 a2, v5
  v_accvgpr_read_b32 v3, a3
  v_mul_f32 v3, v3, v2
  v_accvgpr_write_b32 a3, v3
  v_accvgpr_read_b32 v4, a4
  v_mul_f32 v4, v4, v2
  v_accvgpr_write_b32 a4, v4
  v_accvgpr_read_b32 v5, a5
  v_mul_f32 v5, v5, v2
  v_accvgpr_write_b32 a5, v5
  v_accvgpr_read_b32 v3, a6
  v_mul_f32 v3, v3, v2
  v_accvgpr_write_b32 a6, v3
  v_accvgpr_read_b32 v4, a7
  v_mul_f32 v4, v4, v2
  v_accvgpr_write_b32 a7, v4
  v_accvgpr_read_b32 v5, a8
  v_mul_f32 v5, v5, v2
  v_accvgpr_write_b32 a8, v5
  v_accvgpr_read_b32 v3, a9
  v_mul_f32 v3, v3, v2
  v_accvgpr_write_b32 a9, v3
  v_accvgpr_read_b32 v4, a10
  v_mul_f32 v4, v4, v2
  v_accvgpr_write_b32 a10, v4
  v_accvgpr_read_b32 v5, a11
  v_mul_f32 v5, v5, v2
  v_accvgpr_write_b32 a11, v5
  v_accvgpr_read_b32 v3, a12
  v_mul_f32 v3, v3, v2
  v_accvgpr_write_b32 a12, v3
  v_accvgpr_read_b32 v4, a13
  v_mul_f32 v4, v4, v2
  v_accvgpr_write_b32 a13, v4
  v_accvgpr_read_b32 v5, a14
  v_mul_f32 v5, v5, v2
  v_accvgpr_write_b32 a14, v5
  v_accvgpr_read_b32 v3, a15
  v_mul_f32 v3, v3, v2
  v_accvgpr_write_b32 a15, v3
  v_accvgpr_read_b32 v4, a16
  v_mul_f32 v4, v4, v2
  v_accvgpr_write_b32 a16, v4
  v_accvgpr_read_b32 v5, a17
  v_mul_f32 v5, v5, v2
  v_accvgpr_write_b32 a17, v5
  v_accvgpr_read_b32 v3, a18
  v_mul_f32 v3, v3, v2
  v_accvgpr_write_b32 a18, v3
  v_accvgpr_read_b32 v4, a19
  v_mul_f32 v4, v4, v2
  v_accvgpr_write_b32 a19, v4
  v_accvgpr_read_b32 v5, a20
  v_mul_f32 v5, v5, v2
  v_accvgpr_write_b32 a20, v5
  v_accvgpr_read_b32 v3, a21
  v_mul_f32 v3, v3, v2
  v_accvgpr_write_b32 a21, v3
  v_accvgpr_read_b32 v4, a22
  v_mul_f32 v4, v4, v2
  v_accvgpr_write_b32 a22, v4
  v_accvgpr_read_b32 v5, a23
  v_mul_f32 v5, v5, v2
  v_accvgpr_write_b32 a23, v5
  v_accvgpr_read_b32 v3, a24
  v_mul_f32 v3, v3, v2
  v_accvgpr_write_b32 a24, v3
  v_accvgpr_read_b32 v4, a25
  v_mul_f32 v4, v4, v2
  v_accvgpr_write_b32 a25, v4
  v_accvgpr_read_b32 v5, a26
  v_mul_f32 v5, v5, v2
  v_accvgpr_write_b32 a26, v5
  v_accvgpr_read_b32 v3, a27
  v_mul_f32 v3, v3, v2
  v_accvgpr_write_b32 a27, v3
  v_accvgpr_read_b32 v4, a28
  v_mul_f32 v4, v4, v2
  v_accvgpr_write_b32 a28, v4
  v_accvgpr_read_b32 v5, a29
  v_mul_f32 v5, v5, v2
  v_accvgpr_write_b32 a29, v5
  v_accvgpr_read_b32 v3, a30
  v_mul_f32 v3, v3, v2
  v_accvgpr_write_b32 a30, v3
  v_accvgpr_read_b32 v4, a31
  v_mul_f32 v4, v4, v2
  v_accvgpr_write_b32 a31, v4
  v_accvgpr_read_b32 v5, a224
  v_mul_f32 v5, v5, v2
  v_accvgpr_write_b32 a224, v5
  v_accvgpr_read_b32 v3, a225
  v_mul_f32 v3, v3, v2
  v_accvgpr_write_b32 a225, v3
  v_accvgpr_read_b32 v4, a226
  v_mul_f32 v4, v4, v2
  v_accvgpr_write_b32 a226, v4
  v_accvgpr_read_b32 v5, a227
  v_mul_f32 v5, v5, v2
  v_accvgpr_write_b32 a227, v5
  v_sub_f32 v116, v116, v1
  v_sub_f32 v117, v117, v1
  v_sub_f32 v118, v118, v1
  v_sub_f32 v119, v119, v1
  v_sub_f32 v84, v84, v1
  v_sub_f32 v85, v85, v1
  v_sub_f32 v86, v86, v1
  v_sub_f32 v87, v87, v1
  v_sub_f32 v88, v88, v1
  v_sub_f32 v89, v89, v1
  v_sub_f32 v90, v90, v1
  v_sub_f32 v91, v91, v1
  v_sub_f32 v52, v52, v1
  v_sub_f32 v53, v53, v1
  v_sub_f32 v54, v54, v1
  v_sub_f32 v55, v55, v1
  v_sub_f32 v56, v56, v1
  v_sub_f32 v57, v57, v1
  v_sub_f32 v58, v58, v1
  v_sub_f32 v59, v59, v1
  v_max3_f32 v1, v92, v93, v94
  v_max3_f32 v1, v1, v95, v96
  v_max3_f32 v1, v1, v97, v98
  v_max_f32 v1, v1, v99
  v_mov_b32 v2, v1
  s_nop 1
  v_permlane16_swap_b32 v1, v2
  v_max_f32 v1, v1, v2
  v_mov_b32 v2, v1
  s_nop 1
  v_permlane32_swap_b32 v1, v2
  v_max_f32 v1, v1, v2
  v_add_f32 v1, v7, v1
  v_max_f32 v1, 0, v1
  v_ceil_f32 v1, v1
  v_exp_f32 v2, -v1
  s_nop 0
  v_lshlrev_b32 v3, 16, v136
  v_and_b32 v4, 0xffff0000, v136
  v_mul_f32 v3, v3, v2
  v_mul_f32 v4, v4, v2
  v_cvt_pk_bf16_f32 v136, v3, v4
  v_lshlrev_b32 v3, 16, v137
  v_and_b32 v4, 0xffff0000, v137
  v_mul_f32 v3, v3, v2
  v_mul_f32 v4, v4, v2
  v_cvt_pk_bf16_f32 v137, v3, v4
  v_lshlrev_b32 v3, 16, v138
  v_and_b32 v4, 0xffff0000, v138
  v_mul_f32 v3, v3, v2
  v_mul_f32 v4, v4, v2
  v_cvt_pk_bf16_f32 v138, v3, v4
  v_lshlrev_b32 v3, 16, v139
  v_and_b32 v4, 0xffff0000, v139
  v_mul_f32 v3, v3, v2
  v_mul_f32 v4, v4, v2
  v_cvt_pk_bf16_f32 v139, v3, v4
  v_accvgpr_read_b32 v3, a32
  v_mul_f32 v3, v3, v2
  v_accvgpr_write_b32 a32, v3
  v_accvgpr_read_b32 v4, a33
  v_mul_f32 v4, v4, v2
  v_accvgpr_write_b32 a33, v4
  v_accvgpr_read_b32 v5, a34
  v_mul_f32 v5, v5, v2
  v_accvgpr_write_b32 a34, v5
  v_accvgpr_read_b32 v3, a35
  v_mul_f32 v3, v3, v2
  v_accvgpr_write_b32 a35, v3
  v_accvgpr_read_b32 v4, a36
  v_mul_f32 v4, v4, v2
  v_accvgpr_write_b32 a36, v4
  v_accvgpr_read_b32 v5, a37
  v_mul_f32 v5, v5, v2
  v_accvgpr_write_b32 a37, v5
  v_accvgpr_read_b32 v3, a38
  v_mul_f32 v3, v3, v2
  v_accvgpr_write_b32 a38, v3
  v_accvgpr_read_b32 v4, a39
  v_mul_f32 v4, v4, v2
  v_accvgpr_write_b32 a39, v4
  v_accvgpr_read_b32 v5, a40
  v_mul_f32 v5, v5, v2
  v_accvgpr_write_b32 a40, v5
  v_accvgpr_read_b32 v3, a41
  v_mul_f32 v3, v3, v2
  v_accvgpr_write_b32 a41, v3
  v_accvgpr_read_b32 v4, a42
  v_mul_f32 v4, v4, v2
  v_accvgpr_write_b32 a42, v4
  v_accvgpr_read_b32 v5, a43
  v_mul_f32 v5, v5, v2
  v_accvgpr_write_b32 a43, v5
  v_accvgpr_read_b32 v3, a44
  v_mul_f32 v3, v3, v2
  v_accvgpr_write_b32 a44, v3
  v_accvgpr_read_b32 v4, a45
  v_mul_f32 v4, v4, v2
  v_accvgpr_write_b32 a45, v4
  v_accvgpr_read_b32 v5, a46
  v_mul_f32 v5, v5, v2
  v_accvgpr_write_b32 a46, v5
  v_accvgpr_read_b32 v3, a47
  v_mul_f32 v3, v3, v2
  v_accvgpr_write_b32 a47, v3
  v_accvgpr_read_b32 v4, a48
  v_mul_f32 v4, v4, v2
  v_accvgpr_write_b32 a48, v4
  v_accvgpr_read_b32 v5, a49
  v_mul_f32 v5, v5, v2
  v_accvgpr_write_b32 a49, v5
  v_accvgpr_read_b32 v3, a50
  v_mul_f32 v3, v3, v2
  v_accvgpr_write_b32 a50, v3
  v_accvgpr_read_b32 v4, a51
  v_mul_f32 v4, v4, v2
  v_accvgpr_write_b32 a51, v4
  v_accvgpr_read_b32 v5, a52
  v_mul_f32 v5, v5, v2
  v_accvgpr_write_b32 a52, v5
  v_accvgpr_read_b32 v3, a53
  v_mul_f32 v3, v3, v2
  v_accvgpr_write_b32 a53, v3
  v_accvgpr_read_b32 v4, a54
  v_mul_f32 v4, v4, v2
  v_accvgpr_write_b32 a54, v4
  v_accvgpr_read_b32 v5, a55
  v_mul_f32 v5, v5, v2
  v_accvgpr_write_b32 a55, v5
  v_accvgpr_read_b32 v3, a56
  v_mul_f32 v3, v3, v2
  v_accvgpr_write_b32 a56, v3
  v_accvgpr_read_b32 v4, a57
  v_mul_f32 v4, v4, v2
  v_accvgpr_write_b32 a57, v4
  v_accvgpr_read_b32 v5, a58
  v_mul_f32 v5, v5, v2
  v_accvgpr_write_b32 a58, v5
  v_accvgpr_read_b32 v3, a59
  v_mul_f32 v3, v3, v2
  v_accvgpr_write_b32 a59, v3
  v_accvgpr_read_b32 v4, a60
  v_mul_f32 v4, v4, v2
  v_accvgpr_write_b32 a60, v4
  v_accvgpr_read_b32 v5, a61
  v_mul_f32 v5, v5, v2
  v_accvgpr_write_b32 a61, v5
  v_accvgpr_read_b32 v3, a62
  v_mul_f32 v3, v3, v2
  v_accvgpr_write_b32 a62, v3
  v_accvgpr_read_b32 v4, a63
  v_mul_f32 v4, v4, v2
  v_accvgpr_write_b32 a63, v4
  v_accvgpr_read_b32 v5, a228
  v_mul_f32 v5, v5, v2
  v_accvgpr_write_b32 a228, v5
  v_accvgpr_read_b32 v3, a229
  v_mul_f32 v3, v3, v2
  v_accvgpr_write_b32 a229, v3
  v_accvgpr_read_b32 v4, a230
  v_mul_f32 v4, v4, v2
  v_accvgpr_write_b32 a230, v4
  v_accvgpr_read_b32 v5, a231
  v_mul_f32 v5, v5, v2
  v_accvgpr_write_b32 a231, v5
  v_sub_f32 v120, v120, v1
  v_sub_f32 v121, v121, v1
  v_sub_f32 v122, v122, v1
  v_sub_f32 v123, v123, v1
  v_sub_f32 v92, v92, v1
  v_sub_f32 v93, v93, v1
  v_sub_f32 v94, v94, v1
  v_sub_f32 v95, v95, v1
  v_sub_f32 v96, v96, v1
  v_sub_f32 v97, v97, v1
  v_sub_f32 v98, v98, v1
  v_sub_f32 v99, v99, v1
  v_sub_f32 v60, v60, v1
  v_sub_f32 v61, v61, v1
  v_sub_f32 v62, v62, v1
  v_sub_f32 v63, v63, v1
  v_sub_f32 v64, v64, v1
  v_sub_f32 v65, v65, v1
  v_sub_f32 v66, v66, v1
  v_sub_f32 v67, v67, v1
  v_max3_f32 v1, v100, v101, v102
  v_max3_f32 v1, v1, v103, v104
  v_max3_f32 v1, v1, v105, v106
  v_max_f32 v1, v1, v107
  v_mov_b32 v2, v1
  s_nop 1
  v_permlane16_swap_b32 v1, v2
  v_max_f32 v1, v1, v2
  v_mov_b32 v2, v1
  s_nop 1
  v_permlane32_swap_b32 v1, v2
  v_max_f32 v1, v1, v2
  v_add_f32 v1, v7, v1
  v_max_f32 v1, 0, v1
  v_ceil_f32 v1, v1
  v_exp_f32 v2, -v1
  s_nop 0
  v_lshlrev_b32 v3, 16, v140
  v_and_b32 v4, 0xffff0000, v140
  v_mul_f32 v3, v3, v2
  v_mul_f32 v4, v4, v2
  v_cvt_pk_bf16_f32 v140, v3, v4
  v_lshlrev_b32 v3, 16, v141
  v_and_b32 v4, 0xffff0000, v141
  v_mul_f32 v3, v3, v2
  v_mul_f32 v4, v4, v2
  v_cvt_pk_bf16_f32 v141, v3, v4
  v_lshlrev_b32 v3, 16, v142
  v_and_b32 v4, 0xffff0000, v142
  v_mul_f32 v3, v3, v2
  v_mul_f32 v4, v4, v2
  v_cvt_pk_bf16_f32 v142, v3, v4
  v_lshlrev_b32 v3, 16, v143
  v_and_b32 v4, 0xffff0000, v143
  v_mul_f32 v3, v3, v2
  v_mul_f32 v4, v4, v2
  v_cvt_pk_bf16_f32 v143, v3, v4
  v_accvgpr_read_b32 v3, a64
  v_mul_f32 v3, v3, v2
  v_accvgpr_write_b32 a64, v3
  v_accvgpr_read_b32 v4, a65
  v_mul_f32 v4, v4, v2
  v_accvgpr_write_b32 a65, v4
  v_accvgpr_read_b32 v5, a66
  v_mul_f32 v5, v5, v2
  v_accvgpr_write_b32 a66, v5
  v_accvgpr_read_b32 v3, a67
  v_mul_f32 v3, v3, v2
  v_accvgpr_write_b32 a67, v3
  v_accvgpr_read_b32 v4, a68
  v_mul_f32 v4, v4, v2
  v_accvgpr_write_b32 a68, v4
  v_accvgpr_read_b32 v5, a69
  v_mul_f32 v5, v5, v2
  v_accvgpr_write_b32 a69, v5
  v_accvgpr_read_b32 v3, a70
  v_mul_f32 v3, v3, v2
  v_accvgpr_write_b32 a70, v3
  v_accvgpr_read_b32 v4, a71
  v_mul_f32 v4, v4, v2
  v_accvgpr_write_b32 a71, v4
  v_accvgpr_read_b32 v5, a72
  v_mul_f32 v5, v5, v2
  v_accvgpr_write_b32 a72, v5
  v_accvgpr_read_b32 v3, a73
  v_mul_f32 v3, v3, v2
  v_accvgpr_write_b32 a73, v3
  v_accvgpr_read_b32 v4, a74
  v_mul_f32 v4, v4, v2
  v_accvgpr_write_b32 a74, v4
  v_accvgpr_read_b32 v5, a75
  v_mul_f32 v5, v5, v2
  v_accvgpr_write_b32 a75, v5
  v_accvgpr_read_b32 v3, a76
  v_mul_f32 v3, v3, v2
  v_accvgpr_write_b32 a76, v3
  v_accvgpr_read_b32 v4, a77
  v_mul_f32 v4, v4, v2
  v_accvgpr_write_b32 a77, v4
  v_accvgpr_read_b32 v5, a78
  v_mul_f32 v5, v5, v2
  v_accvgpr_write_b32 a78, v5
  v_accvgpr_read_b32 v3, a79
  v_mul_f32 v3, v3, v2
  v_accvgpr_write_b32 a79, v3
  v_accvgpr_read_b32 v4, a80
  v_mul_f32 v4, v4, v2
  v_accvgpr_write_b32 a80, v4
  v_accvgpr_read_b32 v5, a81
  v_mul_f32 v5, v5, v2
  v_accvgpr_write_b32 a81, v5
  v_accvgpr_read_b32 v3, a82
  v_mul_f32 v3, v3, v2
  v_accvgpr_write_b32 a82, v3
  v_accvgpr_read_b32 v4, a83
  v_mul_f32 v4, v4, v2
  v_accvgpr_write_b32 a83, v4
  v_accvgpr_read_b32 v5, a84
  v_mul_f32 v5, v5, v2
  v_accvgpr_write_b32 a84, v5
  v_accvgpr_read_b32 v3, a85
  v_mul_f32 v3, v3, v2
  v_accvgpr_write_b32 a85, v3
  v_accvgpr_read_b32 v4, a86
  v_mul_f32 v4, v4, v2
  v_accvgpr_write_b32 a86, v4
  v_accvgpr_read_b32 v5, a87
  v_mul_f32 v5, v5, v2
  v_accvgpr_write_b32 a87, v5
  v_accvgpr_read_b32 v3, a88
  v_mul_f32 v3, v3, v2
  v_accvgpr_write_b32 a88, v3
  v_accvgpr_read_b32 v4, a89
  v_mul_f32 v4, v4, v2
  v_accvgpr_write_b32 a89, v4
  v_accvgpr_read_b32 v5, a90
  v_mul_f32 v5, v5, v2
  v_accvgpr_write_b32 a90, v5
  v_accvgpr_read_b32 v3, a91
  v_mul_f32 v3, v3, v2
  v_accvgpr_write_b32 a91, v3
  v_accvgpr_read_b32 v4, a92
  v_mul_f32 v4, v4, v2
  v_accvgpr_write_b32 a92, v4
  v_accvgpr_read_b32 v5, a93
  v_mul_f32 v5, v5, v2
  v_accvgpr_write_b32 a93, v5
  v_accvgpr_read_b32 v3, a94
  v_mul_f32 v3, v3, v2
  v_accvgpr_write_b32 a94, v3
  v_accvgpr_read_b32 v4, a95
  v_mul_f32 v4, v4, v2
  v_accvgpr_write_b32 a95, v4
  v_accvgpr_read_b32 v5, a232
  v_mul_f32 v5, v5, v2
  v_accvgpr_write_b32 a232, v5
  v_accvgpr_read_b32 v3, a233
  v_mul_f32 v3, v3, v2
  v_accvgpr_write_b32 a233, v3
  v_accvgpr_read_b32 v4, a234
  v_mul_f32 v4, v4, v2
  v_accvgpr_write_b32 a234, v4
  v_accvgpr_read_b32 v5, a235
  v_mul_f32 v5, v5, v2
  v_accvgpr_write_b32 a235, v5
  v_sub_f32 v124, v124, v1
  v_sub_f32 v125, v125, v1
  v_sub_f32 v126, v126, v1
  v_sub_f32 v127, v127, v1
  v_sub_f32 v100, v100, v1
  v_sub_f32 v101, v101, v1
  v_sub_f32 v102, v102, v1
  v_sub_f32 v103, v103, v1
  v_sub_f32 v104, v104, v1
  v_sub_f32 v105, v105, v1
  v_sub_f32 v106, v106, v1
  v_sub_f32 v107, v107, v1
  v_sub_f32 v68, v68, v1
  v_sub_f32 v69, v69, v1
  v_sub_f32 v70, v70, v1
  v_sub_f32 v71, v71, v1
  v_sub_f32 v72, v72, v1
  v_sub_f32 v73, v73, v1
  v_sub_f32 v74, v74, v1
  v_sub_f32 v75, v75, v1
  v_max3_f32 v1, v108, v109, v110
  v_max3_f32 v1, v1, v111, v112
  v_max3_f32 v1, v1, v113, v114
  v_max_f32 v1, v1, v115
  v_mov_b32 v2, v1
  s_nop 1
  v_permlane16_swap_b32 v1, v2
  v_max_f32 v1, v1, v2
  v_mov_b32 v2, v1
  s_nop 1
  v_permlane32_swap_b32 v1, v2
  v_max_f32 v1, v1, v2
  v_add_f32 v1, v7, v1
  v_max_f32 v1, 0, v1
  v_ceil_f32 v1, v1
  v_exp_f32 v2, -v1
  s_nop 0
  v_lshlrev_b32 v3, 16, v144
  v_and_b32 v4, 0xffff0000, v144
  v_mul_f32 v3, v3, v2
  v_mul_f32 v4, v4, v2
  v_cvt_pk_bf16_f32 v144, v3, v4
  v_lshlrev_b32 v3, 16, v145
  v_and_b32 v4, 0xffff0000, v145
  v_mul_f32 v3, v3, v2
  v_mul_f32 v4, v4, v2
  v_cvt_pk_bf16_f32 v145, v3, v4
  v_lshlrev_b32 v3, 16, v146
  v_and_b32 v4, 0xffff0000, v146
  v_mul_f32 v3, v3, v2
  v_mul_f32 v4, v4, v2
  v_cvt_pk_bf16_f32 v146, v3, v4
  v_lshlrev_b32 v3, 16, v147
  v_and_b32 v4, 0xffff0000, v147
  v_mul_f32 v3, v3, v2
  v_mul_f32 v4, v4, v2
  v_cvt_pk_bf16_f32 v147, v3, v4
  v_accvgpr_read_b32 v3, a96
  v_mul_f32 v3, v3, v2
  v_accvgpr_write_b32 a96, v3
  v_accvgpr_read_b32 v4, a97
  v_mul_f32 v4, v4, v2
  v_accvgpr_write_b32 a97, v4
  v_accvgpr_read_b32 v5, a98
  v_mul_f32 v5, v5, v2
  v_accvgpr_write_b32 a98, v5
  v_accvgpr_read_b32 v3, a99
  v_mul_f32 v3, v3, v2
  v_accvgpr_write_b32 a99, v3
  v_accvgpr_read_b32 v4, a100
  v_mul_f32 v4, v4, v2
  v_accvgpr_write_b32 a100, v4
  v_accvgpr_read_b32 v5, a101
  v_mul_f32 v5, v5, v2
  v_accvgpr_write_b32 a101, v5
  v_accvgpr_read_b32 v3, a102
  v_mul_f32 v3, v3, v2
  v_accvgpr_write_b32 a102, v3
  v_accvgpr_read_b32 v4, a103
  v_mul_f32 v4, v4, v2
  v_accvgpr_write_b32 a103, v4
  v_accvgpr_read_b32 v5, a104
  v_mul_f32 v5, v5, v2
  v_accvgpr_write_b32 a104, v5
  v_accvgpr_read_b32 v3, a105
  v_mul_f32 v3, v3, v2
  v_accvgpr_write_b32 a105, v3
  v_accvgpr_read_b32 v4, a106
  v_mul_f32 v4, v4, v2
  v_accvgpr_write_b32 a106, v4
  v_accvgpr_read_b32 v5, a107
  v_mul_f32 v5, v5, v2
  v_accvgpr_write_b32 a107, v5
  v_accvgpr_read_b32 v3, a108
  v_mul_f32 v3, v3, v2
  v_accvgpr_write_b32 a108, v3
  v_accvgpr_read_b32 v4, a109
  v_mul_f32 v4, v4, v2
  v_accvgpr_write_b32 a109, v4
  v_accvgpr_read_b32 v5, a110
  v_mul_f32 v5, v5, v2
  v_accvgpr_write_b32 a110, v5
  v_accvgpr_read_b32 v3, a111
  v_mul_f32 v3, v3, v2
  v_accvgpr_write_b32 a111, v3
  v_accvgpr_read_b32 v4, a112
  v_mul_f32 v4, v4, v2
  v_accvgpr_write_b32 a112, v4
  v_accvgpr_read_b32 v5, a113
  v_mul_f32 v5, v5, v2
  v_accvgpr_write_b32 a113, v5
  v_accvgpr_read_b32 v3, a114
  v_mul_f32 v3, v3, v2
  v_accvgpr_write_b32 a114, v3
  v_accvgpr_read_b32 v4, a115
  v_mul_f32 v4, v4, v2
  v_accvgpr_write_b32 a115, v4
  v_accvgpr_read_b32 v5, a116
  v_mul_f32 v5, v5, v2
  v_accvgpr_write_b32 a116, v5
  v_accvgpr_read_b32 v3, a117
  v_mul_f32 v3, v3, v2
  v_accvgpr_write_b32 a117, v3
  v_accvgpr_read_b32 v4, a118
  v_mul_f32 v4, v4, v2
  v_accvgpr_write_b32 a118, v4
  v_accvgpr_read_b32 v5, a119
  v_mul_f32 v5, v5, v2
  v_accvgpr_write_b32 a119, v5
  v_accvgpr_read_b32 v3, a120
  v_mul_f32 v3, v3, v2
  v_accvgpr_write_b32 a120, v3
  v_accvgpr_read_b32 v4, a121
  v_mul_f32 v4, v4, v2
  v_accvgpr_write_b32 a121, v4
  v_accvgpr_read_b32 v5, a122
  v_mul_f32 v5, v5, v2
  v_accvgpr_write_b32 a122, v5
  v_accvgpr_read_b32 v3, a123
  v_mul_f32 v3, v3, v2
  v_accvgpr_write_b32 a123, v3
  v_accvgpr_read_b32 v4, a124
  v_mul_f32 v4, v4, v2
  v_accvgpr_write_b32 a124, v4
  v_accvgpr_read_b32 v5, a125
  v_mul_f32 v5, v5, v2
  v_accvgpr_write_b32 a125, v5
  v_accvgpr_read_b32 v3, a126
  v_mul_f32 v3, v3, v2
  v_accvgpr_write_b32 a126, v3
  v_accvgpr_read_b32 v4, a127
  v_mul_f32 v4, v4, v2
  v_accvgpr_write_b32 a127, v4
  v_accvgpr_read_b32 v5, a236
  v_mul_f32 v5, v5, v2
  v_accvgpr_write_b32 a236, v5
  v_accvgpr_read_b32 v3, a237
  v_mul_f32 v3, v3, v2
  v_accvgpr_write_b32 a237, v3
  v_accvgpr_read_b32 v4, a238
  v_mul_f32 v4, v4, v2
  v_accvgpr_write_b32 a238, v4
  v_accvgpr_read_b32 v5, a239
  v_mul_f32 v5, v5, v2
  v_accvgpr_write_b32 a239, v5
  v_sub_f32 v128, v128, v1
  v_sub_f32 v129, v129, v1
  v_sub_f32 v130, v130, v1
  v_sub_f32 v131, v131, v1
  v_sub_f32 v108, v108, v1
  v_sub_f32 v109, v109, v1
  v_sub_f32 v110, v110, v1
  v_sub_f32 v111, v111, v1
  v_sub_f32 v112, v112, v1
  v_sub_f32 v113, v113, v1
  v_sub_f32 v114, v114, v1
  v_sub_f32 v115, v115, v1
  v_sub_f32 v76, v76, v1
  v_sub_f32 v77, v77, v1
  v_sub_f32 v78, v78, v1
  v_sub_f32 v79, v79, v1
  v_sub_f32 v80, v80, v1
  v_sub_f32 v81, v81, v1
  v_sub_f32 v82, v82, v1
  v_sub_f32 v83, v83, v1
  v_exp_f32 v28, v84
  v_exp_f32 v29, v85
  v_exp_f32 v30, v86
  v_exp_f32 v31, v87
  v_cvt_pk_bf16_f32 v148, v28, v29
  v_exp_f32 v32, v88
  v_exp_f32 v33, v89
  v_cvt_pk_bf16_f32 v149, v30, v31
  v_exp_f32 v34, v90
  v_exp_f32 v35, v91
  v_cvt_pk_bf16_f32 v150, v32, v33
  v_exp_f32 v28, v92
  v_exp_f32 v29, v93
  v_cvt_pk_bf16_f32 v151, v34, v35
  v_exp_f32 v30, v94
  v_exp_f32 v31, v95
  v_cvt_pk_bf16_f32 v152, v28, v29
  v_exp_f32 v32, v96
  v_exp_f32 v33, v97
  v_cvt_pk_bf16_f32 v153, v30, v31
  v_exp_f32 v34, v98
  v_exp_f32 v35, v99
  v_cvt_pk_bf16_f32 v154, v32, v33
  v_exp_f32 v28, v100
  v_exp_f32 v29, v101
  v_cvt_pk_bf16_f32 v155, v34, v35
  v_exp_f32 v30, v102
  v_exp_f32 v31, v103
  v_cvt_pk_bf16_f32 v156, v28, v29
  v_exp_f32 v32, v104
  v_exp_f32 v33, v105
  v_cvt_pk_bf16_f32 v157, v30, v31
  v_exp_f32 v34, v106
  v_exp_f32 v35, v107
  v_cvt_pk_bf16_f32 v158, v32, v33
  v_exp_f32 v28, v108
  v_exp_f32 v29, v109
  v_cvt_pk_bf16_f32 v159, v34, v35
  v_exp_f32 v30, v110
  v_exp_f32 v31, v111
  v_cvt_pk_bf16_f32 v160, v28, v29
  v_exp_f32 v32, v112
  v_exp_f32 v33, v113
  v_cvt_pk_bf16_f32 v161, v30, v31
  v_exp_f32 v34, v114
  v_exp_f32 v35, v115
  v_cvt_pk_bf16_f32 v162, v32, v33
  v_cvt_pk_bf16_f32 v163, v34, v35
  s_nop 1
  s_branch L_retb2a
L_rareb2b:
  s_nop 15
  v_max3_f32 v1, v52, v53, v54
  v_max3_f32 v1, v1, v55, v56
  v_max3_f32 v1, v1, v57, v58
  v_max_f32 v1, v1, v59
  v_mov_b32 v2, v1
  s_nop 1
  v_permlane16_swap_b32 v1, v2
  v_max_f32 v1, v1, v2
  v_mov_b32 v2, v1
  s_nop 1
  v_permlane32_swap_b32 v1, v2
  v_max_f32 v1, v1, v2
  v_add_f32 v1, v7, v1
  v_max_f32 v1, 0, v1
  v_ceil_f32 v1, v1
  v_exp_f32 v2, -v1
  s_nop 0
  v_lshlrev_b32 v3, 16, v132
  v_and_b32 v4, 0xffff0000, v132
  v_mul_f32 v3, v3, v2
  v_mul_f32 v4, v4, v2
  v_cvt_pk_bf16_f32 v132, v3, v4
  v_lshlrev_b32 v3, 16, v133
  v_and_b32 v4, 0xffff0000, v133
  v_mul_f32 v3, v3, v2
  v_mul_f32 v4, v4, v2
  v_cvt_pk_bf16_f32 v133, v3, v4
  v_lshlrev_b32 v3, 16, v134
  v_and_b32 v4, 0xffff0000, v134
  v_mul_f32 v3, v3, v2
  v_mul_f32 v4, v4, v2
  v_cvt_pk_bf16_f32 v134, v3, v4
  v_lshlrev_b32 v3, 16, v135
  v_and_b32 v4, 0xffff0000, v135
  v_mul_f32 v3, v3, v2
  v_mul_f32 v4, v4, v2
  v_cvt_pk_bf16_f32 v135, v3, v4
  v_lshlrev_b32 v3, 16, v148
  v_and_b32 v4, 0xffff0000, v148
  v_mul_f32 v3, v3, v2
  v_mul_f32 v4, v4, v2
  v_cvt_pk_bf16_f32 v148, v3, v4
  v_lshlrev_b32 v3, 16, v149
  v_and_b32 v4, 0xffff0000, v149
  v_mul_f32 v3, v3, v2
  v_mul_f32 v4, v4, v2
  v_cvt_pk_bf16_f32 v149, v3, v4
  v_lshlrev_b32 v3, 16, v150
  v_and_b32 v4, 0xffff0000, v150
  v_mul_f32 v3, v3, v2
  v_mul_f32 v4, v4, v2
  v_cvt_pk_bf16_f32 v150, v3, v4
  v_lshlrev_b32 v3, 16, v151
  v_and_b32 v4, 0xffff0000, v151
  v_mul_f32 v3, v3, v2
  v_mul_f32 v4, v4, v2
  v_cvt_pk_bf16_f32 v151, v3, v4
  v_accvgpr_read_b32 v3, a0
  v_mul_f32 v3, v3, v2
  v_accvgpr_write_b32 a0, v3
  v_accvgpr_read_b32 v4, a1
  v_mul_f32 v4, v4, v2
  v_accvgpr_write_b32 a1, v4
  v_accvgpr_read_b32 v5, a2
  v_mul_f32 v5, v5, v2
  v_accvgpr_write_b32 a2, v5
  v_accvgpr_read_b32 v3, a3
  v_mul_f32 v3, v3, v2
  v_accvgpr_write_b32 a3, v3
  v_accvgpr_read_b32 v4, a4
  v_mul_f32 v4, v4, v2
  v_accvgpr_write_b32 a4, v4
  v_accvgpr_read_b32 v5, a5
  v_mul_f32 v5, v5, v2
  v_accvgpr_write_b32 a5, v5
  v_accvgpr_read_b32 v3, a6
  v_mul_f32 v3, v3, v2
  v_accvgpr_write_b32 a6, v3
  v_accvgpr_read_b32 v4, a7
  v_mul_f32 v4, v4, v2
  v_accvgpr_write_b32 a7, v4
  v_accvgpr_read_b32 v5, a8
  v_mul_f32 v5, v5, v2
  v_accvgpr_write_b32 a8, v5
  v_accvgpr_read_b32 v3, a9
  v_mul_f32 v3, v3, v2
  v_accvgpr_write_b32 a9, v3
  v_accvgpr_read_b32 v4, a10
  v_mul_f32 v4, v4, v2
  v_accvgpr_write_b32 a10, v4
  v_accvgpr_read_b32 v5, a11
  v_mul_f32 v5, v5, v2
  v_accvgpr_write_b32 a11, v5
  v_accvgpr_read_b32 v3, a12
  v_mul_f32 v3, v3, v2
  v_accvgpr_write_b32 a12, v3
  v_accvgpr_read_b32 v4, a13
  v_mul_f32 v4, v4, v2
  v_accvgpr_write_b32 a13, v4
  v_accvgpr_read_b32 v5, a14
  v_mul_f32 v5, v5, v2
  v_accvgpr_write_b32 a14, v5
  v_accvgpr_read_b32 v3, a15
  v_mul_f32 v3, v3, v2
  v_accvgpr_write_b32 a15, v3
  v_accvgpr_read_b32 v4, a16
  v_mul_f32 v4, v4, v2
  v_accvgpr_write_b32 a16, v4
  v_accvgpr_read_b32 v5, a17
  v_mul_f32 v5, v5, v2
  v_accvgpr_write_b32 a17, v5
  v_accvgpr_read_b32 v3, a18
  v_mul_f32 v3, v3, v2
  v_accvgpr_write_b32 a18, v3
  v_accvgpr_read_b32 v4, a19
  v_mul_f32 v4, v4, v2
  v_accvgpr_write_b32 a19, v4
  v_accvgpr_read_b32 v5, a20
  v_mul_f32 v5, v5, v2
  v_accvgpr_write_b32 a20, v5
  v_accvgpr_read_b32 v3, a21
  v_mul_f32 v3, v3, v2
  v_accvgpr_write_b32 a21, v3
  v_accvgpr_read_b32 v4, a22
  v_mul_f32 v4, v4, v2
  v_accvgpr_write_b32 a22, v4
  v_accvgpr_read_b32 v5, a23
  v_mul_f32 v5, v5, v2
  v_accvgpr_write_b32 a23, v5
  v_accvgpr_read_b32 v3, a24
  v_mul_f32 v3, v3, v2
  v_accvgpr_write_b32 a24, v3
  v_accvgpr_read_b32 v4, a25
  v_mul_f32 v4, v4, v2
  v_accvgpr_write_b32 a25, v4
  v_accvgpr_read_b32 v5, a26
  v_mul_f32 v5, v5, v2
  v_accvgpr_write_b32 a26, v5
  v_accvgpr_read_b32 v3, a27
  v_mul_f32 v3, v3, v2
  v_accvgpr_write_b32 a27, v3
  v_accvgpr_read_b32 v4, a28
  v_mul_f32 v4, v4, v2
  v_accvgpr_write_b32 a28, v4
  v_accvgpr_read_b32 v5, a29
  v_mul_f32 v5, v5, v2
  v_accvgpr_write_b32 a29, v5
  v_accvgpr_read_b32 v3, a30
  v_mul_f32 v3, v3, v2
  v_accvgpr_write_b32 a30, v3
  v_accvgpr_read_b32 v4, a31
  v_mul_f32 v4, v4, v2
  v_accvgpr_write_b32 a31, v4
  v_accvgpr_read_b32 v5, a224
  v_mul_f32 v5, v5, v2
  v_accvgpr_write_b32 a224, v5
  v_accvgpr_read_b32 v3, a225
  v_mul_f32 v3, v3, v2
  v_accvgpr_write_b32 a225, v3
  v_accvgpr_read_b32 v4, a226
  v_mul_f32 v4, v4, v2
  v_accvgpr_write_b32 a226, v4
  v_accvgpr_read_b32 v5, a227
  v_mul_f32 v5, v5, v2
  v_accvgpr_write_b32 a227, v5
  v_sub_f32 v116, v116, v1
  v_sub_f32 v117, v117, v1
  v_sub_f32 v118, v118, v1
  v_sub_f32 v119, v119, v1
  v_sub_f32 v52, v52, v1
  v_sub_f32 v53, v53, v1
  v_sub_f32 v54, v54, v1
  v_sub_f32 v55, v55, v1
  v_sub_f32 v56, v56, v1
  v_sub_f32 v57, v57, v1
  v_sub_f32 v58, v58, v1
  v_sub_f32 v59, v59, v1
  v_sub_f32 v84, v84, v1
  v_sub_f32 v85, v85, v1
  v_sub_f32 v86, v86, v1
  v_sub_f32 v87, v87, v1
  v_sub_f32 v88, v88, v1
  v_sub_f32 v89, v89, v1
  v_sub_f32 v90, v90, v1
  v_sub_f32 v91, v91, v1
  v_max3_f32 v1, v60, v61, v62
  v_max3_f32 v1, v1, v63, v64
  v_max3_f32 v1, v1, v65, v66
  v_max_f32 v1, v1, v67
  v_mov_b32 v2, v1
  s_nop 1
  v_permlane16_swap_b32 v1, v2
  v_max_f32 v1, v1, v2
  v_mov_b32 v2, v1
  s_nop 1
  v_permlane32_swap_b32 v1, v2
  v_max_f32 v1, v1, v2
  v_add_f32 v1, v7, v1
  v_max_f32 v1, 0, v1
  v_ceil_f32 v1, v1
  v_exp_f32 v2, -v1
  s_nop 0
  v_lshlrev_b32 v3, 16, v136
  v_and_b32 v4, 0xffff0000, v136
  v_mul_f32 v3, v3, v2
  v_mul_f32 v4, v4, v2
  v_cvt_pk_bf16_f32 v136, v3, v4
  v_lshlrev_b32 v3, 16, v137
  v_and_b32 v4, 0xffff0000, v137
  v_mul_f32 v3, v3, v2
  v_mul_f32 v4, v4, v2
  v_cvt_pk_bf16_f32 v137, v3, v4
  v_lshlrev_b32 v3, 16, v138
  v_and_b32 v4, 0xffff0000, v138
  v_mul_f32 v3, v3, v2
  v_mul_f32 v4, v4, v2
  v_cvt_pk_bf16_f32 v138, v3, v4
  v_lshlrev_b32 v3, 16, v139
  v_and_b32 v4, 0xffff0000, v139
  v_mul_f32 v3, v3, v2
  v_mul_f32 v4, v4, v2
  v_cvt_pk_bf16_f32 v139, v3, v4
  v_lshlrev_b32 v3, 16, v152
  v_and_b32 v4, 0xffff0000, v152
  v_mul_f32 v3, v3, v2
  v_mul_f32 v4, v4, v2
  v_cvt_pk_bf16_f32 v152, v3, v4
  v_lshlrev_b32 v3, 16, v153
  v_and_b32 v4, 0xffff0000, v153
  v_mul_f32 v3, v3, v2
  v_mul_f32 v4, v4, v2
  v_cvt_pk_bf16_f32 v153, v3, v4
  v_lshlrev_b32 v3, 16, v154
  v_and_b32 v4, 0xffff0000, v154
  v_mul_f32 v3, v3, v2
  v_mul_f32 v4, v4, v2
  v_cvt_pk_bf16_f32 v154, v3, v4
  v_lshlrev_b32 v3, 16, v155
  v_and_b32 v4, 0xffff0000, v155
  v_mul_f32 v3, v3, v2
  v_mul_f32 v4, v4, v2
  v_cvt_pk_bf16_f32 v155, v3, v4
  v_accvgpr_read_b32 v3, a32
  v_mul_f32 v3, v3, v2
  v_accvgpr_write_b32 a32, v3
  v_accvgpr_read_b32 v4, a33
  v_mul_f32 v4, v4, v2
  v_accvgpr_write_b32 a33, v4
  v_accvgpr_read_b32 v5, a34
  v_mul_f32 v5, v5, v2
  v_accvgpr_write_b32 a34, v5
  v_accvgpr_read_b32 v3, a35
  v_mul_f32 v3, v3, v2
  v_accvgpr_write_b32 a35, v3
  v_accvgpr_read_b32 v4, a36
  v_mul_f32 v4, v4, v2
  v_accvgpr_write_b32 a36, v4
  v_accvgpr_read_b32 v5, a37
  v_mul_f32 v5, v5, v2
  v_accvgpr_write_b32 a37, v5
  v_accvgpr_read_b32 v3, a38
  v_mul_f32 v3, v3, v2
  v_accvgpr_write_b32 a38, v3
  v_accvgpr_read_b32 v4, a39
  v_mul_f32 v4, v4, v2
  v_accvgpr_write_b32 a39, v4
  v_accvgpr_read_b32 v5, a40
  v_mul_f32 v5, v5, v2
  v_accvgpr_write_b32 a40, v5
  v_accvgpr_read_b32 v3, a41
  v_mul_f32 v3, v3, v2
  v_accvgpr_write_b32 a41, v3
  v_accvgpr_read_b32 v4, a42
  v_mul_f32 v4, v4, v2
  v_accvgpr_write_b32 a42, v4
  v_accvgpr_read_b32 v5, a43
  v_mul_f32 v5, v5, v2
  v_accvgpr_write_b32 a43, v5
  v_accvgpr_read_b32 v3, a44
  v_mul_f32 v3, v3, v2
  v_accvgpr_write_b32 a44, v3
  v_accvgpr_read_b32 v4, a45
  v_mul_f32 v4, v4, v2
  v_accvgpr_write_b32 a45, v4
  v_accvgpr_read_b32 v5, a46
  v_mul_f32 v5, v5, v2
  v_accvgpr_write_b32 a46, v5
  v_accvgpr_read_b32 v3, a47
  v_mul_f32 v3, v3, v2
  v_accvgpr_write_b32 a47, v3
  v_accvgpr_read_b32 v4, a48
  v_mul_f32 v4, v4, v2
  v_accvgpr_write_b32 a48, v4
  v_accvgpr_read_b32 v5, a49
  v_mul_f32 v5, v5, v2
  v_accvgpr_write_b32 a49, v5
  v_accvgpr_read_b32 v3, a50
  v_mul_f32 v3, v3, v2
  v_accvgpr_write_b32 a50, v3
  v_accvgpr_read_b32 v4, a51
  v_mul_f32 v4, v4, v2
  v_accvgpr_write_b32 a51, v4
  v_accvgpr_read_b32 v5, a52
  v_mul_f32 v5, v5, v2
  v_accvgpr_write_b32 a52, v5
  v_accvgpr_read_b32 v3, a53
  v_mul_f32 v3, v3, v2
  v_accvgpr_write_b32 a53, v3
  v_accvgpr_read_b32 v4, a54
  v_mul_f32 v4, v4, v2
  v_accvgpr_write_b32 a54, v4
  v_accvgpr_read_b32 v5, a55
  v_mul_f32 v5, v5, v2
  v_accvgpr_write_b32 a55, v5
  v_accvgpr_read_b32 v3, a56
  v_mul_f32 v3, v3, v2
  v_accvgpr_write_b32 a56, v3
  v_accvgpr_read_b32 v4, a57
  v_mul_f32 v4, v4, v2
  v_accvgpr_write_b32 a57, v4
  v_accvgpr_read_b32 v5, a58
  v_mul_f32 v5, v5, v2
  v_accvgpr_write_b32 a58, v5
  v_accvgpr_read_b32 v3, a59
  v_mul_f32 v3, v3, v2
  v_accvgpr_write_b32 a59, v3
  v_accvgpr_read_b32 v4, a60
  v_mul_f32 v4, v4, v2
  v_accvgpr_write_b32 a60, v4
  v_accvgpr_read_b32 v5, a61
  v_mul_f32 v5, v5, v2
  v_accvgpr_write_b32 a61, v5
  v_accvgpr_read_b32 v3, a62
  v_mul_f32 v3, v3, v2
  v_accvgpr_write_b32 a62, v3
  v_accvgpr_read_b32 v4, a63
  v_mul_f32 v4, v4, v2
  v_accvgpr_write_b32 a63, v4
  v_accvgpr_read_b32 v5, a228
  v_mul_f32 v5, v5, v2
  v_accvgpr_write_b32 a228, v5
  v_accvgpr_read_b32 v3, a229
  v_mul_f32 v3, v3, v2
  v_accvgpr_write_b32 a229, v3
  v_accvgpr_read_b32 v4, a230
  v_mul_f32 v4, v4, v2
  v_accvgpr_write_b32 a230, v4
  v_accvgpr_read_b32 v5, a231
  v_mul_f32 v5, v5, v2
  v_accvgpr_write_b32 a231, v5
  v_sub_f32 v120, v120, v1
  v_sub_f32 v121, v121, v1
  v_sub_f32 v122, v122, v1
  v_sub_f32 v123, v123, v1
  v_sub_f32 v60, v60, v1
  v_sub_f32 v61, v61, v1
  v_sub_f32 v62, v62, v1
  v_sub_f32 v63, v63, v1
  v_sub_f32 v64, v64, v1
  v_sub_f32 v65, v65, v1
  v_sub_f32 v66, v66, v1
  v_sub_f32 v67, v67, v1
  v_sub_f32 v92, v92, v1
  v_sub_f32 v93, v93, v1
  v_sub_f32 v94, v94, v1
  v_sub_f32 v95, v95, v1
  v_sub_f32 v96, v96, v1
  v_sub_f32 v97, v97, v1
  v_sub_f32 v98, v98, v1
  v_sub_f32 v99, v99, v1
  v_max3_f32 v1, v68, v69, v70
  v_max3_f32 v1, v1, v71, v72
  v_max3_f32 v1, v1, v73, v74
  v_max_f32 v1, v1, v75
  v_mov_b32 v2, v1
  s_nop 1
  v_permlane16_swap_b32 v1, v2
  v_max_f32 v1, v1, v2
  v_mov_b32 v2, v1
  s_nop 1
  v_permlane32_swap_b32 v1, v2
  v_max_f32 v1, v1, v2
  v_add_f32 v1, v7, v1
  v_max_f32 v1, 0, v1
  v_ceil_f32 v1, v1
  v_exp_f32 v2, -v1
  s_nop 0
  v_lshlrev_b32 v3, 16, v140
  v_and_b32 v4, 0xffff0000, v140
  v_mul_f32 v3, v3, v2
  v_mul_f32 v4, v4, v2
  v_cvt_pk_bf16_f32 v140, v3, v4
  v_lshlrev_b32 v3, 16, v141
  v_and_b32 v4, 0xffff0000, v141
  v_mul_f32 v3, v3, v2
  v_mul_f32 v4, v4, v2
  v_cvt_pk_bf16_f32 v141, v3, v4
  v_lshlrev_b32 v3, 16, v142
  v_and_b32 v4, 0xffff0000, v142
  v_mul_f32 v3, v3, v2
  v_mul_f32 v4, v4, v2
  v_cvt_pk_bf16_f32 v142, v3, v4
  v_lshlrev_b32 v3, 16, v143
  v_and_b32 v4, 0xffff0000, v143
  v_mul_f32 v3, v3, v2
  v_mul_f32 v4, v4, v2
  v_cvt_pk_bf16_f32 v143, v3, v4
  v_lshlrev_b32 v3, 16, v156
  v_and_b32 v4, 0xffff0000, v156
  v_mul_f32 v3, v3, v2
  v_mul_f32 v4, v4, v2
  v_cvt_pk_bf16_f32 v156, v3, v4
  v_lshlrev_b32 v3, 16, v157
  v_and_b32 v4, 0xffff0000, v157
  v_mul_f32 v3, v3, v2
  v_mul_f32 v4, v4, v2
  v_cvt_pk_bf16_f32 v157, v3, v4
  v_lshlrev_b32 v3, 16, v158
  v_and_b32 v4, 0xffff0000, v158
  v_mul_f32 v3, v3, v2
  v_mul_f32 v4, v4, v2
  v_cvt_pk_bf16_f32 v158, v3, v4
  v_lshlrev_b32 v3, 16, v159
  v_and_b32 v4, 0xffff0000, v159
  v_mul_f32 v3, v3, v2
  v_mul_f32 v4, v4, v2
  v_cvt_pk_bf16_f32 v159, v3, v4
  v_accvgpr_read_b32 v3, a64
  v_mul_f32 v3, v3, v2
  v_accvgpr_write_b32 a64, v3
  v_accvgpr_read_b32 v4, a65
  v_mul_f32 v4, v4, v2
  v_accvgpr_write_b32 a65, v4
  v_accvgpr_read_b32 v5, a66
  v_mul_f32 v5, v5, v2
  v_accvgpr_write_b32 a66, v5
  v_accvgpr_read_b32 v3, a67
  v_mul_f32 v3, v3, v2
  v_accvgpr_write_b32 a67, v3
  v_accvgpr_read_b32 v4, a68
  v_mul_f32 v4, v4, v2
  v_accvgpr_write_b32 a68, v4
  v_accvgpr_read_b32 v5, a69
  v_mul_f32 v5, v5, v2
  v_accvgpr_write_b32 a69, v5
  v_accvgpr_read_b32 v3, a70
  v_mul_f32 v3, v3, v2
  v_accvgpr_write_b32 a70, v3
  v_accvgpr_read_b32 v4, a71
  v_mul_f32 v4, v4, v2
  v_accvgpr_write_b32 a71, v4
  v_accvgpr_read_b32 v5, a72
  v_mul_f32 v5, v5, v2
  v_accvgpr_write_b32 a72, v5
  v_accvgpr_read_b32 v3, a73
  v_mul_f32 v3, v3, v2
  v_accvgpr_write_b32 a73, v3
  v_accvgpr_read_b32 v4, a74
  v_mul_f32 v4, v4, v2
  v_accvgpr_write_b32 a74, v4
  v_accvgpr_read_b32 v5, a75
  v_mul_f32 v5, v5, v2
  v_accvgpr_write_b32 a75, v5
  v_accvgpr_read_b32 v3, a76
  v_mul_f32 v3, v3, v2
  v_accvgpr_write_b32 a76, v3
  v_accvgpr_read_b32 v4, a77
  v_mul_f32 v4, v4, v2
  v_accvgpr_write_b32 a77, v4
  v_accvgpr_read_b32 v5, a78
  v_mul_f32 v5, v5, v2
  v_accvgpr_write_b32 a78, v5
  v_accvgpr_read_b32 v3, a79
  v_mul_f32 v3, v3, v2
  v_accvgpr_write_b32 a79, v3
  v_accvgpr_read_b32 v4, a80
  v_mul_f32 v4, v4, v2
  v_accvgpr_write_b32 a80, v4
  v_accvgpr_read_b32 v5, a81
  v_mul_f32 v5, v5, v2
  v_accvgpr_write_b32 a81, v5
  v_accvgpr_read_b32 v3, a82
  v_mul_f32 v3, v3, v2
  v_accvgpr_write_b32 a82, v3
  v_accvgpr_read_b32 v4, a83
  v_mul_f32 v4, v4, v2
  v_accvgpr_write_b32 a83, v4
  v_accvgpr_read_b32 v5, a84
  v_mul_f32 v5, v5, v2
  v_accvgpr_write_b32 a84, v5
  v_accvgpr_read_b32 v3, a85
  v_mul_f32 v3, v3, v2
  v_accvgpr_write_b32 a85, v3
  v_accvgpr_read_b32 v4, a86
  v_mul_f32 v4, v4, v2
  v_accvgpr_write_b32 a86, v4
  v_accvgpr_read_b32 v5, a87
  v_mul_f32 v5, v5, v2
  v_accvgpr_write_b32 a87, v5
  v_accvgpr_read_b32 v3, a88
  v_mul_f32 v3, v3, v2
  v_accvgpr_write_b32 a88, v3
  v_accvgpr_read_b32 v4, a89
  v_mul_f32 v4, v4, v2
  v_accvgpr_write_b32 a89, v4
  v_accvgpr_read_b32 v5, a90
  v_mul_f32 v5, v5, v2
  v_accvgpr_write_b32 a90, v5
  v_accvgpr_read_b32 v3, a91
  v_mul_f32 v3, v3, v2
  v_accvgpr_write_b32 a91, v3
  v_accvgpr_read_b32 v4, a92
  v_mul_f32 v4, v4, v2
  v_accvgpr_write_b32 a92, v4
  v_accvgpr_read_b32 v5, a93
  v_mul_f32 v5, v5, v2
  v_accvgpr_write_b32 a93, v5
  v_accvgpr_read_b32 v3, a94
  v_mul_f32 v3, v3, v2
  v_accvgpr_write_b32 a94, v3
  v_accvgpr_read_b32 v4, a95
  v_mul_f32 v4, v4, v2
  v_accvgpr_write_b32 a95, v4
  v_accvgpr_read_b32 v5, a232
  v_mul_f32 v5, v5, v2
  v_accvgpr_write_b32 a232, v5
  v_accvgpr_read_b32 v3, a233
  v_mul_f32 v3, v3, v2
  v_accvgpr_write_b32 a233, v3
  v_accvgpr_read_b32 v4, a234
  v_mul_f32 v4, v4, v2
  v_accvgpr_write_b32 a234, v4
  v_accvgpr_read_b32 v5, a235
  v_mul_f32 v5, v5, v2
  v_accvgpr_write_b32 a235, v5
  v_sub_f32 v124, v124, v1
  v_sub_f32 v125, v125, v1
  v_sub_f32 v126, v126, v1
  v_sub_f32 v127, v127, v1
  v_sub_f32 v68, v68, v1
  v_sub_f32 v69, v69, v1
  v_sub_f32 v70, v70, v1
  v_sub_f32 v71, v71, v1
  v_sub_f32 v72, v72, v1
  v_sub_f32 v73, v73, v1
  v_sub_f32 v74, v74, v1
  v_sub_f32 v75, v75, v1
  v_sub_f32 v100, v100, v1
  v_sub_f32 v101, v101, v1
  v_sub_f32 v102, v102, v1
  v_sub_f32 v103, v103, v1
  v_sub_f32 v104, v104, v1
  v_sub_f32 v105, v105, v1
  v_sub_f32 v106, v106, v1
  v_sub_f32 v107, v107, v1
  v_max3_f32 v1, v76, v77, v78
  v_max3_f32 v1, v1, v79, v80
  v_max3_f32 v1, v1, v81, v82
  v_max_f32 v1, v1, v83
  v_mov_b32 v2, v1
  s_nop 1
  v_permlane16_swap_b32 v1, v2
  v_max_f32 v1, v1, v2
  v_mov_b32 v2, v1
  s_nop 1
  v_permlane32_swap_b32 v1, v2
  v_max_f32 v1, v1, v2
  v_add_f32 v1, v7, v1
  v_max_f32 v1, 0, v1
  v_ceil_f32 v1, v1
  v_exp_f32 v2, -v1
  s_nop 0
  v_lshlrev_b32 v3, 16, v144
  v_and_b32 v4, 0xffff0000, v144
  v_mul_f32 v3, v3, v2
  v_mul_f32 v4, v4, v2
  v_cvt_pk_bf16_f32 v144, v3, v4
  v_lshlrev_b32 v3, 16, v145
  v_and_b32 v4, 0xffff0000, v145
  v_mul_f32 v3, v3, v2
  v_mul_f32 v4, v4, v2
  v_cvt_pk_bf16_f32 v145, v3, v4
  v_lshlrev_b32 v3, 16, v146
  v_and_b32 v4, 0xffff0000, v146
  v_mul_f32 v3, v3, v2
  v_mul_f32 v4, v4, v2
  v_cvt_pk_bf16_f32 v146, v3, v4
  v_lshlrev_b32 v3, 16, v147
  v_and_b32 v4, 0xffff0000, v147
  v_mul_f32 v3, v3, v2
  v_mul_f32 v4, v4, v2
  v_cvt_pk_bf16_f32 v147, v3, v4
  v_lshlrev_b32 v3, 16, v160
  v_and_b32 v4, 0xffff0000, v160
  v_mul_f32 v3, v3, v2
  v_mul_f32 v4, v4, v2
  v_cvt_pk_bf16_f32 v160, v3, v4
  v_lshlrev_b32 v3, 16, v161
  v_and_b32 v4, 0xffff0000, v161
  v_mul_f32 v3, v3, v2
  v_mul_f32 v4, v4, v2
  v_cvt_pk_bf16_f32 v161, v3, v4
  v_lshlrev_b32 v3, 16, v162
  v_and_b32 v4, 0xffff0000, v162
  v_mul_f32 v3, v3, v2
  v_mul_f32 v4, v4, v2
  v_cvt_pk_bf16_f32 v162, v3, v4
  v_lshlrev_b32 v3, 16, v163
  v_and_b32 v4, 0xffff0000, v163
  v_mul_f32 v3, v3, v2
  v_mul_f32 v4, v4, v2
  v_cvt_pk_bf16_f32 v163, v3, v4
  v_accvgpr_read_b32 v3, a96
  v_mul_f32 v3, v3, v2
  v_accvgpr_write_b32 a96, v3
  v_accvgpr_read_b32 v4, a97
  v_mul_f32 v4, v4, v2
  v_accvgpr_write_b32 a97, v4
  v_accvgpr_read_b32 v5, a98
  v_mul_f32 v5, v5, v2
  v_accvgpr_write_b32 a98, v5
  v_accvgpr_read_b32 v3, a99
  v_mul_f32 v3, v3, v2
  v_accvgpr_write_b32 a99, v3
  v_accvgpr_read_b32 v4, a100
  v_mul_f32 v4, v4, v2
  v_accvgpr_write_b32 a100, v4
  v_accvgpr_read_b32 v5, a101
  v_mul_f32 v5, v5, v2
  v_accvgpr_write_b32 a101, v5
  v_accvgpr_read_b32 v3, a102
  v_mul_f32 v3, v3, v2
  v_accvgpr_write_b32 a102, v3
  v_accvgpr_read_b32 v4, a103
  v_mul_f32 v4, v4, v2
  v_accvgpr_write_b32 a103, v4
  v_accvgpr_read_b32 v5, a104
  v_mul_f32 v5, v5, v2
  v_accvgpr_write_b32 a104, v5
  v_accvgpr_read_b32 v3, a105
  v_mul_f32 v3, v3, v2
  v_accvgpr_write_b32 a105, v3
  v_accvgpr_read_b32 v4, a106
  v_mul_f32 v4, v4, v2
  v_accvgpr_write_b32 a106, v4
  v_accvgpr_read_b32 v5, a107
  v_mul_f32 v5, v5, v2
  v_accvgpr_write_b32 a107, v5
  v_accvgpr_read_b32 v3, a108
  v_mul_f32 v3, v3, v2
  v_accvgpr_write_b32 a108, v3
  v_accvgpr_read_b32 v4, a109
  v_mul_f32 v4, v4, v2
  v_accvgpr_write_b32 a109, v4
  v_accvgpr_read_b32 v5, a110
  v_mul_f32 v5, v5, v2
  v_accvgpr_write_b32 a110, v5
  v_accvgpr_read_b32 v3, a111
  v_mul_f32 v3, v3, v2
  v_accvgpr_write_b32 a111, v3
  v_accvgpr_read_b32 v4, a112
  v_mul_f32 v4, v4, v2
  v_accvgpr_write_b32 a112, v4
  v_accvgpr_read_b32 v5, a113
  v_mul_f32 v5, v5, v2
  v_accvgpr_write_b32 a113, v5
  v_accvgpr_read_b32 v3, a114
  v_mul_f32 v3, v3, v2
  v_accvgpr_write_b32 a114, v3
  v_accvgpr_read_b32 v4, a115
  v_mul_f32 v4, v4, v2
  v_accvgpr_write_b32 a115, v4
  v_accvgpr_read_b32 v5, a116
  v_mul_f32 v5, v5, v2
  v_accvgpr_write_b32 a116, v5
  v_accvgpr_read_b32 v3, a117
  v_mul_f32 v3, v3, v2
  v_accvgpr_write_b32 a117, v3
  v_accvgpr_read_b32 v4, a118
  v_mul_f32 v4, v4, v2
  v_accvgpr_write_b32 a118, v4
  v_accvgpr_read_b32 v5, a119
  v_mul_f32 v5, v5, v2
  v_accvgpr_write_b32 a119, v5
  v_accvgpr_read_b32 v3, a120
  v_mul_f32 v3, v3, v2
  v_accvgpr_write_b32 a120, v3
  v_accvgpr_read_b32 v4, a121
  v_mul_f32 v4, v4, v2
  v_accvgpr_write_b32 a121, v4
  v_accvgpr_read_b32 v5, a122
  v_mul_f32 v5, v5, v2
  v_accvgpr_write_b32 a122, v5
  v_accvgpr_read_b32 v3, a123
  v_mul_f32 v3, v3, v2
  v_accvgpr_write_b32 a123, v3
  v_accvgpr_read_b32 v4, a124
  v_mul_f32 v4, v4, v2
  v_accvgpr_write_b32 a124, v4
  v_accvgpr_read_b32 v5, a125
  v_mul_f32 v5, v5, v2
  v_accvgpr_write_b32 a125, v5
  v_accvgpr_read_b32 v3, a126
  v_mul_f32 v3, v3, v2
  v_accvgpr_write_b32 a126, v3
  v_accvgpr_read_b32 v4, a127
  v_mul_f32 v4, v4, v2
  v_accvgpr_write_b32 a127, v4
  v_accvgpr_read_b32 v5, a236
  v_mul_f32 v5, v5, v2
  v_accvgpr_write_b32 a236, v5
  v_accvgpr_read_b32 v3, a237
  v_mul_f32 v3, v3, v2
  v_accvgpr_write_b32 a237, v3
  v_accvgpr_read_b32 v4, a238
  v_mul_f32 v4, v4, v2
  v_accvgpr_write_b32 a238, v4
  v_accvgpr_read_b32 v5, a239
  v_mul_f32 v5, v5, v2
  v_accvgpr_write_b32 a239, v5
  v_sub_f32 v128, v128, v1
  v_sub_f32 v129, v129, v1
  v_sub_f32 v130, v130, v1
  v_sub_f32 v131, v131, v1
  v_sub_f32 v76, v76, v1
  v_sub_f32 v77, v77, v1
  v_sub_f32 v78, v78, v1
  v_sub_f32 v79, v79, v1
  v_sub_f32 v80, v80, v1
  v_sub_f32 v81, v81, v1
  v_sub_f32 v82, v82, v1
  v_sub_f32 v83, v83, v1
  v_sub_f32 v108, v108, v1
  v_sub_f32 v109, v109, v1
  v_sub_f32 v110, v110, v1
  v_sub_f32 v111, v111, v1
  v_sub_f32 v112, v112, v1
  v_sub_f32 v113, v113, v1
  v_sub_f32 v114, v114, v1
  v_sub_f32 v115, v115, v1
  v_exp_f32 v28, v52
  v_exp_f32 v29, v53
  v_exp_f32 v30, v54
  v_exp_f32 v31, v55
  v_cvt_pk_bf16_f32 v164, v28, v29
  v_exp_f32 v32, v56
  v_exp_f32 v33, v57
  v_cvt_pk_bf16_f32 v165, v30, v31
  v_exp_f32 v34, v58
  v_exp_f32 v35, v59
  v_cvt_pk_bf16_f32 v166, v32, v33
  v_exp_f32 v28, v60
  v_exp_f32 v29, v61
  v_cvt_pk_bf16_f32 v167, v34, v35
  v_exp_f32 v30, v62
  v_exp_f32 v31, v63
  v_cvt_pk_bf16_f32 v168, v28, v29
  v_exp_f32 v32, v64
  v_exp_f32 v33, v65
  v_cvt_pk_bf16_f32 v169, v30, v31
  v_exp_f32 v34, v66
  v_exp_f32 v35, v67
  v_cvt_pk_bf16_f32 v170, v32, v33
  v_exp_f32 v28, v68
  v_exp_f32 v29, v69
  v_cvt_pk_bf16_f32 v171, v34, v35
  v_exp_f32 v30, v70
  v_exp_f32 v31, v71
  v_cvt_pk_bf16_f32 v172, v28, v29
  v_exp_f32 v32, v72
  v_exp_f32 v33, v73
  v_cvt_pk_bf16_f32 v173, v30, v31
  v_exp_f32 v34, v74
  v_exp_f32 v35, v75
  v_cvt_pk_bf16_f32 v174, v32, v33
  v_exp_f32 v28, v76
  v_exp_f32 v29, v77
  v_cvt_pk_bf16_f32 v175, v34, v35
  v_exp_f32 v30, v78
  v_exp_f32 v31, v79
  v_cvt_pk_bf16_f32 v176, v28, v29
  v_exp_f32 v32, v80
  v_exp_f32 v33, v81
  v_cvt_pk_bf16_f32 v177, v30, v31
  v_exp_f32 v34, v82
  v_exp_f32 v35, v83
  v_cvt_pk_bf16_f32 v178, v32, v33
  v_cvt_pk_bf16_f32 v179, v34, v35
  s_nop 1
  s_branch L_retb2b
L_rareb3a:
  s_nop 15
  v_max3_f32 v1, v84, v85, v86
  v_max3_f32 v1, v1, v87, v88
  v_max3_f32 v1, v1, v89, v90
  v_max_f32 v1, v1, v91
  v_mov_b32 v2, v1
  s_nop 1
  v_permlane16_swap_b32 v1, v2
  v_max_f32 v1, v1, v2
  v_mov_b32 v2, v1
  s_nop 1
  v_permlane32_swap_b32 v1, v2
  v_max_f32 v1, v1, v2
  v_add_f32 v1, v7, v1
  v_max_f32 v1, 0, v1
  v_ceil_f32 v1, v1
  v_exp_f32 v2, -v1
  s_nop 0
  v_lshlrev_b32 v3, 16, v164
  v_and_b32 v4, 0xffff0000, v164
  v_mul_f32 v3, v3, v2
  v_mul_f32 v4, v4, v2
  v_cvt_pk_bf16_f32 v164, v3, v4
  v_lshlrev_b32 v3, 16, v165
  v_and_b32 v4, 0xffff0000, v165
  v_mul_f32 v3, v3, v2
  v_mul_f32 v4, v4, v2
  v_cvt_pk_bf16_f32 v165, v3, v4
  v_lshlrev_b32 v3, 16, v166
  v_and_b32 v4, 0xffff0000, v166
  v_mul_f32 v3, v3, v2
  v_mul_f32 v4, v4, v2
  v_cvt_pk_bf16_f32 v166, v3, v4
  v_lshlrev_b32 v3, 16, v167
  v_and_b32 v4, 0xffff0000, v167
  v_mul_f32 v3, v3, v2
  v_mul_f32 v4, v4, v2
  v_cvt_pk_bf16_f32 v167, v3, v4
  v_accvgpr_read_b32 v3, a0
  v_mul_f32 v3, v3, v2
  v_accvgpr_write_b32 a0, v3
  v_accvgpr_read_b32 v4, a1
  v_mul_f32 v4, v4, v2
  v_accvgpr_write_b32 a1, v4
  v_accvgpr_read_b32 v5, a2
  v_mul_f32 v5, v5, v2
  v_accvgpr_write_b32 a2, v5
  v_accvgpr_read_b32 v3, a3
  v_mul_f32 v3, v3, v2
  v_accvgpr_write_b32 a3, v3
  v_accvgpr_read_b32 v4, a4
  v_mul_f32 v4, v4, v2
  v_accvgpr_write_b32 a4, v4
  v_accvgpr_read_b32 v5, a5
  v_mul_f32 v5, v5, v2
  v_accvgpr_write_b32 a5, v5
  v_accvgpr_read_b32 v3, a6
  v_mul_f32 v3, v3, v2
  v_accvgpr_write_b32 a6, v3
  v_accvgpr_read_b32 v4, a7
  v_mul_f32 v4, v4, v2
  v_accvgpr_write_b32 a7, v4
  v_accvgpr_read_b32 v5, a8
  v_mul_f32 v5, v5, v2
  v_accvgpr_write_b32 a8, v5
  v_accvgpr_read_b32 v3, a9
  v_mul_f32 v3, v3, v2
  v_accvgpr_write_b32 a9, v3
  v_accvgpr_read_b32 v4, a10
  v_mul_f32 v4, v4, v2
  v_accvgpr_write_b32 a10, v4
  v_accvgpr_read_b32 v5, a11
  v_mul_f32 v5, v5, v2
  v_accvgpr_write_b32 a11, v5
  v_accvgpr_read_b32 v3, a12
  v_mul_f32 v3, v3, v2
  v_accvgpr_write_b32 a12, v3
  v_accvgpr_read_b32 v4, a13
  v_mul_f32 v4, v4, v2
  v_accvgpr_write_b32 a13, v4
  v_accvgpr_read_b32 v5, a14
  v_mul_f32 v5, v5, v2
  v_accvgpr_write_b32 a14, v5
  v_accvgpr_read_b32 v3, a15
  v_mul_f32 v3, v3, v2
  v_accvgpr_write_b32 a15, v3
  v_accvgpr_read_b32 v4, a16
  v_mul_f32 v4, v4, v2
  v_accvgpr_write_b32 a16, v4
  v_accvgpr_read_b32 v5, a17
  v_mul_f32 v5, v5, v2
  v_accvgpr_write_b32 a17, v5
  v_accvgpr_read_b32 v3, a18
  v_mul_f32 v3, v3, v2
  v_accvgpr_write_b32 a18, v3
  v_accvgpr_read_b32 v4, a19
  v_mul_f32 v4, v4, v2
  v_accvgpr_write_b32 a19, v4
  v_accvgpr_read_b32 v5, a20
  v_mul_f32 v5, v5, v2
  v_accvgpr_write_b32 a20, v5
  v_accvgpr_read_b32 v3, a21
  v_mul_f32 v3, v3, v2
  v_accvgpr_write_b32 a21, v3
  v_accvgpr_read_b32 v4, a22
  v_mul_f32 v4, v4, v2
  v_accvgpr_write_b32 a22, v4
  v_accvgpr_read_b32 v5, a23
  v_mul_f32 v5, v5, v2
  v_accvgpr_write_b32 a23, v5
  v_accvgpr_read_b32 v3, a24
  v_mul_f32 v3, v3, v2
  v_accvgpr_write_b32 a24, v3
  v_accvgpr_read_b32 v4, a25
  v_mul_f32 v4, v4, v2
  v_accvgpr_write_b32 a25, v4
  v_accvgpr_read_b32 v5, a26
  v_mul_f32 v5, v5, v2
  v_accvgpr_write_b32 a26, v5
  v_accvgpr_read_b32 v3, a27
  v_mul_f32 v3, v3, v2
  v_accvgpr_write_b32 a27, v3
  v_accvgpr_read_b32 v4, a28
  v_mul_f32 v4, v4, v2
  v_accvgpr_write_b32 a28, v4
  v_accvgpr_read_b32 v5, a29
  v_mul_f32 v5, v5, v2
  v_accvgpr_write_b32 a29, v5
  v_accvgpr_read_b32 v3, a30
  v_mul_f32 v3, v3, v2
  v_accvgpr_write_b32 a30, v3
  v_accvgpr_read_b32 v4, a31
  v_mul_f32 v4, v4, v2
  v_accvgpr_write_b32 a31, v4
  v_accvgpr_read_b32 v5, a224
  v_mul_f32 v5, v5, v2
  v_accvgpr_write_b32 a224, v5
  v_accvgpr_read_b32 v3, a225
  v_mul_f32 v3, v3, v2
  v_accvgpr_write_b32 a225, v3
  v_accvgpr_read_b32 v4, a226
  v_mul_f32 v4, v4, v2
  v_accvgpr_write_b32 a226, v4
  v_accvgpr_read_b32 v5, a227
  v_mul_f32 v5, v5, v2
  v_accvgpr_write_b32 a227, v5
  v_sub_f32 v116, v116, v1
  v_sub_f32 v117, v117, v1
  v_sub_f32 v118, v118, v1
  v_sub_f32 v119, v119, v1
  v_sub_f32 v84, v84, v1
  v_sub_f32 v85, v85, v1
  v_sub_f32 v86, v86, v1
  v_sub_f32 v87, v87, v1
  v_sub_f32 v88, v88, v1
  v_sub_f32 v89, v89, v1
  v_sub_f32 v90, v90, v1
  v_sub_f32 v91, v91, v1
  v_sub_f32 v52, v52, v1
  v_sub_f32 v53, v53, v1
  v_sub_f32 v54, v54, v1
  v_sub_f32 v55, v55, v1
  v_sub_f32 v56, v56, v1
  v_sub_f32 v57, v57, v1
  v_sub_f32 v58, v58, v1
  v_sub_f32 v59, v59, v1
  v_max3_f32 v1, v92, v93, v94
  v_max3_f32 v1, v1, v95, v96
  v_max3_f32 v1, v1, v97, v98
  v_max_f32 v1, v1, v99
  v_mov_b32 v2, v1
  s_nop 1
  v_permlane16_swap_b32 v1, v2
  v_max_f32 v1, v1, v2
  v_mov_b32 v2, v1
  s_nop 1
  v_permlane32_swap_b32 v1, v2
  v_max_f32 v1, v1, v2
  v_add_f32 v1, v7, v1
  v_max_f32 v1, 0, v1
  v_ceil_f32 v1, v1
  v_exp_f32 v2, -v1
  s_nop 0
  v_lshlrev_b32 v3, 16, v168
  v_and_b32 v4, 0xffff0000, v168
  v_mul_f32 v3, v3, v2
  v_mul_f32 v4, v4, v2
  v_cvt_pk_bf16_f32 v168, v3, v4
  v_lshlrev_b32 v3, 16, v169
  v_and_b32 v4, 0xffff0000, v169
  v_mul_f32 v3, v3, v2
  v_mul_f32 v4, v4, v2
  v_cvt_pk_bf16_f32 v169, v3, v4
  v_lshlrev_b32 v3, 16, v170
  v_and_b32 v4, 0xffff0000, v170
  v_mul_f32 v3, v3, v2
  v_mul_f32 v4, v4, v2
  v_cvt_pk_bf16_f32 v170, v3, v4
  v_lshlrev_b32 v3, 16, v171
  v_and_b32 v4, 0xffff0000, v171
  v_mul_f32 v3, v3, v2
  v_mul_f32 v4, v4, v2
  v_cvt_pk_bf16_f32 v171, v3, v4
  v_accvgpr_read_b32 v3, a32
  v_mul_f32 v3, v3, v2
  v_accvgpr_write_b32 a32, v3
  v_accvgpr_read_b32 v4, a33
  v_mul_f32 v4, v4, v2
  v_accvgpr_write_b32 a33, v4
  v_accvgpr_read_b32 v5, a34
  v_mul_f32 v5, v5, v2
  v_accvgpr_write_b32 a34, v5
  v_accvgpr_read_b32 v3, a35
  v_mul_f32 v3, v3, v2
  v_accvgpr_write_b32 a35, v3
  v_accvgpr_read_b32 v4, a36
  v_mul_f32 v4, v4, v2
  v_accvgpr_write_b32 a36, v4
  v_accvgpr_read_b32 v5, a37
  v_mul_f32 v5, v5, v2
  v_accvgpr_write_b32 a37, v5
  v_accvgpr_read_b32 v3, a38
  v_mul_f32 v3, v3, v2
  v_accvgpr_write_b32 a38, v3
  v_accvgpr_read_b32 v4, a39
  v_mul_f32 v4, v4, v2
  v_accvgpr_write_b32 a39, v4
  v_accvgpr_read_b32 v5, a40
  v_mul_f32 v5, v5, v2
  v_accvgpr_write_b32 a40, v5
  v_accvgpr_read_b32 v3, a41
  v_mul_f32 v3, v3, v2
  v_accvgpr_write_b32 a41, v3
  v_accvgpr_read_b32 v4, a42
  v_mul_f32 v4, v4, v2
  v_accvgpr_write_b32 a42, v4
  v_accvgpr_read_b32 v5, a43
  v_mul_f32 v5, v5, v2
  v_accvgpr_write_b32 a43, v5
  v_accvgpr_read_b32 v3, a44
  v_mul_f32 v3, v3, v2
  v_accvgpr_write_b32 a44, v3
  v_accvgpr_read_b32 v4, a45
  v_mul_f32 v4, v4, v2
  v_accvgpr_write_b32 a45, v4
  v_accvgpr_read_b32 v5, a46
  v_mul_f32 v5, v5, v2
  v_accvgpr_write_b32 a46, v5
  v_accvgpr_read_b32 v3, a47
  v_mul_f32 v3, v3, v2
  v_accvgpr_write_b32 a47, v3
  v_accvgpr_read_b32 v4, a48
  v_mul_f32 v4, v4, v2
  v_accvgpr_write_b32 a48, v4
  v_accvgpr_read_b32 v5, a49
  v_mul_f32 v5, v5, v2
  v_accvgpr_write_b32 a49, v5
  v_accvgpr_read_b32 v3, a50
  v_mul_f32 v3, v3, v2
  v_accvgpr_write_b32 a50, v3
  v_accvgpr_read_b32 v4, a51
  v_mul_f32 v4, v4, v2
  v_accvgpr_write_b32 a51, v4
  v_accvgpr_read_b32 v5, a52
  v_mul_f32 v5, v5, v2
  v_accvgpr_write_b32 a52, v5
  v_accvgpr_read_b32 v3, a53
  v_mul_f32 v3, v3, v2
  v_accvgpr_write_b32 a53, v3
  v_accvgpr_read_b32 v4, a54
  v_mul_f32 v4, v4, v2
  v_accvgpr_write_b32 a54, v4
  v_accvgpr_read_b32 v5, a55
  v_mul_f32 v5, v5, v2
  v_accvgpr_write_b32 a55, v5
  v_accvgpr_read_b32 v3, a56
  v_mul_f32 v3, v3, v2
  v_accvgpr_write_b32 a56, v3
  v_accvgpr_read_b32 v4, a57
  v_mul_f32 v4, v4, v2
  v_accvgpr_write_b32 a57, v4
  v_accvgpr_read_b32 v5, a58
  v_mul_f32 v5, v5, v2
  v_accvgpr_write_b32 a58, v5
  v_accvgpr_read_b32 v3, a59
  v_mul_f32 v3, v3, v2
  v_accvgpr_write_b32 a59, v3
  v_accvgpr_read_b32 v4, a60
  v_mul_f32 v4, v4, v2
  v_accvgpr_write_b32 a60, v4
  v_accvgpr_read_b32 v5, a61
  v_mul_f32 v5, v5, v2
  v_accvgpr_write_b32 a61, v5
  v_accvgpr_read_b32 v3, a62
  v_mul_f32 v3, v3, v2
  v_accvgpr_write_b32 a62, v3
  v_accvgpr_read_b32 v4, a63
  v_mul_f32 v4, v4, v2
  v_accvgpr_write_b32 a63, v4
  v_accvgpr_read_b32 v5, a228
  v_mul_f32 v5, v5, v2
  v_accvgpr_write_b32 a228, v5
  v_accvgpr_read_b32 v3, a229
  v_mul_f32 v3, v3, v2
  v_accvgpr_write_b32 a229, v3
  v_accvgpr_read_b32 v4, a230
  v_mul_f32 v4, v4, v2
  v_accvgpr_write_b32 a230, v4
  v_accvgpr_read_b32 v5, a231
  v_mul_f32 v5, v5, v2
  v_accvgpr_write_b32 a231, v5
  v_sub_f32 v120, v120, v1
  v_sub_f32 v121, v121, v1
  v_sub_f32 v122, v122, v1
  v_sub_f32 v123, v123, v1
  v_sub_f32 v92, v92, v1
  v_sub_f32 v93, v93, v1
  v_sub_f32 v94, v94, v1
  v_sub_f32 v95, v95, v1
  v_sub_f32 v96, v96, v1
  v_sub_f32 v97, v97, v1
  v_sub_f32 v98, v98, v1
  v_sub_f32 v99, v99, v1
  v_sub_f32 v60, v60, v1
  v_sub_f32 v61, v61, v1
  v_sub_f32 v62, v62, v1
  v_sub_f32 v63, v63, v1
  v_sub_f32 v64, v64, v1
  v_sub_f32 v65, v65, v1
  v_sub_f32 v66, v66, v1
  v_sub_f32 v67, v67, v1
  v_max3_f32 v1, v100, v101, v102
  v_max3_f32 v1, v1, v103, v104
  v_max3_f32 v1, v1, v105, v106
  v_max_f32 v1, v1, v107
  v_mov_b32 v2, v1
  s_nop 1
  v_permlane16_swap_b32 v1, v2
  v_max_f32 v1, v1, v2
  v_mov_b32 v2, v1
  s_nop 1
  v_permlane32_swap_b32 v1, v2
  v_max_f32 v1, v1, v2
  v_add_f32 v1, v7, v1
  v_max_f32 v1, 0, v1
  v_ceil_f32 v1, v1
  v_exp_f32 v2, -v1
  s_nop 0
  v_lshlrev_b32 v3, 16, v172
  v_and_b32 v4, 0xffff0000, v172
  v_mul_f32 v3, v3, v2
  v_mul_f32 v4, v4, v2
  v_cvt_pk_bf16_f32 v172, v3, v4
  v_lshlrev_b32 v3, 16, v173
  v_and_b32 v4, 0xffff0000, v173
  v_mul_f32 v3, v3, v2
  v_mul_f32 v4, v4, v2
  v_cvt_pk_bf16_f32 v173, v3, v4
  v_lshlrev_b32 v3, 16, v174
  v_and_b32 v4, 0xffff0000, v174
  v_mul_f32 v3, v3, v2
  v_mul_f32 v4, v4, v2
  v_cvt_pk_bf16_f32 v174, v3, v4
  v_lshlrev_b32 v3, 16, v175
  v_and_b32 v4, 0xffff0000, v175
  v_mul_f32 v3, v3, v2
  v_mul_f32 v4, v4, v2
  v_cvt_pk_bf16_f32 v175, v3, v4
  v_accvgpr_read_b32 v3, a64
  v_mul_f32 v3, v3, v2
  v_accvgpr_write_b32 a64, v3
  v_accvgpr_read_b32 v4, a65
  v_mul_f32 v4, v4, v2
  v_accvgpr_write_b32 a65, v4
  v_accvgpr_read_b32 v5, a66
  v_mul_f32 v5, v5, v2
  v_accvgpr_write_b32 a66, v5
  v_accvgpr_read_b32 v3, a67
  v_mul_f32 v3, v3, v2
  v_accvgpr_write_b32 a67, v3
  v_accvgpr_read_b32 v4, a68
  v_mul_f32 v4, v4, v2
  v_accvgpr_write_b32 a68, v4
  v_accvgpr_read_b32 v5, a69
  v_mul_f32 v5, v5, v2
  v_accvgpr_write_b32 a69, v5
  v_accvgpr_read_b32 v3, a70
  v_mul_f32 v3, v3, v2
  v_accvgpr_write_b32 a70, v3
  v_accvgpr_read_b32 v4, a71
  v_mul_f32 v4, v4, v2
  v_accvgpr_write_b32 a71, v4
  v_accvgpr_read_b32 v5, a72
  v_mul_f32 v5, v5, v2
  v_accvgpr_write_b32 a72, v5
  v_accvgpr_read_b32 v3, a73
  v_mul_f32 v3, v3, v2
  v_accvgpr_write_b32 a73, v3
  v_accvgpr_read_b32 v4, a74
  v_mul_f32 v4, v4, v2
  v_accvgpr_write_b32 a74, v4
  v_accvgpr_read_b32 v5, a75
  v_mul_f32 v5, v5, v2
  v_accvgpr_write_b32 a75, v5
  v_accvgpr_read_b32 v3, a76
  v_mul_f32 v3, v3, v2
  v_accvgpr_write_b32 a76, v3
  v_accvgpr_read_b32 v4, a77
  v_mul_f32 v4, v4, v2
  v_accvgpr_write_b32 a77, v4
  v_accvgpr_read_b32 v5, a78
  v_mul_f32 v5, v5, v2
  v_accvgpr_write_b32 a78, v5
  v_accvgpr_read_b32 v3, a79
  v_mul_f32 v3, v3, v2
  v_accvgpr_write_b32 a79, v3
  v_accvgpr_read_b32 v4, a80
  v_mul_f32 v4, v4, v2
  v_accvgpr_write_b32 a80, v4
  v_accvgpr_read_b32 v5, a81
  v_mul_f32 v5, v5, v2
  v_accvgpr_write_b32 a81, v5
  v_accvgpr_read_b32 v3, a82
  v_mul_f32 v3, v3, v2
  v_accvgpr_write_b32 a82, v3
  v_accvgpr_read_b32 v4, a83
  v_mul_f32 v4, v4, v2
  v_accvgpr_write_b32 a83, v4
  v_accvgpr_read_b32 v5, a84
  v_mul_f32 v5, v5, v2
  v_accvgpr_write_b32 a84, v5
  v_accvgpr_read_b32 v3, a85
  v_mul_f32 v3, v3, v2
  v_accvgpr_write_b32 a85, v3
  v_accvgpr_read_b32 v4, a86
  v_mul_f32 v4, v4, v2
  v_accvgpr_write_b32 a86, v4
  v_accvgpr_read_b32 v5, a87
  v_mul_f32 v5, v5, v2
  v_accvgpr_write_b32 a87, v5
  v_accvgpr_read_b32 v3, a88
  v_mul_f32 v3, v3, v2
  v_accvgpr_write_b32 a88, v3
  v_accvgpr_read_b32 v4, a89
  v_mul_f32 v4, v4, v2
  v_accvgpr_write_b32 a89, v4
  v_accvgpr_read_b32 v5, a90
  v_mul_f32 v5, v5, v2
  v_accvgpr_write_b32 a90, v5
  v_accvgpr_read_b32 v3, a91
  v_mul_f32 v3, v3, v2
  v_accvgpr_write_b32 a91, v3
  v_accvgpr_read_b32 v4, a92
  v_mul_f32 v4, v4, v2
  v_accvgpr_write_b32 a92, v4
  v_accvgpr_read_b32 v5, a93
  v_mul_f32 v5, v5, v2
  v_accvgpr_write_b32 a93, v5
  v_accvgpr_read_b32 v3, a94
  v_mul_f32 v3, v3, v2
  v_accvgpr_write_b32 a94, v3
  v_accvgpr_read_b32 v4, a95
  v_mul_f32 v4, v4, v2
  v_accvgpr_write_b32 a95, v4
  v_accvgpr_read_b32 v5, a232
  v_mul_f32 v5, v5, v2
  v_accvgpr_write_b32 a232, v5
  v_accvgpr_read_b32 v3, a233
  v_mul_f32 v3, v3, v2
  v_accvgpr_write_b32 a233, v3
  v_accvgpr_read_b32 v4, a234
  v_mul_f32 v4, v4, v2
  v_accvgpr_write_b32 a234, v4
  v_accvgpr_read_b32 v5, a235
  v_mul_f32 v5, v5, v2
  v_accvgpr_write_b32 a235, v5
  v_sub_f32 v124, v124, v1
  v_sub_f32 v125, v125, v1
  v_sub_f32 v126, v126, v1
  v_sub_f32 v127, v127, v1
  v_sub_f32 v100, v100, v1
  v_sub_f32 v101, v101, v1
  v_sub_f32 v102, v102, v1
  v_sub_f32 v103, v103, v1
  v_sub_f32 v104, v104, v1
  v_sub_f32 v105, v105, v1
  v_sub_f32 v106, v106, v1
  v_sub_f32 v107, v107, v1
  v_sub_f32 v68, v68, v1
  v_sub_f32 v69, v69, v1
  v_sub_f32 v70, v70, v1
  v_sub_f32 v71, v71, v1
  v_sub_f32 v72, v72, v1
  v_sub_f32 v73, v73, v1
  v_sub_f32 v74, v74, v1
  v_sub_f32 v75, v75, v1
  v_max3_f32 v1, v108, v109, v110
  v_max3_f32 v1, v1, v111, v112
  v_max3_f32 v1, v1, v113, v114
  v_max_f32 v1, v1, v115
  v_mov_b32 v2, v1
  s_nop 1
  v_permlane16_swap_b32 v1, v2
  v_max_f32 v1, v1, v2
  v_mov_b32 v2, v1
  s_nop 1
  v_permlane32_swap_b32 v1, v2
  v_max_f32 v1, v1, v2
  v_add_f32 v1, v7, v1
  v_max_f32 v1, 0, v1
  v_ceil_f32 v1, v1
  v_exp_f32 v2, -v1
  s_nop 0
  v_lshlrev_b32 v3, 16, v176
  v_and_b32 v4, 0xffff0000, v176
  v_mul_f32 v3, v3, v2
  v_mul_f32 v4, v4, v2
  v_cvt_pk_bf16_f32 v176, v3, v4
  v_lshlrev_b32 v3, 16, v177
  v_and_b32 v4, 0xffff0000, v177
  v_mul_f32 v3, v3, v2
  v_mul_f32 v4, v4, v2
  v_cvt_pk_bf16_f32 v177, v3, v4
  v_lshlrev_b32 v3, 16, v178
  v_and_b32 v4, 0xffff0000, v178
  v_mul_f32 v3, v3, v2
  v_mul_f32 v4, v4, v2
  v_cvt_pk_bf16_f32 v178, v3, v4
  v_lshlrev_b32 v3, 16, v179
  v_and_b32 v4, 0xffff0000, v179
  v_mul_f32 v3, v3, v2
  v_mul_f32 v4, v4, v2
  v_cvt_pk_bf16_f32 v179, v3, v4
  v_accvgpr_read_b32 v3, a96
  v_mul_f32 v3, v3, v2
  v_accvgpr_write_b32 a96, v3
  v_accvgpr_read_b32 v4, a97
  v_mul_f32 v4, v4, v2
  v_accvgpr_write_b32 a97, v4
  v_accvgpr_read_b32 v5, a98
  v_mul_f32 v5, v5, v2
  v_accvgpr_write_b32 a98, v5
  v_accvgpr_read_b32 v3, a99
  v_mul_f32 v3, v3, v2
  v_accvgpr_write_b32 a99, v3
  v_accvgpr_read_b32 v4, a100
  v_mul_f32 v4, v4, v2
  v_accvgpr_write_b32 a100, v4
  v_accvgpr_read_b32 v5, a101
  v_mul_f32 v5, v5, v2
  v_accvgpr_write_b32 a101, v5
  v_accvgpr_read_b32 v3, a102
  v_mul_f32 v3, v3, v2
  v_accvgpr_write_b32 a102, v3
  v_accvgpr_read_b32 v4, a103
  v_mul_f32 v4, v4, v2
  v_accvgpr_write_b32 a103, v4
  v_accvgpr_read_b32 v5, a104
  v_mul_f32 v5, v5, v2
  v_accvgpr_write_b32 a104, v5
  v_accvgpr_read_b32 v3, a105
  v_mul_f32 v3, v3, v2
  v_accvgpr_write_b32 a105, v3
  v_accvgpr_read_b32 v4, a106
  v_mul_f32 v4, v4, v2
  v_accvgpr_write_b32 a106, v4
  v_accvgpr_read_b32 v5, a107
  v_mul_f32 v5, v5, v2
  v_accvgpr_write_b32 a107, v5
  v_accvgpr_read_b32 v3, a108
  v_mul_f32 v3, v3, v2
  v_accvgpr_write_b32 a108, v3
  v_accvgpr_read_b32 v4, a109
  v_mul_f32 v4, v4, v2
  v_accvgpr_write_b32 a109, v4
  v_accvgpr_read_b32 v5, a110
  v_mul_f32 v5, v5, v2
  v_accvgpr_write_b32 a110, v5
  v_accvgpr_read_b32 v3, a111
  v_mul_f32 v3, v3, v2
  v_accvgpr_write_b32 a111, v3
  v_accvgpr_read_b32 v4, a112
  v_mul_f32 v4, v4, v2
  v_accvgpr_write_b32 a112, v4
  v_accvgpr_read_b32 v5, a113
  v_mul_f32 v5, v5, v2
  v_accvgpr_write_b32 a113, v5
  v_accvgpr_read_b32 v3, a114
  v_mul_f32 v3, v3, v2
  v_accvgpr_write_b32 a114, v3
  v_accvgpr_read_b32 v4, a115
  v_mul_f32 v4, v4, v2
  v_accvgpr_write_b32 a115, v4
  v_accvgpr_read_b32 v5, a116
  v_mul_f32 v5, v5, v2
  v_accvgpr_write_b32 a116, v5
  v_accvgpr_read_b32 v3, a117
  v_mul_f32 v3, v3, v2
  v_accvgpr_write_b32 a117, v3
  v_accvgpr_read_b32 v4, a118
  v_mul_f32 v4, v4, v2
  v_accvgpr_write_b32 a118, v4
  v_accvgpr_read_b32 v5, a119
  v_mul_f32 v5, v5, v2
  v_accvgpr_write_b32 a119, v5
  v_accvgpr_read_b32 v3, a120
  v_mul_f32 v3, v3, v2
  v_accvgpr_write_b32 a120, v3
  v_accvgpr_read_b32 v4, a121
  v_mul_f32 v4, v4, v2
  v_accvgpr_write_b32 a121, v4
  v_accvgpr_read_b32 v5, a122
  v_mul_f32 v5, v5, v2
  v_accvgpr_write_b32 a122, v5
  v_accvgpr_read_b32 v3, a123
  v_mul_f32 v3, v3, v2
  v_accvgpr_write_b32 a123, v3
  v_accvgpr_read_b32 v4, a124
  v_mul_f32 v4, v4, v2
  v_accvgpr_write_b32 a124, v4
  v_accvgpr_read_b32 v5, a125
  v_mul_f32 v5, v5, v2
  v_accvgpr_write_b32 a125, v5
  v_accvgpr_read_b32 v3, a126
  v_mul_f32 v3, v3, v2
  v_accvgpr_write_b32 a126, v3
  v_accvgpr_read_b32 v4, a127
  v_mul_f32 v4, v4, v2
  v_accvgpr_write_b32 a127, v4
  v_accvgpr_read_b32 v5, a236
  v_mul_f32 v5, v5, v2
  v_accvgpr_write_b32 a236, v5
  v_accvgpr_read_b32 v3, a237
  v_mul_f32 v3, v3, v2
  v_accvgpr_write_b32 a237, v3
  v_accvgpr_read_b32 v4, a238
  v_mul_f32 v4, v4, v2
  v_accvgpr_write_b32 a238, v4
  v_accvgpr_read_b32 v5, a239
  v_mul_f32 v5, v5, v2
  v_accvgpr_write_b32 a239, v5
  v_sub_f32 v128, v128, v1
  v_sub_f32 v129, v129, v1
  v_sub_f32 v130, v130, v1
  v_sub_f32 v131, v131, v1
  v_sub_f32 v108, v108, v1
  v_sub_f32 v109, v109, v1
  v_sub_f32 v110, v110, v1
  v_sub_f32 v111, v111, v1
  v_sub_f32 v112, v112, v1
  v_sub_f32 v113, v113, v1
  v_sub_f32 v114, v114, v1
  v_sub_f32 v115, v115, v1
  v_sub_f32 v76, v76, v1
  v_sub_f32 v77, v77, v1
  v_sub_f32 v78, v78, v1
  v_sub_f32 v79, v79, v1
  v_sub_f32 v80, v80, v1
  v_sub_f32 v81, v81, v1
  v_sub_f32 v82, v82, v1
  v_sub_f32 v83, v83, v1
  v_exp_f32 v28, v84
  v_exp_f32 v29, v85
  v_exp_f32 v30, v86
  v_exp_f32 v31, v87
  v_cvt_pk_bf16_f32 v36, v28, v29
  v_exp_f32 v32, v88
  v_exp_f32 v33, v89
  v_cvt_pk_bf16_f32 v37, v30, v31
  v_exp_f32 v34, v90
  v_exp_f32 v35, v91
  v_cvt_pk_bf16_f32 v38, v32, v33
  v_exp_f32 v28, v92
  v_exp_f32 v29, v93
  v_cvt_pk_bf16_f32 v39, v34, v35
  v_exp_f32 v30, v94
  v_exp_f32 v31, v95
  v_cvt_pk_bf16_f32 v40, v28, v29
  v_exp_f32 v32, v96
  v_exp_f32 v33, v97
  v_cvt_pk_bf16_f32 v41, v30, v31
  v_exp_f32 v34, v98
  v_exp_f32 v35, v99
  v_cvt_pk_bf16_f32 v42, v32, v33
  v_exp_f32 v28, v100
  v_exp_f32 v29, v101
  v_cvt_pk_bf16_f32 v43, v34, v35
  v_exp_f32 v30, v102
  v_exp_f32 v31, v103
  v_cvt_pk_bf16_f32 v44, v28, v29
  v_exp_f32 v32, v104
  v_exp_f32 v33, v105
  v_cvt_pk_bf16_f32 v45, v30, v31
  v_exp_f32 v34, v106
  v_exp_f32 v35, v107
  v_cvt_pk_bf16_f32 v46, v32, v33
  v_exp_f32 v28, v108
  v_exp_f32 v29, v109
  v_cvt_pk_bf16_f32 v47, v34, v35
  v_exp_f32 v30, v110
  v_exp_f32 v31, v111
  v_cvt_pk_bf16_f32 v14, v28, v29
  v_exp_f32 v32, v112
  v_exp_f32 v33, v113
  v_cvt_pk_bf16_f32 v15, v30, v31
  v_exp_f32 v34, v114
  v_exp_f32 v35, v115
  v_cvt_pk_bf16_f32 v16, v32, v33
  v_cvt_pk_bf16_f32 v17, v34, v35
  s_nop 1
  s_branch L_retb3a
L_rareb3b:
  s_nop 15
  v_max3_f32 v1, v52, v53, v54
  v_max3_f32 v1, v1, v55, v56
  v_max3_f32 v1, v1, v57, v58
  v_max_f32 v1, v1, v59
  v_mov_b32 v2, v1
  s_nop 1
  v_permlane16_swap_b32 v1, v2
  v_max_f32 v1, v1, v2
  v_mov_b32 v2, v1
  s_nop 1
  v_permlane32_swap_b32 v1, v2
  v_max_f32 v1, v1, v2
  v_add_f32 v1, v7, v1
  v_max_f32 v1, 0, v1
  v_ceil_f32 v1, v1
  v_exp_f32 v2, -v1
  s_nop 0
  v_lshlrev_b32 v3, 16, v164
  v_and_b32 v4, 0xffff0000, v164
  v_mul_f32 v3, v3, v2
  v_mul_f32 v4, v4, v2
  v_cvt_pk_bf16_f32 v164, v3, v4
  v_lshlrev_b32 v3, 16, v165
  v_and_b32 v4, 0xffff0000, v165
  v_mul_f32 v3, v3, v2
  v_mul_f32 v4, v4, v2
  v_cvt_pk_bf16_f32 v165, v3, v4
  v_lshlrev_b32 v3, 16, v166
  v_and_b32 v4, 0xffff0000, v166
  v_mul_f32 v3, v3, v2
  v_mul_f32 v4, v4, v2
  v_cvt_pk_bf16_f32 v166, v3, v4
  v_lshlrev_b32 v3, 16, v167
  v_and_b32 v4, 0xffff0000, v167
  v_mul_f32 v3, v3, v2
  v_mul_f32 v4, v4, v2
  v_cvt_pk_bf16_f32 v167, v3, v4
  v_lshlrev_b32 v3, 16, v36
  v_and_b32 v4, 0xffff0000, v36
  v_mul_f32 v3, v3, v2
  v_mul_f32 v4, v4, v2
  v_cvt_pk_bf16_f32 v36, v3, v4
  v_lshlrev_b32 v3, 16, v37
  v_and_b32 v4, 0xffff0000, v37
  v_mul_f32 v3, v3, v2
  v_mul_f32 v4, v4, v2
  v_cvt_pk_bf16_f32 v37, v3, v4
  v_lshlrev_b32 v3, 16, v38
  v_and_b32 v4, 0xffff0000, v38
  v_mul_f32 v3, v3, v2
  v_mul_f32 v4, v4, v2
  v_cvt_pk_bf16_f32 v38, v3, v4
  v_lshlrev_b32 v3, 16, v39
  v_and_b32 v4, 0xffff0000, v39
  v_mul_f32 v3, v3, v2
  v_mul_f32 v4, v4, v2
  v_cvt_pk_bf16_f32 v39, v3, v4
  v_accvgpr_read_b32 v3, a0
  v_mul_f32 v3, v3, v2
  v_accvgpr_write_b32 a0, v3
  v_accvgpr_read_b32 v4, a1
  v_mul_f32 v4, v4, v2
  v_accvgpr_write_b32 a1, v4
  v_accvgpr_read_b32 v5, a2
  v_mul_f32 v5, v5, v2
  v_accvgpr_write_b32 a2, v5
  v_accvgpr_read_b32 v3, a3
  v_mul_f32 v3, v3, v2
  v_accvgpr_write_b32 a3, v3
  v_accvgpr_read_b32 v4, a4
  v_mul_f32 v4, v4, v2
  v_accvgpr_write_b32 a4, v4
  v_accvgpr_read_b32 v5, a5
  v_mul_f32 v5, v5, v2
  v_accvgpr_write_b32 a5, v5
  v_accvgpr_read_b32 v3, a6
  v_mul_f32 v3, v3, v2
  v_accvgpr_write_b32 a6, v3
  v_accvgpr_read_b32 v4, a7
  v_mul_f32 v4, v4, v2
  v_accvgpr_write_b32 a7, v4
  v_accvgpr_read_b32 v5, a8
  v_mul_f32 v5, v5, v2
  v_accvgpr_write_b32 a8, v5
  v_accvgpr_read_b32 v3, a9
  v_mul_f32 v3, v3, v2
  v_accvgpr_write_b32 a9, v3
  v_accvgpr_read_b32 v4, a10
  v_mul_f32 v4, v4, v2
  v_accvgpr_write_b32 a10, v4
  v_accvgpr_read_b32 v5, a11
  v_mul_f32 v5, v5, v2
  v_accvgpr_write_b32 a11, v5
  v_accvgpr_read_b32 v3, a12
  v_mul_f32 v3, v3, v2
  v_accvgpr_write_b32 a12, v3
  v_accvgpr_read_b32 v4, a13
  v_mul_f32 v4, v4, v2
  v_accvgpr_write_b32 a13, v4
  v_accvgpr_read_b32 v5, a14
  v_mul_f32 v5, v5, v2
  v_accvgpr_write_b32 a14, v5
  v_accvgpr_read_b32 v3, a15
  v_mul_f32 v3, v3, v2
  v_accvgpr_write_b32 a15, v3
  v_accvgpr_read_b32 v4, a16
  v_mul_f32 v4, v4, v2
  v_accvgpr_write_b32 a16, v4
  v_accvgpr_read_b32 v5, a17
  v_mul_f32 v5, v5, v2
  v_accvgpr_write_b32 a17, v5
  v_accvgpr_read_b32 v3, a18
  v_mul_f32 v3, v3, v2
  v_accvgpr_write_b32 a18, v3
  v_accvgpr_read_b32 v4, a19
  v_mul_f32 v4, v4, v2
  v_accvgpr_write_b32 a19, v4
  v_accvgpr_read_b32 v5, a20
  v_mul_f32 v5, v5, v2
  v_accvgpr_write_b32 a20, v5
  v_accvgpr_read_b32 v3, a21
  v_mul_f32 v3, v3, v2
  v_accvgpr_write_b32 a21, v3
  v_accvgpr_read_b32 v4, a22
  v_mul_f32 v4, v4, v2
  v_accvgpr_write_b32 a22, v4
  v_accvgpr_read_b32 v5, a23
  v_mul_f32 v5, v5, v2
  v_accvgpr_write_b32 a23, v5
  v_accvgpr_read_b32 v3, a24
  v_mul_f32 v3, v3, v2
  v_accvgpr_write_b32 a24, v3
  v_accvgpr_read_b32 v4, a25
  v_mul_f32 v4, v4, v2
  v_accvgpr_write_b32 a25, v4
  v_accvgpr_read_b32 v5, a26
  v_mul_f32 v5, v5, v2
  v_accvgpr_write_b32 a26, v5
  v_accvgpr_read_b32 v3, a27
  v_mul_f32 v3, v3, v2
  v_accvgpr_write_b32 a27, v3
  v_accvgpr_read_b32 v4, a28
  v_mul_f32 v4, v4, v2
  v_accvgpr_write_b32 a28, v4
  v_accvgpr_read_b32 v5, a29
  v_mul_f32 v5, v5, v2
  v_accvgpr_write_b32 a29, v5
  v_accvgpr_read_b32 v3, a30
  v_mul_f32 v3, v3, v2
  v_accvgpr_write_b32 a30, v3
  v_accvgpr_read_b32 v4, a31
  v_mul_f32 v4, v4, v2
  v_accvgpr_write_b32 a31, v4
  v_accvgpr_read_b32 v5, a224
  v_mul_f32 v5, v5, v2
  v_accvgpr_write_b32 a224, v5
  v_accvgpr_read_b32 v3, a225
  v_mul_f32 v3, v3, v2
  v_accvgpr_write_b32 a225, v3
  v_accvgpr_read_b32 v4, a226
  v_mul_f32 v4, v4, v2
  v_accvgpr_write_b32 a226, v4
  v_accvgpr_read_b32 v5, a227
  v_mul_f32 v5, v5, v2
  v_accvgpr_write_b32 a227, v5
  v_sub_f32 v116, v116, v1
  v_sub_f32 v117, v117, v1
  v_sub_f32 v118, v118, v1
  v_sub_f32 v119, v119, v1
  v_sub_f32 v52, v52, v1
  v_sub_f32 v53, v53, v1
  v_sub_f32 v54, v54, v1
  v_sub_f32 v55, v55, v1
  v_sub_f32 v56, v56, v1
  v_sub_f32 v57, v57, v1
  v_sub_f32 v58, v58, v1
  v_sub_f32 v59, v59, v1
  v_sub_f32 v84, v84, v1
  v_sub_f32 v85, v85, v1
  v_sub_f32 v86, v86, v1
  v_sub_f32 v87, v87, v1
  v_sub_f32 v88, v88, v1
  v_sub_f32 v89, v89, v1
  v_sub_f32 v90, v90, v1
  v_sub_f32 v91, v91, v1
  v_max3_f32 v1, v60, v61, v62
  v_max3_f32 v1, v1, v63, v64
  v_max3_f32 v1, v1, v65, v66
  v_max_f32 v1, v1, v67
  v_mov_b32 v2, v1
  s_nop 1
  v_permlane16_swap_b32 v1, v2
  v_max_f32 v1, v1, v2
  v_mov_b32 v2, v1
  s_nop 1
  v_permlane32_swap_b32 v1, v2
  v_max_f32 v1, v1, v2
  v_add_f32 v1, v7, v1
  v_max_f32 v1, 0, v1
  v_ceil_f32 v1, v1
  v_exp_f32 v2, -v1
  s_nop 0
  v_lshlrev_b32 v3, 16, v168
  v_and_b32 v4, 0xffff0000, v168
  v_mul_f32 v3, v3, v2
  v_mul_f32 v4, v4, v2
  v_cvt_pk_bf16_f32 v168, v3, v4
  v_lshlrev_b32 v3, 16, v169
  v_and_b32 v4, 0xffff0000, v169
  v_mul_f32 v3, v3, v2
  v_mul_f32 v4, v4, v2
  v_cvt_pk_bf16_f32 v169, v3, v4
  v_lshlrev_b32 v3, 16, v170
  v_and_b32 v4, 0xffff0000, v170
  v_mul_f32 v3, v3, v2
  v_mul_f32 v4, v4, v2
  v_cvt_pk_bf16_f32 v170, v3, v4
  v_lshlrev_b32 v3, 16, v171
  v_and_b32 v4, 0xffff0000, v171
  v_mul_f32 v3, v3, v2
  v_mul_f32 v4, v4, v2
  v_cvt_pk_bf16_f32 v171, v3, v4
  v_lshlrev_b32 v3, 16, v40
  v_and_b32 v4, 0xffff0000, v40
  v_mul_f32 v3, v3, v2
  v_mul_f32 v4, v4, v2
  v_cvt_pk_bf16_f32 v40, v3, v4
  v_lshlrev_b32 v3, 16, v41
  v_and_b32 v4, 0xffff0000, v41
  v_mul_f32 v3, v3, v2
  v_mul_f32 v4, v4, v2
  v_cvt_pk_bf16_f32 v41, v3, v4
  v_lshlrev_b32 v3, 16, v42
  v_and_b32 v4, 0xffff0000, v42
  v_mul_f32 v3, v3, v2
  v_mul_f32 v4, v4, v2
  v_cvt_pk_bf16_f32 v42, v3, v4
  v_lshlrev_b32 v3, 16, v43
  v_and_b32 v4, 0xffff0000, v43
  v_mul_f32 v3, v3, v2
  v_mul_f32 v4, v4, v2
  v_cvt_pk_bf16_f32 v43, v3, v4
  v_accvgpr_read_b32 v3, a32
  v_mul_f32 v3, v3, v2
  v_accvgpr_write_b32 a32, v3
  v_accvgpr_read_b32 v4, a33
  v_mul_f32 v4, v4, v2
  v_accvgpr_write_b32 a33, v4
  v_accvgpr_read_b32 v5, a34
  v_mul_f32 v5, v5, v2
  v_accvgpr_write_b32 a34, v5
  v_accvgpr_read_b32 v3, a35
  v_mul_f32 v3, v3, v2
  v_accvgpr_write_b32 a35, v3
  v_accvgpr_read_b32 v4, a36
  v_mul_f32 v4, v4, v2
  v_accvgpr_write_b32 a36, v4
  v_accvgpr_read_b32 v5, a37
  v_mul_f32 v5, v5, v2
  v_accvgpr_write_b32 a37, v5
  v_accvgpr_read_b32 v3, a38
  v_mul_f32 v3, v3, v2
  v_accvgpr_write_b32 a38, v3
  v_accvgpr_read_b32 v4, a39
  v_mul_f32 v4, v4, v2
  v_accvgpr_write_b32 a39, v4
  v_accvgpr_read_b32 v5, a40
  v_mul_f32 v5, v5, v2
  v_accvgpr_write_b32 a40, v5
  v_accvgpr_read_b32 v3, a41
  v_mul_f32 v3, v3, v2
  v_accvgpr_write_b32 a41, v3
  v_accvgpr_read_b32 v4, a42
  v_mul_f32 v4, v4, v2
  v_accvgpr_write_b32 a42, v4
  v_accvgpr_read_b32 v5, a43
  v_mul_f32 v5, v5, v2
  v_accvgpr_write_b32 a43, v5
  v_accvgpr_read_b32 v3, a44
  v_mul_f32 v3, v3, v2
  v_accvgpr_write_b32 a44, v3
  v_accvgpr_read_b32 v4, a45
  v_mul_f32 v4, v4, v2
  v_accvgpr_write_b32 a45, v4
  v_accvgpr_read_b32 v5, a46
  v_mul_f32 v5, v5, v2
  v_accvgpr_write_b32 a46, v5
  v_accvgpr_read_b32 v3, a47
  v_mul_f32 v3, v3, v2
  v_accvgpr_write_b32 a47, v3
  v_accvgpr_read_b32 v4, a48
  v_mul_f32 v4, v4, v2
  v_accvgpr_write_b32 a48, v4
  v_accvgpr_read_b32 v5, a49
  v_mul_f32 v5, v5, v2
  v_accvgpr_write_b32 a49, v5
  v_accvgpr_read_b32 v3, a50
  v_mul_f32 v3, v3, v2
  v_accvgpr_write_b32 a50, v3
  v_accvgpr_read_b32 v4, a51
  v_mul_f32 v4, v4, v2
  v_accvgpr_write_b32 a51, v4
  v_accvgpr_read_b32 v5, a52
  v_mul_f32 v5, v5, v2
  v_accvgpr_write_b32 a52, v5
  v_accvgpr_read_b32 v3, a53
  v_mul_f32 v3, v3, v2
  v_accvgpr_write_b32 a53, v3
  v_accvgpr_read_b32 v4, a54
  v_mul_f32 v4, v4, v2
  v_accvgpr_write_b32 a54, v4
  v_accvgpr_read_b32 v5, a55
  v_mul_f32 v5, v5, v2
  v_accvgpr_write_b32 a55, v5
  v_accvgpr_read_b32 v3, a56
  v_mul_f32 v3, v3, v2
  v_accvgpr_write_b32 a56, v3
  v_accvgpr_read_b32 v4, a57
  v_mul_f32 v4, v4, v2
  v_accvgpr_write_b32 a57, v4
  v_accvgpr_read_b32 v5, a58
  v_mul_f32 v5, v5, v2
  v_accvgpr_write_b32 a58, v5
  v_accvgpr_read_b32 v3, a59
  v_mul_f32 v3, v3, v2
  v_accvgpr_write_b32 a59, v3
  v_accvgpr_read_b32 v4, a60
  v_mul_f32 v4, v4, v2
  v_accvgpr_write_b32 a60, v4
  v_accvgpr_read_b32 v5, a61
  v_mul_f32 v5, v5, v2
  v_accvgpr_write_b32 a61, v5
  v_accvgpr_read_b32 v3, a62
  v_mul_f32 v3, v3, v2
  v_accvgpr_write_b32 a62, v3
  v_accvgpr_read_b32 v4, a63
  v_mul_f32 v4, v4, v2
  v_accvgpr_write_b32 a63, v4
  v_accvgpr_read_b32 v5, a228
  v_mul_f32 v5, v5, v2
  v_accvgpr_write_b32 a228, v5
  v_accvgpr_read_b32 v3, a229
  v_mul_f32 v3, v3, v2
  v_accvgpr_write_b32 a229, v3
  v_accvgpr_read_b32 v4, a230
  v_mul_f32 v4, v4, v2
  v_accvgpr_write_b32 a230, v4
  v_accvgpr_read_b32 v5, a231
  v_mul_f32 v5, v5, v2
  v_accvgpr_write_b32 a231, v5
  v_sub_f32 v120, v120, v1
  v_sub_f32 v121, v121, v1
  v_sub_f32 v122, v122, v1
  v_sub_f32 v123, v123, v1
  v_sub_f32 v60, v60, v1
  v_sub_f32 v61, v61, v1
  v_sub_f32 v62, v62, v1
  v_sub_f32 v63, v63, v1
  v_sub_f32 v64, v64, v1
  v_sub_f32 v65, v65, v1
  v_sub_f32 v66, v66, v1
  v_sub_f32 v67, v67, v1
  v_sub_f32 v92, v92, v1
  v_sub_f32 v93, v93, v1
  v_sub_f32 v94, v94, v1
  v_sub_f32 v95, v95, v1
  v_sub_f32 v96, v96, v1
  v_sub_f32 v97, v97, v1
  v_sub_f32 v98, v98, v1
  v_sub_f32 v99, v99, v1
  v_max3_f32 v1, v68, v69, v70
  v_max3_f32 v1, v1, v71, v72
  v_max3_f32 v1, v1, v73, v74
  v_max_f32 v1, v1, v75
  v_mov_b32 v2, v1
  s_nop 1
  v_permlane16_swap_b32 v1, v2
  v_max_f32 v1, v1, v2
  v_mov_b32 v2, v1
  s_nop 1
  v_permlane32_swap_b32 v1, v2
  v_max_f32 v1, v1, v2
  v_add_f32 v1, v7, v1
  v_max_f32 v1, 0, v1
  v_ceil_f32 v1, v1
  v_exp_f32 v2, -v1
  s_nop 0
  v_lshlrev_b32 v3, 16, v172
  v_and_b32 v4, 0xffff0000, v172
  v_mul_f32 v3, v3, v2
  v_mul_f32 v4, v4, v2
  v_cvt_pk_bf16_f32 v172, v3, v4
  v_lshlrev_b32 v3, 16, v173
  v_and_b32 v4, 0xffff0000, v173
  v_mul_f32 v3, v3, v2
  v_mul_f32 v4, v4, v2
  v_cvt_pk_bf16_f32 v173, v3, v4
  v_lshlrev_b32 v3, 16, v174
  v_and_b32 v4, 0xffff0000, v174
  v_mul_f32 v3, v3, v2
  v_mul_f32 v4, v4, v2
  v_cvt_pk_bf16_f32 v174, v3, v4
  v_lshlrev_b32 v3, 16, v175
  v_and_b32 v4, 0xffff0000, v175
  v_mul_f32 v3, v3, v2
  v_mul_f32 v4, v4, v2
  v_cvt_pk_bf16_f32 v175, v3, v4
  v_lshlrev_b32 v3, 16, v44
  v_and_b32 v4, 0xffff0000, v44
  v_mul_f32 v3, v3, v2
  v_mul_f32 v4, v4, v2
  v_cvt_pk_bf16_f32 v44, v3, v4
  v_lshlrev_b32 v3, 16, v45
  v_and_b32 v4, 0xffff0000, v45
  v_mul_f32 v3, v3, v2
  v_mul_f32 v4, v4, v2
  v_cvt_pk_bf16_f32 v45, v3, v4
  v_lshlrev_b32 v3, 16, v46
  v_and_b32 v4, 0xffff0000, v46
  v_mul_f32 v3, v3, v2
  v_mul_f32 v4, v4, v2
  v_cvt_pk_bf16_f32 v46, v3, v4
  v_lshlrev_b32 v3, 16, v47
  v_and_b32 v4, 0xffff0000, v47
  v_mul_f32 v3, v3, v2
  v_mul_f32 v4, v4, v2
  v_cvt_pk_bf16_f32 v47, v3, v4
  v_accvgpr_read_b32 v3, a64
  v_mul_f32 v3, v3, v2
  v_accvgpr_write_b32 a64, v3
  v_accvgpr_read_b32 v4, a65
  v_mul_f32 v4, v4, v2
  v_accvgpr_write_b32 a65, v4
  v_accvgpr_read_b32 v5, a66
  v_mul_f32 v5, v5, v2
  v_accvgpr_write_b32 a66, v5
  v_accvgpr_read_b32 v3, a67
  v_mul_f32 v3, v3, v2
  v_accvgpr_write_b32 a67, v3
  v_accvgpr_read_b32 v4, a68
  v_mul_f32 v4, v4, v2
  v_accvgpr_write_b32 a68, v4
  v_accvgpr_read_b32 v5, a69
  v_mul_f32 v5, v5, v2
  v_accvgpr_write_b32 a69, v5
  v_accvgpr_read_b32 v3, a70
  v_mul_f32 v3, v3, v2
  v_accvgpr_write_b32 a70, v3
  v_accvgpr_read_b32 v4, a71
  v_mul_f32 v4, v4, v2
  v_accvgpr_write_b32 a71, v4
  v_accvgpr_read_b32 v5, a72
  v_mul_f32 v5, v5, v2
  v_accvgpr_write_b32 a72, v5
  v_accvgpr_read_b32 v3, a73
  v_mul_f32 v3, v3, v2
  v_accvgpr_write_b32 a73, v3
  v_accvgpr_read_b32 v4, a74
  v_mul_f32 v4, v4, v2
  v_accvgpr_write_b32 a74, v4
  v_accvgpr_read_b32 v5, a75
  v_mul_f32 v5, v5, v2
  v_accvgpr_write_b32 a75, v5
  v_accvgpr_read_b32 v3, a76
  v_mul_f32 v3, v3, v2
  v_accvgpr_write_b32 a76, v3
  v_accvgpr_read_b32 v4, a77
  v_mul_f32 v4, v4, v2
  v_accvgpr_write_b32 a77, v4
  v_accvgpr_read_b32 v5, a78
  v_mul_f32 v5, v5, v2
  v_accvgpr_write_b32 a78, v5
  v_accvgpr_read_b32 v3, a79
  v_mul_f32 v3, v3, v2
  v_accvgpr_write_b32 a79, v3
  v_accvgpr_read_b32 v4, a80
  v_mul_f32 v4, v4, v2
  v_accvgpr_write_b32 a80, v4
  v_accvgpr_read_b32 v5, a81
  v_mul_f32 v5, v5, v2
  v_accvgpr_write_b32 a81, v5
  v_accvgpr_read_b32 v3, a82
  v_mul_f32 v3, v3, v2
  v_accvgpr_write_b32 a82, v3
  v_accvgpr_read_b32 v4, a83
  v_mul_f32 v4, v4, v2
  v_accvgpr_write_b32 a83, v4
  v_accvgpr_read_b32 v5, a84
  v_mul_f32 v5, v5, v2
  v_accvgpr_write_b32 a84, v5
  v_accvgpr_read_b32 v3, a85
  v_mul_f32 v3, v3, v2
  v_accvgpr_write_b32 a85, v3
  v_accvgpr_read_b32 v4, a86
  v_mul_f32 v4, v4, v2
  v_accvgpr_write_b32 a86, v4
  v_accvgpr_read_b32 v5, a87
  v_mul_f32 v5, v5, v2
  v_accvgpr_write_b32 a87, v5
  v_accvgpr_read_b32 v3, a88
  v_mul_f32 v3, v3, v2
  v_accvgpr_write_b32 a88, v3
  v_accvgpr_read_b32 v4, a89
  v_mul_f32 v4, v4, v2
  v_accvgpr_write_b32 a89, v4
  v_accvgpr_read_b32 v5, a90
  v_mul_f32 v5, v5, v2
  v_accvgpr_write_b32 a90, v5
  v_accvgpr_read_b32 v3, a91
  v_mul_f32 v3, v3, v2
  v_accvgpr_write_b32 a91, v3
  v_accvgpr_read_b32 v4, a92
  v_mul_f32 v4, v4, v2
  v_accvgpr_write_b32 a92, v4
  v_accvgpr_read_b32 v5, a93
  v_mul_f32 v5, v5, v2
  v_accvgpr_write_b32 a93, v5
  v_accvgpr_read_b32 v3, a94
  v_mul_f32 v3, v3, v2
  v_accvgpr_write_b32 a94, v3
  v_accvgpr_read_b32 v4, a95
  v_mul_f32 v4, v4, v2
  v_accvgpr_write_b32 a95, v4
  v_accvgpr_read_b32 v5, a232
  v_mul_f32 v5, v5, v2
  v_accvgpr_write_b32 a232, v5
  v_accvgpr_read_b32 v3, a233
  v_mul_f32 v3, v3, v2
  v_accvgpr_write_b32 a233, v3
  v_accvgpr_read_b32 v4, a234
  v_mul_f32 v4, v4, v2
  v_accvgpr_write_b32 a234, v4
  v_accvgpr_read_b32 v5, a235
  v_mul_f32 v5, v5, v2
  v_accvgpr_write_b32 a235, v5
  v_sub_f32 v124, v124, v1
  v_sub_f32 v125, v125, v1
  v_sub_f32 v126, v126, v1
  v_sub_f32 v127, v127, v1
  v_sub_f32 v68, v68, v1
  v_sub_f32 v69, v69, v1
  v_sub_f32 v70, v70, v1
  v_sub_f32 v71, v71, v1
  v_sub_f32 v72, v72, v1
  v_sub_f32 v73, v73, v1
  v_sub_f32 v74, v74, v1
  v_sub_f32 v75, v75, v1
  v_sub_f32 v100, v100, v1
  v_sub_f32 v101, v101, v1
  v_sub_f32 v102, v102, v1
  v_sub_f32 v103, v103, v1
  v_sub_f32 v104, v104, v1
  v_sub_f32 v105, v105, v1
  v_sub_f32 v106, v106, v1
  v_sub_f32 v107, v107, v1
  v_max3_f32 v1, v76, v77, v78
  v_max3_f32 v1, v1, v79, v80
  v_max3_f32 v1, v1, v81, v82
  v_max_f32 v1, v1, v83
  v_mov_b32 v2, v1
  s_nop 1
  v_permlane16_swap_b32 v1, v2
  v_max_f32 v1, v1, v2
  v_mov_b32 v2, v1
  s_nop 1
  v_permlane32_swap_b32 v1, v2
  v_max_f32 v1, v1, v2
  v_add_f32 v1, v7, v1
  v_max_f32 v1, 0, v1
  v_ceil_f32 v1, v1
  v_exp_f32 v2, -v1
  s_nop 0
  v_lshlrev_b32 v3, 16, v176
  v_and_b32 v4, 0xffff0000, v176
  v_mul_f32 v3, v3, v2
  v_mul_f32 v4, v4, v2
  v_cvt_pk_bf16_f32 v176, v3, v4
  v_lshlrev_b32 v3, 16, v177
  v_and_b32 v4, 0xffff0000, v177
  v_mul_f32 v3, v3, v2
  v_mul_f32 v4, v4, v2
  v_cvt_pk_bf16_f32 v177, v3, v4
  v_lshlrev_b32 v3, 16, v178
  v_and_b32 v4, 0xffff0000, v178
  v_mul_f32 v3, v3, v2
  v_mul_f32 v4, v4, v2
  v_cvt_pk_bf16_f32 v178, v3, v4
  v_lshlrev_b32 v3, 16, v179
  v_and_b32 v4, 0xffff0000, v179
  v_mul_f32 v3, v3, v2
  v_mul_f32 v4, v4, v2
  v_cvt_pk_bf16_f32 v179, v3, v4
  v_lshlrev_b32 v3, 16, v14
  v_and_b32 v4, 0xffff0000, v14
  v_mul_f32 v3, v3, v2
  v_mul_f32 v4, v4, v2
  v_cvt_pk_bf16_f32 v14, v3, v4
  v_lshlrev_b32 v3, 16, v15
  v_and_b32 v4, 0xffff0000, v15
  v_mul_f32 v3, v3, v2
  v_mul_f32 v4, v4, v2
  v_cvt_pk_bf16_f32 v15, v3, v4
  v_lshlrev_b32 v3, 16, v16
  v_and_b32 v4, 0xffff0000, v16
  v_mul_f32 v3, v3, v2
  v_mul_f32 v4, v4, v2
  v_cvt_pk_bf16_f32 v16, v3, v4
  v_lshlrev_b32 v3, 16, v17
  v_and_b32 v4, 0xffff0000, v17
  v_mul_f32 v3, v3, v2
  v_mul_f32 v4, v4, v2
  v_cvt_pk_bf16_f32 v17, v3, v4
  v_accvgpr_read_b32 v3, a96
  v_mul_f32 v3, v3, v2
  v_accvgpr_write_b32 a96, v3
  v_accvgpr_read_b32 v4, a97
  v_mul_f32 v4, v4, v2
  v_accvgpr_write_b32 a97, v4
  v_accvgpr_read_b32 v5, a98
  v_mul_f32 v5, v5, v2
  v_accvgpr_write_b32 a98, v5
  v_accvgpr_read_b32 v3, a99
  v_mul_f32 v3, v3, v2
  v_accvgpr_write_b32 a99, v3
  v_accvgpr_read_b32 v4, a100
  v_mul_f32 v4, v4, v2
  v_accvgpr_write_b32 a100, v4
  v_accvgpr_read_b32 v5, a101
  v_mul_f32 v5, v5, v2
  v_accvgpr_write_b32 a101, v5
  v_accvgpr_read_b32 v3, a102
  v_mul_f32 v3, v3, v2
  v_accvgpr_write_b32 a102, v3
  v_accvgpr_read_b32 v4, a103
  v_mul_f32 v4, v4, v2
  v_accvgpr_write_b32 a103, v4
  v_accvgpr_read_b32 v5, a104
  v_mul_f32 v5, v5, v2
  v_accvgpr_write_b32 a104, v5
  v_accvgpr_read_b32 v3, a105
  v_mul_f32 v3, v3, v2
  v_accvgpr_write_b32 a105, v3
  v_accvgpr_read_b32 v4, a106
  v_mul_f32 v4, v4, v2
  v_accvgpr_write_b32 a106, v4
  v_accvgpr_read_b32 v5, a107
  v_mul_f32 v5, v5, v2
  v_accvgpr_write_b32 a107, v5
  v_accvgpr_read_b32 v3, a108
  v_mul_f32 v3, v3, v2
  v_accvgpr_write_b32 a108, v3
  v_accvgpr_read_b32 v4, a109
  v_mul_f32 v4, v4, v2
  v_accvgpr_write_b32 a109, v4
  v_accvgpr_read_b32 v5, a110
  v_mul_f32 v5, v5, v2
  v_accvgpr_write_b32 a110, v5
  v_accvgpr_read_b32 v3, a111
  v_mul_f32 v3, v3, v2
  v_accvgpr_write_b32 a111, v3
  v_accvgpr_read_b32 v4, a112
  v_mul_f32 v4, v4, v2
  v_accvgpr_write_b32 a112, v4
  v_accvgpr_read_b32 v5, a113
  v_mul_f32 v5, v5, v2
  v_accvgpr_write_b32 a113, v5
  v_accvgpr_read_b32 v3, a114
  v_mul_f32 v3, v3, v2
  v_accvgpr_write_b32 a114, v3
  v_accvgpr_read_b32 v4, a115
  v_mul_f32 v4, v4, v2
  v_accvgpr_write_b32 a115, v4
  v_accvgpr_read_b32 v5, a116
  v_mul_f32 v5, v5, v2
  v_accvgpr_write_b32 a116, v5
  v_accvgpr_read_b32 v3, a117
  v_mul_f32 v3, v3, v2
  v_accvgpr_write_b32 a117, v3
  v_accvgpr_read_b32 v4, a118
  v_mul_f32 v4, v4, v2
  v_accvgpr_write_b32 a118, v4
  v_accvgpr_read_b32 v5, a119
  v_mul_f32 v5, v5, v2
  v_accvgpr_write_b32 a119, v5
  v_accvgpr_read_b32 v3, a120
  v_mul_f32 v3, v3, v2
  v_accvgpr_write_b32 a120, v3
  v_accvgpr_read_b32 v4, a121
  v_mul_f32 v4, v4, v2
  v_accvgpr_write_b32 a121, v4
  v_accvgpr_read_b32 v5, a122
  v_mul_f32 v5, v5, v2
  v_accvgpr_write_b32 a122, v5
  v_accvgpr_read_b32 v3, a123
  v_mul_f32 v3, v3, v2
  v_accvgpr_write_b32 a123, v3
  v_accvgpr_read_b32 v4, a124
  v_mul_f32 v4, v4, v2
  v_accvgpr_write_b32 a124, v4
  v_accvgpr_read_b32 v5, a125
  v_mul_f32 v5, v5, v2
  v_accvgpr_write_b32 a125, v5
  v_accvgpr_read_b32 v3, a126
  v_mul_f32 v3, v3, v2
  v_accvgpr_write_b32 a126, v3
  v_accvgpr_read_b32 v4, a127
  v_mul_f32 v4, v4, v2
  v_accvgpr_write_b32 a127, v4
  v_accvgpr_read_b32 v5, a236
  v_mul_f32 v5, v5, v2
  v_accvgpr_write_b32 a236, v5
  v_accvgpr_read_b32 v3, a237
  v_mul_f32 v3, v3, v2
  v_accvgpr_write_b32 a237, v3
  v_accvgpr_read_b32 v4, a238
  v_mul_f32 v4, v4, v2
  v_accvgpr_write_b32 a238, v4
  v_accvgpr_read_b32 v5, a239
  v_mul_f32 v5, v5, v2
  v_accvgpr_write_b32 a239, v5
  v_sub_f32 v128, v128, v1
  v_sub_f32 v129, v129, v1
  v_sub_f32 v130, v130, v1
  v_sub_f32 v131, v131, v1
  v_sub_f32 v76, v76, v1
  v_sub_f32 v77, v77, v1
  v_sub_f32 v78, v78, v1
  v_sub_f32 v79, v79, v1
  v_sub_f32 v80, v80, v1
  v_sub_f32 v81, v81, v1
  v_sub_f32 v82, v82, v1
  v_sub_f32 v83, v83, v1
  v_sub_f32 v108, v108, v1
  v_sub_f32 v109, v109, v1
  v_sub_f32 v110, v110, v1
  v_sub_f32 v111, v111, v1
  v_sub_f32 v112, v112, v1
  v_sub_f32 v113, v113, v1
  v_sub_f32 v114, v114, v1
  v_sub_f32 v115, v115, v1
  v_exp_f32 v28, v52
  v_exp_f32 v29, v53
  v_exp_f32 v30, v54
  v_exp_f32 v31, v55
  v_cvt_pk_bf16_f32 v132, v28, v29
  v_exp_f32 v32, v56
  v_exp_f32 v33, v57
  v_cvt_pk_bf16_f32 v133, v30, v31
  v_exp_f32 v34, v58
  v_exp_f32 v35, v59
  v_cvt_pk_bf16_f32 v134, v32, v33
  v_exp_f32 v28, v60
  v_exp_f32 v29, v61
  v_cvt_pk_bf16_f32 v135, v34, v35
  v_exp_f32 v30, v62
  v_exp_f32 v31, v63
  v_cvt_pk_bf16_f32 v136, v28, v29
  v_exp_f32 v32, v64
  v_exp_f32 v33, v65
  v_cvt_pk_bf16_f32 v137, v30, v31
  v_exp_f32 v34, v66
  v_exp_f32 v35, v67
  v_cvt_pk_bf16_f32 v138, v32, v33
  v_exp_f32 v28, v68
  v_exp_f32 v29, v69
  v_cvt_pk_bf16_f32 v139, v34, v35
  v_exp_f32 v30, v70
  v_exp_f32 v31, v71
  v_cvt_pk_bf16_f32 v140, v28, v29
  v_exp_f32 v32, v72
  v_exp_f32 v33, v73
  v_cvt_pk_bf16_f32 v141, v30, v31
  v_exp_f32 v34, v74
  v_exp_f32 v35, v75
  v_cvt_pk_bf16_f32 v142, v32, v33
  v_exp_f32 v28, v76
  v_exp_f32 v29, v77
  v_cvt_pk_bf16_f32 v143, v34, v35
  v_exp_f32 v30, v78
  v_exp_f32 v31, v79
  v_cvt_pk_bf16_f32 v144, v28, v29
  v_exp_f32 v32, v80
  v_exp_f32 v33, v81
  v_cvt_pk_bf16_f32 v145, v30, v31
  v_exp_f32 v34, v82
  v_exp_f32 v35, v83
  v_cvt_pk_bf16_f32 v146, v32, v33
  v_cvt_pk_bf16_f32 v147, v34, v35
  s_nop 1
  s_branch L_retb3b
L_rareb0a:
  s_nop 15
  v_max3_f32 v1, v84, v85, v86
  v_max3_f32 v1, v1, v87, v88
  v_max3_f32 v1, v1, v89, v90
  v_max_f32 v1, v1, v91
  v_mov_b32 v2, v1
  s_nop 1
  v_permlane16_swap_b32 v1, v2
  v_max_f32 v1, v1, v2
  v_mov_b32 v2, v1
  s_nop 1
  v_permlane32_swap_b32 v1, v2
  v_max_f32 v1, v1, v2
  v_add_f32 v1, v7, v1
  v_max_f32 v1, 0, v1
  v_ceil_f32 v1, v1
  v_exp_f32 v2, -v1
  s_nop 0
  v_lshlrev_b32 v3, 16, v132
  v_and_b32 v4, 0xffff0000, v132
  v_mul_f32 v3, v3, v2
  v_mul_f32 v4, v4, v2
  v_cvt_pk_bf16_f32 v132, v3, v4
  v_lshlrev_b32 v3, 16, v133
  v_and_b32 v4, 0xffff0000, v133
  v_mul_f32 v3, v3, v2
  v_mul_f32 v4, v4, v2
  v_cvt_pk_bf16_f32 v133, v3, v4
  v_lshlrev_b32 v3, 16, v134
  v_and_b32 v4, 0xffff0000, v134
  v_mul_f32 v3, v3, v2
  v_mul_f32 v4, v4, v2
  v_cvt_pk_bf16_f32 v134, v3, v4
  v_lshlrev_b32 v3, 16, v135
  v_and_b32 v4, 0xffff0000, v135
  v_mul_f32 v3, v3, v2
  v_mul_f32 v4, v4, v2
  v_cvt_pk_bf16_f32 v135, v3, v4
  v_accvgpr_read_b32 v3, a0
  v_mul_f32 v3, v3, v2
  v_accvgpr_write_b32 a0, v3
  v_accvgpr_read_b32 v4, a1
  v_mul_f32 v4, v4, v2
  v_accvgpr_write_b32 a1, v4
  v_accvgpr_read_b32 v5, a2
  v_mul_f32 v5, v5, v2
  v_accvgpr_write_b32 a2, v5
  v_accvgpr_read_b32 v3, a3
  v_mul_f32 v3, v3, v2
  v_accvgpr_write_b32 a3, v3
  v_accvgpr_read_b32 v4, a4
  v_mul_f32 v4, v4, v2
  v_accvgpr_write_b32 a4, v4
  v_accvgpr_read_b32 v5, a5
  v_mul_f32 v5, v5, v2
  v_accvgpr_write_b32 a5, v5
  v_accvgpr_read_b32 v3, a6
  v_mul_f32 v3, v3, v2
  v_accvgpr_write_b32 a6, v3
  v_accvgpr_read_b32 v4, a7
  v_mul_f32 v4, v4, v2
  v_accvgpr_write_b32 a7, v4
  v_accvgpr_read_b32 v5, a8
  v_mul_f32 v5, v5, v2
  v_accvgpr_write_b32 a8, v5
  v_accvgpr_read_b32 v3, a9
  v_mul_f32 v3, v3, v2
  v_accvgpr_write_b32 a9, v3
  v_accvgpr_read_b32 v4, a10
  v_mul_f32 v4, v4, v2
  v_accvgpr_write_b32 a10, v4
  v_accvgpr_read_b32 v5, a11
  v_mul_f32 v5, v5, v2
  v_accvgpr_write_b32 a11, v5
  v_accvgpr_read_b32 v3, a12
  v_mul_f32 v3, v3, v2
  v_accvgpr_write_b32 a12, v3
  v_accvgpr_read_b32 v4, a13
  v_mul_f32 v4, v4, v2
  v_accvgpr_write_b32 a13, v4
  v_accvgpr_read_b32 v5, a14
  v_mul_f32 v5, v5, v2
  v_accvgpr_write_b32 a14, v5
  v_accvgpr_read_b32 v3, a15
  v_mul_f32 v3, v3, v2
  v_accvgpr_write_b32 a15, v3
  v_accvgpr_read_b32 v4, a16
  v_mul_f32 v4, v4, v2
  v_accvgpr_write_b32 a16, v4
  v_accvgpr_read_b32 v5, a17
  v_mul_f32 v5, v5, v2
  v_accvgpr_write_b32 a17, v5
  v_accvgpr_read_b32 v3, a18
  v_mul_f32 v3, v3, v2
  v_accvgpr_write_b32 a18, v3
  v_accvgpr_read_b32 v4, a19
  v_mul_f32 v4, v4, v2
  v_accvgpr_write_b32 a19, v4
  v_accvgpr_read_b32 v5, a20
  v_mul_f32 v5, v5, v2
  v_accvgpr_write_b32 a20, v5
  v_accvgpr_read_b32 v3, a21
  v_mul_f32 v3, v3, v2
  v_accvgpr_write_b32 a21, v3
  v_accvgpr_read_b32 v4, a22
  v_mul_f32 v4, v4, v2
  v_accvgpr_write_b32 a22, v4
  v_accvgpr_read_b32 v5, a23
  v_mul_f32 v5, v5, v2
  v_accvgpr_write_b32 a23, v5
  v_accvgpr_read_b32 v3, a24
  v_mul_f32 v3, v3, v2
  v_accvgpr_write_b32 a24, v3
  v_accvgpr_read_b32 v4, a25
  v_mul_f32 v4, v4, v2
  v_accvgpr_write_b32 a25, v4
  v_accvgpr_read_b32 v5, a26
  v_mul_f32 v5, v5, v2
  v_accvgpr_write_b32 a26, v5
  v_accvgpr_read_b32 v3, a27
  v_mul_f32 v3, v3, v2
  v_accvgpr_write_b32 a27, v3
  v_accvgpr_read_b32 v4, a28
  v_mul_f32 v4, v4, v2
  v_accvgpr_write_b32 a28, v4
  v_accvgpr_read_b32 v5, a29
  v_mul_f32 v5, v5, v2
  v_accvgpr_write_b32 a29, v5
  v_accvgpr_read_b32 v3, a30
  v_mul_f32 v3, v3, v2
  v_accvgpr_write_b32 a30, v3
  v_accvgpr_read_b32 v4, a31
  v_mul_f32 v4, v4, v2
  v_accvgpr_write_b32 a31, v4
  v_accvgpr_read_b32 v5, a224
  v_mul_f32 v5, v5, v2
  v_accvgpr_write_b32 a224, v5
  v_accvgpr_read_b32 v3, a225
  v_mul_f32 v3, v3, v2
  v_accvgpr_write_b32 a225, v3
  v_accvgpr_read_b32 v4, a226
  v_mul_f32 v4, v4, v2
  v_accvgpr_write_b32 a226, v4
  v_accvgpr_read_b32 v5, a227
  v_mul_f32 v5, v5, v2
  v_accvgpr_write_b32 a227, v5
  v_sub_f32 v116, v116, v1
  v_sub_f32 v117, v117, v1
  v_sub_f32 v118, v118, v1
  v_sub_f32 v119, v119, v1
  v_sub_f32 v84, v84, v1
  v_sub_f32 v85, v85, v1
  v_sub_f32 v86, v86, v1
  v_sub_f32 v87, v87, v1
  v_sub_f32 v88, v88, v1
  v_sub_f32 v89, v89, v1
  v_sub_f32 v90, v90, v1
  v_sub_f32 v91, v91, v1
  v_sub_f32 v52, v52, v1
  v_sub_f32 v53, v53, v1
  v_sub_f32 v54, v54, v1
  v_sub_f32 v55, v55, v1
  v_sub_f32 v56, v56, v1
  v_sub_f32 v57, v57, v1
  v_sub_f32 v58, v58, v1
  v_sub_f32 v59, v59, v1
  v_max3_f32 v1, v92, v93, v94
  v_max3_f32 v1, v1, v95, v96
  v_max3_f32 v1, v1, v97, v98
  v_max_f32 v1, v1, v99
  v_mov_b32 v2, v1
  s_nop 1
  v_permlane16_swap_b32 v1, v2
  v_max_f32 v1, v1, v2
  v_mov_b32 v2, v1
  s_nop 1
  v_permlane32_swap_b32 v1, v2
  v_max_f32 v1, v1, v2
  v_add_f32 v1, v7, v1
  v_max_f32 v1, 0, v1
  v_ceil_f32 v1, v1
  v_exp_f32 v2, -v1
  s_nop 0
  v_lshlrev_b32 v3, 16, v136
  v_and_b32 v4, 0xffff0000, v136
  v_mul_f32 v3, v3, v2
  v_mul_f32 v4, v4, v2
  v_cvt_pk_bf16_f32 v136, v3, v4
  v_lshlrev_b32 v3, 16, v137
  v_and_b32 v4, 0xffff0000, v137
  v_mul_f32 v3, v3, v2
  v_mul_f32 v4, v4, v2
  v_cvt_pk_bf16_f32 v137, v3, v4
  v_lshlrev_b32 v3, 16, v138
  v_and_b32 v4, 0xffff0000, v138
  v_mul_f32 v3, v3, v2
  v_mul_f32 v4, v4, v2
  v_cvt_pk_bf16_f32 v138, v3, v4
  v_lshlrev_b32 v3, 16, v139
  v_and_b32 v4, 0xffff0000, v139
  v_mul_f32 v3, v3, v2
  v_mul_f32 v4, v4, v2
  v_cvt_pk_bf16_f32 v139, v3, v4
  v_accvgpr_read_b32 v3, a32
  v_mul_f32 v3, v3, v2
  v_accvgpr_write_b32 a32, v3
  v_accvgpr_read_b32 v4, a33
  v_mul_f32 v4, v4, v2
  v_accvgpr_write_b32 a33, v4
  v_accvgpr_read_b32 v5, a34
  v_mul_f32 v5, v5, v2
  v_accvgpr_write_b32 a34, v5
  v_accvgpr_read_b32 v3, a35
  v_mul_f32 v3, v3, v2
  v_accvgpr_write_b32 a35, v3
  v_accvgpr_read_b32 v4, a36
  v_mul_f32 v4, v4, v2
  v_accvgpr_write_b32 a36, v4
  v_accvgpr_read_b32 v5, a37
  v_mul_f32 v5, v5, v2
  v_accvgpr_write_b32 a37, v5
  v_accvgpr_read_b32 v3, a38
  v_mul_f32 v3, v3, v2
  v_accvgpr_write_b32 a38, v3
  v_accvgpr_read_b32 v4, a39
  v_mul_f32 v4, v4, v2
  v_accvgpr_write_b32 a39, v4
  v_accvgpr_read_b32 v5, a40
  v_mul_f32 v5, v5, v2
  v_accvgpr_write_b32 a40, v5
  v_accvgpr_read_b32 v3, a41
  v_mul_f32 v3, v3, v2
  v_accvgpr_write_b32 a41, v3
  v_accvgpr_read_b32 v4, a42
  v_mul_f32 v4, v4, v2
  v_accvgpr_write_b32 a42, v4
  v_accvgpr_read_b32 v5, a43
  v_mul_f32 v5, v5, v2
  v_accvgpr_write_b32 a43, v5
  v_accvgpr_read_b32 v3, a44
  v_mul_f32 v3, v3, v2
  v_accvgpr_write_b32 a44, v3
  v_accvgpr_read_b32 v4, a45
  v_mul_f32 v4, v4, v2
  v_accvgpr_write_b32 a45, v4
  v_accvgpr_read_b32 v5, a46
  v_mul_f32 v5, v5, v2
  v_accvgpr_write_b32 a46, v5
  v_accvgpr_read_b32 v3, a47
  v_mul_f32 v3, v3, v2
  v_accvgpr_write_b32 a47, v3
  v_accvgpr_read_b32 v4, a48
  v_mul_f32 v4, v4, v2
  v_accvgpr_write_b32 a48, v4
  v_accvgpr_read_b32 v5, a49
  v_mul_f32 v5, v5, v2
  v_accvgpr_write_b32 a49, v5
  v_accvgpr_read_b32 v3, a50
  v_mul_f32 v3, v3, v2
  v_accvgpr_write_b32 a50, v3
  v_accvgpr_read_b32 v4, a51
  v_mul_f32 v4, v4, v2
  v_accvgpr_write_b32 a51, v4
  v_accvgpr_read_b32 v5, a52
  v_mul_f32 v5, v5, v2
  v_accvgpr_write_b32 a52, v5
  v_accvgpr_read_b32 v3, a53
  v_mul_f32 v3, v3, v2
  v_accvgpr_write_b32 a53, v3
  v_accvgpr_read_b32 v4, a54
  v_mul_f32 v4, v4, v2
  v_accvgpr_write_b32 a54, v4
  v_accvgpr_read_b32 v5, a55
  v_mul_f32 v5, v5, v2
  v_accvgpr_write_b32 a55, v5
  v_accvgpr_read_b32 v3, a56
  v_mul_f32 v3, v3, v2
  v_accvgpr_write_b32 a56, v3
  v_accvgpr_read_b32 v4, a57
  v_mul_f32 v4, v4, v2
  v_accvgpr_write_b32 a57, v4
  v_accvgpr_read_b32 v5, a58
  v_mul_f32 v5, v5, v2
  v_accvgpr_write_b32 a58, v5
  v_accvgpr_read_b32 v3, a59
  v_mul_f32 v3, v3, v2
  v_accvgpr_write_b32 a59, v3
  v_accvgpr_read_b32 v4, a60
  v_mul_f32 v4, v4, v2
  v_accvgpr_write_b32 a60, v4
  v_accvgpr_read_b32 v5, a61
  v_mul_f32 v5, v5, v2
  v_accvgpr_write_b32 a61, v5
  v_accvgpr_read_b32 v3, a62
  v_mul_f32 v3, v3, v2
  v_accvgpr_write_b32 a62, v3
  v_accvgpr_read_b32 v4, a63
  v_mul_f32 v4, v4, v2
  v_accvgpr_write_b32 a63, v4
  v_accvgpr_read_b32 v5, a228
  v_mul_f32 v5, v5, v2
  v_accvgpr_write_b32 a228, v5
  v_accvgpr_read_b32 v3, a229
  v_mul_f32 v3, v3, v2
  v_accvgpr_write_b32 a229, v3
  v_accvgpr_read_b32 v4, a230
  v_mul_f32 v4, v4, v2
  v_accvgpr_write_b32 a230, v4
  v_accvgpr_read_b32 v5, a231
  v_mul_f32 v5, v5, v2
  v_accvgpr_write_b32 a231, v5
  v_sub_f32 v120, v120, v1
  v_sub_f32 v121, v121, v1
  v_sub_f32 v122, v122, v1
  v_sub_f32 v123, v123, v1
  v_sub_f32 v92, v92, v1
  v_sub_f32 v93, v93, v1
  v_sub_f32 v94, v94, v1
  v_sub_f32 v95, v95, v1
  v_sub_f32 v96, v96, v1
  v_sub_f32 v97, v97, v1
  v_sub_f32 v98, v98, v1
  v_sub_f32 v99, v99, v1
  v_sub_f32 v60, v60, v1
  v_sub_f32 v61, v61, v1
  v_sub_f32 v62, v62, v1
  v_sub_f32 v63, v63, v1
  v_sub_f32 v64, v64, v1
  v_sub_f32 v65, v65, v1
  v_sub_f32 v66, v66, v1
  v_sub_f32 v67, v67, v1
  v_max3_f32 v1, v100, v101, v102
  v_max3_f32 v1, v1, v103, v104
  v_max3_f32 v1, v1, v105, v106
  v_max_f32 v1, v1, v107
  v_mov_b32 v2, v1
  s_nop 1
  v_permlane16_swap_b32 v1, v2
  v_max_f32 v1, v1, v2
  v_mov_b32 v2, v1
  s_nop 1
  v_permlane32_swap_b32 v1, v2
  v_max_f32 v1, v1, v2
  v_add_f32 v1, v7, v1
  v_max_f32 v1, 0, v1
  v_ceil_f32 v1, v1
  v_exp_f32 v2, -v1
  s_nop 0
  v_lshlrev_b32 v3, 16, v140
  v_and_b32 v4, 0xffff0000, v140
  v_mul_f32 v3, v3, v2
  v_mul_f32 v4, v4, v2
  v_cvt_pk_bf16_f32 v140, v3, v4
  v_lshlrev_b32 v3, 16, v141
  v_and_b32 v4, 0xffff0000, v141
  v_mul_f32 v3, v3, v2
  v_mul_f32 v4, v4, v2
  v_cvt_pk_bf16_f32 v141, v3, v4
  v_lshlrev_b32 v3, 16, v142
  v_and_b32 v4, 0xffff0000, v142
  v_mul_f32 v3, v3, v2
  v_mul_f32 v4, v4, v2
  v_cvt_pk_bf16_f32 v142, v3, v4
  v_lshlrev_b32 v3, 16, v143
  v_and_b32 v4, 0xffff0000, v143
  v_mul_f32 v3, v3, v2
  v_mul_f32 v4, v4, v2
  v_cvt_pk_bf16_f32 v143, v3, v4
  v_accvgpr_read_b32 v3, a64
  v_mul_f32 v3, v3, v2
  v_accvgpr_write_b32 a64, v3
  v_accvgpr_read_b32 v4, a65
  v_mul_f32 v4, v4, v2
  v_accvgpr_write_b32 a65, v4
  v_accvgpr_read_b32 v5, a66
  v_mul_f32 v5, v5, v2
  v_accvgpr_write_b32 a66, v5
  v_accvgpr_read_b32 v3, a67
  v_mul_f32 v3, v3, v2
  v_accvgpr_write_b32 a67, v3
  v_accvgpr_read_b32 v4, a68
  v_mul_f32 v4, v4, v2
  v_accvgpr_write_b32 a68, v4
  v_accvgpr_read_b32 v5, a69
  v_mul_f32 v5, v5, v2
  v_accvgpr_write_b32 a69, v5
  v_accvgpr_read_b32 v3, a70
  v_mul_f32 v3, v3, v2
  v_accvgpr_write_b32 a70, v3
  v_accvgpr_read_b32 v4, a71
  v_mul_f32 v4, v4, v2
  v_accvgpr_write_b32 a71, v4
  v_accvgpr_read_b32 v5, a72
  v_mul_f32 v5, v5, v2
  v_accvgpr_write_b32 a72, v5
  v_accvgpr_read_b32 v3, a73
  v_mul_f32 v3, v3, v2
  v_accvgpr_write_b32 a73, v3
  v_accvgpr_read_b32 v4, a74
  v_mul_f32 v4, v4, v2
  v_accvgpr_write_b32 a74, v4
  v_accvgpr_read_b32 v5, a75
  v_mul_f32 v5, v5, v2
  v_accvgpr_write_b32 a75, v5
  v_accvgpr_read_b32 v3, a76
  v_mul_f32 v3, v3, v2
  v_accvgpr_write_b32 a76, v3
  v_accvgpr_read_b32 v4, a77
  v_mul_f32 v4, v4, v2
  v_accvgpr_write_b32 a77, v4
  v_accvgpr_read_b32 v5, a78
  v_mul_f32 v5, v5, v2
  v_accvgpr_write_b32 a78, v5
  v_accvgpr_read_b32 v3, a79
  v_mul_f32 v3, v3, v2
  v_accvgpr_write_b32 a79, v3
  v_accvgpr_read_b32 v4, a80
  v_mul_f32 v4, v4, v2
  v_accvgpr_write_b32 a80, v4
  v_accvgpr_read_b32 v5, a81
  v_mul_f32 v5, v5, v2
  v_accvgpr_write_b32 a81, v5
  v_accvgpr_read_b32 v3, a82
  v_mul_f32 v3, v3, v2
  v_accvgpr_write_b32 a82, v3
  v_accvgpr_read_b32 v4, a83
  v_mul_f32 v4, v4, v2
  v_accvgpr_write_b32 a83, v4
  v_accvgpr_read_b32 v5, a84
  v_mul_f32 v5, v5, v2
  v_accvgpr_write_b32 a84, v5
  v_accvgpr_read_b32 v3, a85
  v_mul_f32 v3, v3, v2
  v_accvgpr_write_b32 a85, v3
  v_accvgpr_read_b32 v4, a86
  v_mul_f32 v4, v4, v2
  v_accvgpr_write_b32 a86, v4
  v_accvgpr_read_b32 v5, a87
  v_mul_f32 v5, v5, v2
  v_accvgpr_write_b32 a87, v5
  v_accvgpr_read_b32 v3, a88
  v_mul_f32 v3, v3, v2
  v_accvgpr_write_b32 a88, v3
  v_accvgpr_read_b32 v4, a89
  v_mul_f32 v4, v4, v2
  v_accvgpr_write_b32 a89, v4
  v_accvgpr_read_b32 v5, a90
  v_mul_f32 v5, v5, v2
  v_accvgpr_write_b32 a90, v5
  v_accvgpr_read_b32 v3, a91
  v_mul_f32 v3, v3, v2
  v_accvgpr_write_b32 a91, v3
  v_accvgpr_read_b32 v4, a92
  v_mul_f32 v4, v4, v2
  v_accvgpr_write_b32 a92, v4
  v_accvgpr_read_b32 v5, a93
  v_mul_f32 v5, v5, v2
  v_accvgpr_write_b32 a93, v5
  v_accvgpr_read_b32 v3, a94
  v_mul_f32 v3, v3, v2
  v_accvgpr_write_b32 a94, v3
  v_accvgpr_read_b32 v4, a95
  v_mul_f32 v4, v4, v2
  v_accvgpr_write_b32 a95, v4
  v_accvgpr_read_b32 v5, a232
  v_mul_f32 v5, v5, v2
  v_accvgpr_write_b32 a232, v5
  v_accvgpr_read_b32 v3, a233
  v_mul_f32 v3, v3, v2
  v_accvgpr_write_b32 a233, v3
  v_accvgpr_read_b32 v4, a234
  v_mul_f32 v4, v4, v2
  v_accvgpr_write_b32 a234, v4
  v_accvgpr_read_b32 v5, a235
  v_mul_f32 v5, v5, v2
  v_accvgpr_write_b32 a235, v5
  v_sub_f32 v124, v124, v1
  v_sub_f32 v125, v125, v1
  v_sub_f32 v126, v126, v1
  v_sub_f32 v127, v127, v1
  v_sub_f32 v100, v100, v1
  v_sub_f32 v101, v101, v1
  v_sub_f32 v102, v102, v1
  v_sub_f32 v103, v103, v1
  v_sub_f32 v104, v104, v1
  v_sub_f32 v105, v105, v1
  v_sub_f32 v106, v106, v1
  v_sub_f32 v107, v107, v1
  v_sub_f32 v68, v68, v1
  v_sub_f32 v69, v69, v1
  v_sub_f32 v70, v70, v1
  v_sub_f32 v71, v71, v1
  v_sub_f32 v72, v72, v1
  v_sub_f32 v73, v73, v1
  v_sub_f32 v74, v74, v1
  v_sub_f32 v75, v75, v1
  v_max3_f32 v1, v108, v109, v110
  v_max3_f32 v1, v1, v111, v112
  v_max3_f32 v1, v1, v113, v114
  v_max_f32 v1, v1, v115
  v_mov_b32 v2, v1
  s_nop 1
  v_permlane16_swap_b32 v1, v2
  v_max_f32 v1, v1, v2
  v_mov_b32 v2, v1
  s_nop 1
  v_permlane32_swap_b32 v1, v2
  v_max_f32 v1, v1, v2
  v_add_f32 v1, v7, v1
  v_max_f32 v1, 0, v1
  v_ceil_f32 v1, v1
  v_exp_f32 v2, -v1
  s_nop 0
  v_lshlrev_b32 v3, 16, v144
  v_and_b32 v4, 0xffff0000, v144
  v_mul_f32 v3, v3, v2
  v_mul_f32 v4, v4, v2
  v_cvt_pk_bf16_f32 v144, v3, v4
  v_lshlrev_b32 v3, 16, v145
  v_and_b32 v4, 0xffff0000, v145
  v_mul_f32 v3, v3, v2
  v_mul_f32 v4, v4, v2
  v_cvt_pk_bf16_f32 v145, v3, v4
  v_lshlrev_b32 v3, 16, v146
  v_and_b32 v4, 0xffff0000, v146
  v_mul_f32 v3, v3, v2
  v_mul_f32 v4, v4, v2
  v_cvt_pk_bf16_f32 v146, v3, v4
  v_lshlrev_b32 v3, 16, v147
  v_and_b32 v4, 0xffff0000, v147
  v_mul_f32 v3, v3, v2
  v_mul_f32 v4, v4, v2
  v_cvt_pk_bf16_f32 v147, v3, v4
  v_accvgpr_read_b32 v3, a96
  v_mul_f32 v3, v3, v2
  v_accvgpr_write_b32 a96, v3
  v_accvgpr_read_b32 v4, a97
  v_mul_f32 v4, v4, v2
  v_accvgpr_write_b32 a97, v4
  v_accvgpr_read_b32 v5, a98
  v_mul_f32 v5, v5, v2
  v_accvgpr_write_b32 a98, v5
  v_accvgpr_read_b32 v3, a99
  v_mul_f32 v3, v3, v2
  v_accvgpr_write_b32 a99, v3
  v_accvgpr_read_b32 v4, a100
  v_mul_f32 v4, v4, v2
  v_accvgpr_write_b32 a100, v4
  v_accvgpr_read_b32 v5, a101
  v_mul_f32 v5, v5, v2
  v_accvgpr_write_b32 a101, v5
  v_accvgpr_read_b32 v3, a102
  v_mul_f32 v3, v3, v2
  v_accvgpr_write_b32 a102, v3
  v_accvgpr_read_b32 v4, a103
  v_mul_f32 v4, v4, v2
  v_accvgpr_write_b32 a103, v4
  v_accvgpr_read_b32 v5, a104
  v_mul_f32 v5, v5, v2
  v_accvgpr_write_b32 a104, v5
  v_accvgpr_read_b32 v3, a105
  v_mul_f32 v3, v3, v2
  v_accvgpr_write_b32 a105, v3
  v_accvgpr_read_b32 v4, a106
  v_mul_f32 v4, v4, v2
  v_accvgpr_write_b32 a106, v4
  v_accvgpr_read_b32 v5, a107
  v_mul_f32 v5, v5, v2
  v_accvgpr_write_b32 a107, v5
  v_accvgpr_read_b32 v3, a108
  v_mul_f32 v3, v3, v2
  v_accvgpr_write_b32 a108, v3
  v_accvgpr_read_b32 v4, a109
  v_mul_f32 v4, v4, v2
  v_accvgpr_write_b32 a109, v4
  v_accvgpr_read_b32 v5, a110
  v_mul_f32 v5, v5, v2
  v_accvgpr_write_b32 a110, v5
  v_accvgpr_read_b32 v3, a111
  v_mul_f32 v3, v3, v2
  v_accvgpr_write_b32 a111, v3
  v_accvgpr_read_b32 v4, a112
  v_mul_f32 v4, v4, v2
  v_accvgpr_write_b32 a112, v4
  v_accvgpr_read_b32 v5, a113
  v_mul_f32 v5, v5, v2
  v_accvgpr_write_b32 a113, v5
  v_accvgpr_read_b32 v3, a114
  v_mul_f32 v3, v3, v2
  v_accvgpr_write_b32 a114, v3
  v_accvgpr_read_b32 v4, a115
  v_mul_f32 v4, v4, v2
  v_accvgpr_write_b32 a115, v4
  v_accvgpr_read_b32 v5, a116
  v_mul_f32 v5, v5, v2
  v_accvgpr_write_b32 a116, v5
  v_accvgpr_read_b32 v3, a117
  v_mul_f32 v3, v3, v2
  v_accvgpr_write_b32 a117, v3
  v_accvgpr_read_b32 v4, a118
  v_mul_f32 v4, v4, v2
  v_accvgpr_write_b32 a118, v4
  v_accvgpr_read_b32 v5, a119
  v_mul_f32 v5, v5, v2
  v_accvgpr_write_b32 a119, v5
  v_accvgpr_read_b32 v3, a120
  v_mul_f32 v3, v3, v2
  v_accvgpr_write_b32 a120, v3
  v_accvgpr_read_b32 v4, a121
  v_mul_f32 v4, v4, v2
  v_accvgpr_write_b32 a121, v4
  v_accvgpr_read_b32 v5, a122
  v_mul_f32 v5, v5, v2
  v_accvgpr_write_b32 a122, v5
  v_accvgpr_read_b32 v3, a123
  v_mul_f32 v3, v3, v2
  v_accvgpr_write_b32 a123, v3
  v_accvgpr_read_b32 v4, a124
  v_mul_f32 v4, v4, v2
  v_accvgpr_write_b32 a124, v4
  v_accvgpr_read_b32 v5, a125
  v_mul_f32 v5, v5, v2
  v_accvgpr_write_b32 a125, v5
  v_accvgpr_read_b32 v3, a126
  v_mul_f32 v3, v3, v2
  v_accvgpr_write_b32 a126, v3
  v_accvgpr_read_b32 v4, a127
  v_mul_f32 v4, v4, v2
  v_accvgpr_write_b32 a127, v4
  v_accvgpr_read_b32 v5, a236
  v_mul_f32 v5, v5, v2
  v_accvgpr_write_b32 a236, v5
  v_accvgpr_read_b32 v3, a237
  v_mul_f32 v3, v3, v2
  v_accvgpr_write_b32 a237, v3
  v_accvgpr_read_b32 v4, a238
  v_mul_f32 v4, v4, v2
  v_accvgpr_write_b32 a238, v4
  v_accvgpr_read_b32 v5, a239
  v_mul_f32 v5, v5, v2
  v_accvgpr_write_b32 a239, v5
  v_sub_f32 v128, v128, v1
  v_sub_f32 v129, v129, v1
  v_sub_f32 v130, v130, v1
  v_sub_f32 v131, v131, v1
  v_sub_f32 v108, v108, v1
  v_sub_f32 v109, v109, v1
  v_sub_f32 v110, v110, v1
  v_sub_f32 v111, v111, v1
  v_sub_f32 v112, v112, v1
  v_sub_f32 v113, v113, v1
  v_sub_f32 v114, v114, v1
  v_sub_f32 v115, v115, v1
  v_sub_f32 v76, v76, v1
  v_sub_f32 v77, v77, v1
  v_sub_f32 v78, v78, v1
  v_sub_f32 v79, v79, v1
  v_sub_f32 v80, v80, v1
  v_sub_f32 v81, v81, v1
  v_sub_f32 v82, v82, v1
  v_sub_f32 v83, v83, v1
  v_exp_f32 v28, v84
  v_exp_f32 v29, v85
  v_exp_f32 v30, v86
  v_exp_f32 v31, v87
  v_cvt_pk_bf16_f32 v148, v28, v29
  v_exp_f32 v32, v88
  v_exp_f32 v33, v89
  v_cvt_pk_bf16_f32 v149, v30, v31
  v_exp_f32 v34, v90
  v_exp_f32 v35, v91
  v_cvt_pk_bf16_f32 v150, v32, v33
  v_exp_f32 v28, v92
  v_exp_f32 v29, v93
  v_cvt_pk_bf16_f32 v151, v34, v35
  v_exp_f32 v30, v94
  v_exp_f32 v31, v95
  v_cvt_pk_bf16_f32 v152, v28, v29
  v_exp_f32 v32, v96
  v_exp_f32 v33, v97
  v_cvt_pk_bf16_f32 v153, v30, v31
  v_exp_f32 v34, v98
  v_exp_f32 v35, v99
  v_cvt_pk_bf16_f32 v154, v32, v33
  v_exp_f32 v28, v100
  v_exp_f32 v29, v101
  v_cvt_pk_bf16_f32 v155, v34, v35
  v_exp_f32 v30, v102
  v_exp_f32 v31, v103
  v_cvt_pk_bf16_f32 v156, v28, v29
  v_exp_f32 v32, v104
  v_exp_f32 v33, v105
  v_cvt_pk_bf16_f32 v157, v30, v31
  v_exp_f32 v34, v106
  v_exp_f32 v35, v107
  v_cvt_pk_bf16_f32 v158, v32, v33
  v_exp_f32 v28, v108
  v_exp_f32 v29, v109
  v_cvt_pk_bf16_f32 v159, v34, v35
  v_exp_f32 v30, v110
  v_exp_f32 v31, v111
  v_cvt_pk_bf16_f32 v160, v28, v29
  v_exp_f32 v32, v112
  v_exp_f32 v33, v113
  v_cvt_pk_bf16_f32 v161, v30, v31
  v_exp_f32 v34, v114
  v_exp_f32 v35, v115
  v_cvt_pk_bf16_f32 v162, v32, v33
  v_cvt_pk_bf16_f32 v163, v34, v35
  s_nop 1
  s_branch L_retb0a
L_rareb0b:
  s_nop 15
  v_max3_f32 v1, v52, v53, v54
  v_max3_f32 v1, v1, v55, v56
  v_max3_f32 v1, v1, v57, v58
  v_max_f32 v1, v1, v59
  v_mov_b32 v2, v1
  s_nop 1
  v_permlane16_swap_b32 v1, v2
  v_max_f32 v1, v1, v2
  v_mov_b32 v2, v1
  s_nop 1
  v_permlane32_swap_b32 v1, v2
  v_max_f32 v1, v1, v2
  v_add_f32 v1, v7, v1
  v_max_f32 v1, 0, v1
  v_ceil_f32 v1, v1
  v_exp_f32 v2, -v1
  s_nop 0
  v_lshlrev_b32 v3, 16, v132
  v_and_b32 v4, 0xffff0000, v132
  v_mul_f32 v3, v3, v2
  v_mul_f32 v4, v4, v2
  v_cvt_pk_bf16_f32 v132, v3, v4
  v_lshlrev_b32 v3, 16, v133
  v_and_b32 v4, 0xffff0000, v133
  v_mul_f32 v3, v3, v2
  v_mul_f32 v4, v4, v2
  v_cvt_pk_bf16_f32 v133, v3, v4
  v_lshlrev_b32 v3, 16, v134
  v_and_b32 v4, 0xffff0000, v134
  v_mul_f32 v3, v3, v2
  v_mul_f32 v4, v4, v2
  v_cvt_pk_bf16_f32 v134, v3, v4
  v_lshlrev_b32 v3, 16, v135
  v_and_b32 v4, 0xffff0000, v135
  v_mul_f32 v3, v3, v2
  v_mul_f32 v4, v4, v2
  v_cvt_pk_bf16_f32 v135, v3, v4
  v_lshlrev_b32 v3, 16, v148
  v_and_b32 v4, 0xffff0000, v148
  v_mul_f32 v3, v3, v2
  v_mul_f32 v4, v4, v2
  v_cvt_pk_bf16_f32 v148, v3, v4
  v_lshlrev_b32 v3, 16, v149
  v_and_b32 v4, 0xffff0000, v149
  v_mul_f32 v3, v3, v2
  v_mul_f32 v4, v4, v2
  v_cvt_pk_bf16_f32 v149, v3, v4
  v_lshlrev_b32 v3, 16, v150
  v_and_b32 v4, 0xffff0000, v150
  v_mul_f32 v3, v3, v2
  v_mul_f32 v4, v4, v2
  v_cvt_pk_bf16_f32 v150, v3, v4
  v_lshlrev_b32 v3, 16, v151
  v_and_b32 v4, 0xffff0000, v151
  v_mul_f32 v3, v3, v2
  v_mul_f32 v4, v4, v2
  v_cvt_pk_bf16_f32 v151, v3, v4
  v_accvgpr_read_b32 v3, a0
  v_mul_f32 v3, v3, v2
  v_accvgpr_write_b32 a0, v3
  v_accvgpr_read_b32 v4, a1
  v_mul_f32 v4, v4, v2
  v_accvgpr_write_b32 a1, v4
  v_accvgpr_read_b32 v5, a2
  v_mul_f32 v5, v5, v2
  v_accvgpr_write_b32 a2, v5
  v_accvgpr_read_b32 v3, a3
  v_mul_f32 v3, v3, v2
  v_accvgpr_write_b32 a3, v3
  v_accvgpr_read_b32 v4, a4
  v_mul_f32 v4, v4, v2
  v_accvgpr_write_b32 a4, v4
  v_accvgpr_read_b32 v5, a5
  v_mul_f32 v5, v5, v2
  v_accvgpr_write_b32 a5, v5
  v_accvgpr_read_b32 v3, a6
  v_mul_f32 v3, v3, v2
  v_accvgpr_write_b32 a6, v3
  v_accvgpr_read_b32 v4, a7
  v_mul_f32 v4, v4, v2
  v_accvgpr_write_b32 a7, v4
  v_accvgpr_read_b32 v5, a8
  v_mul_f32 v5, v5, v2
  v_accvgpr_write_b32 a8, v5
  v_accvgpr_read_b32 v3, a9
  v_mul_f32 v3, v3, v2
  v_accvgpr_write_b32 a9, v3
  v_accvgpr_read_b32 v4, a10
  v_mul_f32 v4, v4, v2
  v_accvgpr_write_b32 a10, v4
  v_accvgpr_read_b32 v5, a11
  v_mul_f32 v5, v5, v2
  v_accvgpr_write_b32 a11, v5
  v_accvgpr_read_b32 v3, a12
  v_mul_f32 v3, v3, v2
  v_accvgpr_write_b32 a12, v3
  v_accvgpr_read_b32 v4, a13
  v_mul_f32 v4, v4, v2
  v_accvgpr_write_b32 a13, v4
  v_accvgpr_read_b32 v5, a14
  v_mul_f32 v5, v5, v2
  v_accvgpr_write_b32 a14, v5
  v_accvgpr_read_b32 v3, a15
  v_mul_f32 v3, v3, v2
  v_accvgpr_write_b32 a15, v3
  v_accvgpr_read_b32 v4, a16
  v_mul_f32 v4, v4, v2
  v_accvgpr_write_b32 a16, v4
  v_accvgpr_read_b32 v5, a17
  v_mul_f32 v5, v5, v2
  v_accvgpr_write_b32 a17, v5
  v_accvgpr_read_b32 v3, a18
  v_mul_f32 v3, v3, v2
  v_accvgpr_write_b32 a18, v3
  v_accvgpr_read_b32 v4, a19
  v_mul_f32 v4, v4, v2
  v_accvgpr_write_b32 a19, v4
  v_accvgpr_read_b32 v5, a20
  v_mul_f32 v5, v5, v2
  v_accvgpr_write_b32 a20, v5
  v_accvgpr_read_b32 v3, a21
  v_mul_f32 v3, v3, v2
  v_accvgpr_write_b32 a21, v3
  v_accvgpr_read_b32 v4, a22
  v_mul_f32 v4, v4, v2
  v_accvgpr_write_b32 a22, v4
  v_accvgpr_read_b32 v5, a23
  v_mul_f32 v5, v5, v2
  v_accvgpr_write_b32 a23, v5
  v_accvgpr_read_b32 v3, a24
  v_mul_f32 v3, v3, v2
  v_accvgpr_write_b32 a24, v3
  v_accvgpr_read_b32 v4, a25
  v_mul_f32 v4, v4, v2
  v_accvgpr_write_b32 a25, v4
  v_accvgpr_read_b32 v5, a26
  v_mul_f32 v5, v5, v2
  v_accvgpr_write_b32 a26, v5
  v_accvgpr_read_b32 v3, a27
  v_mul_f32 v3, v3, v2
  v_accvgpr_write_b32 a27, v3
  v_accvgpr_read_b32 v4, a28
  v_mul_f32 v4, v4, v2
  v_accvgpr_write_b32 a28, v4
  v_accvgpr_read_b32 v5, a29
  v_mul_f32 v5, v5, v2
  v_accvgpr_write_b32 a29, v5
  v_accvgpr_read_b32 v3, a30
  v_mul_f32 v3, v3, v2
  v_accvgpr_write_b32 a30, v3
  v_accvgpr_read_b32 v4, a31
  v_mul_f32 v4, v4, v2
  v_accvgpr_write_b32 a31, v4
  v_accvgpr_read_b32 v5, a224
  v_mul_f32 v5, v5, v2
  v_accvgpr_write_b32 a224, v5
  v_accvgpr_read_b32 v3, a225
  v_mul_f32 v3, v3, v2
  v_accvgpr_write_b32 a225, v3
  v_accvgpr_read_b32 v4, a226
  v_mul_f32 v4, v4, v2
  v_accvgpr_write_b32 a226, v4
  v_accvgpr_read_b32 v5, a227
  v_mul_f32 v5, v5, v2
  v_accvgpr_write_b32 a227, v5
  v_sub_f32 v116, v116, v1
  v_sub_f32 v117, v117, v1
  v_sub_f32 v118, v118, v1
  v_sub_f32 v119, v119, v1
  v_sub_f32 v52, v52, v1
  v_sub_f32 v53, v53, v1
  v_sub_f32 v54, v54, v1
  v_sub_f32 v55, v55, v1
  v_sub_f32 v56, v56, v1
  v_sub_f32 v57, v57, v1
  v_sub_f32 v58, v58, v1
  v_sub_f32 v59, v59, v1
  v_sub_f32 v84, v84, v1
  v_sub_f32 v85, v85, v1
  v_sub_f32 v86, v86, v1
  v_sub_f32 v87, v87, v1
  v_sub_f32 v88, v88, v1
  v_sub_f32 v89, v89, v1
  v_sub_f32 v90, v90, v1
  v_sub_f32 v91, v91, v1
  v_max3_f32 v1, v60, v61, v62
  v_max3_f32 v1, v1, v63, v64
  v_max3_f32 v1, v1, v65, v66
  v_max_f32 v1, v1, v67
  v_mov_b32 v2, v1
  s_nop 1
  v_permlane16_swap_b32 v1, v2
  v_max_f32 v1, v1, v2
  v_mov_b32 v2, v1
  s_nop 1
  v_permlane32_swap_b32 v1, v2
  v_max_f32 v1, v1, v2
  v_add_f32 v1, v7, v1
  v_max_f32 v1, 0, v1
  v_ceil_f32 v1, v1
  v_exp_f32 v2, -v1
  s_nop 0
  v_lshlrev_b32 v3, 16, v136
  v_and_b32 v4, 0xffff0000, v136
  v_mul_f32 v3, v3, v2
  v_mul_f32 v4, v4, v2
  v_cvt_pk_bf16_f32 v136, v3, v4
  v_lshlrev_b32 v3, 16, v137
  v_and_b32 v4, 0xffff0000, v137
  v_mul_f32 v3, v3, v2
  v_mul_f32 v4, v4, v2
  v_cvt_pk_bf16_f32 v137, v3, v4
  v_lshlrev_b32 v3, 16, v138
  v_and_b32 v4, 0xffff0000, v138
  v_mul_f32 v3, v3, v2
  v_mul_f32 v4, v4, v2
  v_cvt_pk_bf16_f32 v138, v3, v4
  v_lshlrev_b32 v3, 16, v139
  v_and_b32 v4, 0xffff0000, v139
  v_mul_f32 v3, v3, v2
  v_mul_f32 v4, v4, v2
  v_cvt_pk_bf16_f32 v139, v3, v4
  v_lshlrev_b32 v3, 16, v152
  v_and_b32 v4, 0xffff0000, v152
  v_mul_f32 v3, v3, v2
  v_mul_f32 v4, v4, v2
  v_cvt_pk_bf16_f32 v152, v3, v4
  v_lshlrev_b32 v3, 16, v153
  v_and_b32 v4, 0xffff0000, v153
  v_mul_f32 v3, v3, v2
  v_mul_f32 v4, v4, v2
  v_cvt_pk_bf16_f32 v153, v3, v4
  v_lshlrev_b32 v3, 16, v154
  v_and_b32 v4, 0xffff0000, v154
  v_mul_f32 v3, v3, v2
  v_mul_f32 v4, v4, v2
  v_cvt_pk_bf16_f32 v154, v3, v4
  v_lshlrev_b32 v3, 16, v155
  v_and_b32 v4, 0xffff0000, v155
  v_mul_f32 v3, v3, v2
  v_mul_f32 v4, v4, v2
  v_cvt_pk_bf16_f32 v155, v3, v4
  v_accvgpr_read_b32 v3, a32
  v_mul_f32 v3, v3, v2
  v_accvgpr_write_b32 a32, v3
  v_accvgpr_read_b32 v4, a33
  v_mul_f32 v4, v4, v2
  v_accvgpr_write_b32 a33, v4
  v_accvgpr_read_b32 v5, a34
  v_mul_f32 v5, v5, v2
  v_accvgpr_write_b32 a34, v5
  v_accvgpr_read_b32 v3, a35
  v_mul_f32 v3, v3, v2
  v_accvgpr_write_b32 a35, v3
  v_accvgpr_read_b32 v4, a36
  v_mul_f32 v4, v4, v2
  v_accvgpr_write_b32 a36, v4
  v_accvgpr_read_b32 v5, a37
  v_mul_f32 v5, v5, v2
  v_accvgpr_write_b32 a37, v5
  v_accvgpr_read_b32 v3, a38
  v_mul_f32 v3, v3, v2
  v_accvgpr_write_b32 a38, v3
  v_accvgpr_read_b32 v4, a39
  v_mul_f32 v4, v4, v2
  v_accvgpr_write_b32 a39, v4
  v_accvgpr_read_b32 v5, a40
  v_mul_f32 v5, v5, v2
  v_accvgpr_write_b32 a40, v5
  v_accvgpr_read_b32 v3, a41
  v_mul_f32 v3, v3, v2
  v_accvgpr_write_b32 a41, v3
  v_accvgpr_read_b32 v4, a42
  v_mul_f32 v4, v4, v2
  v_accvgpr_write_b32 a42, v4
  v_accvgpr_read_b32 v5, a43
  v_mul_f32 v5, v5, v2
  v_accvgpr_write_b32 a43, v5
  v_accvgpr_read_b32 v3, a44
  v_mul_f32 v3, v3, v2
  v_accvgpr_write_b32 a44, v3
  v_accvgpr_read_b32 v4, a45
  v_mul_f32 v4, v4, v2
  v_accvgpr_write_b32 a45, v4
  v_accvgpr_read_b32 v5, a46
  v_mul_f32 v5, v5, v2
  v_accvgpr_write_b32 a46, v5
  v_accvgpr_read_b32 v3, a47
  v_mul_f32 v3, v3, v2
  v_accvgpr_write_b32 a47, v3
  v_accvgpr_read_b32 v4, a48
  v_mul_f32 v4, v4, v2
  v_accvgpr_write_b32 a48, v4
  v_accvgpr_read_b32 v5, a49
  v_mul_f32 v5, v5, v2
  v_accvgpr_write_b32 a49, v5
  v_accvgpr_read_b32 v3, a50
  v_mul_f32 v3, v3, v2
  v_accvgpr_write_b32 a50, v3
  v_accvgpr_read_b32 v4, a51
  v_mul_f32 v4, v4, v2
  v_accvgpr_write_b32 a51, v4
  v_accvgpr_read_b32 v5, a52
  v_mul_f32 v5, v5, v2
  v_accvgpr_write_b32 a52, v5
  v_accvgpr_read_b32 v3, a53
  v_mul_f32 v3, v3, v2
  v_accvgpr_write_b32 a53, v3
  v_accvgpr_read_b32 v4, a54
  v_mul_f32 v4, v4, v2
  v_accvgpr_write_b32 a54, v4
  v_accvgpr_read_b32 v5, a55
  v_mul_f32 v5, v5, v2
  v_accvgpr_write_b32 a55, v5
  v_accvgpr_read_b32 v3, a56
  v_mul_f32 v3, v3, v2
  v_accvgpr_write_b32 a56, v3
  v_accvgpr_read_b32 v4, a57
  v_mul_f32 v4, v4, v2
  v_accvgpr_write_b32 a57, v4
  v_accvgpr_read_b32 v5, a58
  v_mul_f32 v5, v5, v2
  v_accvgpr_write_b32 a58, v5
  v_accvgpr_read_b32 v3, a59
  v_mul_f32 v3, v3, v2
  v_accvgpr_write_b32 a59, v3
  v_accvgpr_read_b32 v4, a60
  v_mul_f32 v4, v4, v2
  v_accvgpr_write_b32 a60, v4
  v_accvgpr_read_b32 v5, a61
  v_mul_f32 v5, v5, v2
  v_accvgpr_write_b32 a61, v5
  v_accvgpr_read_b32 v3, a62
  v_mul_f32 v3, v3, v2
  v_accvgpr_write_b32 a62, v3
  v_accvgpr_read_b32 v4, a63
  v_mul_f32 v4, v4, v2
  v_accvgpr_write_b32 a63, v4
  v_accvgpr_read_b32 v5, a228
  v_mul_f32 v5, v5, v2
  v_accvgpr_write_b32 a228, v5
  v_accvgpr_read_b32 v3, a229
  v_mul_f32 v3, v3, v2
  v_accvgpr_write_b32 a229, v3
  v_accvgpr_read_b32 v4, a230
  v_mul_f32 v4, v4, v2
  v_accvgpr_write_b32 a230, v4
  v_accvgpr_read_b32 v5, a231
  v_mul_f32 v5, v5, v2
  v_accvgpr_write_b32 a231, v5
  v_sub_f32 v120, v120, v1
  v_sub_f32 v121, v121, v1
  v_sub_f32 v122, v122, v1
  v_sub_f32 v123, v123, v1
  v_sub_f32 v60, v60, v1
  v_sub_f32 v61, v61, v1
  v_sub_f32 v62, v62, v1
  v_sub_f32 v63, v63, v1
  v_sub_f32 v64, v64, v1
  v_sub_f32 v65, v65, v1
  v_sub_f32 v66, v66, v1
  v_sub_f32 v67, v67, v1
  v_sub_f32 v92, v92, v1
  v_sub_f32 v93, v93, v1
  v_sub_f32 v94, v94, v1
  v_sub_f32 v95, v95, v1
  v_sub_f32 v96, v96, v1
  v_sub_f32 v97, v97, v1
  v_sub_f32 v98, v98, v1
  v_sub_f32 v99, v99, v1
  v_max3_f32 v1, v68, v69, v70
  v_max3_f32 v1, v1, v71, v72
  v_max3_f32 v1, v1, v73, v74
  v_max_f32 v1, v1, v75
  v_mov_b32 v2, v1
  s_nop 1
  v_permlane16_swap_b32 v1, v2
  v_max_f32 v1, v1, v2
  v_mov_b32 v2, v1
  s_nop 1
  v_permlane32_swap_b32 v1, v2
  v_max_f32 v1, v1, v2
  v_add_f32 v1, v7, v1
  v_max_f32 v1, 0, v1
  v_ceil_f32 v1, v1
  v_exp_f32 v2, -v1
  s_nop 0
  v_lshlrev_b32 v3, 16, v140
  v_and_b32 v4, 0xffff0000, v140
  v_mul_f32 v3, v3, v2
  v_mul_f32 v4, v4, v2
  v_cvt_pk_bf16_f32 v140, v3, v4
  v_lshlrev_b32 v3, 16, v141
  v_and_b32 v4, 0xffff0000, v141
  v_mul_f32 v3, v3, v2
  v_mul_f32 v4, v4, v2
  v_cvt_pk_bf16_f32 v141, v3, v4
  v_lshlrev_b32 v3, 16, v142
  v_and_b32 v4, 0xffff0000, v142
  v_mul_f32 v3, v3, v2
  v_mul_f32 v4, v4, v2
  v_cvt_pk_bf16_f32 v142, v3, v4
  v_lshlrev_b32 v3, 16, v143
  v_and_b32 v4, 0xffff0000, v143
  v_mul_f32 v3, v3, v2
  v_mul_f32 v4, v4, v2
  v_cvt_pk_bf16_f32 v143, v3, v4
  v_lshlrev_b32 v3, 16, v156
  v_and_b32 v4, 0xffff0000, v156
  v_mul_f32 v3, v3, v2
  v_mul_f32 v4, v4, v2
  v_cvt_pk_bf16_f32 v156, v3, v4
  v_lshlrev_b32 v3, 16, v157
  v_and_b32 v4, 0xffff0000, v157
  v_mul_f32 v3, v3, v2
  v_mul_f32 v4, v4, v2
  v_cvt_pk_bf16_f32 v157, v3, v4
  v_lshlrev_b32 v3, 16, v158
  v_and_b32 v4, 0xffff0000, v158
  v_mul_f32 v3, v3, v2
  v_mul_f32 v4, v4, v2
  v_cvt_pk_bf16_f32 v158, v3, v4
  v_lshlrev_b32 v3, 16, v159
  v_and_b32 v4, 0xffff0000, v159
  v_mul_f32 v3, v3, v2
  v_mul_f32 v4, v4, v2
  v_cvt_pk_bf16_f32 v159, v3, v4
  v_accvgpr_read_b32 v3, a64
  v_mul_f32 v3, v3, v2
  v_accvgpr_write_b32 a64, v3
  v_accvgpr_read_b32 v4, a65
  v_mul_f32 v4, v4, v2
  v_accvgpr_write_b32 a65, v4
  v_accvgpr_read_b32 v5, a66
  v_mul_f32 v5, v5, v2
  v_accvgpr_write_b32 a66, v5
  v_accvgpr_read_b32 v3, a67
  v_mul_f32 v3, v3, v2
  v_accvgpr_write_b32 a67, v3
  v_accvgpr_read_b32 v4, a68
  v_mul_f32 v4, v4, v2
  v_accvgpr_write_b32 a68, v4
  v_accvgpr_read_b32 v5, a69
  v_mul_f32 v5, v5, v2
  v_accvgpr_write_b32 a69, v5
  v_accvgpr_read_b32 v3, a70
  v_mul_f32 v3, v3, v2
  v_accvgpr_write_b32 a70, v3
  v_accvgpr_read_b32 v4, a71
  v_mul_f32 v4, v4, v2
  v_accvgpr_write_b32 a71, v4
  v_accvgpr_read_b32 v5, a72
  v_mul_f32 v5, v5, v2
  v_accvgpr_write_b32 a72, v5
  v_accvgpr_read_b32 v3, a73
  v_mul_f32 v3, v3, v2
  v_accvgpr_write_b32 a73, v3
  v_accvgpr_read_b32 v4, a74
  v_mul_f32 v4, v4, v2
  v_accvgpr_write_b32 a74, v4
  v_accvgpr_read_b32 v5, a75
  v_mul_f32 v5, v5, v2
  v_accvgpr_write_b32 a75, v5
  v_accvgpr_read_b32 v3, a76
  v_mul_f32 v3, v3, v2
  v_accvgpr_write_b32 a76, v3
  v_accvgpr_read_b32 v4, a77
  v_mul_f32 v4, v4, v2
  v_accvgpr_write_b32 a77, v4
  v_accvgpr_read_b32 v5, a78
  v_mul_f32 v5, v5, v2
  v_accvgpr_write_b32 a78, v5
  v_accvgpr_read_b32 v3, a79
  v_mul_f32 v3, v3, v2
  v_accvgpr_write_b32 a79, v3
  v_accvgpr_read_b32 v4, a80
  v_mul_f32 v4, v4, v2
  v_accvgpr_write_b32 a80, v4
  v_accvgpr_read_b32 v5, a81
  v_mul_f32 v5, v5, v2
  v_accvgpr_write_b32 a81, v5
  v_accvgpr_read_b32 v3, a82
  v_mul_f32 v3, v3, v2
  v_accvgpr_write_b32 a82, v3
  v_accvgpr_read_b32 v4, a83
  v_mul_f32 v4, v4, v2
  v_accvgpr_write_b32 a83, v4
  v_accvgpr_read_b32 v5, a84
  v_mul_f32 v5, v5, v2
  v_accvgpr_write_b32 a84, v5
  v_accvgpr_read_b32 v3, a85
  v_mul_f32 v3, v3, v2
  v_accvgpr_write_b32 a85, v3
  v_accvgpr_read_b32 v4, a86
  v_mul_f32 v4, v4, v2
  v_accvgpr_write_b32 a86, v4
  v_accvgpr_read_b32 v5, a87
  v_mul_f32 v5, v5, v2
  v_accvgpr_write_b32 a87, v5
  v_accvgpr_read_b32 v3, a88
  v_mul_f32 v3, v3, v2
  v_accvgpr_write_b32 a88, v3
  v_accvgpr_read_b32 v4, a89
  v_mul_f32 v4, v4, v2
  v_accvgpr_write_b32 a89, v4
  v_accvgpr_read_b32 v5, a90
  v_mul_f32 v5, v5, v2
  v_accvgpr_write_b32 a90, v5
  v_accvgpr_read_b32 v3, a91
  v_mul_f32 v3, v3, v2
  v_accvgpr_write_b32 a91, v3
  v_accvgpr_read_b32 v4, a92
  v_mul_f32 v4, v4, v2
  v_accvgpr_write_b32 a92, v4
  v_accvgpr_read_b32 v5, a93
  v_mul_f32 v5, v5, v2
  v_accvgpr_write_b32 a93, v5
  v_accvgpr_read_b32 v3, a94
  v_mul_f32 v3, v3, v2
  v_accvgpr_write_b32 a94, v3
  v_accvgpr_read_b32 v4, a95
  v_mul_f32 v4, v4, v2
  v_accvgpr_write_b32 a95, v4
  v_accvgpr_read_b32 v5, a232
  v_mul_f32 v5, v5, v2
  v_accvgpr_write_b32 a232, v5
  v_accvgpr_read_b32 v3, a233
  v_mul_f32 v3, v3, v2
  v_accvgpr_write_b32 a233, v3
  v_accvgpr_read_b32 v4, a234
  v_mul_f32 v4, v4, v2
  v_accvgpr_write_b32 a234, v4
  v_accvgpr_read_b32 v5, a235
  v_mul_f32 v5, v5, v2
  v_accvgpr_write_b32 a235, v5
  v_sub_f32 v124, v124, v1
  v_sub_f32 v125, v125, v1
  v_sub_f32 v126, v126, v1
  v_sub_f32 v127, v127, v1
  v_sub_f32 v68, v68, v1
  v_sub_f32 v69, v69, v1
  v_sub_f32 v70, v70, v1
  v_sub_f32 v71, v71, v1
  v_sub_f32 v72, v72, v1
  v_sub_f32 v73, v73, v1
  v_sub_f32 v74, v74, v1
  v_sub_f32 v75, v75, v1
  v_sub_f32 v100, v100, v1
  v_sub_f32 v101, v101, v1
  v_sub_f32 v102, v102, v1
  v_sub_f32 v103, v103, v1
  v_sub_f32 v104, v104, v1
  v_sub_f32 v105, v105, v1
  v_sub_f32 v106, v106, v1
  v_sub_f32 v107, v107, v1
  v_max3_f32 v1, v76, v77, v78
  v_max3_f32 v1, v1, v79, v80
  v_max3_f32 v1, v1, v81, v82
  v_max_f32 v1, v1, v83
  v_mov_b32 v2, v1
  s_nop 1
  v_permlane16_swap_b32 v1, v2
  v_max_f32 v1, v1, v2
  v_mov_b32 v2, v1
  s_nop 1
  v_permlane32_swap_b32 v1, v2
  v_max_f32 v1, v1, v2
  v_add_f32 v1, v7, v1
  v_max_f32 v1, 0, v1
  v_ceil_f32 v1, v1
  v_exp_f32 v2, -v1
  s_nop 0
  v_lshlrev_b32 v3, 16, v144
  v_and_b32 v4, 0xffff0000, v144
  v_mul_f32 v3, v3, v2
  v_mul_f32 v4, v4, v2
  v_cvt_pk_bf16_f32 v144, v3, v4
  v_lshlrev_b32 v3, 16, v145
  v_and_b32 v4, 0xffff0000, v145
  v_mul_f32 v3, v3, v2
  v_mul_f32 v4, v4, v2
  v_cvt_pk_bf16_f32 v145, v3, v4
  v_lshlrev_b32 v3, 16, v146
  v_and_b32 v4, 0xffff0000, v146
  v_mul_f32 v3, v3, v2
  v_mul_f32 v4, v4, v2
  v_cvt_pk_bf16_f32 v146, v3, v4
  v_lshlrev_b32 v3, 16, v147
  v_and_b32 v4, 0xffff0000, v147
  v_mul_f32 v3, v3, v2
  v_mul_f32 v4, v4, v2
  v_cvt_pk_bf16_f32 v147, v3, v4
  v_lshlrev_b32 v3, 16, v160
  v_and_b32 v4, 0xffff0000, v160
  v_mul_f32 v3, v3, v2
  v_mul_f32 v4, v4, v2
  v_cvt_pk_bf16_f32 v160, v3, v4
  v_lshlrev_b32 v3, 16, v161
  v_and_b32 v4, 0xffff0000, v161
  v_mul_f32 v3, v3, v2
  v_mul_f32 v4, v4, v2
  v_cvt_pk_bf16_f32 v161, v3, v4
  v_lshlrev_b32 v3, 16, v162
  v_and_b32 v4, 0xffff0000, v162
  v_mul_f32 v3, v3, v2
  v_mul_f32 v4, v4, v2
  v_cvt_pk_bf16_f32 v162, v3, v4
  v_lshlrev_b32 v3, 16, v163
  v_and_b32 v4, 0xffff0000, v163
  v_mul_f32 v3, v3, v2
  v_mul_f32 v4, v4, v2
  v_cvt_pk_bf16_f32 v163, v3, v4
  v_accvgpr_read_b32 v3, a96
  v_mul_f32 v3, v3, v2
  v_accvgpr_write_b32 a96, v3
  v_accvgpr_read_b32 v4, a97
  v_mul_f32 v4, v4, v2
  v_accvgpr_write_b32 a97, v4
  v_accvgpr_read_b32 v5, a98
  v_mul_f32 v5, v5, v2
  v_accvgpr_write_b32 a98, v5
  v_accvgpr_read_b32 v3, a99
  v_mul_f32 v3, v3, v2
  v_accvgpr_write_b32 a99, v3
  v_accvgpr_read_b32 v4, a100
  v_mul_f32 v4, v4, v2
  v_accvgpr_write_b32 a100, v4
  v_accvgpr_read_b32 v5, a101
  v_mul_f32 v5, v5, v2
  v_accvgpr_write_b32 a101, v5
  v_accvgpr_read_b32 v3, a102
  v_mul_f32 v3, v3, v2
  v_accvgpr_write_b32 a102, v3
  v_accvgpr_read_b32 v4, a103
  v_mul_f32 v4, v4, v2
  v_accvgpr_write_b32 a103, v4
  v_accvgpr_read_b32 v5, a104
  v_mul_f32 v5, v5, v2
  v_accvgpr_write_b32 a104, v5
  v_accvgpr_read_b32 v3, a105
  v_mul_f32 v3, v3, v2
  v_accvgpr_write_b32 a105, v3
  v_accvgpr_read_b32 v4, a106
  v_mul_f32 v4, v4, v2
  v_accvgpr_write_b32 a106, v4
  v_accvgpr_read_b32 v5, a107
  v_mul_f32 v5, v5, v2
  v_accvgpr_write_b32 a107, v5
  v_accvgpr_read_b32 v3, a108
  v_mul_f32 v3, v3, v2
  v_accvgpr_write_b32 a108, v3
  v_accvgpr_read_b32 v4, a109
  v_mul_f32 v4, v4, v2
  v_accvgpr_write_b32 a109, v4
  v_accvgpr_read_b32 v5, a110
  v_mul_f32 v5, v5, v2
  v_accvgpr_write_b32 a110, v5
  v_accvgpr_read_b32 v3, a111
  v_mul_f32 v3, v3, v2
  v_accvgpr_write_b32 a111, v3
  v_accvgpr_read_b32 v4, a112
  v_mul_f32 v4, v4, v2
  v_accvgpr_write_b32 a112, v4
  v_accvgpr_read_b32 v5, a113
  v_mul_f32 v5, v5, v2
  v_accvgpr_write_b32 a113, v5
  v_accvgpr_read_b32 v3, a114
  v_mul_f32 v3, v3, v2
  v_accvgpr_write_b32 a114, v3
  v_accvgpr_read_b32 v4, a115
  v_mul_f32 v4, v4, v2
  v_accvgpr_write_b32 a115, v4
  v_accvgpr_read_b32 v5, a116
  v_mul_f32 v5, v5, v2
  v_accvgpr_write_b32 a116, v5
  v_accvgpr_read_b32 v3, a117
  v_mul_f32 v3, v3, v2
  v_accvgpr_write_b32 a117, v3
  v_accvgpr_read_b32 v4, a118
  v_mul_f32 v4, v4, v2
  v_accvgpr_write_b32 a118, v4
  v_accvgpr_read_b32 v5, a119
  v_mul_f32 v5, v5, v2
  v_accvgpr_write_b32 a119, v5
  v_accvgpr_read_b32 v3, a120
  v_mul_f32 v3, v3, v2
  v_accvgpr_write_b32 a120, v3
  v_accvgpr_read_b32 v4, a121
  v_mul_f32 v4, v4, v2
  v_accvgpr_write_b32 a121, v4
  v_accvgpr_read_b32 v5, a122
  v_mul_f32 v5, v5, v2
  v_accvgpr_write_b32 a122, v5
  v_accvgpr_read_b32 v3, a123
  v_mul_f32 v3, v3, v2
  v_accvgpr_write_b32 a123, v3
  v_accvgpr_read_b32 v4, a124
  v_mul_f32 v4, v4, v2
  v_accvgpr_write_b32 a124, v4
  v_accvgpr_read_b32 v5, a125
  v_mul_f32 v5, v5, v2
  v_accvgpr_write_b32 a125, v5
  v_accvgpr_read_b32 v3, a126
  v_mul_f32 v3, v3, v2
  v_accvgpr_write_b32 a126, v3
  v_accvgpr_read_b32 v4, a127
  v_mul_f32 v4, v4, v2
  v_accvgpr_write_b32 a127, v4
  v_accvgpr_read_b32 v5, a236
  v_mul_f32 v5, v5, v2
  v_accvgpr_write_b32 a236, v5
  v_accvgpr_read_b32 v3, a237
  v_mul_f32 v3, v3, v2
  v_accvgpr_write_b32 a237, v3
  v_accvgpr_read_b32 v4, a238
  v_mul_f32 v4, v4, v2
  v_accvgpr_write_b32 a238, v4
  v_accvgpr_read_b32 v5, a239
  v_mul_f32 v5, v5, v2
  v_accvgpr_write_b32 a239, v5
  v_sub_f32 v128, v128, v1
  v_sub_f32 v129, v129, v1
  v_sub_f32 v130, v130, v1
  v_sub_f32 v131, v131, v1
  v_sub_f32 v76, v76, v1
  v_sub_f32 v77, v77, v1
  v_sub_f32 v78, v78, v1
  v_sub_f32 v79, v79, v1
  v_sub_f32 v80, v80, v1
  v_sub_f32 v81, v81, v1
  v_sub_f32 v82, v82, v1
  v_sub_f32 v83, v83, v1
  v_sub_f32 v108, v108, v1
  v_sub_f32 v109, v109, v1
  v_sub_f32 v110, v110, v1
  v_sub_f32 v111, v111, v1
  v_sub_f32 v112, v112, v1
  v_sub_f32 v113, v113, v1
  v_sub_f32 v114, v114, v1
  v_sub_f32 v115, v115, v1
  v_exp_f32 v28, v52
  v_exp_f32 v29, v53
  v_exp_f32 v30, v54
  v_exp_f32 v31, v55
  v_cvt_pk_bf16_f32 v164, v28, v29
  v_exp_f32 v32, v56
  v_exp_f32 v33, v57
  v_cvt_pk_bf16_f32 v165, v30, v31
  v_exp_f32 v34, v58
  v_exp_f32 v35, v59
  v_cvt_pk_bf16_f32 v166, v32, v33
  v_exp_f32 v28, v60
  v_exp_f32 v29, v61
  v_cvt_pk_bf16_f32 v167, v34, v35
  v_exp_f32 v30, v62
  v_exp_f32 v31, v63
  v_cvt_pk_bf16_f32 v168, v28, v29
  v_exp_f32 v32, v64
  v_exp_f32 v33, v65
  v_cvt_pk_bf16_f32 v169, v30, v31
  v_exp_f32 v34, v66
  v_exp_f32 v35, v67
  v_cvt_pk_bf16_f32 v170, v32, v33
  v_exp_f32 v28, v68
  v_exp_f32 v29, v69
  v_cvt_pk_bf16_f32 v171, v34, v35
  v_exp_f32 v30, v70
  v_exp_f32 v31, v71
  v_cvt_pk_bf16_f32 v172, v28, v29
  v_exp_f32 v32, v72
  v_exp_f32 v33, v73
  v_cvt_pk_bf16_f32 v173, v30, v31
  v_exp_f32 v34, v74
  v_exp_f32 v35, v75
  v_cvt_pk_bf16_f32 v174, v32, v33
  v_exp_f32 v28, v76
  v_exp_f32 v29, v77
  v_cvt_pk_bf16_f32 v175, v34, v35
  v_exp_f32 v30, v78
  v_exp_f32 v31, v79
  v_cvt_pk_bf16_f32 v176, v28, v29
  v_exp_f32 v32, v80
  v_exp_f32 v33, v81
  v_cvt_pk_bf16_f32 v177, v30, v31
  v_exp_f32 v34, v82
  v_exp_f32 v35, v83
  v_cvt_pk_bf16_f32 v178, v32, v33
  v_cvt_pk_bf16_f32 v179, v34, v35
  s_nop 1
  s_branch L_retb0b
L_raret3a:
  s_nop 15
  v_max3_f32 v1, v84, v85, v86
  v_max3_f32 v1, v1, v87, v88
  v_max3_f32 v1, v1, v89, v90
  v_max_f32 v1, v1, v91
  v_mov_b32 v2, v1
  s_nop 1
  v_permlane16_swap_b32 v1, v2
  v_max_f32 v1, v1, v2
  v_mov_b32 v2, v1
  s_nop 1
  v_permlane32_swap_b32 v1, v2
  v_max_f32 v1, v1, v2
  v_add_f32 v1, v7, v1
  v_max_f32 v1, 0, v1
  v_ceil_f32 v1, v1
  v_exp_f32 v2, -v1
  s_nop 0
  v_lshlrev_b32 v3, 16, v164
  v_and_b32 v4, 0xffff0000, v164
  v_mul_f32 v3, v3, v2
  v_mul_f32 v4, v4, v2
  v_cvt_pk_bf16_f32 v164, v3, v4
  v_lshlrev_b32 v3, 16, v165
  v_and_b32 v4, 0xffff0000, v165
  v_mul_f32 v3, v3, v2
  v_mul_f32 v4, v4, v2
  v_cvt_pk_bf16_f32 v165, v3, v4
  v_lshlrev_b32 v3, 16, v166
  v_and_b32 v4, 0xffff0000, v166
  v_mul_f32 v3, v3, v2
  v_mul_f32 v4, v4, v2
  v_cvt_pk_bf16_f32 v166, v3, v4
  v_lshlrev_b32 v3, 16, v167
  v_and_b32 v4, 0xffff0000, v167
  v_mul_f32 v3, v3, v2
  v_mul_f32 v4, v4, v2
  v_cvt_pk_bf16_f32 v167, v3, v4
  v_accvgpr_read_b32 v3, a0
  v_mul_f32 v3, v3, v2
  v_accvgpr_write_b32 a0, v3
  v_accvgpr_read_b32 v4, a1
  v_mul_f32 v4, v4, v2
  v_accvgpr_write_b32 a1, v4
  v_accvgpr_read_b32 v5, a2
  v_mul_f32 v5, v5, v2
  v_accvgpr_write_b32 a2, v5
  v_accvgpr_read_b32 v3, a3
  v_mul_f32 v3, v3, v2
  v_accvgpr_write_b32 a3, v3
  v_accvgpr_read_b32 v4, a4
  v_mul_f32 v4, v4, v2
  v_accvgpr_write_b32 a4, v4
  v_accvgpr_read_b32 v5, a5
  v_mul_f32 v5, v5, v2
  v_accvgpr_write_b32 a5, v5
  v_accvgpr_read_b32 v3, a6
  v_mul_f32 v3, v3, v2
  v_accvgpr_write_b32 a6, v3
  v_accvgpr_read_b32 v4, a7
  v_mul_f32 v4, v4, v2
  v_accvgpr_write_b32 a7, v4
  v_accvgpr_read_b32 v5, a8
  v_mul_f32 v5, v5, v2
  v_accvgpr_write_b32 a8, v5
  v_accvgpr_read_b32 v3, a9
  v_mul_f32 v3, v3, v2
  v_accvgpr_write_b32 a9, v3
  v_accvgpr_read_b32 v4, a10
  v_mul_f32 v4, v4, v2
  v_accvgpr_write_b32 a10, v4
  v_accvgpr_read_b32 v5, a11
  v_mul_f32 v5, v5, v2
  v_accvgpr_write_b32 a11, v5
  v_accvgpr_read_b32 v3, a12
  v_mul_f32 v3, v3, v2
  v_accvgpr_write_b32 a12, v3
  v_accvgpr_read_b32 v4, a13
  v_mul_f32 v4, v4, v2
  v_accvgpr_write_b32 a13, v4
  v_accvgpr_read_b32 v5, a14
  v_mul_f32 v5, v5, v2
  v_accvgpr_write_b32 a14, v5
  v_accvgpr_read_b32 v3, a15
  v_mul_f32 v3, v3, v2
  v_accvgpr_write_b32 a15, v3
  v_accvgpr_read_b32 v4, a16
  v_mul_f32 v4, v4, v2
  v_accvgpr_write_b32 a16, v4
  v_accvgpr_read_b32 v5, a17
  v_mul_f32 v5, v5, v2
  v_accvgpr_write_b32 a17, v5
  v_accvgpr_read_b32 v3, a18
  v_mul_f32 v3, v3, v2
  v_accvgpr_write_b32 a18, v3
  v_accvgpr_read_b32 v4, a19
  v_mul_f32 v4, v4, v2
  v_accvgpr_write_b32 a19, v4
  v_accvgpr_read_b32 v5, a20
  v_mul_f32 v5, v5, v2
  v_accvgpr_write_b32 a20, v5
  v_accvgpr_read_b32 v3, a21
  v_mul_f32 v3, v3, v2
  v_accvgpr_write_b32 a21, v3
  v_accvgpr_read_b32 v4, a22
  v_mul_f32 v4, v4, v2
  v_accvgpr_write_b32 a22, v4
  v_accvgpr_read_b32 v5, a23
  v_mul_f32 v5, v5, v2
  v_accvgpr_write_b32 a23, v5
  v_accvgpr_read_b32 v3, a24
  v_mul_f32 v3, v3, v2
  v_accvgpr_write_b32 a24, v3
  v_accvgpr_read_b32 v4, a25
  v_mul_f32 v4, v4, v2
  v_accvgpr_write_b32 a25, v4
  v_accvgpr_read_b32 v5, a26
  v_mul_f32 v5, v5, v2
  v_accvgpr_write_b32 a26, v5
  v_accvgpr_read_b32 v3, a27
  v_mul_f32 v3, v3, v2
  v_accvgpr_write_b32 a27, v3
  v_accvgpr_read_b32 v4, a28
  v_mul_f32 v4, v4, v2
  v_accvgpr_write_b32 a28, v4
  v_accvgpr_read_b32 v5, a29
  v_mul_f32 v5, v5, v2
  v_accvgpr_write_b32 a29, v5
  v_accvgpr_read_b32 v3, a30
  v_mul_f32 v3, v3, v2
  v_accvgpr_write_b32 a30, v3
  v_accvgpr_read_b32 v4, a31
  v_mul_f32 v4, v4, v2
  v_accvgpr_write_b32 a31, v4
  v_accvgpr_read_b32 v5, a224
  v_mul_f32 v5, v5, v2
  v_accvgpr_write_b32 a224, v5
  v_accvgpr_read_b32 v3, a225
  v_mul_f32 v3, v3, v2
  v_accvgpr_write_b32 a225, v3
  v_accvgpr_read_b32 v4, a226
  v_mul_f32 v4, v4, v2
  v_accvgpr_write_b32 a226, v4
  v_accvgpr_read_b32 v5, a227
  v_mul_f32 v5, v5, v2
  v_accvgpr_write_b32 a227, v5
  v_sub_f32 v116, v116, v1
  v_sub_f32 v117, v117, v1
  v_sub_f32 v118, v118, v1
  v_sub_f32 v119, v119, v1
  v_sub_f32 v84, v84, v1
  v_sub_f32 v85, v85, v1
  v_sub_f32 v86, v86, v1
  v_sub_f32 v87, v87, v1
  v_sub_f32 v88, v88, v1
  v_sub_f32 v89, v89, v1
  v_sub_f32 v90, v90, v1
  v_sub_f32 v91, v91, v1
  v_sub_f32 v52, v52, v1
  v_sub_f32 v53, v53, v1
  v_sub_f32 v54, v54, v1
  v_sub_f32 v55, v55, v1
  v_sub_f32 v56, v56, v1
  v_sub_f32 v57, v57, v1
  v_sub_f32 v58, v58, v1
  v_sub_f32 v59, v59, v1
  v_max3_f32 v1, v92, v93, v94
  v_max3_f32 v1, v1, v95, v96
  v_max3_f32 v1, v1, v97, v98
  v_max_f32 v1, v1, v99
  v_mov_b32 v2, v1
  s_nop 1
  v_permlane16_swap_b32 v1, v2
  v_max_f32 v1, v1, v2
  v_mov_b32 v2, v1
  s_nop 1
  v_permlane32_swap_b32 v1, v2
  v_max_f32 v1, v1, v2
  v_add_f32 v1, v7, v1
  v_max_f32 v1, 0, v1
  v_ceil_f32 v1, v1
  v_exp_f32 v2, -v1
  s_nop 0
  v_lshlrev_b32 v3, 16, v168
  v_and_b32 v4, 0xffff0000, v168
  v_mul_f32 v3, v3, v2
  v_mul_f32 v4, v4, v2
  v_cvt_pk_bf16_f32 v168, v3, v4
  v_lshlrev_b32 v3, 16, v169
  v_and_b32 v4, 0xffff0000, v169
  v_mul_f32 v3, v3, v2
  v_mul_f32 v4, v4, v2
  v_cvt_pk_bf16_f32 v169, v3, v4
  v_lshlrev_b32 v3, 16, v170
  v_and_b32 v4, 0xffff0000, v170
  v_mul_f32 v3, v3, v2
  v_mul_f32 v4, v4, v2
  v_cvt_pk_bf16_f32 v170, v3, v4
  v_lshlrev_b32 v3, 16, v171
  v_and_b32 v4, 0xffff0000, v171
  v_mul_f32 v3, v3, v2
  v_mul_f32 v4, v4, v2
  v_cvt_pk_bf16_f32 v171, v3, v4
  v_accvgpr_read_b32 v3, a32
  v_mul_f32 v3, v3, v2
  v_accvgpr_write_b32 a32, v3
  v_accvgpr_read_b32 v4, a33
  v_mul_f32 v4, v4, v2
  v_accvgpr_write_b32 a33, v4
  v_accvgpr_read_b32 v5, a34
  v_mul_f32 v5, v5, v2
  v_accvgpr_write_b32 a34, v5
  v_accvgpr_read_b32 v3, a35
  v_mul_f32 v3, v3, v2
  v_accvgpr_write_b32 a35, v3
  v_accvgpr_read_b32 v4, a36
  v_mul_f32 v4, v4, v2
  v_accvgpr_write_b32 a36, v4
  v_accvgpr_read_b32 v5, a37
  v_mul_f32 v5, v5, v2
  v_accvgpr_write_b32 a37, v5
  v_accvgpr_read_b32 v3, a38
  v_mul_f32 v3, v3, v2
  v_accvgpr_write_b32 a38, v3
  v_accvgpr_read_b32 v4, a39
  v_mul_f32 v4, v4, v2
  v_accvgpr_write_b32 a39, v4
  v_accvgpr_read_b32 v5, a40
  v_mul_f32 v5, v5, v2
  v_accvgpr_write_b32 a40, v5
  v_accvgpr_read_b32 v3, a41
  v_mul_f32 v3, v3, v2
  v_accvgpr_write_b32 a41, v3
  v_accvgpr_read_b32 v4, a42
  v_mul_f32 v4, v4, v2
  v_accvgpr_write_b32 a42, v4
  v_accvgpr_read_b32 v5, a43
  v_mul_f32 v5, v5, v2
  v_accvgpr_write_b32 a43, v5
  v_accvgpr_read_b32 v3, a44
  v_mul_f32 v3, v3, v2
  v_accvgpr_write_b32 a44, v3
  v_accvgpr_read_b32 v4, a45
  v_mul_f32 v4, v4, v2
  v_accvgpr_write_b32 a45, v4
  v_accvgpr_read_b32 v5, a46
  v_mul_f32 v5, v5, v2
  v_accvgpr_write_b32 a46, v5
  v_accvgpr_read_b32 v3, a47
  v_mul_f32 v3, v3, v2
  v_accvgpr_write_b32 a47, v3
  v_accvgpr_read_b32 v4, a48
  v_mul_f32 v4, v4, v2
  v_accvgpr_write_b32 a48, v4
  v_accvgpr_read_b32 v5, a49
  v_mul_f32 v5, v5, v2
  v_accvgpr_write_b32 a49, v5
  v_accvgpr_read_b32 v3, a50
  v_mul_f32 v3, v3, v2
  v_accvgpr_write_b32 a50, v3
  v_accvgpr_read_b32 v4, a51
  v_mul_f32 v4, v4, v2
  v_accvgpr_write_b32 a51, v4
  v_accvgpr_read_b32 v5, a52
  v_mul_f32 v5, v5, v2
  v_accvgpr_write_b32 a52, v5
  v_accvgpr_read_b32 v3, a53
  v_mul_f32 v3, v3, v2
  v_accvgpr_write_b32 a53, v3
  v_accvgpr_read_b32 v4, a54
  v_mul_f32 v4, v4, v2
  v_accvgpr_write_b32 a54, v4
  v_accvgpr_read_b32 v5, a55
  v_mul_f32 v5, v5, v2
  v_accvgpr_write_b32 a55, v5
  v_accvgpr_read_b32 v3, a56
  v_mul_f32 v3, v3, v2
  v_accvgpr_write_b32 a56, v3
  v_accvgpr_read_b32 v4, a57
  v_mul_f32 v4, v4, v2
  v_accvgpr_write_b32 a57, v4
  v_accvgpr_read_b32 v5, a58
  v_mul_f32 v5, v5, v2
  v_accvgpr_write_b32 a58, v5
  v_accvgpr_read_b32 v3, a59
  v_mul_f32 v3, v3, v2
  v_accvgpr_write_b32 a59, v3
  v_accvgpr_read_b32 v4, a60
  v_mul_f32 v4, v4, v2
  v_accvgpr_write_b32 a60, v4
  v_accvgpr_read_b32 v5, a61
  v_mul_f32 v5, v5, v2
  v_accvgpr_write_b32 a61, v5
  v_accvgpr_read_b32 v3, a62
  v_mul_f32 v3, v3, v2
  v_accvgpr_write_b32 a62, v3
  v_accvgpr_read_b32 v4, a63
  v_mul_f32 v4, v4, v2
  v_accvgpr_write_b32 a63, v4
  v_accvgpr_read_b32 v5, a228
  v_mul_f32 v5, v5, v2
  v_accvgpr_write_b32 a228, v5
  v_accvgpr_read_b32 v3, a229
  v_mul_f32 v3, v3, v2
  v_accvgpr_write_b32 a229, v3
  v_accvgpr_read_b32 v4, a230
  v_mul_f32 v4, v4, v2
  v_accvgpr_write_b32 a230, v4
  v_accvgpr_read_b32 v5, a231
  v_mul_f32 v5, v5, v2
  v_accvgpr_write_b32 a231, v5
  v_sub_f32 v120, v120, v1
  v_sub_f32 v121, v121, v1
  v_sub_f32 v122, v122, v1
  v_sub_f32 v123, v123, v1
  v_sub_f32 v92, v92, v1
  v_sub_f32 v93, v93, v1
  v_sub_f32 v94, v94, v1
  v_sub_f32 v95, v95, v1
  v_sub_f32 v96, v96, v1
  v_sub_f32 v97, v97, v1
  v_sub_f32 v98, v98, v1
  v_sub_f32 v99, v99, v1
  v_sub_f32 v60, v60, v1
  v_sub_f32 v61, v61, v1
  v_sub_f32 v62, v62, v1
  v_sub_f32 v63, v63, v1
  v_sub_f32 v64, v64, v1
  v_sub_f32 v65, v65, v1
  v_sub_f32 v66, v66, v1
  v_sub_f32 v67, v67, v1
  v_max3_f32 v1, v100, v101, v102
  v_max3_f32 v1, v1, v103, v104
  v_max3_f32 v1, v1, v105, v106
  v_max_f32 v1, v1, v107
  v_mov_b32 v2, v1
  s_nop 1
  v_permlane16_swap_b32 v1, v2
  v_max_f32 v1, v1, v2
  v_mov_b32 v2, v1
  s_nop 1
  v_permlane32_swap_b32 v1, v2
  v_max_f32 v1, v1, v2
  v_add_f32 v1, v7, v1
  v_max_f32 v1, 0, v1
  v_ceil_f32 v1, v1
  v_exp_f32 v2, -v1
  s_nop 0
  v_lshlrev_b32 v3, 16, v172
  v_and_b32 v4, 0xffff0000, v172
  v_mul_f32 v3, v3, v2
  v_mul_f32 v4, v4, v2
  v_cvt_pk_bf16_f32 v172, v3, v4
  v_lshlrev_b32 v3, 16, v173
  v_and_b32 v4, 0xffff0000, v173
  v_mul_f32 v3, v3, v2
  v_mul_f32 v4, v4, v2
  v_cvt_pk_bf16_f32 v173, v3, v4
  v_lshlrev_b32 v3, 16, v174
  v_and_b32 v4, 0xffff0000, v174
  v_mul_f32 v3, v3, v2
  v_mul_f32 v4, v4, v2
  v_cvt_pk_bf16_f32 v174, v3, v4
  v_lshlrev_b32 v3, 16, v175
  v_and_b32 v4, 0xffff0000, v175
  v_mul_f32 v3, v3, v2
  v_mul_f32 v4, v4, v2
  v_cvt_pk_bf16_f32 v175, v3, v4
  v_accvgpr_read_b32 v3, a64
  v_mul_f32 v3, v3, v2
  v_accvgpr_write_b32 a64, v3
  v_accvgpr_read_b32 v4, a65
  v_mul_f32 v4, v4, v2
  v_accvgpr_write_b32 a65, v4
  v_accvgpr_read_b32 v5, a66
  v_mul_f32 v5, v5, v2
  v_accvgpr_write_b32 a66, v5
  v_accvgpr_read_b32 v3, a67
  v_mul_f32 v3, v3, v2
  v_accvgpr_write_b32 a67, v3
  v_accvgpr_read_b32 v4, a68
  v_mul_f32 v4, v4, v2
  v_accvgpr_write_b32 a68, v4
  v_accvgpr_read_b32 v5, a69
  v_mul_f32 v5, v5, v2
  v_accvgpr_write_b32 a69, v5
  v_accvgpr_read_b32 v3, a70
  v_mul_f32 v3, v3, v2
  v_accvgpr_write_b32 a70, v3
  v_accvgpr_read_b32 v4, a71
  v_mul_f32 v4, v4, v2
  v_accvgpr_write_b32 a71, v4
  v_accvgpr_read_b32 v5, a72
  v_mul_f32 v5, v5, v2
  v_accvgpr_write_b32 a72, v5
  v_accvgpr_read_b32 v3, a73
  v_mul_f32 v3, v3, v2
  v_accvgpr_write_b32 a73, v3
  v_accvgpr_read_b32 v4, a74
  v_mul_f32 v4, v4, v2
  v_accvgpr_write_b32 a74, v4
  v_accvgpr_read_b32 v5, a75
  v_mul_f32 v5, v5, v2
  v_accvgpr_write_b32 a75, v5
  v_accvgpr_read_b32 v3, a76
  v_mul_f32 v3, v3, v2
  v_accvgpr_write_b32 a76, v3
  v_accvgpr_read_b32 v4, a77
  v_mul_f32 v4, v4, v2
  v_accvgpr_write_b32 a77, v4
  v_accvgpr_read_b32 v5, a78
  v_mul_f32 v5, v5, v2
  v_accvgpr_write_b32 a78, v5
  v_accvgpr_read_b32 v3, a79
  v_mul_f32 v3, v3, v2
  v_accvgpr_write_b32 a79, v3
  v_accvgpr_read_b32 v4, a80
  v_mul_f32 v4, v4, v2
  v_accvgpr_write_b32 a80, v4
  v_accvgpr_read_b32 v5, a81
  v_mul_f32 v5, v5, v2
  v_accvgpr_write_b32 a81, v5
  v_accvgpr_read_b32 v3, a82
  v_mul_f32 v3, v3, v2
  v_accvgpr_write_b32 a82, v3
  v_accvgpr_read_b32 v4, a83
  v_mul_f32 v4, v4, v2
  v_accvgpr_write_b32 a83, v4
  v_accvgpr_read_b32 v5, a84
  v_mul_f32 v5, v5, v2
  v_accvgpr_write_b32 a84, v5
  v_accvgpr_read_b32 v3, a85
  v_mul_f32 v3, v3, v2
  v_accvgpr_write_b32 a85, v3
  v_accvgpr_read_b32 v4, a86
  v_mul_f32 v4, v4, v2
  v_accvgpr_write_b32 a86, v4
  v_accvgpr_read_b32 v5, a87
  v_mul_f32 v5, v5, v2
  v_accvgpr_write_b32 a87, v5
  v_accvgpr_read_b32 v3, a88
  v_mul_f32 v3, v3, v2
  v_accvgpr_write_b32 a88, v3
  v_accvgpr_read_b32 v4, a89
  v_mul_f32 v4, v4, v2
  v_accvgpr_write_b32 a89, v4
  v_accvgpr_read_b32 v5, a90
  v_mul_f32 v5, v5, v2
  v_accvgpr_write_b32 a90, v5
  v_accvgpr_read_b32 v3, a91
  v_mul_f32 v3, v3, v2
  v_accvgpr_write_b32 a91, v3
  v_accvgpr_read_b32 v4, a92
  v_mul_f32 v4, v4, v2
  v_accvgpr_write_b32 a92, v4
  v_accvgpr_read_b32 v5, a93
  v_mul_f32 v5, v5, v2
  v_accvgpr_write_b32 a93, v5
  v_accvgpr_read_b32 v3, a94
  v_mul_f32 v3, v3, v2
  v_accvgpr_write_b32 a94, v3
  v_accvgpr_read_b32 v4, a95
  v_mul_f32 v4, v4, v2
  v_accvgpr_write_b32 a95, v4
  v_accvgpr_read_b32 v5, a232
  v_mul_f32 v5, v5, v2
  v_accvgpr_write_b32 a232, v5
  v_accvgpr_read_b32 v3, a233
  v_mul_f32 v3, v3, v2
  v_accvgpr_write_b32 a233, v3
  v_accvgpr_read_b32 v4, a234
  v_mul_f32 v4, v4, v2
  v_accvgpr_write_b32 a234, v4
  v_accvgpr_read_b32 v5, a235
  v_mul_f32 v5, v5, v2
  v_accvgpr_write_b32 a235, v5
  v_sub_f32 v124, v124, v1
  v_sub_f32 v125, v125, v1
  v_sub_f32 v126, v126, v1
  v_sub_f32 v127, v127, v1
  v_sub_f32 v100, v100, v1
  v_sub_f32 v101, v101, v1
  v_sub_f32 v102, v102, v1
  v_sub_f32 v103, v103, v1
  v_sub_f32 v104, v104, v1
  v_sub_f32 v105, v105, v1
  v_sub_f32 v106, v106, v1
  v_sub_f32 v107, v107, v1
  v_sub_f32 v68, v68, v1
  v_sub_f32 v69, v69, v1
  v_sub_f32 v70, v70, v1
  v_sub_f32 v71, v71, v1
  v_sub_f32 v72, v72, v1
  v_sub_f32 v73, v73, v1
  v_sub_f32 v74, v74, v1
  v_sub_f32 v75, v75, v1
  v_max3_f32 v1, v108, v109, v110
  v_max3_f32 v1, v1, v111, v112
  v_max3_f32 v1, v1, v113, v114
  v_max_f32 v1, v1, v115
  v_mov_b32 v2, v1
  s_nop 1
  v_permlane16_swap_b32 v1, v2
  v_max_f32 v1, v1, v2
  v_mov_b32 v2, v1
  s_nop 1
  v_permlane32_swap_b32 v1, v2
  v_max_f32 v1, v1, v2
  v_add_f32 v1, v7, v1
  v_max_f32 v1, 0, v1
  v_ceil_f32 v1, v1
  v_exp_f32 v2, -v1
  s_nop 0
  v_lshlrev_b32 v3, 16, v176
  v_and_b32 v4, 0xffff0000, v176
  v_mul_f32 v3, v3, v2
  v_mul_f32 v4, v4, v2
  v_cvt_pk_bf16_f32 v176, v3, v4
  v_lshlrev_b32 v3, 16, v177
  v_and_b32 v4, 0xffff0000, v177
  v_mul_f32 v3, v3, v2
  v_mul_f32 v4, v4, v2
  v_cvt_pk_bf16_f32 v177, v3, v4
  v_lshlrev_b32 v3, 16, v178
  v_and_b32 v4, 0xffff0000, v178
  v_mul_f32 v3, v3, v2
  v_mul_f32 v4, v4, v2
  v_cvt_pk_bf16_f32 v178, v3, v4
  v_lshlrev_b32 v3, 16, v179
  v_and_b32 v4, 0xffff0000, v179
  v_mul_f32 v3, v3, v2
  v_mul_f32 v4, v4, v2
  v_cvt_pk_bf16_f32 v179, v3, v4
  v_accvgpr_read_b32 v3, a96
  v_mul_f32 v3, v3, v2
  v_accvgpr_write_b32 a96, v3
  v_accvgpr_read_b32 v4, a97
  v_mul_f32 v4, v4, v2
  v_accvgpr_write_b32 a97, v4
  v_accvgpr_read_b32 v5, a98
  v_mul_f32 v5, v5, v2
  v_accvgpr_write_b32 a98, v5
  v_accvgpr_read_b32 v3, a99
  v_mul_f32 v3, v3, v2
  v_accvgpr_write_b32 a99, v3
  v_accvgpr_read_b32 v4, a100
  v_mul_f32 v4, v4, v2
  v_accvgpr_write_b32 a100, v4
  v_accvgpr_read_b32 v5, a101
  v_mul_f32 v5, v5, v2
  v_accvgpr_write_b32 a101, v5
  v_accvgpr_read_b32 v3, a102
  v_mul_f32 v3, v3, v2
  v_accvgpr_write_b32 a102, v3
  v_accvgpr_read_b32 v4, a103
  v_mul_f32 v4, v4, v2
  v_accvgpr_write_b32 a103, v4
  v_accvgpr_read_b32 v5, a104
  v_mul_f32 v5, v5, v2
  v_accvgpr_write_b32 a104, v5
  v_accvgpr_read_b32 v3, a105
  v_mul_f32 v3, v3, v2
  v_accvgpr_write_b32 a105, v3
  v_accvgpr_read_b32 v4, a106
  v_mul_f32 v4, v4, v2
  v_accvgpr_write_b32 a106, v4
  v_accvgpr_read_b32 v5, a107
  v_mul_f32 v5, v5, v2
  v_accvgpr_write_b32 a107, v5
  v_accvgpr_read_b32 v3, a108
  v_mul_f32 v3, v3, v2
  v_accvgpr_write_b32 a108, v3
  v_accvgpr_read_b32 v4, a109
  v_mul_f32 v4, v4, v2
  v_accvgpr_write_b32 a109, v4
  v_accvgpr_read_b32 v5, a110
  v_mul_f32 v5, v5, v2
  v_accvgpr_write_b32 a110, v5
  v_accvgpr_read_b32 v3, a111
  v_mul_f32 v3, v3, v2
  v_accvgpr_write_b32 a111, v3
  v_accvgpr_read_b32 v4, a112
  v_mul_f32 v4, v4, v2
  v_accvgpr_write_b32 a112, v4
  v_accvgpr_read_b32 v5, a113
  v_mul_f32 v5, v5, v2
  v_accvgpr_write_b32 a113, v5
  v_accvgpr_read_b32 v3, a114
  v_mul_f32 v3, v3, v2
  v_accvgpr_write_b32 a114, v3
  v_accvgpr_read_b32 v4, a115
  v_mul_f32 v4, v4, v2
  v_accvgpr_write_b32 a115, v4
  v_accvgpr_read_b32 v5, a116
  v_mul_f32 v5, v5, v2
  v_accvgpr_write_b32 a116, v5
  v_accvgpr_read_b32 v3, a117
  v_mul_f32 v3, v3, v2
  v_accvgpr_write_b32 a117, v3
  v_accvgpr_read_b32 v4, a118
  v_mul_f32 v4, v4, v2
  v_accvgpr_write_b32 a118, v4
  v_accvgpr_read_b32 v5, a119
  v_mul_f32 v5, v5, v2
  v_accvgpr_write_b32 a119, v5
  v_accvgpr_read_b32 v3, a120
  v_mul_f32 v3, v3, v2
  v_accvgpr_write_b32 a120, v3
  v_accvgpr_read_b32 v4, a121
  v_mul_f32 v4, v4, v2
  v_accvgpr_write_b32 a121, v4
  v_accvgpr_read_b32 v5, a122
  v_mul_f32 v5, v5, v2
  v_accvgpr_write_b32 a122, v5
  v_accvgpr_read_b32 v3, a123
  v_mul_f32 v3, v3, v2
  v_accvgpr_write_b32 a123, v3
  v_accvgpr_read_b32 v4, a124
  v_mul_f32 v4, v4, v2
  v_accvgpr_write_b32 a124, v4
  v_accvgpr_read_b32 v5, a125
  v_mul_f32 v5, v5, v2
  v_accvgpr_write_b32 a125, v5
  v_accvgpr_read_b32 v3, a126
  v_mul_f32 v3, v3, v2
  v_accvgpr_write_b32 a126, v3
  v_accvgpr_read_b32 v4, a127
  v_mul_f32 v4, v4, v2
  v_accvgpr_write_b32 a127, v4
  v_accvgpr_read_b32 v5, a236
  v_mul_f32 v5, v5, v2
  v_accvgpr_write_b32 a236, v5
  v_accvgpr_read_b32 v3, a237
  v_mul_f32 v3, v3, v2
  v_accvgpr_write_b32 a237, v3
  v_accvgpr_read_b32 v4, a238
  v_mul_f32 v4, v4, v2
  v_accvgpr_write_b32 a238, v4
  v_accvgpr_read_b32 v5, a239
  v_mul_f32 v5, v5, v2
  v_accvgpr_write_b32 a239, v5
  v_sub_f32 v128, v128, v1
  v_sub_f32 v129, v129, v1
  v_sub_f32 v130, v130, v1
  v_sub_f32 v131, v131, v1
  v_sub_f32 v108, v108, v1
  v_sub_f32 v109, v109, v1
  v_sub_f32 v110, v110, v1
  v_sub_f32 v111, v111, v1
  v_sub_f32 v112, v112, v1
  v_sub_f32 v113, v113, v1
  v_sub_f32 v114, v114, v1
  v_sub_f32 v115, v115, v1
  v_sub_f32 v76, v76, v1
  v_sub_f32 v77, v77, v1
  v_sub_f32 v78, v78, v1
  v_sub_f32 v79, v79, v1
  v_sub_f32 v80, v80, v1
  v_sub_f32 v81, v81, v1
  v_sub_f32 v82, v82, v1
  v_sub_f32 v83, v83, v1
  v_exp_f32 v28, v84
  v_exp_f32 v29, v85
  v_exp_f32 v30, v86
  v_exp_f32 v31, v87
  v_cvt_pk_bf16_f32 v36, v28, v29
  v_exp_f32 v32, v88
  v_exp_f32 v33, v89
  v_cvt_pk_bf16_f32 v37, v30, v31
  v_exp_f32 v34, v90
  v_exp_f32 v35, v91
  v_cvt_pk_bf16_f32 v38, v32, v33
  v_exp_f32 v28, v92
  v_exp_f32 v29, v93
  v_cvt_pk_bf16_f32 v39, v34, v35
  v_exp_f32 v30, v94
  v_exp_f32 v31, v95
  v_cvt_pk_bf16_f32 v40, v28, v29
  v_exp_f32 v32, v96
  v_exp_f32 v33, v97
  v_cvt_pk_bf16_f32 v41, v30, v31
  v_exp_f32 v34, v98
  v_exp_f32 v35, v99
  v_cvt_pk_bf16_f32 v42, v32, v33
  v_exp_f32 v28, v100
  v_exp_f32 v29, v101
  v_cvt_pk_bf16_f32 v43, v34, v35
  v_exp_f32 v30, v102
  v_exp_f32 v31, v103
  v_cvt_pk_bf16_f32 v44, v28, v29
  v_exp_f32 v32, v104
  v_exp_f32 v33, v105
  v_cvt_pk_bf16_f32 v45, v30, v31
  v_exp_f32 v34, v106
  v_exp_f32 v35, v107
  v_cvt_pk_bf16_f32 v46, v32, v33
  v_exp_f32 v28, v108
  v_exp_f32 v29, v109
  v_cvt_pk_bf16_f32 v47, v34, v35
  v_exp_f32 v30, v110
  v_exp_f32 v31, v111
  v_cvt_pk_bf16_f32 v14, v28, v29
  v_exp_f32 v32, v112
  v_exp_f32 v33, v113
  v_cvt_pk_bf16_f32 v15, v30, v31
  v_exp_f32 v34, v114
  v_exp_f32 v35, v115
  v_cvt_pk_bf16_f32 v16, v32, v33
  v_cvt_pk_bf16_f32 v17, v34, v35
  s_nop 1
  s_branch L_rett3a
.section .rodata,"a"
.p2align 6
.amdhsa_kernel adaLN_cond__gqa_block_cached__glu_gated_reglu__prompt_kernel
  .amdhsa_next_free_vgpr 512
  .amdhsa_next_free_sgpr 96
  .amdhsa_accum_offset 256
  .amdhsa_group_segment_fixed_size 0
  .amdhsa_kernarg_size 112
  .amdhsa_user_sgpr_count 2
  .amdhsa_user_sgpr_kernarg_segment_ptr 1
  .amdhsa_system_sgpr_workgroup_id_x 1
.end_amdhsa_kernel
```
